```python
import torch

def _softmax(x, axis=-1):
    return torch.softmax(x, dim=axis)

def _gelu(x):
    return torch.nn.functional.gelu(x, approximate='tanh')

def _silu(x):
    return torch.nn.functional.silu(x)

def _sigmoid(x):
    return torch.sigmoid(x)

def _layernorm(x, axis=-1, eps=1e-05):
    m = x.mean(dim=axis, keepdim=True)
    v = x.var(dim=axis, keepdim=True, unbiased=False)
    return (x - m) / torch.sqrt(v + eps)

def _scatter_add(tgt, idx, src, axis=0):
    return tgt.clone().index_add_(axis, idx, src)

def _segment_sum(src, seg, n):
    out = torch.zeros((n,) + src.shape[1:], dtype=src.dtype)
    return out.index_add_(0, seg, src)

def _pad(x, pw):
    flat = tuple((v for pair in reversed(pw) for v in pair))
    return torch.nn.functional.pad(x, flat)
kernel_name = 'gated_mix__mha_block__mixer_gmlp__prompt'

def setup_inputs():

    _w = lambda a: (lambda t: t.to(torch.bfloat16) if t.is_floating_point() else t)(torch.as_tensor(a))

    def _A_setup():
        B, S, D, H = (1, 2048, 1024, 32)
        return {'x': _w((lambda *s: torch.randn(*s, dtype=torch.bfloat16) * 0.05)(B, S, D)), 'wqkv': _w((lambda *s: torch.randn(*s, dtype=torch.bfloat16) * 0.8)(D, 3 * D)), 'wo': _w((lambda *s: torch.randn(*s, dtype=torch.bfloat16) * 0.1)(D, D))}
    _A_in = _A_setup()

    def _B_setup():
        B, S, D, F = (1, 2048, 1024, 3584)
        Fh = F // 2
        return {'x': _w((lambda *s: torch.randn(*s, dtype=torch.bfloat16) * 0.05)(B, S, D)), 'w_in': _w((lambda *s: torch.randn(*s, dtype=torch.bfloat16) * 0.4)(D, 2 * Fh)), 'w_sp': _w(0.01 * (lambda *s: torch.randn(*s, dtype=torch.bfloat16) * 0.4)(S, S)), 'b_sp': _w(1.0 + 0.01 * (lambda *s: torch.randn(*s, dtype=torch.bfloat16) * 0.05)(S)), 'w_out': _w((lambda *s: torch.randn(*s, dtype=torch.bfloat16) * 0.05)(Fh, D))}
    _B_in = _B_setup()
    return {'A_x': _A_in['x'], 'A_wqkv': _A_in['wqkv'], 'A_wo': _A_in['wo'], 'B_x': _B_in['x'], 'B_w_in': _B_in['w_in'], 'B_w_sp': _B_in['w_sp'], 'B_b_sp': _B_in['b_sp'], 'B_w_out': _B_in['w_out'], 'gate_w': _w((lambda *s: torch.randn(*s, dtype=torch.bfloat16) * 0.05)(1024) * 16.0)}

def reference(A_x, A_wqkv, A_wo, B_x, B_w_in, B_w_sp, B_b_sp, B_w_out, gate_w):

    def _A_ref(x, wqkv, wo):
        B, S, D = x.shape
        H = 32
        Dh = D // H
        qkv = (lambda x, *d: x.permute(*d))((x @ wqkv).reshape(B, S, 3, H, Dh), 2, 0, 3, 1, 4)
        q, k, v = (qkv[0], qkv[1], qkv[2])
        scores = torch.einsum('bhqd,bhkd->bhqk', q, k) * Dh ** (-0.5)
        p = _softmax(scores, axis=-1)
        o = torch.einsum('bhqk,bhkd->bhqd', p, v)
        return (lambda x, *d: x.permute(*d))(o, 0, 2, 1, 3).reshape(B, S, D) @ wo

    def _B_ref(x, w_in, w_sp, b_sp, w_out):
        B, S, D = x.shape
        F = w_in.shape[-1]
        Fh = F // 2
        z = _gelu(torch.einsum('bsd,df->bsf', x, w_in))
        z1 = z[..., :Fh].clone()
        z2 = _layernorm(z[..., Fh:], axis=-1)
        g = torch.einsum('ts,bsf->btf', w_sp, z2) + b_sp[None, :, None]
        return torch.einsum('bsf,fd->bsd', z1 * g, w_out)
    x = A_x
    g = _sigmoid((x * gate_w).sum(-1, keepdims=True))
    a = _A_ref(x, A_wqkv, A_wo)
    b = _B_ref(x, B_w_in, B_w_sp, B_b_sp, B_w_out)
    return g * a + (1 - g) * b
```

```asm
; @launch grid=(256,1,1) block=(256,1,1) lds=163840
.amdgcn_target "amdgcn-amd-amdhsa--gfx950"
.text
.globl gated_mix__mha_block__mixer_gmlp__prompt_kernel
.p2align 8
.type gated_mix__mha_block__mixer_gmlp__prompt_kernel,@function
gated_mix__mha_block__mixer_gmlp__prompt_kernel:
    s_cmp_ge_u32 s2, 256
    s_cbranch_scc1 KERNEL_END
    s_load_dwordx16 s[64:79], s[0:1], 0
    s_load_dwordx8 s[80:87], s[0:1], 64
    v_lshrrev_b32 v2, 6, v0
    v_and_b32 v1, 63, v0
    v_readfirstlane_b32 s3, v2
    s_and_b32 s56, s2, 1
    s_lshl_b32 s56, s56, 3
    s_bfe_u32 s57, s2, 0x30003
    s_or_b32 s6, s56, s57
    s_bfe_u32 s56, s2, 0x20001
    s_lshl_b32 s56, s56, 2
    s_lshr_b32 s58, s2, 6
    s_or_b32 s7, s56, s58
    s_add_u32 s101, s57, s58
    s_lshr_b32 s4, s3, 1
    s_and_b32 s5, s3, 1
    s_lshl_b32 s100, s2, 2
    s_add_u32 s100, s100, s3
    s_lshl_b32 s54, s3, 12
    s_and_b32 s101, s101, 3
    s_lshl_b32 s56, s6, 7
    s_lshl_b32 s57, s3, 5
    s_add_u32 s56, s56, s57
    v_lshrrev_b32 v25, 3, v1
    v_add_u32 v25, s56, v25
    v_lshlrev_b32 v25, 11, v25
    v_lshrrev_b32 v26, 4, v1
    v_and_b32 v27, 7, v1
    v_xor_b32 v26, v26, v27
    v_lshlrev_b32 v26, 4, v26
    v_add_u32 v2, v25, v26
    v_xor_b32 v26, 64, v26
    v_add_u32 v26, v25, v26
    v_add_u32 v3, 15360, v26
    v_add_u32 v4, 30720, v2
    v_add_u32 v5, 46080, v26
    v_lshrrev_b32 v25, 3, v1
    v_mul_u32_u24 v25, 6144, v25
    v_bfe_u32 v26, v1, 1, 2
    v_bfe_u32 v27, v1, 4, 1
    v_xor_b32 v26, v26, v27
    v_lshl_add_u32 v25, v26, 5, v25
    v_and_b32 v26, 1, v1
    v_lshl_add_u32 v28, v26, 4, v25
    v_xor_b32 v29, 64, v28
    s_mul_i32 s56, s3, 6
    s_lshl_b32 s58, s7, 7
    s_add_u32 s57, s56, 0
    s_lshr_b32 s59, s57, 3
    s_lshl_b32 s59, s59, 11
    s_and_b32 s57, s57, 7
    s_mul_i32 s57, s57, 49152
    s_add_u32 s57, s57, s59
    s_add_u32 s57, s57, s58
    v_add_u32 v6, s57, v28
    s_add_u32 s57, s56, 1
    s_lshr_b32 s59, s57, 3
    s_lshl_b32 s59, s59, 11
    s_and_b32 s57, s57, 7
    s_mul_i32 s57, s57, 49152
    s_add_u32 s57, s57, s59
    s_add_u32 s57, s57, s58
    s_sub_u32 s57, s57, 1024
    v_add_u32 v7, s57, v29
    s_add_u32 s57, s56, 2
    s_lshr_b32 s59, s57, 3
    s_lshl_b32 s59, s59, 11
    s_and_b32 s57, s57, 7
    s_mul_i32 s57, s57, 49152
    s_add_u32 s57, s57, s59
    s_add_u32 s57, s57, s58
    s_sub_u32 s57, s57, 2048
    v_add_u32 v8, s57, v28
    s_add_u32 s57, s56, 3
    s_lshr_b32 s59, s57, 3
    s_lshl_b32 s59, s59, 11
    s_and_b32 s57, s57, 7
    s_mul_i32 s57, s57, 49152
    s_add_u32 s57, s57, s59
    s_add_u32 s57, s57, s58
    s_sub_u32 s57, s57, 3072
    v_add_u32 v9, s57, v29
    s_add_u32 s57, s56, 4
    s_lshr_b32 s59, s57, 3
    s_lshl_b32 s59, s59, 11
    s_and_b32 s57, s57, 7
    s_mul_i32 s57, s57, 49152
    s_add_u32 s57, s57, s59
    s_add_u32 s57, s57, s58
    v_add_u32 v10, s57, v28
    s_add_u32 s57, s56, 5
    s_lshr_b32 s59, s57, 3
    s_lshl_b32 s59, s59, 11
    s_and_b32 s57, s57, 7
    s_mul_i32 s57, s57, 49152
    s_add_u32 s57, s57, s59
    s_add_u32 s57, s57, s58
    s_sub_u32 s57, s57, 1024
    v_add_u32 v11, s57, v29
    s_lshl_b32 s52, s101, 7
    s_mul_i32 s53, s101, 393216
    s_mul_i32 s55, s3, 6144
    s_mov_b32 s88, 0
    v_and_b32 v240, 15, v1
    v_lshlrev_b32 v240, 7, v240
    v_bfe_u32 v241, v1, 1, 1
    v_lshlrev_b32 v241, 11, v241
    v_and_b32 v242, 1, v1
    v_lshl_add_u32 v241, v242, 7, v241
    v_and_b32 v243, 7, v1
    v_min_u32 v243, 5, v243
    v_lshlrev_b32 v243, 7, v243
    s_waitcnt lgkmcnt(0)
    s_mov_b32 s8, s64
    s_and_b32 s9, s65, 0xffff
    s_mov_b32 s10, 4194304
    s_mov_b32 s11, 0x20000
    s_mov_b32 s12, s66
    s_and_b32 s13, s67, 0xffff
    s_mov_b32 s14, 6291456
    s_mov_b32 s15, 0x20000
    s_add_u32 m0, s54, 0
    s_nop 0
    buffer_load_dwordx4 v2, s[8:11], s52 offen offset:0 lds
    s_add_u32 s88, s88, 1
    s_add_u32 s89, s88, s101
    buffer_load_dwordx4 v3, s[8:11], s52 offen offset:1024 lds
    s_and_b32 s89, s89, 3
    s_andn2_b32 s90, s88, 3
    buffer_load_dwordx4 v4, s[8:11], s52 offen offset:2048 lds
    s_or_b32 s89, s89, s90
    buffer_load_dwordx4 v5, s[8:11], s52 offen offset:3072 lds
    s_lshl_b32 s52, s89, 7
    s_add_u32 m0, s55, 16384
    s_nop 0
    buffer_load_dwordx4 v6, s[12:15], s53 offen offset:0 lds
    buffer_load_dwordx4 v7, s[12:15], s53 offen offset:1024 lds
    buffer_load_dwordx4 v8, s[12:15], s53 offen offset:2048 lds
    buffer_load_dwordx4 v9, s[12:15], s53 offen offset:3072 lds
    s_add_u32 m0, s55, 20480
    s_nop 0
    buffer_load_dwordx4 v10, s[12:15], s53 offen offset:0 lds
    buffer_load_dwordx4 v11, s[12:15], s53 offen offset:1024 lds
    s_mul_i32 s53, s89, 393216
    s_lshl_b32 s62, s100, 12
    buffer_load_dword v242, v241, s[8:11], s62 offen offset:0
    s_mul_i32 s62, s100, 768
    s_add_u32 s62, s62, 0
    buffer_load_dword v242, v243, s[12:15], s62 offen
    s_lshl_b32 s62, s100, 12
    buffer_load_dword v242, v241, s[8:11], s62 offen offset:256
    s_mul_i32 s62, s100, 768
    s_add_u32 s62, s62, 786432
    buffer_load_dword v242, v243, s[12:15], s62 offen
    s_lshl_b32 s62, s100, 12
    buffer_load_dword v242, v241, s[8:11], s62 offen offset:512
    s_mul_i32 s62, s100, 768
    s_add_u32 s62, s62, 1572864
    buffer_load_dword v242, v243, s[12:15], s62 offen
    s_getpc_b64 s[58:59]
    s_and_b32 s58, s58, 0xffffff00
    s_lshr_b32 s56, s2, 3
    s_lshl_b32 s56, s56, 2
    s_add_u32 s56, s56, s3
    s_lshl_b32 s56, s56, 10
    s_min_u32 s56, s56, CODE_BYTES - 1024
    v_lshlrev_b32 v245, 4, v1
    v_add_u32 v245, s56, v245
    global_load_dword v242, v245, s[58:59]
    s_mov_b32 s16, s72
    s_and_b32 s17, s73, 0xffff
    s_mov_b32 s18, 7340032
    s_mov_b32 s19, 0x20000
    s_mov_b32 s20, s74
    s_and_b32 s21, s75, 0xffff
    s_mov_b32 s22, 8388608
    s_mov_b32 s23, 0x20000
    s_mov_b32 s24, s68
    s_and_b32 s25, s69, 0xffff
    s_mov_b32 s26, 2097152
    s_mov_b32 s27, 0x20000
    s_mov_b32 s28, s78
    s_and_b32 s29, s79, 0xffff
    s_mov_b32 s30, 3670016
    s_mov_b32 s31, 0x20000
    s_mov_b32 s32, s86
    s_and_b32 s33, s87, 0xffff
    s_mov_b32 s34, 41943040
    s_mov_b32 s35, 0x20000
    s_mov_b32 s36, s82
    s_and_b32 s37, s83, 0xffff
    s_mov_b32 s38, 4194304
    s_mov_b32 s39, 0x20000
    s_mov_b32 s40, s76
    s_and_b32 s41, s77, 0xffff
    s_mov_b32 s42, 4096
    s_mov_b32 s43, 0x20000
    s_mov_b32 s44, s80
    s_and_b32 s45, s81, 0xffff
    s_mov_b32 s46, 2048
    s_mov_b32 s47, 0x20000
    s_add_u32 s86, s86, 38871040
    s_addc_u32 s87, s87, 0
    s_load_dword s95, s[86:87], 0
    s_lshl_b32 s60, s6, 7
    s_lshl_b32 s61, s7, 3
    s_add_u32 s60, s60, s61
    s_lshl_b32 s61, s3, 1
    s_add_u32 s66, s60, s61
    s_lshl_b32 s60, s66, 11
    v_lshlrev_b32 v160, 6, v1
    v_and_b32 v161, 0x7ff, v160
    buffer_load_dwordx4 v[128:131], v160, s[8:11], s60 offen offset:0
    buffer_load_dwordx4 v[144:147], v161, s[44:47], 0 offen offset:0
    buffer_load_dwordx4 v[132:135], v160, s[8:11], s60 offen offset:16
    buffer_load_dwordx4 v[148:151], v161, s[44:47], 0 offen offset:16
    buffer_load_dwordx4 v[136:139], v160, s[8:11], s60 offen offset:32
    buffer_load_dwordx4 v[152:155], v161, s[44:47], 0 offen offset:32
    buffer_load_dwordx4 v[140:143], v160, s[8:11], s60 offen offset:48
    buffer_load_dwordx4 v[156:159], v161, s[44:47], 0 offen offset:48
    v_and_b32 v25, 15, v1
    v_lshrrev_b32 v26, 1, v25
    v_lshrrev_b32 v27, 4, v1
    v_xor_b32 v26, v26, v27
    v_lshlrev_b32 v26, 4, v26
    v_lshl_add_u32 v26, v25, 7, v26
    s_lshl_b32 s56, s4, 13
    v_add_u32 v13, s56, v26
    v_xor_b32 v16, 64, v13
    v_add_u32 v14, 0x10000, v13
    v_add_u32 v15, 0x20000, v13
    v_add_u32 v17, 0x10000, v16
    s_add_u32 m0, s54, 40960
    s_nop 0
    buffer_load_dwordx4 v2, s[8:11], s52 offen offset:0 lds
    v_add_u32 v18, 0x20000, v16
    v_lshrrev_b32 v25, 4, v1
    v_bfe_u32 v26, v1, 2, 2
    v_mul_u32_u24 v27, 1024, v25
    v_lshl_add_u32 v27, v26, 7, v27
    v_and_b32 v28, 3, v1
    v_lshl_add_u32 v27, v28, 3, v27
    v_lshrrev_b32 v26, 1, v26
    v_and_b32 v25, 1, v25
    v_lshl_or_b32 v25, v25, 1, v26
    s_lshl_b32 s56, s5, 1
    v_xor_b32 v25, s56, v25
    s_add_u32 s88, s88, 1
    s_add_u32 s89, s88, s101
    buffer_load_dwordx4 v3, s[8:11], s52 offen offset:1024 lds
    v_lshl_add_u32 v19, v25, 5, v27
    v_xor_b32 v22, 32, v19
    v_add_u32 v20, 0x10000, v19
    v_add_u32 v21, 0x20000, v19
    v_add_u32 v23, 0x10000, v22
    v_add_u32 v24, 0x20000, v22
    v_accvgpr_write_b32 a196, v13
    v_accvgpr_write_b32 a199, v19
    s_mul_i32 s56, s3, 448
    s_mul_i32 s58, s7, 224
    s_mov_b32 s59, 18725
    v_mov_b32 v187, 3360
    s_and_b32 s89, s89, 3
    s_andn2_b32 s90, s88, 3
    buffer_load_dwordx4 v4, s[8:11], s52 offen offset:2048 lds
    s_add_u32 s57, s56, 0
    v_add_u32 v182, s57, v1
    v_mul_u32_u24 v183, s59, v182
    v_lshrrev_b32 v183, 19, v183
    v_mul_u32_u24 v184, 28, v183
    v_sub_u32 v184, v182, v184
    v_lshrrev_b32 v185, 1, v184
    v_bfe_u32 v186, v183, 3, 1
    v_xor_b32 v185, v185, v186
    v_cmp_lt_u32 vcc, 6, v185
    v_mul_u32_u24 v170, 7168, v183
    v_lshl_add_u32 v170, v185, 5, v170
    s_or_b32 s89, s89, s90
    buffer_load_dwordx4 v5, s[8:11], s52 offen offset:3072 lds
    v_and_b32 v184, 1, v184
    v_lshl_add_u32 v170, v184, 4, v170
    v_cndmask_b32 v186, 0, v187, vcc
    s_sub_u32 s57, s58, 0
    v_add3_u32 v170, v170, v186, s57
    s_add_u32 s57, s56, 64
    v_add_u32 v182, s57, v1
    v_mul_u32_u24 v183, s59, v182
    v_lshrrev_b32 v183, 19, v183
    v_mul_u32_u24 v184, 28, v183
    v_sub_u32 v184, v182, v184
    v_lshrrev_b32 v185, 1, v184
    s_lshl_b32 s52, s89, 7
    s_add_u32 m0, s55, 57344
    s_nop 0
    buffer_load_dwordx4 v6, s[12:15], s53 offen offset:0 lds
    v_bfe_u32 v186, v183, 3, 1
    v_xor_b32 v185, v185, v186
    v_cmp_lt_u32 vcc, 6, v185
    v_mul_u32_u24 v171, 7168, v183
    v_lshl_add_u32 v171, v185, 5, v171
    v_and_b32 v184, 1, v184
    v_lshl_add_u32 v171, v184, 4, v171
    v_cndmask_b32 v186, 0, v187, vcc
    s_sub_u32 s57, s58, 1024
    v_add3_u32 v171, v171, v186, s57
    s_add_u32 s57, s56, 128
    v_add_u32 v182, s57, v1
    buffer_load_dwordx4 v7, s[12:15], s53 offen offset:1024 lds
    v_mul_u32_u24 v183, s59, v182
    v_lshrrev_b32 v183, 19, v183
    v_mul_u32_u24 v184, 28, v183
    v_sub_u32 v184, v182, v184
    v_lshrrev_b32 v185, 1, v184
    v_bfe_u32 v186, v183, 3, 1
    v_xor_b32 v185, v185, v186
    v_cmp_lt_u32 vcc, 6, v185
    v_mul_u32_u24 v172, 7168, v183
    v_lshl_add_u32 v172, v185, 5, v172
    v_and_b32 v184, 1, v184
    v_lshl_add_u32 v172, v184, 4, v172
    buffer_load_dwordx4 v8, s[12:15], s53 offen offset:2048 lds
    v_cndmask_b32 v186, 0, v187, vcc
    s_sub_u32 s57, s58, 2048
    v_add3_u32 v172, v172, v186, s57
    s_add_u32 s57, s56, 192
    v_add_u32 v182, s57, v1
    v_mul_u32_u24 v183, s59, v182
    v_lshrrev_b32 v183, 19, v183
    v_mul_u32_u24 v184, 28, v183
    v_sub_u32 v184, v182, v184
    v_lshrrev_b32 v185, 1, v184
    v_bfe_u32 v186, v183, 3, 1
    v_xor_b32 v185, v185, v186
    buffer_load_dwordx4 v9, s[12:15], s53 offen offset:3072 lds
    v_cmp_lt_u32 vcc, 6, v185
    v_mul_u32_u24 v173, 7168, v183
    v_lshl_add_u32 v173, v185, 5, v173
    v_and_b32 v184, 1, v184
    v_lshl_add_u32 v173, v184, 4, v173
    v_cndmask_b32 v186, 0, v187, vcc
    s_sub_u32 s57, s58, 3072
    v_add3_u32 v173, v173, v186, s57
    s_add_u32 s57, s56, 256
    v_add_u32 v182, s57, v1
    v_mul_u32_u24 v183, s59, v182
    v_lshrrev_b32 v183, 19, v183
    s_add_u32 m0, s55, 61440
    s_nop 0
    buffer_load_dwordx4 v10, s[12:15], s53 offen offset:0 lds
    v_mul_u32_u24 v184, 28, v183
    v_sub_u32 v184, v182, v184
    v_lshrrev_b32 v185, 1, v184
    v_bfe_u32 v186, v183, 3, 1
    v_xor_b32 v185, v185, v186
    v_cmp_lt_u32 vcc, 6, v185
    v_mul_u32_u24 v174, 7168, v183
    v_lshl_add_u32 v174, v185, 5, v174
    v_and_b32 v184, 1, v184
    v_lshl_add_u32 v174, v184, 4, v174
    v_cndmask_b32 v186, 0, v187, vcc
    s_sub_u32 s57, s58, 0
    buffer_load_dwordx4 v11, s[12:15], s53 offen offset:1024 lds
    v_add3_u32 v174, v174, v186, s57
    s_add_u32 s57, s56, 320
    v_add_u32 v182, s57, v1
    v_mul_u32_u24 v183, s59, v182
    v_lshrrev_b32 v183, 19, v183
    v_mul_u32_u24 v184, 28, v183
    v_sub_u32 v184, v182, v184
    v_lshrrev_b32 v185, 1, v184
    v_bfe_u32 v186, v183, 3, 1
    v_xor_b32 v185, v185, v186
    v_cmp_lt_u32 vcc, 6, v185
    v_mul_u32_u24 v175, 7168, v183
    s_mul_i32 s53, s89, 393216
    s_add_u32 m0, s54, 81920
    s_nop 0
    buffer_load_dwordx4 v2, s[8:11], s52 offen offset:0 lds
    v_lshl_add_u32 v175, v185, 5, v175
    v_and_b32 v184, 1, v184
    v_lshl_add_u32 v175, v184, 4, v175
    v_cndmask_b32 v186, 0, v187, vcc
    s_sub_u32 s57, s58, 1024
    v_add3_u32 v175, v175, v186, s57
    s_add_u32 s57, s56, 384
    v_add_u32 v182, s57, v1
    v_mul_u32_u24 v183, s59, v182
    v_lshrrev_b32 v183, 19, v183
    v_mul_u32_u24 v184, 28, v183
    v_sub_u32 v184, v182, v184
    s_add_u32 s88, s88, 1
    s_add_u32 s89, s88, s101
    buffer_load_dwordx4 v3, s[8:11], s52 offen offset:1024 lds
    v_lshrrev_b32 v185, 1, v184
    v_bfe_u32 v186, v183, 3, 1
    v_xor_b32 v185, v185, v186
    v_cmp_lt_u32 vcc, 6, v185
    v_mul_u32_u24 v176, 7168, v183
    v_lshl_add_u32 v176, v185, 5, v176
    v_and_b32 v184, 1, v184
    v_lshl_add_u32 v176, v184, 4, v176
    v_cndmask_b32 v186, 0, v187, vcc
    s_sub_u32 s57, s58, 2048
    v_add3_u32 v176, v176, v186, s57
    v_lshrrev_b32 v182, 4, v1
    s_and_b32 s89, s89, 3
    s_andn2_b32 s90, s88, 3
    buffer_load_dwordx4 v4, s[8:11], s52 offen offset:2048 lds
    v_bfe_u32 v183, v1, 2, 2
    v_lshl_add_u32 v184, v182, 3, v183
    v_mul_u32_u24 v184, 448, v184
    v_and_b32 v185, 3, v1
    v_lshl_add_u32 v184, v185, 3, v184
    v_and_b32 v182, 1, v182
    v_lshlrev_b32 v182, 5, v182
    v_add_u32 v180, v184, v182
    v_sub_u32 v181, v184, v182
    v_add_u32 v181, 32, v181
    s_lshl_b32 s56, s5, 7
    v_add_u32 v178, s56, v180
    s_or_b32 s89, s89, s90
    buffer_load_dwordx4 v5, s[8:11], s52 offen offset:3072 lds
    v_add_u32 v179, s56, v181
    v_accvgpr_write_b32 a200, v170
    v_accvgpr_write_b32 a201, v171
    v_accvgpr_write_b32 a202, v172
    v_accvgpr_write_b32 a203, v173
    v_accvgpr_write_b32 a204, v174
    v_accvgpr_write_b32 a205, v175
    v_accvgpr_write_b32 a206, v176
    v_accvgpr_write_b32 a207, v177
    v_accvgpr_write_b32 a208, v178
    v_accvgpr_write_b32 a209, v179
    v_accvgpr_write_b32 a210, v180
    s_lshl_b32 s52, s89, 7
    s_add_u32 m0, s55, 98304
    s_nop 0
    buffer_load_dwordx4 v6, s[12:15], s53 offen offset:0 lds
    v_accvgpr_write_b32 a211, v181
    v_and_b32 v252, 15, v1
    v_lshlrev_b32 v252, 2, v252
    s_lshl_b32 s56, s6, 7
    s_add_u32 s56, s56, 38862848
    v_add_u32 v253, s56, v252
    s_lshl_b32 s57, s7, 2
    s_add_u32 s92, s56, s57
    s_lshl_b32 s56, s7, 7
    s_add_u32 s56, s56, 38866944
    v_add_u32 v254, s56, v252
    s_lshl_b32 s57, s6, 2
    buffer_load_dwordx4 v7, s[12:15], s53 offen offset:1024 lds
    s_add_u32 s93, s56, s57
    v_mov_b32 v255, 0
    s_lshl_b32 s56, s6, 7
    s_lshl_b32 s57, s3, 5
    s_add_u32 s56, s56, s57
    v_lshrrev_b32 v182, 3, v1
    v_add_u32 v182, s56, v182
    v_lshlrev_b32 v182, 12, v182
    v_lshrrev_b32 v183, 4, v1
    v_and_b32 v184, 7, v1
    v_xor_b32 v183, v183, v184
    v_lshlrev_b32 v183, 4, v183
    buffer_load_dwordx4 v8, s[12:15], s53 offen offset:2048 lds
    v_add_u32 v170, v182, v183
    v_xor_b32 v183, 64, v183
    v_add_u32 v183, v182, v183
    v_add_u32 v171, 31744, v183
    v_add_u32 v172, 63488, v170
    v_add_u32 v173, 95232, v183
    v_accvgpr_write_b32 a192, v170
    v_accvgpr_write_b32 a193, v171
    v_accvgpr_write_b32 a194, v172
    v_accvgpr_write_b32 a195, v173
    v_lshrrev_b32 v182, 3, v1
    v_mul_u32_u24 v182, 2048, v182
    buffer_load_dwordx4 v9, s[12:15], s53 offen offset:3072 lds
    v_bfe_u32 v183, v1, 1, 2
    v_bfe_u32 v184, v1, 4, 1
    v_xor_b32 v183, v183, v184
    v_lshl_add_u32 v182, v183, 5, v182
    v_and_b32 v183, 1, v1
    v_lshl_add_u32 v170, v183, 4, v182
    s_lshl_b32 s56, s3, 15
    s_lshl_b32 s57, s7, 7
    s_add_u32 s56, s56, s57
    v_xor_b32 v171, 64, v170
    v_add_u32 v170, s56, v170
    s_add_u32 s56, s56, 15360
    s_add_u32 m0, s55, 102400
    s_nop 0
    buffer_load_dwordx4 v10, s[12:15], s53 offen offset:0 lds
    v_add_u32 v171, s56, v171
    v_accvgpr_write_b32 a197, v170
    v_accvgpr_write_b32 a198, v171
    s_waitcnt vmcnt(19)
    v_mov_b32 v162, 0
    v_mov_b32 v163, 0
    v_dot2_f32_bf16 v162, v128, v144, v162
    v_dot2_f32_bf16 v163, v129, v145, v163
    v_dot2_f32_bf16 v162, v130, v146, v162
    v_dot2_f32_bf16 v163, v131, v147, v163
    v_dot2_f32_bf16 v162, v132, v148, v162
    v_dot2_f32_bf16 v163, v133, v149, v163
    buffer_load_dwordx4 v11, s[12:15], s53 offen offset:1024 lds
    v_dot2_f32_bf16 v162, v134, v150, v162
    v_dot2_f32_bf16 v163, v135, v151, v163
    v_dot2_f32_bf16 v162, v136, v152, v162
    v_dot2_f32_bf16 v163, v137, v153, v163
    v_dot2_f32_bf16 v162, v138, v154, v162
    v_dot2_f32_bf16 v163, v139, v155, v163
    v_dot2_f32_bf16 v162, v140, v156, v162
    v_dot2_f32_bf16 v163, v141, v157, v163
    v_dot2_f32_bf16 v162, v142, v158, v162
    v_dot2_f32_bf16 v163, v143, v159, v163
    s_nop 2
    v_add_f32 v162, v162, v163
    s_nop 1
    v_add_f32_dpp v162, v162, v162 quad_perm:[1,0,3,2] row_mask:0xf bank_mask:0xf
    s_mul_i32 s53, s89, 393216
    s_add_u32 m0, s54, 122880
    s_nop 0
    buffer_load_dwordx4 v2, s[8:11], s52 offen offset:0 lds
    v_add_f32_dpp v162, v162, v162 quad_perm:[2,3,0,1] row_mask:0xf bank_mask:0xf
    s_nop 1
    v_add_f32_dpp v162, v162, v162 row_half_mirror row_mask:0xf bank_mask:0xf
    s_nop 1
    v_add_f32_dpp v162, v162, v162 row_mirror row_mask:0xf bank_mask:0xf
    v_mov_b32 v163, v162
    s_nop 1
    v_permlane16_swap_b32 v162, v163
    v_add_f32 v162, v162, v163
    v_mul_f32 v162, 3216550459, v162
    v_exp_f32 v162, v162
    s_nop 0
    v_add_f32 v162, 1.0, v162
    v_rcp_f32 v162, v162
    v_lshrrev_b32 v163, 5, v1
    v_lshlrev_b32 v163, 2, v163
    s_add_u32 s88, s88, 1
    s_add_u32 s89, s88, s101
    buffer_load_dwordx4 v3, s[8:11], s52 offen offset:1024 lds
    s_lshl_b32 s56, s66, 2
    s_add_u32 s56, s56, 38797312
    buffer_store_dword v162, v163, s[32:35], s56 offen sc1
    s_barrier
    ds_read_b64_tr_b16 a[16:17], v19 offset:16384
    ds_read_b64_tr_b16 a[18:19], v19 offset:16896
    ds_read_b128 a[0:3], v13 offset:0
    ds_read_b128 a[4:7], v13 offset:2048
    ds_read_b128 a[8:11], v13 offset:4096
    ds_read_b128 a[12:15], v13 offset:6144
    ds_read_b64_tr_b16 a[20:21], v22 offset:16384
    ds_read_b64_tr_b16 a[22:23], v22 offset:16896
    ds_read_b64_tr_b16 a[24:25], v19 offset:24576
    ds_read_b64_tr_b16 a[26:27], v19 offset:25088
    ds_read_b64_tr_b16 a[28:29], v22 offset:24576
    ds_read_b64_tr_b16 a[30:31], v22 offset:25088
    ds_read_b64_tr_b16 a[32:33], v19 offset:32768
    ds_read_b64_tr_b16 a[34:35], v19 offset:33280
    ds_read_b64_tr_b16 a[36:37], v22 offset:32768
    ds_read_b64_tr_b16 a[38:39], v22 offset:33280
    s_waitcnt lgkmcnt(0)
    v_mfma_f32_16x16x32_bf16 v[32:35], a[16:19], a[0:3], 0
    ds_read_b64_tr_b16 a[64:65], v19 offset:20480
    s_and_b32 s89, s89, 3
    s_andn2_b32 s90, s88, 3
    v_mfma_f32_16x16x32_bf16 v[36:39], a[16:19], a[4:7], 0
    ds_read_b64_tr_b16 a[66:67], v19 offset:20992
    buffer_load_dwordx4 v4, s[8:11], s52 offen offset:2048 lds
    s_or_b32 s89, s89, s90
    v_mfma_f32_16x16x32_bf16 v[40:43], a[16:19], a[8:11], 0
    ds_read_b128 a[48:51], v16 offset:0
    v_mfma_f32_16x16x32_bf16 v[44:47], a[16:19], a[12:15], 0
    ds_read_b128 a[52:55], v16 offset:2048
    v_mfma_f32_16x16x32_bf16 v[48:51], a[20:23], a[0:3], 0
    ds_read_b128 a[56:59], v16 offset:4096
    v_mfma_f32_16x16x32_bf16 v[52:55], a[20:23], a[4:7], 0
    buffer_load_dwordx4 v5, s[8:11], s52 offen offset:3072 lds
    s_lshl_b32 s52, s89, 7
    v_mfma_f32_16x16x32_bf16 v[56:59], a[20:23], a[8:11], 0
    ds_read_b128 a[60:63], v16 offset:6144
    v_mfma_f32_16x16x32_bf16 v[60:63], a[20:23], a[12:15], 0
    ds_read_b64_tr_b16 a[68:69], v22 offset:20480
    s_add_u32 m0, s55, 139264
    v_mfma_f32_16x16x32_bf16 v[64:67], a[24:27], a[0:3], 0
    buffer_load_dwordx4 v6, s[12:15], s53 offen offset:0 lds
    v_mfma_f32_16x16x32_bf16 v[68:71], a[24:27], a[4:7], 0
    ds_read_b64_tr_b16 a[70:71], v22 offset:20992
    v_mfma_f32_16x16x32_bf16 v[72:75], a[24:27], a[8:11], 0
    ds_read_b64_tr_b16 a[72:73], v19 offset:28672
    v_mfma_f32_16x16x32_bf16 v[76:79], a[24:27], a[12:15], 0
    ds_read_b64_tr_b16 a[74:75], v19 offset:29184
    v_mfma_f32_16x16x32_bf16 v[80:83], a[28:31], a[0:3], 0
    buffer_load_dwordx4 v7, s[12:15], s53 offen offset:1024 lds
    v_mfma_f32_16x16x32_bf16 v[84:87], a[28:31], a[4:7], 0
    ds_read_b64_tr_b16 a[76:77], v22 offset:28672
    v_mfma_f32_16x16x32_bf16 v[88:91], a[28:31], a[8:11], 0
    ds_read_b64_tr_b16 a[78:79], v22 offset:29184
    v_mfma_f32_16x16x32_bf16 v[92:95], a[28:31], a[12:15], 0
    buffer_load_dwordx4 v8, s[12:15], s53 offen offset:2048 lds
    v_mfma_f32_16x16x32_bf16 v[96:99], a[0:3], a[32:35], 0
    ds_read_b64_tr_b16 a[80:81], v19 offset:36864
    v_mfma_f32_16x16x32_bf16 v[100:103], a[4:7], a[32:35], 0
    ds_read_b64_tr_b16 a[82:83], v19 offset:37376
    v_mfma_f32_16x16x32_bf16 v[104:107], a[8:11], a[32:35], 0
    buffer_load_dwordx4 v9, s[12:15], s53 offen offset:3072 lds
    v_mfma_f32_16x16x32_bf16 v[108:111], a[12:15], a[32:35], 0
    ds_read_b64_tr_b16 a[84:85], v22 offset:36864
    v_mfma_f32_16x16x32_bf16 v[112:115], a[0:3], a[36:39], 0
    ds_read_b64_tr_b16 a[86:87], v22 offset:37376
    v_mfma_f32_16x16x32_bf16 v[116:119], a[4:7], a[36:39], 0
    s_add_u32 m0, s55, 143360
    v_mfma_f32_16x16x32_bf16 v[120:123], a[8:11], a[36:39], 0
    buffer_load_dwordx4 v10, s[12:15], s53 offen offset:0 lds
    v_mfma_f32_16x16x32_bf16 v[124:127], a[12:15], a[36:39], 0
    s_waitcnt vmcnt(20) lgkmcnt(0)
    s_barrier
    s_lshl_b32 s62, s100, 12
    buffer_load_dword v242, v241, s[8:11], s62 offen offset:768
    s_mul_i32 s62, s100, 768
    s_add_u32 s62, s62, 2359296
    buffer_load_dword v242, v243, s[12:15], s62 offen
    v_mfma_f32_16x16x32_bf16 v[32:35], a[64:67], a[48:51], v[32:35]
    ds_read_b64_tr_b16 a[16:17], v19 offset:57344
    v_mfma_f32_16x16x32_bf16 v[36:39], a[64:67], a[52:55], v[36:39]
    ds_read_b64_tr_b16 a[18:19], v19 offset:57856
    buffer_load_dwordx4 v11, s[12:15], s53 offen offset:1024 lds
    s_mul_i32 s53, s89, 393216
    v_mfma_f32_16x16x32_bf16 v[40:43], a[64:67], a[56:59], v[40:43]
    ds_read_b128 a[0:3], v13 offset:40960
    v_mfma_f32_16x16x32_bf16 v[44:47], a[64:67], a[60:63], v[44:47]
    ds_read_b128 a[4:7], v13 offset:43008
    v_mfma_f32_16x16x32_bf16 v[48:51], a[68:71], a[48:51], v[48:51]
    ds_read_b128 a[8:11], v13 offset:45056
    s_add_u32 m0, s54, 0
    v_mfma_f32_16x16x32_bf16 v[52:55], a[68:71], a[52:55], v[52:55]
    buffer_load_dwordx4 v2, s[8:11], s52 offen offset:0 lds
    s_add_u32 s88, s88, 1
    v_mfma_f32_16x16x32_bf16 v[56:59], a[68:71], a[56:59], v[56:59]
    ds_read_b128 a[12:15], v13 offset:47104
    s_add_u32 s89, s88, s101
    v_mfma_f32_16x16x32_bf16 v[60:63], a[68:71], a[60:63], v[60:63]
    ds_read_b64_tr_b16 a[20:21], v22 offset:57344
    v_mfma_f32_16x16x32_bf16 v[64:67], a[72:75], a[48:51], v[64:67]
    buffer_load_dwordx4 v3, s[8:11], s52 offen offset:1024 lds
    s_and_b32 s89, s89, 3
    v_mfma_f32_16x16x32_bf16 v[68:71], a[72:75], a[52:55], v[68:71]
    ds_read_b64_tr_b16 a[22:23], v22 offset:57856
    s_andn2_b32 s90, s88, 3
    v_mfma_f32_16x16x32_bf16 v[72:75], a[72:75], a[56:59], v[72:75]
    ds_read_b64_tr_b16 a[24:25], v20 offset:0
    v_mfma_f32_16x16x32_bf16 v[76:79], a[72:75], a[60:63], v[76:79]
    ds_read_b64_tr_b16 a[26:27], v20 offset:512
    v_mfma_f32_16x16x32_bf16 v[80:83], a[76:79], a[48:51], v[80:83]
    buffer_load_dwordx4 v4, s[8:11], s52 offen offset:2048 lds
    s_or_b32 s89, s89, s90
    v_mfma_f32_16x16x32_bf16 v[84:87], a[76:79], a[52:55], v[84:87]
    ds_read_b64_tr_b16 a[28:29], v23 offset:0
    v_mfma_f32_16x16x32_bf16 v[88:91], a[76:79], a[56:59], v[88:91]
    ds_read_b64_tr_b16 a[30:31], v23 offset:512
    v_mfma_f32_16x16x32_bf16 v[92:95], a[76:79], a[60:63], v[92:95]
    buffer_load_dwordx4 v5, s[8:11], s52 offen offset:3072 lds
    s_lshl_b32 s52, s89, 7
    v_mfma_f32_16x16x32_bf16 v[96:99], a[48:51], a[80:83], v[96:99]
    ds_read_b64_tr_b16 a[32:33], v20 offset:8192
    v_mfma_f32_16x16x32_bf16 v[100:103], a[52:55], a[80:83], v[100:103]
    ds_read_b64_tr_b16 a[34:35], v20 offset:8704
    s_add_u32 m0, s55, 16384
    v_mfma_f32_16x16x32_bf16 v[104:107], a[56:59], a[80:83], v[104:107]
    buffer_load_dwordx4 v6, s[12:15], s53 offen offset:0 lds
    v_mfma_f32_16x16x32_bf16 v[108:111], a[60:63], a[80:83], v[108:111]
    ds_read_b64_tr_b16 a[36:37], v23 offset:8192
    v_mfma_f32_16x16x32_bf16 v[112:115], a[48:51], a[84:87], v[112:115]
    ds_read_b64_tr_b16 a[38:39], v23 offset:8704
    v_mfma_f32_16x16x32_bf16 v[116:119], a[52:55], a[84:87], v[116:119]
    v_mfma_f32_16x16x32_bf16 v[120:123], a[56:59], a[84:87], v[120:123]
    buffer_load_dwordx4 v7, s[12:15], s53 offen offset:1024 lds
    v_mfma_f32_16x16x32_bf16 v[124:127], a[60:63], a[84:87], v[124:127]
    s_waitcnt lgkmcnt(0)
    v_mfma_f32_16x16x32_bf16 v[32:35], a[16:19], a[0:3], v[32:35]
    ds_read_b64_tr_b16 a[64:65], v19 offset:61440
    v_mfma_f32_16x16x32_bf16 v[36:39], a[16:19], a[4:7], v[36:39]
    ds_read_b64_tr_b16 a[66:67], v19 offset:61952
    v_mfma_f32_16x16x32_bf16 v[40:43], a[16:19], a[8:11], v[40:43]
    ds_read_b128 a[48:51], v16 offset:40960
    v_mfma_f32_16x16x32_bf16 v[44:47], a[16:19], a[12:15], v[44:47]
    buffer_load_dwordx4 v8, s[12:15], s53 offen offset:2048 lds
    v_mfma_f32_16x16x32_bf16 v[48:51], a[20:23], a[0:3], v[48:51]
    ds_read_b128 a[52:55], v16 offset:43008
    v_mfma_f32_16x16x32_bf16 v[52:55], a[20:23], a[4:7], v[52:55]
    ds_read_b128 a[56:59], v16 offset:45056
    v_mfma_f32_16x16x32_bf16 v[56:59], a[20:23], a[8:11], v[56:59]
    ds_read_b128 a[60:63], v16 offset:47104
    v_mfma_f32_16x16x32_bf16 v[60:63], a[20:23], a[12:15], v[60:63]
    ds_read_b64_tr_b16 a[68:69], v22 offset:61440
    v_mfma_f32_16x16x32_bf16 v[64:67], a[24:27], a[0:3], v[64:67]
    ds_read_b64_tr_b16 a[70:71], v22 offset:61952
    v_mfma_f32_16x16x32_bf16 v[68:71], a[24:27], a[4:7], v[68:71]
    buffer_load_dwordx4 v9, s[12:15], s53 offen offset:3072 lds
    v_mfma_f32_16x16x32_bf16 v[72:75], a[24:27], a[8:11], v[72:75]
    ds_read_b64_tr_b16 a[72:73], v20 offset:4096
    v_mfma_f32_16x16x32_bf16 v[76:79], a[24:27], a[12:15], v[76:79]
    ds_read_b64_tr_b16 a[74:75], v20 offset:4608
    v_mfma_f32_16x16x32_bf16 v[80:83], a[28:31], a[0:3], v[80:83]
    ds_read_b64_tr_b16 a[76:77], v23 offset:4096
    v_mfma_f32_16x16x32_bf16 v[84:87], a[28:31], a[4:7], v[84:87]
    ds_read_b64_tr_b16 a[78:79], v23 offset:4608
    v_mfma_f32_16x16x32_bf16 v[88:91], a[28:31], a[8:11], v[88:91]
    ds_read_b64_tr_b16 a[80:81], v20 offset:12288
    s_add_u32 m0, s55, 20480
    v_mfma_f32_16x16x32_bf16 v[92:95], a[28:31], a[12:15], v[92:95]
    buffer_load_dwordx4 v10, s[12:15], s53 offen offset:0 lds
    v_mfma_f32_16x16x32_bf16 v[96:99], a[0:3], a[32:35], v[96:99]
    ds_read_b64_tr_b16 a[82:83], v20 offset:12800
    v_mfma_f32_16x16x32_bf16 v[100:103], a[4:7], a[32:35], v[100:103]
    ds_read_b64_tr_b16 a[84:85], v23 offset:12288
    v_mfma_f32_16x16x32_bf16 v[104:107], a[8:11], a[32:35], v[104:107]
    ds_read_b64_tr_b16 a[86:87], v23 offset:12800
    v_mfma_f32_16x16x32_bf16 v[108:111], a[12:15], a[32:35], v[108:111]
    v_mfma_f32_16x16x32_bf16 v[112:115], a[0:3], a[36:39], v[112:115]
    v_mfma_f32_16x16x32_bf16 v[116:119], a[4:7], a[36:39], v[116:119]
    buffer_load_dwordx4 v11, s[12:15], s53 offen offset:1024 lds
    s_mul_i32 s53, s89, 393216
    v_mfma_f32_16x16x32_bf16 v[120:123], a[8:11], a[36:39], v[120:123]
    v_mfma_f32_16x16x32_bf16 v[124:127], a[12:15], a[36:39], v[124:127]
    s_waitcnt vmcnt(23) lgkmcnt(0)
    s_barrier
    v_mfma_f32_16x16x32_bf16 v[32:35], a[64:67], a[48:51], v[32:35]
    ds_read_b64_tr_b16 a[16:17], v20 offset:32768
    v_mfma_f32_16x16x32_bf16 v[36:39], a[64:67], a[52:55], v[36:39]
    ds_read_b64_tr_b16 a[18:19], v20 offset:33280
    s_add_u32 m0, s54, 40960
    v_mfma_f32_16x16x32_bf16 v[40:43], a[64:67], a[56:59], v[40:43]
    buffer_load_dwordx4 v2, s[8:11], s52 offen offset:0 lds
    s_add_u32 s88, s88, 1
    v_mfma_f32_16x16x32_bf16 v[44:47], a[64:67], a[60:63], v[44:47]
    ds_read_b128 a[0:3], v14 offset:16384
    s_add_u32 s89, s88, s101
    v_mfma_f32_16x16x32_bf16 v[48:51], a[68:71], a[48:51], v[48:51]
    ds_read_b128 a[4:7], v14 offset:18432
    v_mfma_f32_16x16x32_bf16 v[52:55], a[68:71], a[52:55], v[52:55]
    ds_read_b128 a[8:11], v14 offset:20480
    v_mfma_f32_16x16x32_bf16 v[56:59], a[68:71], a[56:59], v[56:59]
    ds_read_b128 a[12:15], v14 offset:22528
    v_mfma_f32_16x16x32_bf16 v[60:63], a[68:71], a[60:63], v[60:63]
    buffer_load_dwordx4 v3, s[8:11], s52 offen offset:1024 lds
    s_and_b32 s89, s89, 3
    v_mfma_f32_16x16x32_bf16 v[64:67], a[72:75], a[48:51], v[64:67]
    ds_read_b64_tr_b16 a[20:21], v23 offset:32768
    s_andn2_b32 s90, s88, 3
    v_mfma_f32_16x16x32_bf16 v[68:71], a[72:75], a[52:55], v[68:71]
    ds_read_b64_tr_b16 a[22:23], v23 offset:33280
    v_mfma_f32_16x16x32_bf16 v[72:75], a[72:75], a[56:59], v[72:75]
    ds_read_b64_tr_b16 a[24:25], v20 offset:40960
    v_mfma_f32_16x16x32_bf16 v[76:79], a[72:75], a[60:63], v[76:79]
    ds_read_b64_tr_b16 a[26:27], v20 offset:41472
    v_mfma_f32_16x16x32_bf16 v[80:83], a[76:79], a[48:51], v[80:83]
    buffer_load_dwordx4 v4, s[8:11], s52 offen offset:2048 lds
    s_or_b32 s89, s89, s90
    v_mfma_f32_16x16x32_bf16 v[84:87], a[76:79], a[52:55], v[84:87]
    ds_read_b64_tr_b16 a[28:29], v23 offset:40960
    v_mfma_f32_16x16x32_bf16 v[88:91], a[76:79], a[56:59], v[88:91]
    ds_read_b64_tr_b16 a[30:31], v23 offset:41472
    v_mfma_f32_16x16x32_bf16 v[92:95], a[76:79], a[60:63], v[92:95]
    ds_read_b64_tr_b16 a[32:33], v20 offset:49152
    v_mfma_f32_16x16x32_bf16 v[96:99], a[48:51], a[80:83], v[96:99]
    buffer_load_dwordx4 v5, s[8:11], s52 offen offset:3072 lds
    s_lshl_b32 s52, s89, 7
    v_mfma_f32_16x16x32_bf16 v[100:103], a[52:55], a[80:83], v[100:103]
    ds_read_b64_tr_b16 a[34:35], v20 offset:49664
    v_mfma_f32_16x16x32_bf16 v[104:107], a[56:59], a[80:83], v[104:107]
    ds_read_b64_tr_b16 a[36:37], v23 offset:49152
    v_mfma_f32_16x16x32_bf16 v[108:111], a[60:63], a[80:83], v[108:111]
    ds_read_b64_tr_b16 a[38:39], v23 offset:49664
    v_mfma_f32_16x16x32_bf16 v[112:115], a[48:51], a[84:87], v[112:115]
    s_add_u32 m0, s55, 57344
    v_mfma_f32_16x16x32_bf16 v[116:119], a[52:55], a[84:87], v[116:119]
    buffer_load_dwordx4 v6, s[12:15], s53 offen offset:0 lds
    v_mfma_f32_16x16x32_bf16 v[120:123], a[56:59], a[84:87], v[120:123]
    v_mfma_f32_16x16x32_bf16 v[124:127], a[60:63], a[84:87], v[124:127]
    s_waitcnt lgkmcnt(0)
    v_mfma_f32_16x16x32_bf16 v[32:35], a[16:19], a[0:3], v[32:35]
    ds_read_b64_tr_b16 a[64:65], v20 offset:36864
    v_mfma_f32_16x16x32_bf16 v[36:39], a[16:19], a[4:7], v[36:39]
    ds_read_b64_tr_b16 a[66:67], v20 offset:37376
    v_mfma_f32_16x16x32_bf16 v[40:43], a[16:19], a[8:11], v[40:43]
    buffer_load_dwordx4 v7, s[12:15], s53 offen offset:1024 lds
    v_mfma_f32_16x16x32_bf16 v[44:47], a[16:19], a[12:15], v[44:47]
    ds_read_b128 a[48:51], v17 offset:16384
    v_mfma_f32_16x16x32_bf16 v[48:51], a[20:23], a[0:3], v[48:51]
    ds_read_b128 a[52:55], v17 offset:18432
    v_mfma_f32_16x16x32_bf16 v[52:55], a[20:23], a[4:7], v[52:55]
    ds_read_b128 a[56:59], v17 offset:20480
    v_mfma_f32_16x16x32_bf16 v[56:59], a[20:23], a[8:11], v[56:59]
    ds_read_b128 a[60:63], v17 offset:22528
    v_mfma_f32_16x16x32_bf16 v[60:63], a[20:23], a[12:15], v[60:63]
    buffer_load_dwordx4 v8, s[12:15], s53 offen offset:2048 lds
    v_mfma_f32_16x16x32_bf16 v[64:67], a[24:27], a[0:3], v[64:67]
    ds_read_b64_tr_b16 a[68:69], v23 offset:36864
    v_mfma_f32_16x16x32_bf16 v[68:71], a[24:27], a[4:7], v[68:71]
    ds_read_b64_tr_b16 a[70:71], v23 offset:37376
    v_mfma_f32_16x16x32_bf16 v[72:75], a[24:27], a[8:11], v[72:75]
    ds_read_b64_tr_b16 a[72:73], v20 offset:45056
    v_mfma_f32_16x16x32_bf16 v[76:79], a[24:27], a[12:15], v[76:79]
    ds_read_b64_tr_b16 a[74:75], v20 offset:45568
    v_mfma_f32_16x16x32_bf16 v[80:83], a[28:31], a[0:3], v[80:83]
    buffer_load_dwordx4 v9, s[12:15], s53 offen offset:3072 lds
    v_mfma_f32_16x16x32_bf16 v[84:87], a[28:31], a[4:7], v[84:87]
    ds_read_b64_tr_b16 a[76:77], v23 offset:45056
    v_mfma_f32_16x16x32_bf16 v[88:91], a[28:31], a[8:11], v[88:91]
    ds_read_b64_tr_b16 a[78:79], v23 offset:45568
    v_mfma_f32_16x16x32_bf16 v[92:95], a[28:31], a[12:15], v[92:95]
    ds_read_b64_tr_b16 a[80:81], v20 offset:53248
    s_add_u32 m0, s55, 61440
    v_mfma_f32_16x16x32_bf16 v[96:99], a[0:3], a[32:35], v[96:99]
    buffer_load_dwordx4 v10, s[12:15], s53 offen offset:0 lds
    v_mfma_f32_16x16x32_bf16 v[100:103], a[4:7], a[32:35], v[100:103]
    ds_read_b64_tr_b16 a[82:83], v20 offset:53760
    v_mfma_f32_16x16x32_bf16 v[104:107], a[8:11], a[32:35], v[104:107]
    ds_read_b64_tr_b16 a[84:85], v23 offset:53248
    v_mfma_f32_16x16x32_bf16 v[108:111], a[12:15], a[32:35], v[108:111]
    ds_read_b64_tr_b16 a[86:87], v23 offset:53760
    v_mfma_f32_16x16x32_bf16 v[112:115], a[0:3], a[36:39], v[112:115]
    v_mfma_f32_16x16x32_bf16 v[116:119], a[4:7], a[36:39], v[116:119]
    buffer_load_dwordx4 v11, s[12:15], s53 offen offset:1024 lds
    s_mul_i32 s53, s89, 393216
    v_mfma_f32_16x16x32_bf16 v[120:123], a[8:11], a[36:39], v[120:123]
    v_mfma_f32_16x16x32_bf16 v[124:127], a[12:15], a[36:39], v[124:127]
    s_waitcnt vmcnt(20) lgkmcnt(0)
    s_barrier
    s_lshl_b32 s62, s100, 12
    buffer_load_dword v242, v241, s[8:11], s62 offen offset:1024
    s_mul_i32 s62, s100, 768
    s_add_u32 s62, s62, 3145728
    buffer_load_dword v242, v243, s[12:15], s62 offen
    v_mfma_f32_16x16x32_bf16 v[32:35], a[64:67], a[48:51], v[32:35]
    ds_read_b64_tr_b16 a[16:17], v21 offset:8192
    v_mfma_f32_16x16x32_bf16 v[36:39], a[64:67], a[52:55], v[36:39]
    ds_read_b64_tr_b16 a[18:19], v21 offset:8704
    s_add_u32 m0, s54, 81920
    v_mfma_f32_16x16x32_bf16 v[40:43], a[64:67], a[56:59], v[40:43]
    buffer_load_dwordx4 v2, s[8:11], s52 offen offset:0 lds
    s_add_u32 s88, s88, 1
    v_mfma_f32_16x16x32_bf16 v[44:47], a[64:67], a[60:63], v[44:47]
    ds_read_b128 a[0:3], v14 offset:57344
    s_add_u32 s89, s88, s101
    v_mfma_f32_16x16x32_bf16 v[48:51], a[68:71], a[48:51], v[48:51]
    ds_read_b128 a[4:7], v14 offset:59392
    v_mfma_f32_16x16x32_bf16 v[52:55], a[68:71], a[52:55], v[52:55]
    ds_read_b128 a[8:11], v14 offset:61440
    v_mfma_f32_16x16x32_bf16 v[56:59], a[68:71], a[56:59], v[56:59]
    ds_read_b128 a[12:15], v14 offset:63488
    v_mfma_f32_16x16x32_bf16 v[60:63], a[68:71], a[60:63], v[60:63]
    buffer_load_dwordx4 v3, s[8:11], s52 offen offset:1024 lds
    s_and_b32 s89, s89, 3
    v_mfma_f32_16x16x32_bf16 v[64:67], a[72:75], a[48:51], v[64:67]
    ds_read_b64_tr_b16 a[20:21], v24 offset:8192
    s_andn2_b32 s90, s88, 3
    v_mfma_f32_16x16x32_bf16 v[68:71], a[72:75], a[52:55], v[68:71]
    ds_read_b64_tr_b16 a[22:23], v24 offset:8704
    v_mfma_f32_16x16x32_bf16 v[72:75], a[72:75], a[56:59], v[72:75]
    ds_read_b64_tr_b16 a[24:25], v21 offset:16384
    v_mfma_f32_16x16x32_bf16 v[76:79], a[72:75], a[60:63], v[76:79]
    ds_read_b64_tr_b16 a[26:27], v21 offset:16896
    v_mfma_f32_16x16x32_bf16 v[80:83], a[76:79], a[48:51], v[80:83]
    buffer_load_dwordx4 v4, s[8:11], s52 offen offset:2048 lds
    s_or_b32 s89, s89, s90
    v_mfma_f32_16x16x32_bf16 v[84:87], a[76:79], a[52:55], v[84:87]
    ds_read_b64_tr_b16 a[28:29], v24 offset:16384
    v_mfma_f32_16x16x32_bf16 v[88:91], a[76:79], a[56:59], v[88:91]
    ds_read_b64_tr_b16 a[30:31], v24 offset:16896
    v_mfma_f32_16x16x32_bf16 v[92:95], a[76:79], a[60:63], v[92:95]
    ds_read_b64_tr_b16 a[32:33], v21 offset:24576
    v_mfma_f32_16x16x32_bf16 v[96:99], a[48:51], a[80:83], v[96:99]
    buffer_load_dwordx4 v5, s[8:11], s52 offen offset:3072 lds
    s_lshl_b32 s52, s89, 7
    v_mfma_f32_16x16x32_bf16 v[100:103], a[52:55], a[80:83], v[100:103]
    ds_read_b64_tr_b16 a[34:35], v21 offset:25088
    v_mfma_f32_16x16x32_bf16 v[104:107], a[56:59], a[80:83], v[104:107]
    ds_read_b64_tr_b16 a[36:37], v24 offset:24576
    v_mfma_f32_16x16x32_bf16 v[108:111], a[60:63], a[80:83], v[108:111]
    ds_read_b64_tr_b16 a[38:39], v24 offset:25088
    v_mfma_f32_16x16x32_bf16 v[112:115], a[48:51], a[84:87], v[112:115]
    s_add_u32 m0, s55, 98304
    v_mfma_f32_16x16x32_bf16 v[116:119], a[52:55], a[84:87], v[116:119]
    buffer_load_dwordx4 v6, s[12:15], s53 offen offset:0 lds
    v_mfma_f32_16x16x32_bf16 v[120:123], a[56:59], a[84:87], v[120:123]
    v_mfma_f32_16x16x32_bf16 v[124:127], a[60:63], a[84:87], v[124:127]
    s_waitcnt lgkmcnt(0)
    v_mfma_f32_16x16x32_bf16 v[32:35], a[16:19], a[0:3], v[32:35]
    ds_read_b64_tr_b16 a[64:65], v21 offset:12288
    v_mfma_f32_16x16x32_bf16 v[36:39], a[16:19], a[4:7], v[36:39]
    ds_read_b64_tr_b16 a[66:67], v21 offset:12800
    v_mfma_f32_16x16x32_bf16 v[40:43], a[16:19], a[8:11], v[40:43]
    buffer_load_dwordx4 v7, s[12:15], s53 offen offset:1024 lds
    v_mfma_f32_16x16x32_bf16 v[44:47], a[16:19], a[12:15], v[44:47]
    ds_read_b128 a[48:51], v17 offset:57344
    v_mfma_f32_16x16x32_bf16 v[48:51], a[20:23], a[0:3], v[48:51]
    ds_read_b128 a[52:55], v17 offset:59392
    v_mfma_f32_16x16x32_bf16 v[52:55], a[20:23], a[4:7], v[52:55]
    ds_read_b128 a[56:59], v17 offset:61440
    v_mfma_f32_16x16x32_bf16 v[56:59], a[20:23], a[8:11], v[56:59]
    ds_read_b128 a[60:63], v17 offset:63488
    v_mfma_f32_16x16x32_bf16 v[60:63], a[20:23], a[12:15], v[60:63]
    buffer_load_dwordx4 v8, s[12:15], s53 offen offset:2048 lds
    v_mfma_f32_16x16x32_bf16 v[64:67], a[24:27], a[0:3], v[64:67]
    ds_read_b64_tr_b16 a[68:69], v24 offset:12288
    v_mfma_f32_16x16x32_bf16 v[68:71], a[24:27], a[4:7], v[68:71]
    ds_read_b64_tr_b16 a[70:71], v24 offset:12800
    v_mfma_f32_16x16x32_bf16 v[72:75], a[24:27], a[8:11], v[72:75]
    ds_read_b64_tr_b16 a[72:73], v21 offset:20480
    v_mfma_f32_16x16x32_bf16 v[76:79], a[24:27], a[12:15], v[76:79]
    ds_read_b64_tr_b16 a[74:75], v21 offset:20992
    v_mfma_f32_16x16x32_bf16 v[80:83], a[28:31], a[0:3], v[80:83]
    buffer_load_dwordx4 v9, s[12:15], s53 offen offset:3072 lds
    v_mfma_f32_16x16x32_bf16 v[84:87], a[28:31], a[4:7], v[84:87]
    ds_read_b64_tr_b16 a[76:77], v24 offset:20480
    v_mfma_f32_16x16x32_bf16 v[88:91], a[28:31], a[8:11], v[88:91]
    ds_read_b64_tr_b16 a[78:79], v24 offset:20992
    v_mfma_f32_16x16x32_bf16 v[92:95], a[28:31], a[12:15], v[92:95]
    ds_read_b64_tr_b16 a[80:81], v21 offset:28672
    s_add_u32 m0, s55, 102400
    v_mfma_f32_16x16x32_bf16 v[96:99], a[0:3], a[32:35], v[96:99]
    buffer_load_dwordx4 v10, s[12:15], s53 offen offset:0 lds
    v_mfma_f32_16x16x32_bf16 v[100:103], a[4:7], a[32:35], v[100:103]
    ds_read_b64_tr_b16 a[82:83], v21 offset:29184
    v_mfma_f32_16x16x32_bf16 v[104:107], a[8:11], a[32:35], v[104:107]
    ds_read_b64_tr_b16 a[84:85], v24 offset:28672
    v_mfma_f32_16x16x32_bf16 v[108:111], a[12:15], a[32:35], v[108:111]
    ds_read_b64_tr_b16 a[86:87], v24 offset:29184
    v_mfma_f32_16x16x32_bf16 v[112:115], a[0:3], a[36:39], v[112:115]
    v_mfma_f32_16x16x32_bf16 v[116:119], a[4:7], a[36:39], v[116:119]
    buffer_load_dwordx4 v11, s[12:15], s53 offen offset:1024 lds
    s_mul_i32 s53, s89, 393216
    v_mfma_f32_16x16x32_bf16 v[120:123], a[8:11], a[36:39], v[120:123]
    v_mfma_f32_16x16x32_bf16 v[124:127], a[12:15], a[36:39], v[124:127]
    s_waitcnt vmcnt(22) lgkmcnt(0)
    s_barrier
    v_mfma_f32_16x16x32_bf16 v[32:35], a[64:67], a[48:51], v[32:35]
    ds_read_b64_tr_b16 a[16:17], v19 offset:16384
    v_mfma_f32_16x16x32_bf16 v[36:39], a[64:67], a[52:55], v[36:39]
    ds_read_b64_tr_b16 a[18:19], v19 offset:16896
    s_add_u32 m0, s54, 122880
    v_mfma_f32_16x16x32_bf16 v[40:43], a[64:67], a[56:59], v[40:43]
    buffer_load_dwordx4 v2, s[8:11], s52 offen offset:0 lds
    s_add_u32 s88, s88, 1
    v_mfma_f32_16x16x32_bf16 v[44:47], a[64:67], a[60:63], v[44:47]
    ds_read_b128 a[0:3], v13 offset:0
    s_add_u32 s89, s88, s101
    v_mfma_f32_16x16x32_bf16 v[48:51], a[68:71], a[48:51], v[48:51]
    ds_read_b128 a[4:7], v13 offset:2048
    v_mfma_f32_16x16x32_bf16 v[52:55], a[68:71], a[52:55], v[52:55]
    ds_read_b128 a[8:11], v13 offset:4096
    v_mfma_f32_16x16x32_bf16 v[56:59], a[68:71], a[56:59], v[56:59]
    ds_read_b128 a[12:15], v13 offset:6144
    v_mfma_f32_16x16x32_bf16 v[60:63], a[68:71], a[60:63], v[60:63]
    buffer_load_dwordx4 v3, s[8:11], s52 offen offset:1024 lds
    s_and_b32 s89, s89, 3
    v_mfma_f32_16x16x32_bf16 v[64:67], a[72:75], a[48:51], v[64:67]
    ds_read_b64_tr_b16 a[20:21], v22 offset:16384
    s_andn2_b32 s90, s88, 3
    v_mfma_f32_16x16x32_bf16 v[68:71], a[72:75], a[52:55], v[68:71]
    ds_read_b64_tr_b16 a[22:23], v22 offset:16896
    v_mfma_f32_16x16x32_bf16 v[72:75], a[72:75], a[56:59], v[72:75]
    ds_read_b64_tr_b16 a[24:25], v19 offset:24576
    v_mfma_f32_16x16x32_bf16 v[76:79], a[72:75], a[60:63], v[76:79]
    ds_read_b64_tr_b16 a[26:27], v19 offset:25088
    v_mfma_f32_16x16x32_bf16 v[80:83], a[76:79], a[48:51], v[80:83]
    buffer_load_dwordx4 v4, s[8:11], s52 offen offset:2048 lds
    s_or_b32 s89, s89, s90
    v_mfma_f32_16x16x32_bf16 v[84:87], a[76:79], a[52:55], v[84:87]
    ds_read_b64_tr_b16 a[28:29], v22 offset:24576
    v_mfma_f32_16x16x32_bf16 v[88:91], a[76:79], a[56:59], v[88:91]
    ds_read_b64_tr_b16 a[30:31], v22 offset:25088
    v_mfma_f32_16x16x32_bf16 v[92:95], a[76:79], a[60:63], v[92:95]
    ds_read_b64_tr_b16 a[32:33], v19 offset:32768
    v_mfma_f32_16x16x32_bf16 v[96:99], a[48:51], a[80:83], v[96:99]
    buffer_load_dwordx4 v5, s[8:11], s52 offen offset:3072 lds
    s_lshl_b32 s52, s89, 7
    v_mfma_f32_16x16x32_bf16 v[100:103], a[52:55], a[80:83], v[100:103]
    ds_read_b64_tr_b16 a[34:35], v19 offset:33280
    v_mfma_f32_16x16x32_bf16 v[104:107], a[56:59], a[80:83], v[104:107]
    ds_read_b64_tr_b16 a[36:37], v22 offset:32768
    v_mfma_f32_16x16x32_bf16 v[108:111], a[60:63], a[80:83], v[108:111]
    ds_read_b64_tr_b16 a[38:39], v22 offset:33280
    v_mfma_f32_16x16x32_bf16 v[112:115], a[48:51], a[84:87], v[112:115]
    s_add_u32 m0, s55, 139264
    v_mfma_f32_16x16x32_bf16 v[116:119], a[52:55], a[84:87], v[116:119]
    buffer_load_dwordx4 v6, s[12:15], s53 offen offset:0 lds
    v_mfma_f32_16x16x32_bf16 v[120:123], a[56:59], a[84:87], v[120:123]
    v_mfma_f32_16x16x32_bf16 v[124:127], a[60:63], a[84:87], v[124:127]
    s_waitcnt lgkmcnt(0)
    v_mfma_f32_16x16x32_bf16 v[32:35], a[16:19], a[0:3], v[32:35]
    ds_read_b64_tr_b16 a[64:65], v19 offset:20480
    v_mfma_f32_16x16x32_bf16 v[36:39], a[16:19], a[4:7], v[36:39]
    ds_read_b64_tr_b16 a[66:67], v19 offset:20992
    v_mfma_f32_16x16x32_bf16 v[40:43], a[16:19], a[8:11], v[40:43]
    buffer_load_dwordx4 v7, s[12:15], s53 offen offset:1024 lds
    v_mfma_f32_16x16x32_bf16 v[44:47], a[16:19], a[12:15], v[44:47]
    ds_read_b128 a[48:51], v16 offset:0
    v_mfma_f32_16x16x32_bf16 v[48:51], a[20:23], a[0:3], v[48:51]
    ds_read_b128 a[52:55], v16 offset:2048
    v_mfma_f32_16x16x32_bf16 v[52:55], a[20:23], a[4:7], v[52:55]
    ds_read_b128 a[56:59], v16 offset:4096
    v_mfma_f32_16x16x32_bf16 v[56:59], a[20:23], a[8:11], v[56:59]
    ds_read_b128 a[60:63], v16 offset:6144
    v_mfma_f32_16x16x32_bf16 v[60:63], a[20:23], a[12:15], v[60:63]
    buffer_load_dwordx4 v8, s[12:15], s53 offen offset:2048 lds
    v_mfma_f32_16x16x32_bf16 v[64:67], a[24:27], a[0:3], v[64:67]
    ds_read_b64_tr_b16 a[68:69], v22 offset:20480
    v_mfma_f32_16x16x32_bf16 v[68:71], a[24:27], a[4:7], v[68:71]
    ds_read_b64_tr_b16 a[70:71], v22 offset:20992
    v_mfma_f32_16x16x32_bf16 v[72:75], a[24:27], a[8:11], v[72:75]
    ds_read_b64_tr_b16 a[72:73], v19 offset:28672
    v_mfma_f32_16x16x32_bf16 v[76:79], a[24:27], a[12:15], v[76:79]
    ds_read_b64_tr_b16 a[74:75], v19 offset:29184
    v_mfma_f32_16x16x32_bf16 v[80:83], a[28:31], a[0:3], v[80:83]
    buffer_load_dwordx4 v9, s[12:15], s53 offen offset:3072 lds
    v_mfma_f32_16x16x32_bf16 v[84:87], a[28:31], a[4:7], v[84:87]
    ds_read_b64_tr_b16 a[76:77], v22 offset:28672
    v_mfma_f32_16x16x32_bf16 v[88:91], a[28:31], a[8:11], v[88:91]
    ds_read_b64_tr_b16 a[78:79], v22 offset:29184
    v_mfma_f32_16x16x32_bf16 v[92:95], a[28:31], a[12:15], v[92:95]
    ds_read_b64_tr_b16 a[80:81], v19 offset:36864
    s_add_u32 m0, s55, 143360
    v_mfma_f32_16x16x32_bf16 v[96:99], a[0:3], a[32:35], v[96:99]
    buffer_load_dwordx4 v10, s[12:15], s53 offen offset:0 lds
    v_mfma_f32_16x16x32_bf16 v[100:103], a[4:7], a[32:35], v[100:103]
    ds_read_b64_tr_b16 a[82:83], v19 offset:37376
    v_mfma_f32_16x16x32_bf16 v[104:107], a[8:11], a[32:35], v[104:107]
    ds_read_b64_tr_b16 a[84:85], v22 offset:36864
    v_mfma_f32_16x16x32_bf16 v[108:111], a[12:15], a[32:35], v[108:111]
    ds_read_b64_tr_b16 a[86:87], v22 offset:37376
    v_mfma_f32_16x16x32_bf16 v[112:115], a[0:3], a[36:39], v[112:115]
    v_mfma_f32_16x16x32_bf16 v[116:119], a[4:7], a[36:39], v[116:119]
    buffer_load_dwordx4 v11, s[12:15], s53 offen offset:1024 lds
    s_mul_i32 s53, s89, 393216
    v_mfma_f32_16x16x32_bf16 v[120:123], a[8:11], a[36:39], v[120:123]
    v_mfma_f32_16x16x32_bf16 v[124:127], a[12:15], a[36:39], v[124:127]
    s_waitcnt vmcnt(22) lgkmcnt(0)
    s_barrier
    s_lshl_b32 s62, s100, 12
    buffer_load_dword v242, v241, s[8:11], s62 offen offset:1280
    s_mul_i32 s62, s100, 768
    s_add_u32 s62, s62, 3932160
    buffer_load_dword v242, v243, s[12:15], s62 offen
    v_mfma_f32_16x16x32_bf16 v[32:35], a[64:67], a[48:51], v[32:35]
    ds_read_b64_tr_b16 a[16:17], v19 offset:57344
    v_mfma_f32_16x16x32_bf16 v[36:39], a[64:67], a[52:55], v[36:39]
    ds_read_b64_tr_b16 a[18:19], v19 offset:57856
    s_add_u32 m0, s54, 0
    v_mfma_f32_16x16x32_bf16 v[40:43], a[64:67], a[56:59], v[40:43]
    buffer_load_dwordx4 v2, s[8:11], s52 offen offset:0 lds
    s_add_u32 s88, s88, 1
    v_mfma_f32_16x16x32_bf16 v[44:47], a[64:67], a[60:63], v[44:47]
    ds_read_b128 a[0:3], v13 offset:40960
    s_add_u32 s89, s88, s101
    v_mfma_f32_16x16x32_bf16 v[48:51], a[68:71], a[48:51], v[48:51]
    ds_read_b128 a[4:7], v13 offset:43008
    v_mfma_f32_16x16x32_bf16 v[52:55], a[68:71], a[52:55], v[52:55]
    ds_read_b128 a[8:11], v13 offset:45056
    v_mfma_f32_16x16x32_bf16 v[56:59], a[68:71], a[56:59], v[56:59]
    ds_read_b128 a[12:15], v13 offset:47104
    v_mfma_f32_16x16x32_bf16 v[60:63], a[68:71], a[60:63], v[60:63]
    buffer_load_dwordx4 v3, s[8:11], s52 offen offset:1024 lds
    s_and_b32 s89, s89, 3
    v_mfma_f32_16x16x32_bf16 v[64:67], a[72:75], a[48:51], v[64:67]
    ds_read_b64_tr_b16 a[20:21], v22 offset:57344
    s_andn2_b32 s90, s88, 3
    v_mfma_f32_16x16x32_bf16 v[68:71], a[72:75], a[52:55], v[68:71]
    ds_read_b64_tr_b16 a[22:23], v22 offset:57856
    v_mfma_f32_16x16x32_bf16 v[72:75], a[72:75], a[56:59], v[72:75]
    ds_read_b64_tr_b16 a[24:25], v20 offset:0
    v_mfma_f32_16x16x32_bf16 v[76:79], a[72:75], a[60:63], v[76:79]
    ds_read_b64_tr_b16 a[26:27], v20 offset:512
    v_mfma_f32_16x16x32_bf16 v[80:83], a[76:79], a[48:51], v[80:83]
    buffer_load_dwordx4 v4, s[8:11], s52 offen offset:2048 lds
    s_or_b32 s89, s89, s90
    v_mfma_f32_16x16x32_bf16 v[84:87], a[76:79], a[52:55], v[84:87]
    ds_read_b64_tr_b16 a[28:29], v23 offset:0
    v_mfma_f32_16x16x32_bf16 v[88:91], a[76:79], a[56:59], v[88:91]
    ds_read_b64_tr_b16 a[30:31], v23 offset:512
    v_mfma_f32_16x16x32_bf16 v[92:95], a[76:79], a[60:63], v[92:95]
    ds_read_b64_tr_b16 a[32:33], v20 offset:8192
    v_mfma_f32_16x16x32_bf16 v[96:99], a[48:51], a[80:83], v[96:99]
    buffer_load_dwordx4 v5, s[8:11], s52 offen offset:3072 lds
    s_lshl_b32 s52, s89, 7
    v_mfma_f32_16x16x32_bf16 v[100:103], a[52:55], a[80:83], v[100:103]
    ds_read_b64_tr_b16 a[34:35], v20 offset:8704
    v_mfma_f32_16x16x32_bf16 v[104:107], a[56:59], a[80:83], v[104:107]
    ds_read_b64_tr_b16 a[36:37], v23 offset:8192
    v_mfma_f32_16x16x32_bf16 v[108:111], a[60:63], a[80:83], v[108:111]
    ds_read_b64_tr_b16 a[38:39], v23 offset:8704
    v_mfma_f32_16x16x32_bf16 v[112:115], a[48:51], a[84:87], v[112:115]
    s_add_u32 m0, s55, 16384
    v_mfma_f32_16x16x32_bf16 v[116:119], a[52:55], a[84:87], v[116:119]
    buffer_load_dwordx4 v6, s[12:15], s53 offen offset:0 lds
    v_mfma_f32_16x16x32_bf16 v[120:123], a[56:59], a[84:87], v[120:123]
    v_mfma_f32_16x16x32_bf16 v[124:127], a[60:63], a[84:87], v[124:127]
    s_waitcnt lgkmcnt(0)
    v_mfma_f32_16x16x32_bf16 v[32:35], a[16:19], a[0:3], v[32:35]
    ds_read_b64_tr_b16 a[64:65], v19 offset:61440
    v_mfma_f32_16x16x32_bf16 v[36:39], a[16:19], a[4:7], v[36:39]
    ds_read_b64_tr_b16 a[66:67], v19 offset:61952
    v_mfma_f32_16x16x32_bf16 v[40:43], a[16:19], a[8:11], v[40:43]
    buffer_load_dwordx4 v7, s[12:15], s53 offen offset:1024 lds
    v_mfma_f32_16x16x32_bf16 v[44:47], a[16:19], a[12:15], v[44:47]
    ds_read_b128 a[48:51], v16 offset:40960
    v_mfma_f32_16x16x32_bf16 v[48:51], a[20:23], a[0:3], v[48:51]
    ds_read_b128 a[52:55], v16 offset:43008
    v_mfma_f32_16x16x32_bf16 v[52:55], a[20:23], a[4:7], v[52:55]
    ds_read_b128 a[56:59], v16 offset:45056
    v_mfma_f32_16x16x32_bf16 v[56:59], a[20:23], a[8:11], v[56:59]
    ds_read_b128 a[60:63], v16 offset:47104
    v_mfma_f32_16x16x32_bf16 v[60:63], a[20:23], a[12:15], v[60:63]
    buffer_load_dwordx4 v8, s[12:15], s53 offen offset:2048 lds
    v_mfma_f32_16x16x32_bf16 v[64:67], a[24:27], a[0:3], v[64:67]
    ds_read_b64_tr_b16 a[68:69], v22 offset:61440
    v_mfma_f32_16x16x32_bf16 v[68:71], a[24:27], a[4:7], v[68:71]
    ds_read_b64_tr_b16 a[70:71], v22 offset:61952
    v_mfma_f32_16x16x32_bf16 v[72:75], a[24:27], a[8:11], v[72:75]
    ds_read_b64_tr_b16 a[72:73], v20 offset:4096
    v_mfma_f32_16x16x32_bf16 v[76:79], a[24:27], a[12:15], v[76:79]
    ds_read_b64_tr_b16 a[74:75], v20 offset:4608
    v_mfma_f32_16x16x32_bf16 v[80:83], a[28:31], a[0:3], v[80:83]
    buffer_load_dwordx4 v9, s[12:15], s53 offen offset:3072 lds
    v_mfma_f32_16x16x32_bf16 v[84:87], a[28:31], a[4:7], v[84:87]
    ds_read_b64_tr_b16 a[76:77], v23 offset:4096
    v_mfma_f32_16x16x32_bf16 v[88:91], a[28:31], a[8:11], v[88:91]
    ds_read_b64_tr_b16 a[78:79], v23 offset:4608
    v_mfma_f32_16x16x32_bf16 v[92:95], a[28:31], a[12:15], v[92:95]
    ds_read_b64_tr_b16 a[80:81], v20 offset:12288
    s_add_u32 m0, s55, 20480
    v_mfma_f32_16x16x32_bf16 v[96:99], a[0:3], a[32:35], v[96:99]
    buffer_load_dwordx4 v10, s[12:15], s53 offen offset:0 lds
    v_mfma_f32_16x16x32_bf16 v[100:103], a[4:7], a[32:35], v[100:103]
    ds_read_b64_tr_b16 a[82:83], v20 offset:12800
    v_mfma_f32_16x16x32_bf16 v[104:107], a[8:11], a[32:35], v[104:107]
    ds_read_b64_tr_b16 a[84:85], v23 offset:12288
    v_mfma_f32_16x16x32_bf16 v[108:111], a[12:15], a[32:35], v[108:111]
    ds_read_b64_tr_b16 a[86:87], v23 offset:12800
    v_mfma_f32_16x16x32_bf16 v[112:115], a[0:3], a[36:39], v[112:115]
    v_mfma_f32_16x16x32_bf16 v[116:119], a[4:7], a[36:39], v[116:119]
    buffer_load_dwordx4 v11, s[12:15], s53 offen offset:1024 lds
    s_mul_i32 s53, s89, 393216
    v_mfma_f32_16x16x32_bf16 v[120:123], a[8:11], a[36:39], v[120:123]
    v_mfma_f32_16x16x32_bf16 v[124:127], a[12:15], a[36:39], v[124:127]
    s_waitcnt vmcnt(22) lgkmcnt(0)
    s_barrier
    v_mfma_f32_16x16x32_bf16 v[32:35], a[64:67], a[48:51], v[32:35]
    ds_read_b64_tr_b16 a[16:17], v20 offset:32768
    v_mfma_f32_16x16x32_bf16 v[36:39], a[64:67], a[52:55], v[36:39]
    ds_read_b64_tr_b16 a[18:19], v20 offset:33280
    s_add_u32 m0, s54, 40960
    v_mfma_f32_16x16x32_bf16 v[40:43], a[64:67], a[56:59], v[40:43]
    buffer_load_dwordx4 v2, s[8:11], s52 offen offset:0 lds
    s_add_u32 s88, s88, 1
    v_mfma_f32_16x16x32_bf16 v[44:47], a[64:67], a[60:63], v[44:47]
    ds_read_b128 a[0:3], v14 offset:16384
    s_add_u32 s89, s88, s101
    v_mfma_f32_16x16x32_bf16 v[48:51], a[68:71], a[48:51], v[48:51]
    ds_read_b128 a[4:7], v14 offset:18432
    v_mfma_f32_16x16x32_bf16 v[52:55], a[68:71], a[52:55], v[52:55]
    ds_read_b128 a[8:11], v14 offset:20480
    v_mfma_f32_16x16x32_bf16 v[56:59], a[68:71], a[56:59], v[56:59]
    ds_read_b128 a[12:15], v14 offset:22528
    v_mfma_f32_16x16x32_bf16 v[60:63], a[68:71], a[60:63], v[60:63]
    buffer_load_dwordx4 v3, s[8:11], s52 offen offset:1024 lds
    s_and_b32 s89, s89, 3
    v_mfma_f32_16x16x32_bf16 v[64:67], a[72:75], a[48:51], v[64:67]
    ds_read_b64_tr_b16 a[20:21], v23 offset:32768
    s_andn2_b32 s90, s88, 3
    v_mfma_f32_16x16x32_bf16 v[68:71], a[72:75], a[52:55], v[68:71]
    ds_read_b64_tr_b16 a[22:23], v23 offset:33280
    v_mfma_f32_16x16x32_bf16 v[72:75], a[72:75], a[56:59], v[72:75]
    ds_read_b64_tr_b16 a[24:25], v20 offset:40960
    v_mfma_f32_16x16x32_bf16 v[76:79], a[72:75], a[60:63], v[76:79]
    ds_read_b64_tr_b16 a[26:27], v20 offset:41472
    v_mfma_f32_16x16x32_bf16 v[80:83], a[76:79], a[48:51], v[80:83]
    buffer_load_dwordx4 v4, s[8:11], s52 offen offset:2048 lds
    s_or_b32 s89, s89, s90
    v_mfma_f32_16x16x32_bf16 v[84:87], a[76:79], a[52:55], v[84:87]
    ds_read_b64_tr_b16 a[28:29], v23 offset:40960
    v_mfma_f32_16x16x32_bf16 v[88:91], a[76:79], a[56:59], v[88:91]
    ds_read_b64_tr_b16 a[30:31], v23 offset:41472
    v_mfma_f32_16x16x32_bf16 v[92:95], a[76:79], a[60:63], v[92:95]
    ds_read_b64_tr_b16 a[32:33], v20 offset:49152
    v_mfma_f32_16x16x32_bf16 v[96:99], a[48:51], a[80:83], v[96:99]
    buffer_load_dwordx4 v5, s[8:11], s52 offen offset:3072 lds
    s_lshl_b32 s52, s89, 7
    v_mfma_f32_16x16x32_bf16 v[100:103], a[52:55], a[80:83], v[100:103]
    ds_read_b64_tr_b16 a[34:35], v20 offset:49664
    v_mfma_f32_16x16x32_bf16 v[104:107], a[56:59], a[80:83], v[104:107]
    ds_read_b64_tr_b16 a[36:37], v23 offset:49152
    v_mfma_f32_16x16x32_bf16 v[108:111], a[60:63], a[80:83], v[108:111]
    ds_read_b64_tr_b16 a[38:39], v23 offset:49664
    v_mfma_f32_16x16x32_bf16 v[112:115], a[48:51], a[84:87], v[112:115]
    s_add_u32 m0, s55, 57344
    v_mfma_f32_16x16x32_bf16 v[116:119], a[52:55], a[84:87], v[116:119]
    buffer_load_dwordx4 v6, s[12:15], s53 offen offset:0 lds
    v_mfma_f32_16x16x32_bf16 v[120:123], a[56:59], a[84:87], v[120:123]
    v_mfma_f32_16x16x32_bf16 v[124:127], a[60:63], a[84:87], v[124:127]
    s_waitcnt lgkmcnt(0)
    v_mfma_f32_16x16x32_bf16 v[32:35], a[16:19], a[0:3], v[32:35]
    ds_read_b64_tr_b16 a[64:65], v20 offset:36864
    v_mfma_f32_16x16x32_bf16 v[36:39], a[16:19], a[4:7], v[36:39]
    ds_read_b64_tr_b16 a[66:67], v20 offset:37376
    v_mfma_f32_16x16x32_bf16 v[40:43], a[16:19], a[8:11], v[40:43]
    buffer_load_dwordx4 v7, s[12:15], s53 offen offset:1024 lds
    v_mfma_f32_16x16x32_bf16 v[44:47], a[16:19], a[12:15], v[44:47]
    ds_read_b128 a[48:51], v17 offset:16384
    v_mfma_f32_16x16x32_bf16 v[48:51], a[20:23], a[0:3], v[48:51]
    ds_read_b128 a[52:55], v17 offset:18432
    v_mfma_f32_16x16x32_bf16 v[52:55], a[20:23], a[4:7], v[52:55]
    ds_read_b128 a[56:59], v17 offset:20480
    v_mfma_f32_16x16x32_bf16 v[56:59], a[20:23], a[8:11], v[56:59]
    ds_read_b128 a[60:63], v17 offset:22528
    v_mfma_f32_16x16x32_bf16 v[60:63], a[20:23], a[12:15], v[60:63]
    buffer_load_dwordx4 v8, s[12:15], s53 offen offset:2048 lds
    v_mfma_f32_16x16x32_bf16 v[64:67], a[24:27], a[0:3], v[64:67]
    ds_read_b64_tr_b16 a[68:69], v23 offset:36864
    v_mfma_f32_16x16x32_bf16 v[68:71], a[24:27], a[4:7], v[68:71]
    ds_read_b64_tr_b16 a[70:71], v23 offset:37376
    v_mfma_f32_16x16x32_bf16 v[72:75], a[24:27], a[8:11], v[72:75]
    ds_read_b64_tr_b16 a[72:73], v20 offset:45056
    v_mfma_f32_16x16x32_bf16 v[76:79], a[24:27], a[12:15], v[76:79]
    ds_read_b64_tr_b16 a[74:75], v20 offset:45568
    v_mfma_f32_16x16x32_bf16 v[80:83], a[28:31], a[0:3], v[80:83]
    buffer_load_dwordx4 v9, s[12:15], s53 offen offset:3072 lds
    v_mfma_f32_16x16x32_bf16 v[84:87], a[28:31], a[4:7], v[84:87]
    ds_read_b64_tr_b16 a[76:77], v23 offset:45056
    v_mfma_f32_16x16x32_bf16 v[88:91], a[28:31], a[8:11], v[88:91]
    ds_read_b64_tr_b16 a[78:79], v23 offset:45568
    v_mfma_f32_16x16x32_bf16 v[92:95], a[28:31], a[12:15], v[92:95]
    ds_read_b64_tr_b16 a[80:81], v20 offset:53248
    s_add_u32 m0, s55, 61440
    v_mfma_f32_16x16x32_bf16 v[96:99], a[0:3], a[32:35], v[96:99]
    buffer_load_dwordx4 v10, s[12:15], s53 offen offset:0 lds
    v_mfma_f32_16x16x32_bf16 v[100:103], a[4:7], a[32:35], v[100:103]
    ds_read_b64_tr_b16 a[82:83], v20 offset:53760
    v_mfma_f32_16x16x32_bf16 v[104:107], a[8:11], a[32:35], v[104:107]
    ds_read_b64_tr_b16 a[84:85], v23 offset:53248
    v_mfma_f32_16x16x32_bf16 v[108:111], a[12:15], a[32:35], v[108:111]
    ds_read_b64_tr_b16 a[86:87], v23 offset:53760
    v_mfma_f32_16x16x32_bf16 v[112:115], a[0:3], a[36:39], v[112:115]
    v_mfma_f32_16x16x32_bf16 v[116:119], a[4:7], a[36:39], v[116:119]
    buffer_load_dwordx4 v11, s[12:15], s53 offen offset:1024 lds
    s_mul_i32 s53, s89, 393216
    v_mfma_f32_16x16x32_bf16 v[120:123], a[8:11], a[36:39], v[120:123]
    v_mfma_f32_16x16x32_bf16 v[124:127], a[12:15], a[36:39], v[124:127]
    s_waitcnt vmcnt(22) lgkmcnt(0)
    s_barrier
    s_lshl_b32 s62, s100, 12
    buffer_load_dword v242, v241, s[8:11], s62 offen offset:1536
    s_mul_i32 s62, s100, 768
    s_add_u32 s62, s62, 4718592
    buffer_load_dword v242, v243, s[12:15], s62 offen
    v_mfma_f32_16x16x32_bf16 v[32:35], a[64:67], a[48:51], v[32:35]
    ds_read_b64_tr_b16 a[16:17], v21 offset:8192
    v_mfma_f32_16x16x32_bf16 v[36:39], a[64:67], a[52:55], v[36:39]
    ds_read_b64_tr_b16 a[18:19], v21 offset:8704
    s_add_u32 m0, s54, 81920
    v_mfma_f32_16x16x32_bf16 v[40:43], a[64:67], a[56:59], v[40:43]
    buffer_load_dwordx4 v2, s[8:11], s52 offen offset:0 lds
    s_add_u32 s88, s88, 1
    v_mfma_f32_16x16x32_bf16 v[44:47], a[64:67], a[60:63], v[44:47]
    ds_read_b128 a[0:3], v14 offset:57344
    s_add_u32 s89, s88, s101
    v_mfma_f32_16x16x32_bf16 v[48:51], a[68:71], a[48:51], v[48:51]
    ds_read_b128 a[4:7], v14 offset:59392
    v_mfma_f32_16x16x32_bf16 v[52:55], a[68:71], a[52:55], v[52:55]
    ds_read_b128 a[8:11], v14 offset:61440
    v_mfma_f32_16x16x32_bf16 v[56:59], a[68:71], a[56:59], v[56:59]
    ds_read_b128 a[12:15], v14 offset:63488
    v_mfma_f32_16x16x32_bf16 v[60:63], a[68:71], a[60:63], v[60:63]
    buffer_load_dwordx4 v3, s[8:11], s52 offen offset:1024 lds
    s_and_b32 s89, s89, 3
    v_mfma_f32_16x16x32_bf16 v[64:67], a[72:75], a[48:51], v[64:67]
    ds_read_b64_tr_b16 a[20:21], v24 offset:8192
    s_andn2_b32 s90, s88, 3
    v_mfma_f32_16x16x32_bf16 v[68:71], a[72:75], a[52:55], v[68:71]
    ds_read_b64_tr_b16 a[22:23], v24 offset:8704
    v_mfma_f32_16x16x32_bf16 v[72:75], a[72:75], a[56:59], v[72:75]
    ds_read_b64_tr_b16 a[24:25], v21 offset:16384
    v_mfma_f32_16x16x32_bf16 v[76:79], a[72:75], a[60:63], v[76:79]
    ds_read_b64_tr_b16 a[26:27], v21 offset:16896
    v_mfma_f32_16x16x32_bf16 v[80:83], a[76:79], a[48:51], v[80:83]
    buffer_load_dwordx4 v4, s[8:11], s52 offen offset:2048 lds
    s_or_b32 s89, s89, s90
    v_mfma_f32_16x16x32_bf16 v[84:87], a[76:79], a[52:55], v[84:87]
    ds_read_b64_tr_b16 a[28:29], v24 offset:16384
    v_mfma_f32_16x16x32_bf16 v[88:91], a[76:79], a[56:59], v[88:91]
    ds_read_b64_tr_b16 a[30:31], v24 offset:16896
    v_mfma_f32_16x16x32_bf16 v[92:95], a[76:79], a[60:63], v[92:95]
    ds_read_b64_tr_b16 a[32:33], v21 offset:24576
    v_mfma_f32_16x16x32_bf16 v[96:99], a[48:51], a[80:83], v[96:99]
    buffer_load_dwordx4 v5, s[8:11], s52 offen offset:3072 lds
    s_lshl_b32 s52, s89, 7
    v_mfma_f32_16x16x32_bf16 v[100:103], a[52:55], a[80:83], v[100:103]
    ds_read_b64_tr_b16 a[34:35], v21 offset:25088
    v_mfma_f32_16x16x32_bf16 v[104:107], a[56:59], a[80:83], v[104:107]
    ds_read_b64_tr_b16 a[36:37], v24 offset:24576
    v_mfma_f32_16x16x32_bf16 v[108:111], a[60:63], a[80:83], v[108:111]
    ds_read_b64_tr_b16 a[38:39], v24 offset:25088
    v_mfma_f32_16x16x32_bf16 v[112:115], a[48:51], a[84:87], v[112:115]
    s_add_u32 m0, s55, 98304
    v_mfma_f32_16x16x32_bf16 v[116:119], a[52:55], a[84:87], v[116:119]
    buffer_load_dwordx4 v6, s[12:15], s53 offen offset:0 lds
    v_mfma_f32_16x16x32_bf16 v[120:123], a[56:59], a[84:87], v[120:123]
    v_mfma_f32_16x16x32_bf16 v[124:127], a[60:63], a[84:87], v[124:127]
    s_waitcnt lgkmcnt(0)
    s_mul_i32 s66, s100, 1792
    s_add_u32 s66, s66, 0
    buffer_load_dword v242, v240, s[16:19], s66 offen
    v_mfma_f32_16x16x32_bf16 v[32:35], a[16:19], a[0:3], v[32:35]
    ds_read_b64_tr_b16 a[64:65], v21 offset:12288
    v_mfma_f32_16x16x32_bf16 v[36:39], a[16:19], a[4:7], v[36:39]
    ds_read_b64_tr_b16 a[66:67], v21 offset:12800
    v_mfma_f32_16x16x32_bf16 v[40:43], a[16:19], a[8:11], v[40:43]
    buffer_load_dwordx4 v7, s[12:15], s53 offen offset:1024 lds
    v_mfma_f32_16x16x32_bf16 v[44:47], a[16:19], a[12:15], v[44:47]
    ds_read_b128 a[48:51], v17 offset:57344
    v_mfma_f32_16x16x32_bf16 v[48:51], a[20:23], a[0:3], v[48:51]
    ds_read_b128 a[52:55], v17 offset:59392
    v_mfma_f32_16x16x32_bf16 v[52:55], a[20:23], a[4:7], v[52:55]
    ds_read_b128 a[56:59], v17 offset:61440
    v_mfma_f32_16x16x32_bf16 v[56:59], a[20:23], a[8:11], v[56:59]
    ds_read_b128 a[60:63], v17 offset:63488
    v_mfma_f32_16x16x32_bf16 v[60:63], a[20:23], a[12:15], v[60:63]
    buffer_load_dwordx4 v8, s[12:15], s53 offen offset:2048 lds
    v_mfma_f32_16x16x32_bf16 v[64:67], a[24:27], a[0:3], v[64:67]
    ds_read_b64_tr_b16 a[68:69], v24 offset:12288
    v_mfma_f32_16x16x32_bf16 v[68:71], a[24:27], a[4:7], v[68:71]
    ds_read_b64_tr_b16 a[70:71], v24 offset:12800
    v_mfma_f32_16x16x32_bf16 v[72:75], a[24:27], a[8:11], v[72:75]
    ds_read_b64_tr_b16 a[72:73], v21 offset:20480
    v_mfma_f32_16x16x32_bf16 v[76:79], a[24:27], a[12:15], v[76:79]
    ds_read_b64_tr_b16 a[74:75], v21 offset:20992
    v_mfma_f32_16x16x32_bf16 v[80:83], a[28:31], a[0:3], v[80:83]
    buffer_load_dwordx4 v9, s[12:15], s53 offen offset:3072 lds
    v_mfma_f32_16x16x32_bf16 v[84:87], a[28:31], a[4:7], v[84:87]
    ds_read_b64_tr_b16 a[76:77], v24 offset:20480
    v_mfma_f32_16x16x32_bf16 v[88:91], a[28:31], a[8:11], v[88:91]
    ds_read_b64_tr_b16 a[78:79], v24 offset:20992
    v_mfma_f32_16x16x32_bf16 v[92:95], a[28:31], a[12:15], v[92:95]
    ds_read_b64_tr_b16 a[80:81], v21 offset:28672
    s_add_u32 m0, s55, 102400
    v_mfma_f32_16x16x32_bf16 v[96:99], a[0:3], a[32:35], v[96:99]
    buffer_load_dwordx4 v10, s[12:15], s53 offen offset:0 lds
    v_mfma_f32_16x16x32_bf16 v[100:103], a[4:7], a[32:35], v[100:103]
    ds_read_b64_tr_b16 a[82:83], v21 offset:29184
    v_mfma_f32_16x16x32_bf16 v[104:107], a[8:11], a[32:35], v[104:107]
    ds_read_b64_tr_b16 a[84:85], v24 offset:28672
    v_mfma_f32_16x16x32_bf16 v[108:111], a[12:15], a[32:35], v[108:111]
    ds_read_b64_tr_b16 a[86:87], v24 offset:29184
    v_mfma_f32_16x16x32_bf16 v[112:115], a[0:3], a[36:39], v[112:115]
    v_mfma_f32_16x16x32_bf16 v[116:119], a[4:7], a[36:39], v[116:119]
    buffer_load_dwordx4 v11, s[12:15], s53 offen offset:1024 lds
    s_mul_i32 s53, s89, 393216
    v_mfma_f32_16x16x32_bf16 v[120:123], a[8:11], a[36:39], v[120:123]
    v_mfma_f32_16x16x32_bf16 v[124:127], a[12:15], a[36:39], v[124:127]
    s_waitcnt vmcnt(23) lgkmcnt(0)
    s_barrier
    v_mfma_f32_16x16x32_bf16 v[32:35], a[64:67], a[48:51], v[32:35]
    ds_read_b64_tr_b16 a[16:17], v19 offset:16384
    v_mfma_f32_16x16x32_bf16 v[36:39], a[64:67], a[52:55], v[36:39]
    ds_read_b64_tr_b16 a[18:19], v19 offset:16896
    s_add_u32 m0, s54, 122880
    v_mfma_f32_16x16x32_bf16 v[40:43], a[64:67], a[56:59], v[40:43]
    buffer_load_dwordx4 v2, s[8:11], s52 offen offset:0 lds
    s_add_u32 s88, s88, 1
    v_mfma_f32_16x16x32_bf16 v[44:47], a[64:67], a[60:63], v[44:47]
    ds_read_b128 a[0:3], v13 offset:0
    s_add_u32 s89, s88, s101
    v_mfma_f32_16x16x32_bf16 v[48:51], a[68:71], a[48:51], v[48:51]
    ds_read_b128 a[4:7], v13 offset:2048
    v_mfma_f32_16x16x32_bf16 v[52:55], a[68:71], a[52:55], v[52:55]
    ds_read_b128 a[8:11], v13 offset:4096
    v_mfma_f32_16x16x32_bf16 v[56:59], a[68:71], a[56:59], v[56:59]
    ds_read_b128 a[12:15], v13 offset:6144
    v_mfma_f32_16x16x32_bf16 v[60:63], a[68:71], a[60:63], v[60:63]
    buffer_load_dwordx4 v3, s[8:11], s52 offen offset:1024 lds
    s_and_b32 s89, s89, 3
    v_mfma_f32_16x16x32_bf16 v[64:67], a[72:75], a[48:51], v[64:67]
    ds_read_b64_tr_b16 a[20:21], v22 offset:16384
    s_andn2_b32 s90, s88, 3
    v_mfma_f32_16x16x32_bf16 v[68:71], a[72:75], a[52:55], v[68:71]
    ds_read_b64_tr_b16 a[22:23], v22 offset:16896
    v_mfma_f32_16x16x32_bf16 v[72:75], a[72:75], a[56:59], v[72:75]
    ds_read_b64_tr_b16 a[24:25], v19 offset:24576
    v_mfma_f32_16x16x32_bf16 v[76:79], a[72:75], a[60:63], v[76:79]
    ds_read_b64_tr_b16 a[26:27], v19 offset:25088
    v_mfma_f32_16x16x32_bf16 v[80:83], a[76:79], a[48:51], v[80:83]
    buffer_load_dwordx4 v4, s[8:11], s52 offen offset:2048 lds
    s_or_b32 s89, s89, s90
    v_mfma_f32_16x16x32_bf16 v[84:87], a[76:79], a[52:55], v[84:87]
    ds_read_b64_tr_b16 a[28:29], v22 offset:24576
    v_mfma_f32_16x16x32_bf16 v[88:91], a[76:79], a[56:59], v[88:91]
    ds_read_b64_tr_b16 a[30:31], v22 offset:25088
    v_mfma_f32_16x16x32_bf16 v[92:95], a[76:79], a[60:63], v[92:95]
    ds_read_b64_tr_b16 a[32:33], v19 offset:32768
    v_mfma_f32_16x16x32_bf16 v[96:99], a[48:51], a[80:83], v[96:99]
    buffer_load_dwordx4 v5, s[8:11], s52 offen offset:3072 lds
    s_lshl_b32 s52, s89, 7
    v_mfma_f32_16x16x32_bf16 v[100:103], a[52:55], a[80:83], v[100:103]
    ds_read_b64_tr_b16 a[34:35], v19 offset:33280
    v_mfma_f32_16x16x32_bf16 v[104:107], a[56:59], a[80:83], v[104:107]
    ds_read_b64_tr_b16 a[36:37], v22 offset:32768
    v_mfma_f32_16x16x32_bf16 v[108:111], a[60:63], a[80:83], v[108:111]
    ds_read_b64_tr_b16 a[38:39], v22 offset:33280
    v_mfma_f32_16x16x32_bf16 v[112:115], a[48:51], a[84:87], v[112:115]
    s_add_u32 m0, s55, 139264
    v_mfma_f32_16x16x32_bf16 v[116:119], a[52:55], a[84:87], v[116:119]
    buffer_load_dwordx4 v6, s[12:15], s53 offen offset:0 lds
    v_mfma_f32_16x16x32_bf16 v[120:123], a[56:59], a[84:87], v[120:123]
    v_mfma_f32_16x16x32_bf16 v[124:127], a[60:63], a[84:87], v[124:127]
    s_waitcnt lgkmcnt(0)
    v_mfma_f32_16x16x32_bf16 v[32:35], a[16:19], a[0:3], v[32:35]
    ds_read_b64_tr_b16 a[64:65], v19 offset:20480
    v_mfma_f32_16x16x32_bf16 v[36:39], a[16:19], a[4:7], v[36:39]
    ds_read_b64_tr_b16 a[66:67], v19 offset:20992
    v_mfma_f32_16x16x32_bf16 v[40:43], a[16:19], a[8:11], v[40:43]
    buffer_load_dwordx4 v7, s[12:15], s53 offen offset:1024 lds
    v_mfma_f32_16x16x32_bf16 v[44:47], a[16:19], a[12:15], v[44:47]
    ds_read_b128 a[48:51], v16 offset:0
    v_mfma_f32_16x16x32_bf16 v[48:51], a[20:23], a[0:3], v[48:51]
    ds_read_b128 a[52:55], v16 offset:2048
    v_mfma_f32_16x16x32_bf16 v[52:55], a[20:23], a[4:7], v[52:55]
    ds_read_b128 a[56:59], v16 offset:4096
    v_mfma_f32_16x16x32_bf16 v[56:59], a[20:23], a[8:11], v[56:59]
    ds_read_b128 a[60:63], v16 offset:6144
    v_mfma_f32_16x16x32_bf16 v[60:63], a[20:23], a[12:15], v[60:63]
    buffer_load_dwordx4 v8, s[12:15], s53 offen offset:2048 lds
    v_mfma_f32_16x16x32_bf16 v[64:67], a[24:27], a[0:3], v[64:67]
    ds_read_b64_tr_b16 a[68:69], v22 offset:20480
    v_mfma_f32_16x16x32_bf16 v[68:71], a[24:27], a[4:7], v[68:71]
    ds_read_b64_tr_b16 a[70:71], v22 offset:20992
    v_mfma_f32_16x16x32_bf16 v[72:75], a[24:27], a[8:11], v[72:75]
    ds_read_b64_tr_b16 a[72:73], v19 offset:28672
    v_mfma_f32_16x16x32_bf16 v[76:79], a[24:27], a[12:15], v[76:79]
    ds_read_b64_tr_b16 a[74:75], v19 offset:29184
    v_mfma_f32_16x16x32_bf16 v[80:83], a[28:31], a[0:3], v[80:83]
    buffer_load_dwordx4 v9, s[12:15], s53 offen offset:3072 lds
    v_mfma_f32_16x16x32_bf16 v[84:87], a[28:31], a[4:7], v[84:87]
    ds_read_b64_tr_b16 a[76:77], v22 offset:28672
    v_mfma_f32_16x16x32_bf16 v[88:91], a[28:31], a[8:11], v[88:91]
    ds_read_b64_tr_b16 a[78:79], v22 offset:29184
    v_mfma_f32_16x16x32_bf16 v[92:95], a[28:31], a[12:15], v[92:95]
    ds_read_b64_tr_b16 a[80:81], v19 offset:36864
    s_add_u32 m0, s55, 143360
    v_mfma_f32_16x16x32_bf16 v[96:99], a[0:3], a[32:35], v[96:99]
    buffer_load_dwordx4 v10, s[12:15], s53 offen offset:0 lds
    v_mfma_f32_16x16x32_bf16 v[100:103], a[4:7], a[32:35], v[100:103]
    ds_read_b64_tr_b16 a[82:83], v19 offset:37376
    v_mfma_f32_16x16x32_bf16 v[104:107], a[8:11], a[32:35], v[104:107]
    ds_read_b64_tr_b16 a[84:85], v22 offset:36864
    v_mfma_f32_16x16x32_bf16 v[108:111], a[12:15], a[32:35], v[108:111]
    ds_read_b64_tr_b16 a[86:87], v22 offset:37376
    v_mfma_f32_16x16x32_bf16 v[112:115], a[0:3], a[36:39], v[112:115]
    v_mfma_f32_16x16x32_bf16 v[116:119], a[4:7], a[36:39], v[116:119]
    buffer_load_dwordx4 v11, s[12:15], s53 offen offset:1024 lds
    s_mul_i32 s53, s89, 393216
    v_mfma_f32_16x16x32_bf16 v[120:123], a[8:11], a[36:39], v[120:123]
    v_mfma_f32_16x16x32_bf16 v[124:127], a[12:15], a[36:39], v[124:127]
    s_waitcnt vmcnt(23) lgkmcnt(0)
    s_barrier
    s_lshl_b32 s62, s100, 12
    buffer_load_dword v242, v241, s[8:11], s62 offen offset:1792
    s_mul_i32 s62, s100, 768
    s_add_u32 s62, s62, 5505024
    buffer_load_dword v242, v243, s[12:15], s62 offen
    v_mfma_f32_16x16x32_bf16 v[32:35], a[64:67], a[48:51], v[32:35]
    ds_read_b64_tr_b16 a[16:17], v19 offset:57344
    v_mfma_f32_16x16x32_bf16 v[36:39], a[64:67], a[52:55], v[36:39]
    ds_read_b64_tr_b16 a[18:19], v19 offset:57856
    s_add_u32 m0, s54, 0
    v_mfma_f32_16x16x32_bf16 v[40:43], a[64:67], a[56:59], v[40:43]
    buffer_load_dwordx4 v2, s[8:11], s52 offen offset:0 lds
    s_add_u32 s88, s88, 1
    v_mfma_f32_16x16x32_bf16 v[44:47], a[64:67], a[60:63], v[44:47]
    ds_read_b128 a[0:3], v13 offset:40960
    s_add_u32 s89, s88, s101
    v_mfma_f32_16x16x32_bf16 v[48:51], a[68:71], a[48:51], v[48:51]
    ds_read_b128 a[4:7], v13 offset:43008
    v_mfma_f32_16x16x32_bf16 v[52:55], a[68:71], a[52:55], v[52:55]
    ds_read_b128 a[8:11], v13 offset:45056
    v_mfma_f32_16x16x32_bf16 v[56:59], a[68:71], a[56:59], v[56:59]
    ds_read_b128 a[12:15], v13 offset:47104
    v_mfma_f32_16x16x32_bf16 v[60:63], a[68:71], a[60:63], v[60:63]
    buffer_load_dwordx4 v3, s[8:11], s52 offen offset:1024 lds
    s_and_b32 s89, s89, 3
    v_mfma_f32_16x16x32_bf16 v[64:67], a[72:75], a[48:51], v[64:67]
    ds_read_b64_tr_b16 a[20:21], v22 offset:57344
    s_andn2_b32 s90, s88, 3
    v_mfma_f32_16x16x32_bf16 v[68:71], a[72:75], a[52:55], v[68:71]
    ds_read_b64_tr_b16 a[22:23], v22 offset:57856
    v_mfma_f32_16x16x32_bf16 v[72:75], a[72:75], a[56:59], v[72:75]
    ds_read_b64_tr_b16 a[24:25], v20 offset:0
    v_mfma_f32_16x16x32_bf16 v[76:79], a[72:75], a[60:63], v[76:79]
    ds_read_b64_tr_b16 a[26:27], v20 offset:512
    v_mfma_f32_16x16x32_bf16 v[80:83], a[76:79], a[48:51], v[80:83]
    buffer_load_dwordx4 v4, s[8:11], s52 offen offset:2048 lds
    s_or_b32 s89, s89, s90
    v_mfma_f32_16x16x32_bf16 v[84:87], a[76:79], a[52:55], v[84:87]
    ds_read_b64_tr_b16 a[28:29], v23 offset:0
    v_mfma_f32_16x16x32_bf16 v[88:91], a[76:79], a[56:59], v[88:91]
    ds_read_b64_tr_b16 a[30:31], v23 offset:512
    v_mfma_f32_16x16x32_bf16 v[92:95], a[76:79], a[60:63], v[92:95]
    ds_read_b64_tr_b16 a[32:33], v20 offset:8192
    v_mfma_f32_16x16x32_bf16 v[96:99], a[48:51], a[80:83], v[96:99]
    buffer_load_dwordx4 v5, s[8:11], s52 offen offset:3072 lds
    s_lshl_b32 s52, s89, 7
    v_mfma_f32_16x16x32_bf16 v[100:103], a[52:55], a[80:83], v[100:103]
    ds_read_b64_tr_b16 a[34:35], v20 offset:8704
    v_mfma_f32_16x16x32_bf16 v[104:107], a[56:59], a[80:83], v[104:107]
    ds_read_b64_tr_b16 a[36:37], v23 offset:8192
    v_mfma_f32_16x16x32_bf16 v[108:111], a[60:63], a[80:83], v[108:111]
    ds_read_b64_tr_b16 a[38:39], v23 offset:8704
    v_mfma_f32_16x16x32_bf16 v[112:115], a[48:51], a[84:87], v[112:115]
    s_add_u32 m0, s55, 16384
    v_mfma_f32_16x16x32_bf16 v[116:119], a[52:55], a[84:87], v[116:119]
    buffer_load_dwordx4 v6, s[12:15], s53 offen offset:0 lds
    v_mfma_f32_16x16x32_bf16 v[120:123], a[56:59], a[84:87], v[120:123]
    v_mfma_f32_16x16x32_bf16 v[124:127], a[60:63], a[84:87], v[124:127]
    s_waitcnt lgkmcnt(0)
    s_mul_i32 s66, s100, 1792
    s_add_u32 s66, s66, 1835008
    buffer_load_dword v242, v240, s[16:19], s66 offen
    v_mfma_f32_16x16x32_bf16 v[32:35], a[16:19], a[0:3], v[32:35]
    ds_read_b64_tr_b16 a[64:65], v19 offset:61440
    v_mfma_f32_16x16x32_bf16 v[36:39], a[16:19], a[4:7], v[36:39]
    ds_read_b64_tr_b16 a[66:67], v19 offset:61952
    v_mfma_f32_16x16x32_bf16 v[40:43], a[16:19], a[8:11], v[40:43]
    buffer_load_dwordx4 v7, s[12:15], s53 offen offset:1024 lds
    v_mfma_f32_16x16x32_bf16 v[44:47], a[16:19], a[12:15], v[44:47]
    ds_read_b128 a[48:51], v16 offset:40960
    v_mfma_f32_16x16x32_bf16 v[48:51], a[20:23], a[0:3], v[48:51]
    ds_read_b128 a[52:55], v16 offset:43008
    v_mfma_f32_16x16x32_bf16 v[52:55], a[20:23], a[4:7], v[52:55]
    ds_read_b128 a[56:59], v16 offset:45056
    v_mfma_f32_16x16x32_bf16 v[56:59], a[20:23], a[8:11], v[56:59]
    ds_read_b128 a[60:63], v16 offset:47104
    v_mfma_f32_16x16x32_bf16 v[60:63], a[20:23], a[12:15], v[60:63]
    buffer_load_dwordx4 v8, s[12:15], s53 offen offset:2048 lds
    v_mfma_f32_16x16x32_bf16 v[64:67], a[24:27], a[0:3], v[64:67]
    ds_read_b64_tr_b16 a[68:69], v22 offset:61440
    v_mfma_f32_16x16x32_bf16 v[68:71], a[24:27], a[4:7], v[68:71]
    ds_read_b64_tr_b16 a[70:71], v22 offset:61952
    v_mfma_f32_16x16x32_bf16 v[72:75], a[24:27], a[8:11], v[72:75]
    ds_read_b64_tr_b16 a[72:73], v20 offset:4096
    v_mfma_f32_16x16x32_bf16 v[76:79], a[24:27], a[12:15], v[76:79]
    ds_read_b64_tr_b16 a[74:75], v20 offset:4608
    v_mfma_f32_16x16x32_bf16 v[80:83], a[28:31], a[0:3], v[80:83]
    buffer_load_dwordx4 v9, s[12:15], s53 offen offset:3072 lds
    v_mfma_f32_16x16x32_bf16 v[84:87], a[28:31], a[4:7], v[84:87]
    ds_read_b64_tr_b16 a[76:77], v23 offset:4096
    v_mfma_f32_16x16x32_bf16 v[88:91], a[28:31], a[8:11], v[88:91]
    ds_read_b64_tr_b16 a[78:79], v23 offset:4608
    v_mfma_f32_16x16x32_bf16 v[92:95], a[28:31], a[12:15], v[92:95]
    ds_read_b64_tr_b16 a[80:81], v20 offset:12288
    s_add_u32 m0, s55, 20480
    v_mfma_f32_16x16x32_bf16 v[96:99], a[0:3], a[32:35], v[96:99]
    buffer_load_dwordx4 v10, s[12:15], s53 offen offset:0 lds
    v_mfma_f32_16x16x32_bf16 v[100:103], a[4:7], a[32:35], v[100:103]
    ds_read_b64_tr_b16 a[82:83], v20 offset:12800
    v_mfma_f32_16x16x32_bf16 v[104:107], a[8:11], a[32:35], v[104:107]
    ds_read_b64_tr_b16 a[84:85], v23 offset:12288
    v_mfma_f32_16x16x32_bf16 v[108:111], a[12:15], a[32:35], v[108:111]
    ds_read_b64_tr_b16 a[86:87], v23 offset:12800
    v_mfma_f32_16x16x32_bf16 v[112:115], a[0:3], a[36:39], v[112:115]
    v_mfma_f32_16x16x32_bf16 v[116:119], a[4:7], a[36:39], v[116:119]
    buffer_load_dwordx4 v11, s[12:15], s53 offen offset:1024 lds
    s_mul_i32 s53, s89, 393216
    v_mfma_f32_16x16x32_bf16 v[120:123], a[8:11], a[36:39], v[120:123]
    v_mfma_f32_16x16x32_bf16 v[124:127], a[12:15], a[36:39], v[124:127]
    s_waitcnt vmcnt(23) lgkmcnt(0)
    s_barrier
    v_mfma_f32_16x16x32_bf16 v[32:35], a[64:67], a[48:51], v[32:35]
    ds_read_b64_tr_b16 a[16:17], v20 offset:32768
    v_mfma_f32_16x16x32_bf16 v[36:39], a[64:67], a[52:55], v[36:39]
    ds_read_b64_tr_b16 a[18:19], v20 offset:33280
    s_add_u32 m0, s54, 40960
    v_mfma_f32_16x16x32_bf16 v[40:43], a[64:67], a[56:59], v[40:43]
    buffer_load_dwordx4 v2, s[8:11], s52 offen offset:0 lds
    s_add_u32 s88, s88, 1
    v_mfma_f32_16x16x32_bf16 v[44:47], a[64:67], a[60:63], v[44:47]
    ds_read_b128 a[0:3], v14 offset:16384
    s_add_u32 s89, s88, s101
    v_mfma_f32_16x16x32_bf16 v[48:51], a[68:71], a[48:51], v[48:51]
    ds_read_b128 a[4:7], v14 offset:18432
    v_mfma_f32_16x16x32_bf16 v[52:55], a[68:71], a[52:55], v[52:55]
    ds_read_b128 a[8:11], v14 offset:20480
    v_mfma_f32_16x16x32_bf16 v[56:59], a[68:71], a[56:59], v[56:59]
    ds_read_b128 a[12:15], v14 offset:22528
    v_mfma_f32_16x16x32_bf16 v[60:63], a[68:71], a[60:63], v[60:63]
    buffer_load_dwordx4 v3, s[8:11], s52 offen offset:1024 lds
    s_and_b32 s89, s89, 3
    v_mfma_f32_16x16x32_bf16 v[64:67], a[72:75], a[48:51], v[64:67]
    ds_read_b64_tr_b16 a[20:21], v23 offset:32768
    s_andn2_b32 s90, s88, 3
    v_mfma_f32_16x16x32_bf16 v[68:71], a[72:75], a[52:55], v[68:71]
    ds_read_b64_tr_b16 a[22:23], v23 offset:33280
    v_mfma_f32_16x16x32_bf16 v[72:75], a[72:75], a[56:59], v[72:75]
    ds_read_b64_tr_b16 a[24:25], v20 offset:40960
    v_mfma_f32_16x16x32_bf16 v[76:79], a[72:75], a[60:63], v[76:79]
    ds_read_b64_tr_b16 a[26:27], v20 offset:41472
    v_mfma_f32_16x16x32_bf16 v[80:83], a[76:79], a[48:51], v[80:83]
    buffer_load_dwordx4 v4, s[8:11], s52 offen offset:2048 lds
    s_or_b32 s89, s89, s90
    v_mfma_f32_16x16x32_bf16 v[84:87], a[76:79], a[52:55], v[84:87]
    ds_read_b64_tr_b16 a[28:29], v23 offset:40960
    v_mfma_f32_16x16x32_bf16 v[88:91], a[76:79], a[56:59], v[88:91]
    ds_read_b64_tr_b16 a[30:31], v23 offset:41472
    v_mfma_f32_16x16x32_bf16 v[92:95], a[76:79], a[60:63], v[92:95]
    ds_read_b64_tr_b16 a[32:33], v20 offset:49152
    v_mfma_f32_16x16x32_bf16 v[96:99], a[48:51], a[80:83], v[96:99]
    buffer_load_dwordx4 v5, s[8:11], s52 offen offset:3072 lds
    s_lshl_b32 s52, s89, 7
    v_mfma_f32_16x16x32_bf16 v[100:103], a[52:55], a[80:83], v[100:103]
    ds_read_b64_tr_b16 a[34:35], v20 offset:49664
    v_mfma_f32_16x16x32_bf16 v[104:107], a[56:59], a[80:83], v[104:107]
    ds_read_b64_tr_b16 a[36:37], v23 offset:49152
    v_mfma_f32_16x16x32_bf16 v[108:111], a[60:63], a[80:83], v[108:111]
    ds_read_b64_tr_b16 a[38:39], v23 offset:49664
    v_mfma_f32_16x16x32_bf16 v[112:115], a[48:51], a[84:87], v[112:115]
    s_add_u32 m0, s55, 57344
    v_mfma_f32_16x16x32_bf16 v[116:119], a[52:55], a[84:87], v[116:119]
    buffer_load_dwordx4 v6, s[12:15], s53 offen offset:0 lds
    v_mfma_f32_16x16x32_bf16 v[120:123], a[56:59], a[84:87], v[120:123]
    v_mfma_f32_16x16x32_bf16 v[124:127], a[60:63], a[84:87], v[124:127]
    s_waitcnt lgkmcnt(0)
    v_mfma_f32_16x16x32_bf16 v[32:35], a[16:19], a[0:3], v[32:35]
    ds_read_b64_tr_b16 a[64:65], v20 offset:36864
    v_mfma_f32_16x16x32_bf16 v[36:39], a[16:19], a[4:7], v[36:39]
    ds_read_b64_tr_b16 a[66:67], v20 offset:37376
    v_mfma_f32_16x16x32_bf16 v[40:43], a[16:19], a[8:11], v[40:43]
    buffer_load_dwordx4 v7, s[12:15], s53 offen offset:1024 lds
    v_mfma_f32_16x16x32_bf16 v[44:47], a[16:19], a[12:15], v[44:47]
    ds_read_b128 a[48:51], v17 offset:16384
    v_mfma_f32_16x16x32_bf16 v[48:51], a[20:23], a[0:3], v[48:51]
    ds_read_b128 a[52:55], v17 offset:18432
    v_mfma_f32_16x16x32_bf16 v[52:55], a[20:23], a[4:7], v[52:55]
    ds_read_b128 a[56:59], v17 offset:20480
    v_mfma_f32_16x16x32_bf16 v[56:59], a[20:23], a[8:11], v[56:59]
    ds_read_b128 a[60:63], v17 offset:22528
    v_mfma_f32_16x16x32_bf16 v[60:63], a[20:23], a[12:15], v[60:63]
    buffer_load_dwordx4 v8, s[12:15], s53 offen offset:2048 lds
    v_mfma_f32_16x16x32_bf16 v[64:67], a[24:27], a[0:3], v[64:67]
    ds_read_b64_tr_b16 a[68:69], v23 offset:36864
    v_mfma_f32_16x16x32_bf16 v[68:71], a[24:27], a[4:7], v[68:71]
    ds_read_b64_tr_b16 a[70:71], v23 offset:37376
    v_mfma_f32_16x16x32_bf16 v[72:75], a[24:27], a[8:11], v[72:75]
    ds_read_b64_tr_b16 a[72:73], v20 offset:45056
    v_mfma_f32_16x16x32_bf16 v[76:79], a[24:27], a[12:15], v[76:79]
    ds_read_b64_tr_b16 a[74:75], v20 offset:45568
    v_mfma_f32_16x16x32_bf16 v[80:83], a[28:31], a[0:3], v[80:83]
    buffer_load_dwordx4 v9, s[12:15], s53 offen offset:3072 lds
    v_mfma_f32_16x16x32_bf16 v[84:87], a[28:31], a[4:7], v[84:87]
    ds_read_b64_tr_b16 a[76:77], v23 offset:45056
    v_mfma_f32_16x16x32_bf16 v[88:91], a[28:31], a[8:11], v[88:91]
    ds_read_b64_tr_b16 a[78:79], v23 offset:45568
    v_mfma_f32_16x16x32_bf16 v[92:95], a[28:31], a[12:15], v[92:95]
    ds_read_b64_tr_b16 a[80:81], v20 offset:53248
    s_add_u32 m0, s55, 61440
    v_mfma_f32_16x16x32_bf16 v[96:99], a[0:3], a[32:35], v[96:99]
    buffer_load_dwordx4 v10, s[12:15], s53 offen offset:0 lds
    v_mfma_f32_16x16x32_bf16 v[100:103], a[4:7], a[32:35], v[100:103]
    ds_read_b64_tr_b16 a[82:83], v20 offset:53760
    v_mfma_f32_16x16x32_bf16 v[104:107], a[8:11], a[32:35], v[104:107]
    ds_read_b64_tr_b16 a[84:85], v23 offset:53248
    v_mfma_f32_16x16x32_bf16 v[108:111], a[12:15], a[32:35], v[108:111]
    ds_read_b64_tr_b16 a[86:87], v23 offset:53760
    v_mfma_f32_16x16x32_bf16 v[112:115], a[0:3], a[36:39], v[112:115]
    v_mfma_f32_16x16x32_bf16 v[116:119], a[4:7], a[36:39], v[116:119]
    buffer_load_dwordx4 v11, s[12:15], s53 offen offset:1024 lds
    s_mul_i32 s53, s89, 393216
    v_mfma_f32_16x16x32_bf16 v[120:123], a[8:11], a[36:39], v[120:123]
    v_mfma_f32_16x16x32_bf16 v[124:127], a[12:15], a[36:39], v[124:127]
    s_waitcnt vmcnt(23) lgkmcnt(0)
    s_barrier
    v_mfma_f32_16x16x32_bf16 v[32:35], a[64:67], a[48:51], v[32:35]
    ds_read_b64_tr_b16 a[16:17], v21 offset:8192
    v_mfma_f32_16x16x32_bf16 v[36:39], a[64:67], a[52:55], v[36:39]
    ds_read_b64_tr_b16 a[18:19], v21 offset:8704
    s_add_u32 m0, s54, 81920
    v_mfma_f32_16x16x32_bf16 v[40:43], a[64:67], a[56:59], v[40:43]
    buffer_load_dwordx4 v2, s[8:11], s52 offen offset:0 lds
    s_add_u32 s88, s88, 1
    v_mfma_f32_16x16x32_bf16 v[44:47], a[64:67], a[60:63], v[44:47]
    ds_read_b128 a[0:3], v14 offset:57344
    s_add_u32 s89, s88, s101
    v_mfma_f32_16x16x32_bf16 v[48:51], a[68:71], a[48:51], v[48:51]
    ds_read_b128 a[4:7], v14 offset:59392
    v_mfma_f32_16x16x32_bf16 v[52:55], a[68:71], a[52:55], v[52:55]
    ds_read_b128 a[8:11], v14 offset:61440
    v_mfma_f32_16x16x32_bf16 v[56:59], a[68:71], a[56:59], v[56:59]
    ds_read_b128 a[12:15], v14 offset:63488
    v_mfma_f32_16x16x32_bf16 v[60:63], a[68:71], a[60:63], v[60:63]
    buffer_load_dwordx4 v3, s[8:11], s52 offen offset:1024 lds
    s_and_b32 s89, s89, 3
    v_mfma_f32_16x16x32_bf16 v[64:67], a[72:75], a[48:51], v[64:67]
    ds_read_b64_tr_b16 a[20:21], v24 offset:8192
    s_andn2_b32 s90, s88, 3
    v_mfma_f32_16x16x32_bf16 v[68:71], a[72:75], a[52:55], v[68:71]
    ds_read_b64_tr_b16 a[22:23], v24 offset:8704
    v_mfma_f32_16x16x32_bf16 v[72:75], a[72:75], a[56:59], v[72:75]
    ds_read_b64_tr_b16 a[24:25], v21 offset:16384
    v_mfma_f32_16x16x32_bf16 v[76:79], a[72:75], a[60:63], v[76:79]
    ds_read_b64_tr_b16 a[26:27], v21 offset:16896
    v_mfma_f32_16x16x32_bf16 v[80:83], a[76:79], a[48:51], v[80:83]
    buffer_load_dwordx4 v4, s[8:11], s52 offen offset:2048 lds
    s_or_b32 s89, s89, s90
    v_mfma_f32_16x16x32_bf16 v[84:87], a[76:79], a[52:55], v[84:87]
    ds_read_b64_tr_b16 a[28:29], v24 offset:16384
    v_mfma_f32_16x16x32_bf16 v[88:91], a[76:79], a[56:59], v[88:91]
    ds_read_b64_tr_b16 a[30:31], v24 offset:16896
    v_mfma_f32_16x16x32_bf16 v[92:95], a[76:79], a[60:63], v[92:95]
    ds_read_b64_tr_b16 a[32:33], v21 offset:24576
    v_mfma_f32_16x16x32_bf16 v[96:99], a[48:51], a[80:83], v[96:99]
    buffer_load_dwordx4 v5, s[8:11], s52 offen offset:3072 lds
    s_lshl_b32 s52, s89, 7
    v_mfma_f32_16x16x32_bf16 v[100:103], a[52:55], a[80:83], v[100:103]
    ds_read_b64_tr_b16 a[34:35], v21 offset:25088
    v_mfma_f32_16x16x32_bf16 v[104:107], a[56:59], a[80:83], v[104:107]
    ds_read_b64_tr_b16 a[36:37], v24 offset:24576
    v_mfma_f32_16x16x32_bf16 v[108:111], a[60:63], a[80:83], v[108:111]
    ds_read_b64_tr_b16 a[38:39], v24 offset:25088
    v_mfma_f32_16x16x32_bf16 v[112:115], a[48:51], a[84:87], v[112:115]
    s_add_u32 m0, s55, 98304
    v_mfma_f32_16x16x32_bf16 v[116:119], a[52:55], a[84:87], v[116:119]
    buffer_load_dwordx4 v6, s[12:15], s53 offen offset:0 lds
    v_mfma_f32_16x16x32_bf16 v[120:123], a[56:59], a[84:87], v[120:123]
    v_mfma_f32_16x16x32_bf16 v[124:127], a[60:63], a[84:87], v[124:127]
    s_waitcnt lgkmcnt(0)
    s_mul_i32 s66, s100, 1792
    s_add_u32 s66, s66, 3670016
    buffer_load_dword v242, v240, s[16:19], s66 offen
    v_mfma_f32_16x16x32_bf16 v[32:35], a[16:19], a[0:3], v[32:35]
    ds_read_b64_tr_b16 a[64:65], v21 offset:12288
    v_mfma_f32_16x16x32_bf16 v[36:39], a[16:19], a[4:7], v[36:39]
    ds_read_b64_tr_b16 a[66:67], v21 offset:12800
    v_mfma_f32_16x16x32_bf16 v[40:43], a[16:19], a[8:11], v[40:43]
    buffer_load_dwordx4 v7, s[12:15], s53 offen offset:1024 lds
    v_mfma_f32_16x16x32_bf16 v[44:47], a[16:19], a[12:15], v[44:47]
    ds_read_b128 a[48:51], v17 offset:57344
    v_mfma_f32_16x16x32_bf16 v[48:51], a[20:23], a[0:3], v[48:51]
    ds_read_b128 a[52:55], v17 offset:59392
    v_mfma_f32_16x16x32_bf16 v[52:55], a[20:23], a[4:7], v[52:55]
    ds_read_b128 a[56:59], v17 offset:61440
    v_mfma_f32_16x16x32_bf16 v[56:59], a[20:23], a[8:11], v[56:59]
    ds_read_b128 a[60:63], v17 offset:63488
    v_mfma_f32_16x16x32_bf16 v[60:63], a[20:23], a[12:15], v[60:63]
    buffer_load_dwordx4 v8, s[12:15], s53 offen offset:2048 lds
    v_mfma_f32_16x16x32_bf16 v[64:67], a[24:27], a[0:3], v[64:67]
    ds_read_b64_tr_b16 a[68:69], v24 offset:12288
    v_mfma_f32_16x16x32_bf16 v[68:71], a[24:27], a[4:7], v[68:71]
    ds_read_b64_tr_b16 a[70:71], v24 offset:12800
    v_mfma_f32_16x16x32_bf16 v[72:75], a[24:27], a[8:11], v[72:75]
    ds_read_b64_tr_b16 a[72:73], v21 offset:20480
    v_mfma_f32_16x16x32_bf16 v[76:79], a[24:27], a[12:15], v[76:79]
    ds_read_b64_tr_b16 a[74:75], v21 offset:20992
    v_mfma_f32_16x16x32_bf16 v[80:83], a[28:31], a[0:3], v[80:83]
    buffer_load_dwordx4 v9, s[12:15], s53 offen offset:3072 lds
    v_mfma_f32_16x16x32_bf16 v[84:87], a[28:31], a[4:7], v[84:87]
    ds_read_b64_tr_b16 a[76:77], v24 offset:20480
    v_mfma_f32_16x16x32_bf16 v[88:91], a[28:31], a[8:11], v[88:91]
    ds_read_b64_tr_b16 a[78:79], v24 offset:20992
    v_mfma_f32_16x16x32_bf16 v[92:95], a[28:31], a[12:15], v[92:95]
    ds_read_b64_tr_b16 a[80:81], v21 offset:28672
    s_add_u32 m0, s55, 102400
    v_mfma_f32_16x16x32_bf16 v[96:99], a[0:3], a[32:35], v[96:99]
    buffer_load_dwordx4 v10, s[12:15], s53 offen offset:0 lds
    v_mfma_f32_16x16x32_bf16 v[100:103], a[4:7], a[32:35], v[100:103]
    ds_read_b64_tr_b16 a[82:83], v21 offset:29184
    v_mfma_f32_16x16x32_bf16 v[104:107], a[8:11], a[32:35], v[104:107]
    ds_read_b64_tr_b16 a[84:85], v24 offset:28672
    v_mfma_f32_16x16x32_bf16 v[108:111], a[12:15], a[32:35], v[108:111]
    ds_read_b64_tr_b16 a[86:87], v24 offset:29184
    v_mfma_f32_16x16x32_bf16 v[112:115], a[0:3], a[36:39], v[112:115]
    v_mfma_f32_16x16x32_bf16 v[116:119], a[4:7], a[36:39], v[116:119]
    buffer_load_dwordx4 v11, s[12:15], s53 offen offset:1024 lds
    s_mul_i32 s53, s89, 393216
    v_mfma_f32_16x16x32_bf16 v[120:123], a[8:11], a[36:39], v[120:123]
    v_mfma_f32_16x16x32_bf16 v[124:127], a[12:15], a[36:39], v[124:127]
    s_waitcnt vmcnt(21) lgkmcnt(0)
    s_barrier
    v_mfma_f32_16x16x32_bf16 v[32:35], a[64:67], a[48:51], v[32:35]
    ds_read_b64_tr_b16 a[16:17], v19 offset:16384
    v_mfma_f32_16x16x32_bf16 v[36:39], a[64:67], a[52:55], v[36:39]
    ds_read_b64_tr_b16 a[18:19], v19 offset:16896
    s_add_u32 m0, s54, 122880
    v_mfma_f32_16x16x32_bf16 v[40:43], a[64:67], a[56:59], v[40:43]
    buffer_load_dwordx4 v2, s[8:11], s52 offen offset:0 lds
    s_add_u32 s88, s88, 1
    v_mfma_f32_16x16x32_bf16 v[44:47], a[64:67], a[60:63], v[44:47]
    ds_read_b128 a[0:3], v13 offset:0
    s_add_u32 s89, s88, s101
    v_mfma_f32_16x16x32_bf16 v[48:51], a[68:71], a[48:51], v[48:51]
    ds_read_b128 a[4:7], v13 offset:2048
    v_mfma_f32_16x16x32_bf16 v[52:55], a[68:71], a[52:55], v[52:55]
    ds_read_b128 a[8:11], v13 offset:4096
    v_mfma_f32_16x16x32_bf16 v[56:59], a[68:71], a[56:59], v[56:59]
    ds_read_b128 a[12:15], v13 offset:6144
    v_mfma_f32_16x16x32_bf16 v[60:63], a[68:71], a[60:63], v[60:63]
    buffer_load_dwordx4 v3, s[8:11], s52 offen offset:1024 lds
    s_and_b32 s89, s89, 3
    v_mfma_f32_16x16x32_bf16 v[64:67], a[72:75], a[48:51], v[64:67]
    ds_read_b64_tr_b16 a[20:21], v22 offset:16384
    s_andn2_b32 s90, s88, 3
    v_mfma_f32_16x16x32_bf16 v[68:71], a[72:75], a[52:55], v[68:71]
    ds_read_b64_tr_b16 a[22:23], v22 offset:16896
    v_mfma_f32_16x16x32_bf16 v[72:75], a[72:75], a[56:59], v[72:75]
    ds_read_b64_tr_b16 a[24:25], v19 offset:24576
    v_mfma_f32_16x16x32_bf16 v[76:79], a[72:75], a[60:63], v[76:79]
    ds_read_b64_tr_b16 a[26:27], v19 offset:25088
    v_mfma_f32_16x16x32_bf16 v[80:83], a[76:79], a[48:51], v[80:83]
    buffer_load_dwordx4 v4, s[8:11], s52 offen offset:2048 lds
    s_or_b32 s89, s89, s90
    v_mfma_f32_16x16x32_bf16 v[84:87], a[76:79], a[52:55], v[84:87]
    ds_read_b64_tr_b16 a[28:29], v22 offset:24576
    v_mfma_f32_16x16x32_bf16 v[88:91], a[76:79], a[56:59], v[88:91]
    ds_read_b64_tr_b16 a[30:31], v22 offset:25088
    v_mfma_f32_16x16x32_bf16 v[92:95], a[76:79], a[60:63], v[92:95]
    ds_read_b64_tr_b16 a[32:33], v19 offset:32768
    v_mfma_f32_16x16x32_bf16 v[96:99], a[48:51], a[80:83], v[96:99]
    buffer_load_dwordx4 v5, s[8:11], s52 offen offset:3072 lds
    s_lshl_b32 s52, s89, 7
    v_mfma_f32_16x16x32_bf16 v[100:103], a[52:55], a[80:83], v[100:103]
    ds_read_b64_tr_b16 a[34:35], v19 offset:33280
    v_mfma_f32_16x16x32_bf16 v[104:107], a[56:59], a[80:83], v[104:107]
    ds_read_b64_tr_b16 a[36:37], v22 offset:32768
    v_mfma_f32_16x16x32_bf16 v[108:111], a[60:63], a[80:83], v[108:111]
    ds_read_b64_tr_b16 a[38:39], v22 offset:33280
    v_mfma_f32_16x16x32_bf16 v[112:115], a[48:51], a[84:87], v[112:115]
    s_add_u32 m0, s55, 139264
    v_mfma_f32_16x16x32_bf16 v[116:119], a[52:55], a[84:87], v[116:119]
    buffer_load_dwordx4 v6, s[12:15], s53 offen offset:0 lds
    v_mfma_f32_16x16x32_bf16 v[120:123], a[56:59], a[84:87], v[120:123]
    v_mfma_f32_16x16x32_bf16 v[124:127], a[60:63], a[84:87], v[124:127]
    s_waitcnt lgkmcnt(0)
    v_mfma_f32_16x16x32_bf16 v[32:35], a[16:19], a[0:3], v[32:35]
    ds_read_b64_tr_b16 a[64:65], v19 offset:20480
    v_mfma_f32_16x16x32_bf16 v[36:39], a[16:19], a[4:7], v[36:39]
    ds_read_b64_tr_b16 a[66:67], v19 offset:20992
    v_mfma_f32_16x16x32_bf16 v[40:43], a[16:19], a[8:11], v[40:43]
    buffer_load_dwordx4 v7, s[12:15], s53 offen offset:1024 lds
    v_mfma_f32_16x16x32_bf16 v[44:47], a[16:19], a[12:15], v[44:47]
    ds_read_b128 a[48:51], v16 offset:0
    v_mfma_f32_16x16x32_bf16 v[48:51], a[20:23], a[0:3], v[48:51]
    ds_read_b128 a[52:55], v16 offset:2048
    v_mfma_f32_16x16x32_bf16 v[52:55], a[20:23], a[4:7], v[52:55]
    ds_read_b128 a[56:59], v16 offset:4096
    v_mfma_f32_16x16x32_bf16 v[56:59], a[20:23], a[8:11], v[56:59]
    ds_read_b128 a[60:63], v16 offset:6144
    v_mfma_f32_16x16x32_bf16 v[60:63], a[20:23], a[12:15], v[60:63]
    buffer_load_dwordx4 v8, s[12:15], s53 offen offset:2048 lds
    v_mfma_f32_16x16x32_bf16 v[64:67], a[24:27], a[0:3], v[64:67]
    ds_read_b64_tr_b16 a[68:69], v22 offset:20480
    v_mfma_f32_16x16x32_bf16 v[68:71], a[24:27], a[4:7], v[68:71]
    ds_read_b64_tr_b16 a[70:71], v22 offset:20992
    v_mfma_f32_16x16x32_bf16 v[72:75], a[24:27], a[8:11], v[72:75]
    ds_read_b64_tr_b16 a[72:73], v19 offset:28672
    v_mfma_f32_16x16x32_bf16 v[76:79], a[24:27], a[12:15], v[76:79]
    ds_read_b64_tr_b16 a[74:75], v19 offset:29184
    v_mfma_f32_16x16x32_bf16 v[80:83], a[28:31], a[0:3], v[80:83]
    buffer_load_dwordx4 v9, s[12:15], s53 offen offset:3072 lds
    v_mfma_f32_16x16x32_bf16 v[84:87], a[28:31], a[4:7], v[84:87]
    ds_read_b64_tr_b16 a[76:77], v22 offset:28672
    v_mfma_f32_16x16x32_bf16 v[88:91], a[28:31], a[8:11], v[88:91]
    ds_read_b64_tr_b16 a[78:79], v22 offset:29184
    v_mfma_f32_16x16x32_bf16 v[92:95], a[28:31], a[12:15], v[92:95]
    ds_read_b64_tr_b16 a[80:81], v19 offset:36864
    s_add_u32 m0, s55, 143360
    v_mfma_f32_16x16x32_bf16 v[96:99], a[0:3], a[32:35], v[96:99]
    buffer_load_dwordx4 v10, s[12:15], s53 offen offset:0 lds
    v_mfma_f32_16x16x32_bf16 v[100:103], a[4:7], a[32:35], v[100:103]
    ds_read_b64_tr_b16 a[82:83], v19 offset:37376
    v_mfma_f32_16x16x32_bf16 v[104:107], a[8:11], a[32:35], v[104:107]
    ds_read_b64_tr_b16 a[84:85], v22 offset:36864
    v_mfma_f32_16x16x32_bf16 v[108:111], a[12:15], a[32:35], v[108:111]
    ds_read_b64_tr_b16 a[86:87], v22 offset:37376
    v_mfma_f32_16x16x32_bf16 v[112:115], a[0:3], a[36:39], v[112:115]
    v_mfma_f32_16x16x32_bf16 v[116:119], a[4:7], a[36:39], v[116:119]
    buffer_load_dwordx4 v11, s[12:15], s53 offen offset:1024 lds
    s_mul_i32 s53, s89, 393216
    v_mfma_f32_16x16x32_bf16 v[120:123], a[8:11], a[36:39], v[120:123]
    v_mfma_f32_16x16x32_bf16 v[124:127], a[12:15], a[36:39], v[124:127]
    s_waitcnt vmcnt(21) lgkmcnt(0)
    s_barrier
    v_mfma_f32_16x16x32_bf16 v[32:35], a[64:67], a[48:51], v[32:35]
    ds_read_b64_tr_b16 a[16:17], v19 offset:57344
    v_mfma_f32_16x16x32_bf16 v[36:39], a[64:67], a[52:55], v[36:39]
    ds_read_b64_tr_b16 a[18:19], v19 offset:57856
    v_mfma_f32_16x16x32_bf16 v[40:43], a[64:67], a[56:59], v[40:43]
    ds_read_b128 a[0:3], v13 offset:40960
    v_mfma_f32_16x16x32_bf16 v[44:47], a[64:67], a[60:63], v[44:47]
    ds_read_b128 a[4:7], v13 offset:43008
    v_mfma_f32_16x16x32_bf16 v[48:51], a[68:71], a[48:51], v[48:51]
    ds_read_b128 a[8:11], v13 offset:45056
    v_mfma_f32_16x16x32_bf16 v[52:55], a[68:71], a[52:55], v[52:55]
    ds_read_b128 a[12:15], v13 offset:47104
    v_mfma_f32_16x16x32_bf16 v[56:59], a[68:71], a[56:59], v[56:59]
    ds_read_b64_tr_b16 a[20:21], v22 offset:57344
    v_mfma_f32_16x16x32_bf16 v[60:63], a[68:71], a[60:63], v[60:63]
    ds_read_b64_tr_b16 a[22:23], v22 offset:57856
    v_mfma_f32_16x16x32_bf16 v[64:67], a[72:75], a[48:51], v[64:67]
    ds_read_b64_tr_b16 a[24:25], v20 offset:0
    v_mfma_f32_16x16x32_bf16 v[68:71], a[72:75], a[52:55], v[68:71]
    ds_read_b64_tr_b16 a[26:27], v20 offset:512
    v_mfma_f32_16x16x32_bf16 v[72:75], a[72:75], a[56:59], v[72:75]
    ds_read_b64_tr_b16 a[28:29], v23 offset:0
    v_mfma_f32_16x16x32_bf16 v[76:79], a[72:75], a[60:63], v[76:79]
    ds_read_b64_tr_b16 a[30:31], v23 offset:512
    v_mfma_f32_16x16x32_bf16 v[80:83], a[76:79], a[48:51], v[80:83]
    ds_read_b64_tr_b16 a[32:33], v20 offset:8192
    v_mfma_f32_16x16x32_bf16 v[84:87], a[76:79], a[52:55], v[84:87]
    ds_read_b64_tr_b16 a[34:35], v20 offset:8704
    v_mfma_f32_16x16x32_bf16 v[88:91], a[76:79], a[56:59], v[88:91]
    ds_read_b64_tr_b16 a[36:37], v23 offset:8192
    v_mfma_f32_16x16x32_bf16 v[92:95], a[76:79], a[60:63], v[92:95]
    ds_read_b64_tr_b16 a[38:39], v23 offset:8704
    v_mfma_f32_16x16x32_bf16 v[96:99], a[48:51], a[80:83], v[96:99]
    v_mfma_f32_16x16x32_bf16 v[100:103], a[52:55], a[80:83], v[100:103]
    v_mfma_f32_16x16x32_bf16 v[104:107], a[56:59], a[80:83], v[104:107]
    v_mfma_f32_16x16x32_bf16 v[108:111], a[60:63], a[80:83], v[108:111]
    v_mfma_f32_16x16x32_bf16 v[112:115], a[48:51], a[84:87], v[112:115]
    v_mfma_f32_16x16x32_bf16 v[116:119], a[52:55], a[84:87], v[116:119]
    v_mfma_f32_16x16x32_bf16 v[120:123], a[56:59], a[84:87], v[120:123]
    v_mfma_f32_16x16x32_bf16 v[124:127], a[60:63], a[84:87], v[124:127]
    s_waitcnt lgkmcnt(0)
    s_mul_i32 s66, s100, 1792
    s_add_u32 s66, s66, 5505024
    buffer_load_dword v242, v240, s[16:19], s66 offen
    v_mfma_f32_16x16x32_bf16 v[32:35], a[16:19], a[0:3], v[32:35]
    ds_read_b64_tr_b16 a[64:65], v19 offset:61440
    v_mfma_f32_16x16x32_bf16 v[36:39], a[16:19], a[4:7], v[36:39]
    ds_read_b64_tr_b16 a[66:67], v19 offset:61952
    v_mfma_f32_16x16x32_bf16 v[40:43], a[16:19], a[8:11], v[40:43]
    ds_read_b128 a[48:51], v16 offset:40960
    v_mfma_f32_16x16x32_bf16 v[44:47], a[16:19], a[12:15], v[44:47]
    ds_read_b128 a[52:55], v16 offset:43008
    v_mfma_f32_16x16x32_bf16 v[48:51], a[20:23], a[0:3], v[48:51]
    ds_read_b128 a[56:59], v16 offset:45056
    v_mfma_f32_16x16x32_bf16 v[52:55], a[20:23], a[4:7], v[52:55]
    ds_read_b128 a[60:63], v16 offset:47104
    v_mfma_f32_16x16x32_bf16 v[56:59], a[20:23], a[8:11], v[56:59]
    ds_read_b64_tr_b16 a[68:69], v22 offset:61440
    v_mfma_f32_16x16x32_bf16 v[60:63], a[20:23], a[12:15], v[60:63]
    ds_read_b64_tr_b16 a[70:71], v22 offset:61952
    v_mfma_f32_16x16x32_bf16 v[64:67], a[24:27], a[0:3], v[64:67]
    ds_read_b64_tr_b16 a[72:73], v20 offset:4096
    v_mfma_f32_16x16x32_bf16 v[68:71], a[24:27], a[4:7], v[68:71]
    ds_read_b64_tr_b16 a[74:75], v20 offset:4608
    v_mfma_f32_16x16x32_bf16 v[72:75], a[24:27], a[8:11], v[72:75]
    ds_read_b64_tr_b16 a[76:77], v23 offset:4096
    v_mfma_f32_16x16x32_bf16 v[76:79], a[24:27], a[12:15], v[76:79]
    ds_read_b64_tr_b16 a[78:79], v23 offset:4608
    v_mfma_f32_16x16x32_bf16 v[80:83], a[28:31], a[0:3], v[80:83]
    ds_read_b64_tr_b16 a[80:81], v20 offset:12288
    v_mfma_f32_16x16x32_bf16 v[84:87], a[28:31], a[4:7], v[84:87]
    ds_read_b64_tr_b16 a[82:83], v20 offset:12800
    v_mfma_f32_16x16x32_bf16 v[88:91], a[28:31], a[8:11], v[88:91]
    ds_read_b64_tr_b16 a[84:85], v23 offset:12288
    v_mfma_f32_16x16x32_bf16 v[92:95], a[28:31], a[12:15], v[92:95]
    ds_read_b64_tr_b16 a[86:87], v23 offset:12800
    v_mfma_f32_16x16x32_bf16 v[96:99], a[0:3], a[32:35], v[96:99]
    v_mfma_f32_16x16x32_bf16 v[100:103], a[4:7], a[32:35], v[100:103]
    v_mfma_f32_16x16x32_bf16 v[104:107], a[8:11], a[32:35], v[104:107]
    v_mfma_f32_16x16x32_bf16 v[108:111], a[12:15], a[32:35], v[108:111]
    v_mfma_f32_16x16x32_bf16 v[112:115], a[0:3], a[36:39], v[112:115]
    v_mfma_f32_16x16x32_bf16 v[116:119], a[4:7], a[36:39], v[116:119]
    v_mfma_f32_16x16x32_bf16 v[120:123], a[8:11], a[36:39], v[120:123]
    v_mfma_f32_16x16x32_bf16 v[124:127], a[12:15], a[36:39], v[124:127]
    s_waitcnt vmcnt(11) lgkmcnt(0)
    s_barrier
    v_accvgpr_read_b32 v6, a200
    v_accvgpr_read_b32 v7, a201
    v_accvgpr_read_b32 v8, a202
    v_accvgpr_read_b32 v9, a203
    v_accvgpr_read_b32 v10, a204
    v_accvgpr_read_b32 v11, a205
    v_accvgpr_read_b32 v12, a206
    s_lshl_b32 s52, s101, 7
    s_mul_i32 s53, s101, 458752
    s_mul_i32 s55, s3, 7168
    s_mov_b32 s88, 0
    v_mfma_f32_16x16x32_bf16 v[32:35], a[64:67], a[48:51], v[32:35]
    ds_read_b64_tr_b16 a[16:17], v20 offset:32768
    v_mfma_f32_16x16x32_bf16 v[36:39], a[64:67], a[52:55], v[36:39]
    ds_read_b64_tr_b16 a[18:19], v20 offset:33280
    v_mfma_f32_16x16x32_bf16 v[40:43], a[64:67], a[56:59], v[40:43]
    ds_read_b128 a[0:3], v14 offset:16384
    s_add_u32 m0, s54, 0
    v_mfma_f32_16x16x32_bf16 v[44:47], a[64:67], a[60:63], v[44:47]
    buffer_load_dwordx4 v2, s[8:11], s52 offen offset:0 lds
    s_add_u32 s88, s88, 1
    v_mfma_f32_16x16x32_bf16 v[48:51], a[68:71], a[48:51], v[48:51]
    ds_read_b128 a[4:7], v14 offset:18432
    s_add_u32 s89, s88, s101
    v_mfma_f32_16x16x32_bf16 v[52:55], a[68:71], a[52:55], v[52:55]
    ds_read_b128 a[8:11], v14 offset:20480
    v_mfma_f32_16x16x32_bf16 v[56:59], a[68:71], a[56:59], v[56:59]
    ds_read_b128 a[12:15], v14 offset:22528
    v_mfma_f32_16x16x32_bf16 v[60:63], a[68:71], a[60:63], v[60:63]
    ds_read_b64_tr_b16 a[20:21], v23 offset:32768
    v_mfma_f32_16x16x32_bf16 v[64:67], a[72:75], a[48:51], v[64:67]
    ds_read_b64_tr_b16 a[22:23], v23 offset:33280
    v_mfma_f32_16x16x32_bf16 v[68:71], a[72:75], a[52:55], v[68:71]
    buffer_load_dwordx4 v3, s[8:11], s52 offen offset:1024 lds
    s_and_b32 s89, s89, 3
    v_mfma_f32_16x16x32_bf16 v[72:75], a[72:75], a[56:59], v[72:75]
    ds_read_b64_tr_b16 a[24:25], v20 offset:40960
    s_andn2_b32 s90, s88, 3
    v_mfma_f32_16x16x32_bf16 v[76:79], a[72:75], a[60:63], v[76:79]
    ds_read_b64_tr_b16 a[26:27], v20 offset:41472
    v_mfma_f32_16x16x32_bf16 v[80:83], a[76:79], a[48:51], v[80:83]
    ds_read_b64_tr_b16 a[28:29], v23 offset:40960
    v_mfma_f32_16x16x32_bf16 v[84:87], a[76:79], a[52:55], v[84:87]
    ds_read_b64_tr_b16 a[30:31], v23 offset:41472
    v_mfma_f32_16x16x32_bf16 v[88:91], a[76:79], a[56:59], v[88:91]
    ds_read_b64_tr_b16 a[32:33], v20 offset:49152
    v_mfma_f32_16x16x32_bf16 v[92:95], a[76:79], a[60:63], v[92:95]
    buffer_load_dwordx4 v4, s[8:11], s52 offen offset:2048 lds
    s_or_b32 s89, s89, s90
    v_mfma_f32_16x16x32_bf16 v[96:99], a[48:51], a[80:83], v[96:99]
    ds_read_b64_tr_b16 a[34:35], v20 offset:49664
    v_mfma_f32_16x16x32_bf16 v[100:103], a[52:55], a[80:83], v[100:103]
    ds_read_b64_tr_b16 a[36:37], v23 offset:49152
    v_mfma_f32_16x16x32_bf16 v[104:107], a[56:59], a[80:83], v[104:107]
    ds_read_b64_tr_b16 a[38:39], v23 offset:49664
    v_mfma_f32_16x16x32_bf16 v[108:111], a[60:63], a[80:83], v[108:111]
    v_mfma_f32_16x16x32_bf16 v[112:115], a[48:51], a[84:87], v[112:115]
    v_mfma_f32_16x16x32_bf16 v[116:119], a[52:55], a[84:87], v[116:119]
    buffer_load_dwordx4 v5, s[8:11], s52 offen offset:3072 lds
    s_lshl_b32 s52, s89, 7
    v_mfma_f32_16x16x32_bf16 v[120:123], a[56:59], a[84:87], v[120:123]
    v_mfma_f32_16x16x32_bf16 v[124:127], a[60:63], a[84:87], v[124:127]
    s_waitcnt lgkmcnt(0)
    v_mfma_f32_16x16x32_bf16 v[32:35], a[16:19], a[0:3], v[32:35]
    ds_read_b64_tr_b16 a[64:65], v20 offset:36864
    v_mfma_f32_16x16x32_bf16 v[36:39], a[16:19], a[4:7], v[36:39]
    ds_read_b64_tr_b16 a[66:67], v20 offset:37376
    v_mfma_f32_16x16x32_bf16 v[40:43], a[16:19], a[8:11], v[40:43]
    ds_read_b128 a[48:51], v17 offset:16384
    s_add_u32 m0, s55, 16384
    v_mfma_f32_16x16x32_bf16 v[44:47], a[16:19], a[12:15], v[44:47]
    buffer_load_dwordx4 v6, s[16:19], s53 offen offset:0 lds
    v_mfma_f32_16x16x32_bf16 v[48:51], a[20:23], a[0:3], v[48:51]
    ds_read_b128 a[52:55], v17 offset:18432
    v_mfma_f32_16x16x32_bf16 v[52:55], a[20:23], a[4:7], v[52:55]
    ds_read_b128 a[56:59], v17 offset:20480
    v_mfma_f32_16x16x32_bf16 v[56:59], a[20:23], a[8:11], v[56:59]
    ds_read_b128 a[60:63], v17 offset:22528
    v_mfma_f32_16x16x32_bf16 v[60:63], a[20:23], a[12:15], v[60:63]
    ds_read_b64_tr_b16 a[68:69], v23 offset:36864
    v_mfma_f32_16x16x32_bf16 v[64:67], a[24:27], a[0:3], v[64:67]
    ds_read_b64_tr_b16 a[70:71], v23 offset:37376
    v_mfma_f32_16x16x32_bf16 v[68:71], a[24:27], a[4:7], v[68:71]
    buffer_load_dwordx4 v7, s[16:19], s53 offen offset:1024 lds
    v_mfma_f32_16x16x32_bf16 v[72:75], a[24:27], a[8:11], v[72:75]
    ds_read_b64_tr_b16 a[72:73], v20 offset:45056
    v_mfma_f32_16x16x32_bf16 v[76:79], a[24:27], a[12:15], v[76:79]
    ds_read_b64_tr_b16 a[74:75], v20 offset:45568
    v_mfma_f32_16x16x32_bf16 v[80:83], a[28:31], a[0:3], v[80:83]
    ds_read_b64_tr_b16 a[76:77], v23 offset:45056
    v_mfma_f32_16x16x32_bf16 v[84:87], a[28:31], a[4:7], v[84:87]
    ds_read_b64_tr_b16 a[78:79], v23 offset:45568
    v_mfma_f32_16x16x32_bf16 v[88:91], a[28:31], a[8:11], v[88:91]
    ds_read_b64_tr_b16 a[80:81], v20 offset:53248
    v_mfma_f32_16x16x32_bf16 v[92:95], a[28:31], a[12:15], v[92:95]
    buffer_load_dwordx4 v8, s[16:19], s53 offen offset:2048 lds
    v_mfma_f32_16x16x32_bf16 v[96:99], a[0:3], a[32:35], v[96:99]
    ds_read_b64_tr_b16 a[82:83], v20 offset:53760
    v_mfma_f32_16x16x32_bf16 v[100:103], a[4:7], a[32:35], v[100:103]
    ds_read_b64_tr_b16 a[84:85], v23 offset:53248
    v_mfma_f32_16x16x32_bf16 v[104:107], a[8:11], a[32:35], v[104:107]
    ds_read_b64_tr_b16 a[86:87], v23 offset:53760
    v_mfma_f32_16x16x32_bf16 v[108:111], a[12:15], a[32:35], v[108:111]
    v_mfma_f32_16x16x32_bf16 v[112:115], a[0:3], a[36:39], v[112:115]
    v_mfma_f32_16x16x32_bf16 v[116:119], a[4:7], a[36:39], v[116:119]
    buffer_load_dwordx4 v9, s[16:19], s53 offen offset:3072 lds
    v_mfma_f32_16x16x32_bf16 v[120:123], a[8:11], a[36:39], v[120:123]
    v_mfma_f32_16x16x32_bf16 v[124:127], a[12:15], a[36:39], v[124:127]
    s_waitcnt vmcnt(9) lgkmcnt(0)
    s_barrier
    v_mfma_f32_16x16x32_bf16 v[32:35], a[64:67], a[48:51], v[32:35]
    ds_read_b64_tr_b16 a[16:17], v21 offset:8192
    v_mfma_f32_16x16x32_bf16 v[36:39], a[64:67], a[52:55], v[36:39]
    ds_read_b64_tr_b16 a[18:19], v21 offset:8704
    v_mfma_f32_16x16x32_bf16 v[40:43], a[64:67], a[56:59], v[40:43]
    ds_read_b128 a[0:3], v14 offset:57344
    s_add_u32 m0, s55, 20480
    v_mfma_f32_16x16x32_bf16 v[44:47], a[64:67], a[60:63], v[44:47]
    buffer_load_dwordx4 v10, s[16:19], s53 offen offset:0 lds
    v_mfma_f32_16x16x32_bf16 v[48:51], a[68:71], a[48:51], v[48:51]
    ds_read_b128 a[4:7], v14 offset:59392
    v_mfma_f32_16x16x32_bf16 v[52:55], a[68:71], a[52:55], v[52:55]
    ds_read_b128 a[8:11], v14 offset:61440
    v_mfma_f32_16x16x32_bf16 v[56:59], a[68:71], a[56:59], v[56:59]
    ds_read_b128 a[12:15], v14 offset:63488
    v_mfma_f32_16x16x32_bf16 v[60:63], a[68:71], a[60:63], v[60:63]
    ds_read_b64_tr_b16 a[20:21], v24 offset:8192
    v_mfma_f32_16x16x32_bf16 v[64:67], a[72:75], a[48:51], v[64:67]
    ds_read_b64_tr_b16 a[22:23], v24 offset:8704
    v_mfma_f32_16x16x32_bf16 v[68:71], a[72:75], a[52:55], v[68:71]
    buffer_load_dwordx4 v11, s[16:19], s53 offen offset:1024 lds
    v_mfma_f32_16x16x32_bf16 v[72:75], a[72:75], a[56:59], v[72:75]
    ds_read_b64_tr_b16 a[24:25], v21 offset:16384
    v_mfma_f32_16x16x32_bf16 v[76:79], a[72:75], a[60:63], v[76:79]
    ds_read_b64_tr_b16 a[26:27], v21 offset:16896
    v_mfma_f32_16x16x32_bf16 v[80:83], a[76:79], a[48:51], v[80:83]
    ds_read_b64_tr_b16 a[28:29], v24 offset:16384
    v_mfma_f32_16x16x32_bf16 v[84:87], a[76:79], a[52:55], v[84:87]
    ds_read_b64_tr_b16 a[30:31], v24 offset:16896
    v_mfma_f32_16x16x32_bf16 v[88:91], a[76:79], a[56:59], v[88:91]
    ds_read_b64_tr_b16 a[32:33], v21 offset:24576
    v_mfma_f32_16x16x32_bf16 v[92:95], a[76:79], a[60:63], v[92:95]
    buffer_load_dwordx4 v12, s[16:19], s53 offen offset:2048 lds
    s_mul_i32 s53, s89, 458752
    v_mfma_f32_16x16x32_bf16 v[96:99], a[48:51], a[80:83], v[96:99]
    ds_read_b64_tr_b16 a[34:35], v21 offset:25088
    v_mfma_f32_16x16x32_bf16 v[100:103], a[52:55], a[80:83], v[100:103]
    ds_read_b64_tr_b16 a[36:37], v24 offset:24576
    v_mfma_f32_16x16x32_bf16 v[104:107], a[56:59], a[80:83], v[104:107]
    ds_read_b64_tr_b16 a[38:39], v24 offset:25088
    v_mfma_f32_16x16x32_bf16 v[108:111], a[60:63], a[80:83], v[108:111]
    v_mfma_f32_16x16x32_bf16 v[112:115], a[48:51], a[84:87], v[112:115]
    s_add_u32 m0, s54, 45056
    v_mfma_f32_16x16x32_bf16 v[116:119], a[52:55], a[84:87], v[116:119]
    buffer_load_dwordx4 v2, s[8:11], s52 offen offset:0 lds
    s_add_u32 s88, s88, 1
    v_mfma_f32_16x16x32_bf16 v[120:123], a[56:59], a[84:87], v[120:123]
    s_add_u32 s89, s88, s101
    v_mfma_f32_16x16x32_bf16 v[124:127], a[60:63], a[84:87], v[124:127]
    s_waitcnt lgkmcnt(0)
    v_mfma_f32_16x16x32_bf16 v[32:35], a[16:19], a[0:3], v[32:35]
    ds_read_b64_tr_b16 a[64:65], v21 offset:12288
    v_mfma_f32_16x16x32_bf16 v[36:39], a[16:19], a[4:7], v[36:39]
    ds_read_b64_tr_b16 a[66:67], v21 offset:12800
    v_mfma_f32_16x16x32_bf16 v[40:43], a[16:19], a[8:11], v[40:43]
    ds_read_b128 a[48:51], v17 offset:57344
    v_mfma_f32_16x16x32_bf16 v[44:47], a[16:19], a[12:15], v[44:47]
    buffer_load_dwordx4 v3, s[8:11], s52 offen offset:1024 lds
    s_and_b32 s89, s89, 3
    v_mfma_f32_16x16x32_bf16 v[48:51], a[20:23], a[0:3], v[48:51]
    ds_read_b128 a[52:55], v17 offset:59392
    s_andn2_b32 s90, s88, 3
    v_mfma_f32_16x16x32_bf16 v[52:55], a[20:23], a[4:7], v[52:55]
    ds_read_b128 a[56:59], v17 offset:61440
    v_mfma_f32_16x16x32_bf16 v[56:59], a[20:23], a[8:11], v[56:59]
    ds_read_b128 a[60:63], v17 offset:63488
    v_mfma_f32_16x16x32_bf16 v[60:63], a[20:23], a[12:15], v[60:63]
    ds_read_b64_tr_b16 a[68:69], v24 offset:12288
    v_mfma_f32_16x16x32_bf16 v[64:67], a[24:27], a[0:3], v[64:67]
    ds_read_b64_tr_b16 a[70:71], v24 offset:12800
    v_mfma_f32_16x16x32_bf16 v[68:71], a[24:27], a[4:7], v[68:71]
    buffer_load_dwordx4 v4, s[8:11], s52 offen offset:2048 lds
    s_or_b32 s89, s89, s90
    v_mfma_f32_16x16x32_bf16 v[72:75], a[24:27], a[8:11], v[72:75]
    ds_read_b64_tr_b16 a[72:73], v21 offset:20480
    v_mfma_f32_16x16x32_bf16 v[76:79], a[24:27], a[12:15], v[76:79]
    ds_read_b64_tr_b16 a[74:75], v21 offset:20992
    v_mfma_f32_16x16x32_bf16 v[80:83], a[28:31], a[0:3], v[80:83]
    ds_read_b64_tr_b16 a[76:77], v24 offset:20480
    v_mfma_f32_16x16x32_bf16 v[84:87], a[28:31], a[4:7], v[84:87]
    ds_read_b64_tr_b16 a[78:79], v24 offset:20992
    v_mfma_f32_16x16x32_bf16 v[88:91], a[28:31], a[8:11], v[88:91]
    ds_read_b64_tr_b16 a[80:81], v21 offset:28672
    v_mfma_f32_16x16x32_bf16 v[92:95], a[28:31], a[12:15], v[92:95]
    buffer_load_dwordx4 v5, s[8:11], s52 offen offset:3072 lds
    s_lshl_b32 s52, s89, 7
    v_mfma_f32_16x16x32_bf16 v[96:99], a[0:3], a[32:35], v[96:99]
    ds_read_b64_tr_b16 a[82:83], v21 offset:29184
    v_mfma_f32_16x16x32_bf16 v[100:103], a[4:7], a[32:35], v[100:103]
    ds_read_b64_tr_b16 a[84:85], v24 offset:28672
    v_mfma_f32_16x16x32_bf16 v[104:107], a[8:11], a[32:35], v[104:107]
    ds_read_b64_tr_b16 a[86:87], v24 offset:29184
    v_mfma_f32_16x16x32_bf16 v[108:111], a[12:15], a[32:35], v[108:111]
    v_mfma_f32_16x16x32_bf16 v[112:115], a[0:3], a[36:39], v[112:115]
    s_add_u32 m0, s55, 61440
    v_mfma_f32_16x16x32_bf16 v[116:119], a[4:7], a[36:39], v[116:119]
    buffer_load_dwordx4 v6, s[16:19], s53 offen offset:0 lds
    v_mfma_f32_16x16x32_bf16 v[120:123], a[8:11], a[36:39], v[120:123]
    v_mfma_f32_16x16x32_bf16 v[124:127], a[12:15], a[36:39], v[124:127]
    s_waitcnt lgkmcnt(0)
    s_barrier
    v_mfma_f32_16x16x32_bf16 v[32:35], a[64:67], a[48:51], v[32:35]
    v_mfma_f32_16x16x32_bf16 v[36:39], a[64:67], a[52:55], v[36:39]
    v_mfma_f32_16x16x32_bf16 v[40:43], a[64:67], a[56:59], v[40:43]
    v_mfma_f32_16x16x32_bf16 v[44:47], a[64:67], a[60:63], v[44:47]
    buffer_load_dwordx4 v7, s[16:19], s53 offen offset:1024 lds
    v_mfma_f32_16x16x32_bf16 v[48:51], a[68:71], a[48:51], v[48:51]
    v_mfma_f32_16x16x32_bf16 v[52:55], a[68:71], a[52:55], v[52:55]
    v_mfma_f32_16x16x32_bf16 v[56:59], a[68:71], a[56:59], v[56:59]
    v_mfma_f32_16x16x32_bf16 v[60:63], a[68:71], a[60:63], v[60:63]
    v_mfma_f32_16x16x32_bf16 v[64:67], a[72:75], a[48:51], v[64:67]
    v_mfma_f32_16x16x32_bf16 v[68:71], a[72:75], a[52:55], v[68:71]
    buffer_load_dwordx4 v8, s[16:19], s53 offen offset:2048 lds
    v_mfma_f32_16x16x32_bf16 v[72:75], a[72:75], a[56:59], v[72:75]
    v_mfma_f32_16x16x32_bf16 v[76:79], a[72:75], a[60:63], v[76:79]
    v_mfma_f32_16x16x32_bf16 v[80:83], a[76:79], a[48:51], v[80:83]
    v_mfma_f32_16x16x32_bf16 v[84:87], a[76:79], a[52:55], v[84:87]
    v_mfma_f32_16x16x32_bf16 v[88:91], a[76:79], a[56:59], v[88:91]
    v_mfma_f32_16x16x32_bf16 v[92:95], a[76:79], a[60:63], v[92:95]
    buffer_load_dwordx4 v9, s[16:19], s53 offen offset:3072 lds
    v_mfma_f32_16x16x32_bf16 v[96:99], a[48:51], a[80:83], v[96:99]
    v_mfma_f32_16x16x32_bf16 v[100:103], a[52:55], a[80:83], v[100:103]
    v_mfma_f32_16x16x32_bf16 v[104:107], a[56:59], a[80:83], v[104:107]
    v_mfma_f32_16x16x32_bf16 v[108:111], a[60:63], a[80:83], v[108:111]
    v_mfma_f32_16x16x32_bf16 v[112:115], a[48:51], a[84:87], v[112:115]
    s_add_u32 m0, s55, 65536
    v_mfma_f32_16x16x32_bf16 v[116:119], a[52:55], a[84:87], v[116:119]
    buffer_load_dwordx4 v10, s[16:19], s53 offen offset:0 lds
    v_mfma_f32_16x16x32_bf16 v[120:123], a[56:59], a[84:87], v[120:123]
    v_mfma_f32_16x16x32_bf16 v[124:127], a[60:63], a[84:87], v[124:127]
    s_mul_i32 s94, s95, 0x9e3779b1
    s_add_u32 s94, s94, 0x7f4a7c15
    s_and_b32 s94, s94, 0xfffffff8
    s_lshl_b32 s56, s7, 1
    s_add_u32 s56, s56, s5
    s_lshl_b32 s65, s56, 18
    s_lshl_b32 s56, s6, 2
    s_lshl_b32 s57, s4, 1
    s_add_u32 s56, s56, s57
    s_lshl_b32 s56, s56, 12
    s_sub_u32 s58, s56, 4096
    s_and_b32 s58, s58, 0x3ffff
    s_add_u32 s58, s58, s65
    s_add_u32 s56, s56, s65
    s_add_u32 s57, s56, 4096
    v_lshlrev_b32 v26, 4, v1
    v_and_b32 v27, 0x33, v1
    v_bfe_u32 v28, v1, 2, 1
    v_lshl_or_b32 v27, v28, 3, v27
    v_bfe_u32 v28, v1, 3, 1
    v_lshl_or_b32 v27, v28, 2, v27
    v_lshlrev_b32 v27, 4, v27
    v_cvt_pk_bf16_f32 v128, v64, v65
    v_cvt_pk_bf16_f32 v129, v66, v67
    v_cvt_pk_bf16_f32 v130, v68, v69
    v_cvt_pk_bf16_f32 v131, v70, v71
    v_cvt_pk_bf16_f32 v132, v80, v81
    v_cvt_pk_bf16_f32 v133, v82, v83
    v_cvt_pk_bf16_f32 v134, v84, v85
    v_cvt_pk_bf16_f32 v135, v86, v87
    v_cvt_pk_bf16_f32 v136, v72, v73
    v_cvt_pk_bf16_f32 v137, v74, v75
    v_cvt_pk_bf16_f32 v138, v76, v77
    v_cvt_pk_bf16_f32 v139, v78, v79
    v_cvt_pk_bf16_f32 v140, v88, v89
    v_cvt_pk_bf16_f32 v141, v90, v91
    v_cvt_pk_bf16_f32 v142, v92, v93
    v_cvt_pk_bf16_f32 v143, v94, v95
    v_permlane16_swap_b32 v128, v130
    v_permlane16_swap_b32 v129, v131
    v_permlane16_swap_b32 v132, v134
    v_permlane16_swap_b32 v133, v135
    v_permlane16_swap_b32 v136, v138
    v_permlane16_swap_b32 v137, v139
    v_permlane16_swap_b32 v140, v142
    v_permlane16_swap_b32 v141, v143
    buffer_store_dwordx4 v[128:131], v27, s[32:35], s58 offen offset:2048 sc1
    buffer_store_dwordx4 v[132:135], v27, s[32:35], s58 offen offset:3072 sc1
    buffer_store_dwordx4 v[136:139], v27, s[32:35], s56 offen offset:2048 sc1
    buffer_store_dwordx4 v[140:143], v27, s[32:35], s56 offen offset:3072 sc1
    v_cvt_pk_bf16_f32 v64, v96, v97
    v_cvt_pk_bf16_f32 v65, v98, v99
    v_cvt_pk_bf16_f32 v66, v112, v113
    v_cvt_pk_bf16_f32 v67, v114, v115
    v_cvt_pk_bf16_f32 v68, v100, v101
    v_cvt_pk_bf16_f32 v69, v102, v103
    v_cvt_pk_bf16_f32 v70, v116, v117
    v_cvt_pk_bf16_f32 v71, v118, v119
    v_cvt_pk_bf16_f32 v72, v104, v105
    v_cvt_pk_bf16_f32 v73, v106, v107
    v_cvt_pk_bf16_f32 v74, v120, v121
    v_cvt_pk_bf16_f32 v75, v122, v123
    v_cvt_pk_bf16_f32 v76, v108, v109
    v_cvt_pk_bf16_f32 v77, v110, v111
    v_cvt_pk_bf16_f32 v78, v124, v125
    v_cvt_pk_bf16_f32 v79, v126, v127
    v_permlane16_swap_b32 v64, v66
    v_permlane16_swap_b32 v65, v67
    v_permlane16_swap_b32 v68, v70
    v_permlane16_swap_b32 v69, v71
    v_permlane16_swap_b32 v72, v74
    v_permlane16_swap_b32 v73, v75
    v_permlane16_swap_b32 v76, v78
    v_permlane16_swap_b32 v77, v79
    buffer_store_dwordx4 v[64:67], v26, s[32:35], s56 offen offset:0 sc1
    buffer_store_dwordx4 v[68:71], v26, s[32:35], s56 offen offset:1024 sc1
    buffer_store_dwordx4 v[72:75], v26, s[32:35], s57 offen offset:0 sc1
    buffer_store_dwordx4 v[76:79], v26, s[32:35], s57 offen offset:1024 sc1
    s_mov_b32 s58, 1048744942
    s_mov_b32 s59, s58
    v_pk_mul_f32 v[32:33], v[32:33], s[58:59]
    v_pk_mul_f32 v[34:35], v[34:35], s[58:59]
    v_pk_mul_f32 v[36:37], v[36:37], s[58:59]
    v_pk_mul_f32 v[38:39], v[38:39], s[58:59]
    v_pk_mul_f32 v[40:41], v[40:41], s[58:59]
    v_pk_mul_f32 v[42:43], v[42:43], s[58:59]
    v_pk_mul_f32 v[44:45], v[44:45], s[58:59]
    v_pk_mul_f32 v[46:47], v[46:47], s[58:59]
    v_pk_mul_f32 v[48:49], v[48:49], s[58:59]
    v_pk_mul_f32 v[50:51], v[50:51], s[58:59]
    v_pk_mul_f32 v[52:53], v[52:53], s[58:59]
    v_pk_mul_f32 v[54:55], v[54:55], s[58:59]
    v_pk_mul_f32 v[56:57], v[56:57], s[58:59]
    v_pk_mul_f32 v[58:59], v[58:59], s[58:59]
    v_pk_mul_f32 v[60:61], v[60:61], s[58:59]
    v_pk_mul_f32 v[62:63], v[62:63], s[58:59]
    v_cvt_pk_bf16_f32 v80, v32, v33
    v_cvt_pk_bf16_f32 v81, v34, v35
    v_cvt_pk_bf16_f32 v82, v36, v37
    v_cvt_pk_bf16_f32 v83, v38, v39
    v_cvt_pk_bf16_f32 v84, v48, v49
    v_cvt_pk_bf16_f32 v85, v50, v51
    v_cvt_pk_bf16_f32 v86, v52, v53
    v_cvt_pk_bf16_f32 v87, v54, v55
    v_cvt_pk_bf16_f32 v88, v40, v41
    v_cvt_pk_bf16_f32 v89, v42, v43
    v_cvt_pk_bf16_f32 v90, v44, v45
    v_cvt_pk_bf16_f32 v91, v46, v47
    v_cvt_pk_bf16_f32 v92, v56, v57
    v_cvt_pk_bf16_f32 v93, v58, v59
    v_cvt_pk_bf16_f32 v94, v60, v61
    v_cvt_pk_bf16_f32 v95, v62, v63
    v_permlane16_swap_b32 v80, v82
    v_permlane16_swap_b32 v81, v83
    v_permlane16_swap_b32 v84, v86
    v_permlane16_swap_b32 v85, v87
    v_permlane16_swap_b32 v88, v90
    v_permlane16_swap_b32 v89, v91
    v_permlane16_swap_b32 v92, v94
    v_permlane16_swap_b32 v93, v95
    v_accvgpr_write_b32 a176, v80
    v_accvgpr_write_b32 a177, v81
    v_accvgpr_write_b32 a178, v82
    v_accvgpr_write_b32 a179, v83
    v_accvgpr_write_b32 a180, v84
    v_accvgpr_write_b32 a181, v85
    v_accvgpr_write_b32 a182, v86
    v_accvgpr_write_b32 a183, v87
    v_accvgpr_write_b32 a184, v88
    v_accvgpr_write_b32 a185, v89
    v_accvgpr_write_b32 a186, v90
    v_accvgpr_write_b32 a187, v91
    v_accvgpr_write_b32 a188, v92
    v_accvgpr_write_b32 a189, v93
    v_accvgpr_write_b32 a190, v94
    v_accvgpr_write_b32 a191, v95
    v_accvgpr_read_b32 v88, a208
    v_accvgpr_read_b32 v91, a209
    v_accvgpr_read_b32 v94, a210
    v_accvgpr_read_b32 v97, a211
    v_add_u32 v89, 0x10000, v88
    v_add_u32 v90, 0x20000, v88
    v_add_u32 v92, 0x10000, v91
    v_add_u32 v93, 0x20000, v91
    v_add_u32 v95, 0x10000, v94
    v_add_u32 v96, 0x20000, v94
    v_add_u32 v98, 0x10000, v97
    v_add_u32 v99, 0x20000, v97
    s_lshl_b32 s56, s5, 12
    v_add_u32 v100, s56, v13
    v_subrev_u32 v106, s56, v13
    v_add_u32 v106, 4096, v106
    v_xor_b32 v103, 64, v100
    v_add_u32 v101, 0x10000, v100
    v_add_u32 v102, 0x20000, v100
    v_add_u32 v104, 0x10000, v103
    v_add_u32 v105, 0x20000, v103
    v_xor_b32 v109, 64, v106
    v_add_u32 v107, 0x10000, v106
    v_add_u32 v108, 0x20000, v106
    v_add_u32 v110, 0x10000, v109
    v_add_u32 v111, 0x20000, v109
    s_waitcnt vmcnt(17)
    s_barrier
    ds_read_b64_tr_b16 a[16:17], v88 offset:16384
    ds_read_b64_tr_b16 a[18:19], v88 offset:18176
    ds_read_b128 a[0:3], v100 offset:0
    ds_read_b128 a[4:7], v100 offset:2048
    ds_read_b128 a[8:11], v106 offset:0
    ds_read_b128 a[12:15], v106 offset:2048
    ds_read_b64_tr_b16 a[20:21], v91 offset:16384
    ds_read_b64_tr_b16 a[22:23], v91 offset:18176
    ds_read_b64_tr_b16 a[24:25], v88 offset:16448
    ds_read_b64_tr_b16 a[26:27], v88 offset:18240
    ds_read_b64_tr_b16 a[28:29], v91 offset:16576
    ds_read_b64_tr_b16 a[30:31], v91 offset:18368
    ds_read_b64_tr_b16 a[32:33], v88 offset:16640
    ds_read_b64_tr_b16 a[34:35], v88 offset:18432
    ds_read_b64_tr_b16 a[36:37], v91 offset:16640
    ds_read_b64_tr_b16 a[38:39], v91 offset:18432
    ds_read_b64_tr_b16 a[40:41], v97 offset:16448
    ds_read_b64_tr_b16 a[42:43], v97 offset:18240
    ds_read_b64_tr_b16 a[44:45], v94 offset:16704
    ds_read_b64_tr_b16 a[46:47], v94 offset:18496
    s_waitcnt lgkmcnt(0)
    v_mfma_f32_16x16x32_bf16 v[128:131], a[16:19], a[0:3], 0
    ds_read_b64_tr_b16 a[64:65], v88 offset:30720
    v_mfma_f32_16x16x32_bf16 v[132:135], a[16:19], a[4:7], 0
    ds_read_b64_tr_b16 a[66:67], v88 offset:32512
    v_mfma_f32_16x16x32_bf16 v[136:139], a[16:19], a[8:11], 0
    ds_read_b128 a[48:51], v103 offset:0
    buffer_load_dwordx4 v11, s[16:19], s53 offen offset:1024 lds
    v_mfma_f32_16x16x32_bf16 v[140:143], a[16:19], a[12:15], 0
    ds_read_b128 a[52:55], v103 offset:2048
    v_mfma_f32_16x16x32_bf16 v[144:147], a[20:23], a[0:3], 0
    ds_read_b128 a[56:59], v109 offset:0
    v_mfma_f32_16x16x32_bf16 v[148:151], a[20:23], a[4:7], 0
    ds_read_b128 a[60:63], v109 offset:2048
    v_mfma_f32_16x16x32_bf16 v[152:155], a[20:23], a[8:11], 0
    buffer_load_dwordx4 v12, s[16:19], s53 offen offset:2048 lds
    s_mul_i32 s53, s89, 458752
    v_mfma_f32_16x16x32_bf16 v[156:159], a[20:23], a[12:15], 0
    ds_read_b64_tr_b16 a[68:69], v91 offset:30720
    v_mfma_f32_16x16x32_bf16 v[160:163], a[24:27], a[0:3], 0
    ds_read_b64_tr_b16 a[70:71], v91 offset:32512
    v_mfma_f32_16x16x32_bf16 v[164:167], a[24:27], a[4:7], 0
    ds_read_b64_tr_b16 a[72:73], v88 offset:30784
    s_add_u32 m0, s54, 90112
    v_mfma_f32_16x16x32_bf16 v[168:171], a[24:27], a[8:11], 0
    buffer_load_dwordx4 v2, s[8:11], s52 offen offset:0 lds
    s_add_u32 s88, s88, 1
    v_mfma_f32_16x16x32_bf16 v[172:175], a[24:27], a[12:15], 0
    ds_read_b64_tr_b16 a[74:75], v88 offset:32576
    s_add_u32 s89, s88, s101
    v_mfma_f32_16x16x32_bf16 v[176:179], a[28:31], a[0:3], 0
    ds_read_b64_tr_b16 a[76:77], v91 offset:30912
    v_mfma_f32_16x16x32_bf16 v[180:183], a[28:31], a[4:7], 0
    ds_read_b64_tr_b16 a[78:79], v91 offset:32704
    v_mfma_f32_16x16x32_bf16 v[184:187], a[28:31], a[8:11], 0
    buffer_load_dwordx4 v3, s[8:11], s52 offen offset:1024 lds
    s_and_b32 s89, s89, 3
    v_mfma_f32_16x16x32_bf16 v[188:191], a[28:31], a[12:15], 0
    ds_read_b64_tr_b16 a[80:81], v88 offset:30976
    s_andn2_b32 s90, s88, 3
    v_mfma_f32_16x16x32_bf16 v[192:195], a[32:35], a[0:3], 0
    ds_read_b64_tr_b16 a[82:83], v88 offset:32768
    v_mfma_f32_16x16x32_bf16 v[196:199], a[32:35], a[4:7], 0
    ds_read_b64_tr_b16 a[84:85], v91 offset:30976
    v_mfma_f32_16x16x32_bf16 v[200:203], a[32:35], a[8:11], 0
    buffer_load_dwordx4 v4, s[8:11], s52 offen offset:2048 lds
    s_or_b32 s89, s89, s90
    v_mfma_f32_16x16x32_bf16 v[204:207], a[32:35], a[12:15], 0
    ds_read_b64_tr_b16 a[86:87], v91 offset:32768
    v_mfma_f32_16x16x32_bf16 v[208:211], a[36:39], a[0:3], 0
    ds_read_b64_tr_b16 a[88:89], v97 offset:30784
    v_mfma_f32_16x16x32_bf16 v[212:215], a[36:39], a[4:7], 0
    ds_read_b64_tr_b16 a[90:91], v97 offset:32576
    v_mfma_f32_16x16x32_bf16 v[216:219], a[36:39], a[8:11], 0
    buffer_load_dwordx4 v5, s[8:11], s52 offen offset:3072 lds
    s_lshl_b32 s52, s89, 7
    v_mfma_f32_16x16x32_bf16 v[220:223], a[36:39], a[12:15], 0
    ds_read_b64_tr_b16 a[92:93], v94 offset:31040
    v_mfma_f32_16x16x32_bf16 v[224:227], a[40:43], a[0:3], 0
    ds_read_b64_tr_b16 a[94:95], v94 offset:32832
    v_mfma_f32_16x16x32_bf16 v[228:231], a[40:43], a[4:7], 0
    s_add_u32 m0, s55, 106496
    v_mfma_f32_16x16x32_bf16 v[232:235], a[44:47], a[0:3], 0
    buffer_load_dwordx4 v6, s[16:19], s53 offen offset:0 lds
    v_mfma_f32_16x16x32_bf16 v[236:239], a[44:47], a[4:7], 0
    s_waitcnt vmcnt(5) lgkmcnt(0)
    s_barrier
    v_mfma_f32_16x16x32_bf16 v[128:131], a[64:67], a[48:51], v[128:131]
    ds_read_b64_tr_b16 a[16:17], v88 offset:61440
    v_mfma_f32_16x16x32_bf16 v[132:135], a[64:67], a[52:55], v[132:135]
    ds_read_b64_tr_b16 a[18:19], v88 offset:63232
    buffer_load_dwordx4 v7, s[16:19], s53 offen offset:1024 lds
    v_mfma_f32_16x16x32_bf16 v[136:139], a[64:67], a[56:59], v[136:139]
    ds_read_b128 a[0:3], v100 offset:45056
    v_mfma_f32_16x16x32_bf16 v[140:143], a[64:67], a[60:63], v[140:143]
    ds_read_b128 a[4:7], v100 offset:47104
    v_mfma_f32_16x16x32_bf16 v[144:147], a[68:71], a[48:51], v[144:147]
    ds_read_b128 a[8:11], v106 offset:45056
    v_mfma_f32_16x16x32_bf16 v[148:151], a[68:71], a[52:55], v[148:151]
    ds_read_b128 a[12:15], v106 offset:47104
    buffer_load_dwordx4 v8, s[16:19], s53 offen offset:2048 lds
    v_mfma_f32_16x16x32_bf16 v[152:155], a[68:71], a[56:59], v[152:155]
    ds_read_b64_tr_b16 a[20:21], v91 offset:61440
    v_mfma_f32_16x16x32_bf16 v[156:159], a[68:71], a[60:63], v[156:159]
    ds_read_b64_tr_b16 a[22:23], v91 offset:63232
    v_mfma_f32_16x16x32_bf16 v[160:163], a[72:75], a[48:51], v[160:163]
    buffer_load_dwordx4 v9, s[16:19], s53 offen offset:3072 lds
    v_mfma_f32_16x16x32_bf16 v[164:167], a[72:75], a[52:55], v[164:167]
    ds_read_b64_tr_b16 a[24:25], v88 offset:61504
    v_mfma_f32_16x16x32_bf16 v[168:171], a[72:75], a[56:59], v[168:171]
    ds_read_b64_tr_b16 a[26:27], v88 offset:63296
    v_mfma_f32_16x16x32_bf16 v[172:175], a[72:75], a[60:63], v[172:175]
    ds_read_b64_tr_b16 a[28:29], v91 offset:61632
    s_add_u32 m0, s55, 110592
    v_mfma_f32_16x16x32_bf16 v[176:179], a[76:79], a[48:51], v[176:179]
    buffer_load_dwordx4 v10, s[16:19], s53 offen offset:0 lds
    v_mfma_f32_16x16x32_bf16 v[180:183], a[76:79], a[52:55], v[180:183]
    ds_read_b64_tr_b16 a[30:31], v91 offset:63424
    v_mfma_f32_16x16x32_bf16 v[184:187], a[76:79], a[56:59], v[184:187]
    ds_read_b64_tr_b16 a[32:33], v88 offset:61696
    v_mfma_f32_16x16x32_bf16 v[188:191], a[76:79], a[60:63], v[188:191]
    buffer_load_dwordx4 v11, s[16:19], s53 offen offset:1024 lds
    v_mfma_f32_16x16x32_bf16 v[192:195], a[80:83], a[48:51], v[192:195]
    ds_read_b64_tr_b16 a[34:35], v88 offset:63488
    v_mfma_f32_16x16x32_bf16 v[196:199], a[80:83], a[52:55], v[196:199]
    ds_read_b64_tr_b16 a[36:37], v91 offset:61696
    v_mfma_f32_16x16x32_bf16 v[200:203], a[80:83], a[56:59], v[200:203]
    ds_read_b64_tr_b16 a[38:39], v91 offset:63488
    v_mfma_f32_16x16x32_bf16 v[204:207], a[80:83], a[60:63], v[204:207]
    buffer_load_dwordx4 v12, s[16:19], s53 offen offset:2048 lds
    s_mul_i32 s53, s89, 458752
    v_mfma_f32_16x16x32_bf16 v[208:211], a[84:87], a[48:51], v[208:211]
    ds_read_b64_tr_b16 a[40:41], v97 offset:61504
    v_mfma_f32_16x16x32_bf16 v[212:215], a[84:87], a[52:55], v[212:215]
    ds_read_b64_tr_b16 a[42:43], v97 offset:63296
    s_add_u32 m0, s54, 0
    v_mfma_f32_16x16x32_bf16 v[216:219], a[84:87], a[56:59], v[216:219]
    buffer_load_dwordx4 v2, s[8:11], s52 offen offset:0 lds
    s_add_u32 s88, s88, 1
    v_mfma_f32_16x16x32_bf16 v[220:223], a[84:87], a[60:63], v[220:223]
    ds_read_b64_tr_b16 a[44:45], v94 offset:61760
    s_add_u32 s89, s88, s101
    v_mfma_f32_16x16x32_bf16 v[224:227], a[88:91], a[48:51], v[224:227]
    ds_read_b64_tr_b16 a[46:47], v94 offset:63552
    v_mfma_f32_16x16x32_bf16 v[228:231], a[88:91], a[52:55], v[228:231]
    v_mfma_f32_16x16x32_bf16 v[232:235], a[92:95], a[48:51], v[232:235]
    buffer_load_dwordx4 v3, s[8:11], s52 offen offset:1024 lds
    s_and_b32 s89, s89, 3
    v_mfma_f32_16x16x32_bf16 v[236:239], a[92:95], a[52:55], v[236:239]
    s_andn2_b32 s90, s88, 3
    s_waitcnt lgkmcnt(0)
    v_mfma_f32_16x16x32_bf16 v[128:131], a[16:19], a[0:3], v[128:131]
    ds_read_b64_tr_b16 a[64:65], v89 offset:10240
    v_mfma_f32_16x16x32_bf16 v[132:135], a[16:19], a[4:7], v[132:135]
    ds_read_b64_tr_b16 a[66:67], v89 offset:12032
    v_mfma_f32_16x16x32_bf16 v[136:139], a[16:19], a[8:11], v[136:139]
    ds_read_b128 a[48:51], v103 offset:45056
    buffer_load_dwordx4 v4, s[8:11], s52 offen offset:2048 lds
    s_or_b32 s89, s89, s90
    v_mfma_f32_16x16x32_bf16 v[140:143], a[16:19], a[12:15], v[140:143]
    ds_read_b128 a[52:55], v103 offset:47104
    v_mfma_f32_16x16x32_bf16 v[144:147], a[20:23], a[0:3], v[144:147]
    ds_read_b128 a[56:59], v109 offset:45056
    v_mfma_f32_16x16x32_bf16 v[148:151], a[20:23], a[4:7], v[148:151]
    ds_read_b128 a[60:63], v109 offset:47104
    v_mfma_f32_16x16x32_bf16 v[152:155], a[20:23], a[8:11], v[152:155]
    buffer_load_dwordx4 v5, s[8:11], s52 offen offset:3072 lds
    s_lshl_b32 s52, s89, 7
    v_mfma_f32_16x16x32_bf16 v[156:159], a[20:23], a[12:15], v[156:159]
    ds_read_b64_tr_b16 a[68:69], v92 offset:10240
    v_mfma_f32_16x16x32_bf16 v[160:163], a[24:27], a[0:3], v[160:163]
    ds_read_b64_tr_b16 a[70:71], v92 offset:12032
    v_mfma_f32_16x16x32_bf16 v[164:167], a[24:27], a[4:7], v[164:167]
    ds_read_b64_tr_b16 a[72:73], v89 offset:10304
    s_add_u32 m0, s55, 16384
    v_mfma_f32_16x16x32_bf16 v[168:171], a[24:27], a[8:11], v[168:171]
    buffer_load_dwordx4 v6, s[16:19], s53 offen offset:0 lds
    v_mfma_f32_16x16x32_bf16 v[172:175], a[24:27], a[12:15], v[172:175]
    ds_read_b64_tr_b16 a[74:75], v89 offset:12096
    v_mfma_f32_16x16x32_bf16 v[176:179], a[28:31], a[0:3], v[176:179]
    ds_read_b64_tr_b16 a[76:77], v92 offset:10432
    v_mfma_f32_16x16x32_bf16 v[180:183], a[28:31], a[4:7], v[180:183]
    ds_read_b64_tr_b16 a[78:79], v92 offset:12224
    v_mfma_f32_16x16x32_bf16 v[184:187], a[28:31], a[8:11], v[184:187]
    buffer_load_dwordx4 v7, s[16:19], s53 offen offset:1024 lds
    v_mfma_f32_16x16x32_bf16 v[188:191], a[28:31], a[12:15], v[188:191]
    ds_read_b64_tr_b16 a[80:81], v89 offset:10496
    v_mfma_f32_16x16x32_bf16 v[192:195], a[32:35], a[0:3], v[192:195]
    ds_read_b64_tr_b16 a[82:83], v89 offset:12288
    v_mfma_f32_16x16x32_bf16 v[196:199], a[32:35], a[4:7], v[196:199]
    ds_read_b64_tr_b16 a[84:85], v92 offset:10496
    v_mfma_f32_16x16x32_bf16 v[200:203], a[32:35], a[8:11], v[200:203]
    buffer_load_dwordx4 v8, s[16:19], s53 offen offset:2048 lds
    v_mfma_f32_16x16x32_bf16 v[204:207], a[32:35], a[12:15], v[204:207]
    ds_read_b64_tr_b16 a[86:87], v92 offset:12288
    v_mfma_f32_16x16x32_bf16 v[208:211], a[36:39], a[0:3], v[208:211]
    ds_read_b64_tr_b16 a[88:89], v98 offset:10304
    v_mfma_f32_16x16x32_bf16 v[212:215], a[36:39], a[4:7], v[212:215]
    ds_read_b64_tr_b16 a[90:91], v98 offset:12096
    v_mfma_f32_16x16x32_bf16 v[216:219], a[36:39], a[8:11], v[216:219]
    buffer_load_dwordx4 v9, s[16:19], s53 offen offset:3072 lds
    v_mfma_f32_16x16x32_bf16 v[220:223], a[36:39], a[12:15], v[220:223]
    ds_read_b64_tr_b16 a[92:93], v95 offset:10560
    v_mfma_f32_16x16x32_bf16 v[224:227], a[40:43], a[0:3], v[224:227]
    ds_read_b64_tr_b16 a[94:95], v95 offset:12352
    v_mfma_f32_16x16x32_bf16 v[228:231], a[40:43], a[4:7], v[228:231]
    s_add_u32 m0, s55, 20480
    v_mfma_f32_16x16x32_bf16 v[232:235], a[44:47], a[0:3], v[232:235]
    buffer_load_dwordx4 v10, s[16:19], s53 offen offset:0 lds
    v_mfma_f32_16x16x32_bf16 v[236:239], a[44:47], a[4:7], v[236:239]
    s_waitcnt vmcnt(9) lgkmcnt(0)
    s_barrier
    v_mfma_f32_16x16x32_bf16 v[128:131], a[64:67], a[48:51], v[128:131]
    ds_read_b64_tr_b16 a[16:17], v89 offset:40960
    v_mfma_f32_16x16x32_bf16 v[132:135], a[64:67], a[52:55], v[132:135]
    ds_read_b64_tr_b16 a[18:19], v89 offset:42752
    buffer_load_dwordx4 v11, s[16:19], s53 offen offset:1024 lds
    v_mfma_f32_16x16x32_bf16 v[136:139], a[64:67], a[56:59], v[136:139]
    ds_read_b128 a[0:3], v101 offset:24576
    v_mfma_f32_16x16x32_bf16 v[140:143], a[64:67], a[60:63], v[140:143]
    ds_read_b128 a[4:7], v101 offset:26624
    v_mfma_f32_16x16x32_bf16 v[144:147], a[68:71], a[48:51], v[144:147]
    ds_read_b128 a[8:11], v107 offset:24576
    v_mfma_f32_16x16x32_bf16 v[148:151], a[68:71], a[52:55], v[148:151]
    ds_read_b128 a[12:15], v107 offset:26624
    buffer_load_dwordx4 v12, s[16:19], s53 offen offset:2048 lds
    s_mul_i32 s53, s89, 458752
    v_mfma_f32_16x16x32_bf16 v[152:155], a[68:71], a[56:59], v[152:155]
    ds_read_b64_tr_b16 a[20:21], v92 offset:40960
    v_mfma_f32_16x16x32_bf16 v[156:159], a[68:71], a[60:63], v[156:159]
    ds_read_b64_tr_b16 a[22:23], v92 offset:42752
    s_add_u32 m0, s54, 45056
    v_mfma_f32_16x16x32_bf16 v[160:163], a[72:75], a[48:51], v[160:163]
    buffer_load_dwordx4 v2, s[8:11], s52 offen offset:0 lds
    s_add_u32 s88, s88, 1
    v_mfma_f32_16x16x32_bf16 v[164:167], a[72:75], a[52:55], v[164:167]
    ds_read_b64_tr_b16 a[24:25], v89 offset:41024
    s_add_u32 s89, s88, s101
    v_mfma_f32_16x16x32_bf16 v[168:171], a[72:75], a[56:59], v[168:171]
    ds_read_b64_tr_b16 a[26:27], v89 offset:42816
    v_mfma_f32_16x16x32_bf16 v[172:175], a[72:75], a[60:63], v[172:175]
    ds_read_b64_tr_b16 a[28:29], v92 offset:41152
    v_mfma_f32_16x16x32_bf16 v[176:179], a[76:79], a[48:51], v[176:179]
    buffer_load_dwordx4 v3, s[8:11], s52 offen offset:1024 lds
    s_and_b32 s89, s89, 3
    v_mfma_f32_16x16x32_bf16 v[180:183], a[76:79], a[52:55], v[180:183]
    ds_read_b64_tr_b16 a[30:31], v92 offset:42944
    s_andn2_b32 s90, s88, 3
    v_mfma_f32_16x16x32_bf16 v[184:187], a[76:79], a[56:59], v[184:187]
    ds_read_b64_tr_b16 a[32:33], v89 offset:41216
    v_mfma_f32_16x16x32_bf16 v[188:191], a[76:79], a[60:63], v[188:191]
    buffer_load_dwordx4 v4, s[8:11], s52 offen offset:2048 lds
    s_or_b32 s89, s89, s90
    v_mfma_f32_16x16x32_bf16 v[192:195], a[80:83], a[48:51], v[192:195]
    ds_read_b64_tr_b16 a[34:35], v89 offset:43008
    v_mfma_f32_16x16x32_bf16 v[196:199], a[80:83], a[52:55], v[196:199]
    ds_read_b64_tr_b16 a[36:37], v92 offset:41216
    v_mfma_f32_16x16x32_bf16 v[200:203], a[80:83], a[56:59], v[200:203]
    ds_read_b64_tr_b16 a[38:39], v92 offset:43008
    v_mfma_f32_16x16x32_bf16 v[204:207], a[80:83], a[60:63], v[204:207]
    buffer_load_dwordx4 v5, s[8:11], s52 offen offset:3072 lds
    s_lshl_b32 s52, s89, 7
    v_mfma_f32_16x16x32_bf16 v[208:211], a[84:87], a[48:51], v[208:211]
    ds_read_b64_tr_b16 a[40:41], v98 offset:41024
    v_mfma_f32_16x16x32_bf16 v[212:215], a[84:87], a[52:55], v[212:215]
    ds_read_b64_tr_b16 a[42:43], v98 offset:42816
    s_add_u32 m0, s55, 61440
    v_mfma_f32_16x16x32_bf16 v[216:219], a[84:87], a[56:59], v[216:219]
    buffer_load_dwordx4 v6, s[16:19], s53 offen offset:0 lds
    v_mfma_f32_16x16x32_bf16 v[220:223], a[84:87], a[60:63], v[220:223]
    ds_read_b64_tr_b16 a[44:45], v95 offset:41280
    v_mfma_f32_16x16x32_bf16 v[224:227], a[88:91], a[48:51], v[224:227]
    ds_read_b64_tr_b16 a[46:47], v95 offset:43072
    v_mfma_f32_16x16x32_bf16 v[228:231], a[88:91], a[52:55], v[228:231]
    v_mfma_f32_16x16x32_bf16 v[232:235], a[92:95], a[48:51], v[232:235]
    buffer_load_dwordx4 v7, s[16:19], s53 offen offset:1024 lds
    v_mfma_f32_16x16x32_bf16 v[236:239], a[92:95], a[52:55], v[236:239]
    s_waitcnt lgkmcnt(0)
    v_mfma_f32_16x16x32_bf16 v[128:131], a[16:19], a[0:3], v[128:131]
    ds_read_b64_tr_b16 a[64:65], v89 offset:55296
    v_mfma_f32_16x16x32_bf16 v[132:135], a[16:19], a[4:7], v[132:135]
    ds_read_b64_tr_b16 a[66:67], v89 offset:57088
    v_mfma_f32_16x16x32_bf16 v[136:139], a[16:19], a[8:11], v[136:139]
    buffer_load_dwordx4 v8, s[16:19], s53 offen offset:2048 lds
    v_mfma_f32_16x16x32_bf16 v[140:143], a[16:19], a[12:15], v[140:143]
    ds_read_b128 a[48:51], v104 offset:24576
    v_mfma_f32_16x16x32_bf16 v[144:147], a[20:23], a[0:3], v[144:147]
    ds_read_b128 a[52:55], v104 offset:26624
    v_mfma_f32_16x16x32_bf16 v[148:151], a[20:23], a[4:7], v[148:151]
    ds_read_b128 a[56:59], v110 offset:24576
    v_mfma_f32_16x16x32_bf16 v[152:155], a[20:23], a[8:11], v[152:155]
    ds_read_b128 a[60:63], v110 offset:26624
    v_mfma_f32_16x16x32_bf16 v[156:159], a[20:23], a[12:15], v[156:159]
    ds_read_b64_tr_b16 a[68:69], v92 offset:55296
    v_mfma_f32_16x16x32_bf16 v[160:163], a[24:27], a[0:3], v[160:163]
    buffer_load_dwordx4 v9, s[16:19], s53 offen offset:3072 lds
    v_mfma_f32_16x16x32_bf16 v[164:167], a[24:27], a[4:7], v[164:167]
    ds_read_b64_tr_b16 a[70:71], v92 offset:57088
    v_mfma_f32_16x16x32_bf16 v[168:171], a[24:27], a[8:11], v[168:171]
    ds_read_b64_tr_b16 a[72:73], v89 offset:55360
    v_mfma_f32_16x16x32_bf16 v[172:175], a[24:27], a[12:15], v[172:175]
    ds_read_b64_tr_b16 a[74:75], v89 offset:57152
    v_mfma_f32_16x16x32_bf16 v[176:179], a[28:31], a[0:3], v[176:179]
    ds_read_b64_tr_b16 a[76:77], v92 offset:55488
    v_mfma_f32_16x16x32_bf16 v[180:183], a[28:31], a[4:7], v[180:183]
    ds_read_b64_tr_b16 a[78:79], v92 offset:57280
    s_add_u32 m0, s55, 65536
    v_mfma_f32_16x16x32_bf16 v[184:187], a[28:31], a[8:11], v[184:187]
    buffer_load_dwordx4 v10, s[16:19], s53 offen offset:0 lds
    v_mfma_f32_16x16x32_bf16 v[188:191], a[28:31], a[12:15], v[188:191]
    ds_read_b64_tr_b16 a[80:81], v89 offset:55552
    v_mfma_f32_16x16x32_bf16 v[192:195], a[32:35], a[0:3], v[192:195]
    ds_read_b64_tr_b16 a[82:83], v89 offset:57344
    v_mfma_f32_16x16x32_bf16 v[196:199], a[32:35], a[4:7], v[196:199]
    ds_read_b64_tr_b16 a[84:85], v92 offset:55552
    v_mfma_f32_16x16x32_bf16 v[200:203], a[32:35], a[8:11], v[200:203]
    ds_read_b64_tr_b16 a[86:87], v92 offset:57344
    v_mfma_f32_16x16x32_bf16 v[204:207], a[32:35], a[12:15], v[204:207]
    buffer_load_dwordx4 v11, s[16:19], s53 offen offset:1024 lds
    v_mfma_f32_16x16x32_bf16 v[208:211], a[36:39], a[0:3], v[208:211]
    ds_read_b64_tr_b16 a[88:89], v98 offset:55360
    v_mfma_f32_16x16x32_bf16 v[212:215], a[36:39], a[4:7], v[212:215]
    ds_read_b64_tr_b16 a[90:91], v98 offset:57152
    v_mfma_f32_16x16x32_bf16 v[216:219], a[36:39], a[8:11], v[216:219]
    ds_read_b64_tr_b16 a[92:93], v95 offset:55616
    v_mfma_f32_16x16x32_bf16 v[220:223], a[36:39], a[12:15], v[220:223]
    ds_read_b64_tr_b16 a[94:95], v95 offset:57408
    v_mfma_f32_16x16x32_bf16 v[224:227], a[40:43], a[0:3], v[224:227]
    v_mfma_f32_16x16x32_bf16 v[228:231], a[40:43], a[4:7], v[228:231]
    buffer_load_dwordx4 v12, s[16:19], s53 offen offset:2048 lds
    s_mul_i32 s53, s89, 458752
    v_mfma_f32_16x16x32_bf16 v[232:235], a[44:47], a[0:3], v[232:235]
    v_mfma_f32_16x16x32_bf16 v[236:239], a[44:47], a[4:7], v[236:239]
    s_waitcnt vmcnt(11) lgkmcnt(0)
    s_barrier
    s_cmp_lg_u32 s3, 1
    s_cbranch_scc1 PUB_1
    s_add_u32 s99, s94, 1
    v_mov_b32 v0, s99
    s_mov_b64 exec, 1
    buffer_store_dword v0, v255, s[32:35], s93 offen sc1
    s_mov_b64 exec, -1
PUB_1:
    v_mfma_f32_16x16x32_bf16 v[128:131], a[64:67], a[48:51], v[128:131]
    ds_read_b64_tr_b16 a[16:17], v88 offset:16384
    v_mfma_f32_16x16x32_bf16 v[132:135], a[64:67], a[52:55], v[132:135]
    ds_read_b64_tr_b16 a[18:19], v88 offset:18176
    s_add_u32 m0, s54, 90112
    v_mfma_f32_16x16x32_bf16 v[136:139], a[64:67], a[56:59], v[136:139]
    buffer_load_dwordx4 v2, s[8:11], s52 offen offset:0 lds
    s_add_u32 s88, s88, 1
    v_mfma_f32_16x16x32_bf16 v[140:143], a[64:67], a[60:63], v[140:143]
    ds_read_b128 a[0:3], v100 offset:0
    s_add_u32 s89, s88, s101
    v_mfma_f32_16x16x32_bf16 v[144:147], a[68:71], a[48:51], v[144:147]
    ds_read_b128 a[4:7], v100 offset:2048
    v_mfma_f32_16x16x32_bf16 v[148:151], a[68:71], a[52:55], v[148:151]
    ds_read_b128 a[8:11], v106 offset:0
    v_mfma_f32_16x16x32_bf16 v[152:155], a[68:71], a[56:59], v[152:155]
    ds_read_b128 a[12:15], v106 offset:2048
    v_mfma_f32_16x16x32_bf16 v[156:159], a[68:71], a[60:63], v[156:159]
    buffer_load_dwordx4 v3, s[8:11], s52 offen offset:1024 lds
    s_and_b32 s89, s89, 3
    v_mfma_f32_16x16x32_bf16 v[160:163], a[72:75], a[48:51], v[160:163]
    ds_read_b64_tr_b16 a[20:21], v91 offset:16384
    s_andn2_b32 s90, s88, 3
    v_mfma_f32_16x16x32_bf16 v[164:167], a[72:75], a[52:55], v[164:167]
    ds_read_b64_tr_b16 a[22:23], v91 offset:18176
    v_mfma_f32_16x16x32_bf16 v[168:171], a[72:75], a[56:59], v[168:171]
    ds_read_b64_tr_b16 a[24:25], v88 offset:16448
    v_mfma_f32_16x16x32_bf16 v[172:175], a[72:75], a[60:63], v[172:175]
    buffer_load_dwordx4 v4, s[8:11], s52 offen offset:2048 lds
    s_or_b32 s89, s89, s90
    v_mfma_f32_16x16x32_bf16 v[176:179], a[76:79], a[48:51], v[176:179]
    ds_read_b64_tr_b16 a[26:27], v88 offset:18240
    v_mfma_f32_16x16x32_bf16 v[180:183], a[76:79], a[52:55], v[180:183]
    ds_read_b64_tr_b16 a[28:29], v91 offset:16576
    v_mfma_f32_16x16x32_bf16 v[184:187], a[76:79], a[56:59], v[184:187]
    ds_read_b64_tr_b16 a[30:31], v91 offset:18368
    v_mfma_f32_16x16x32_bf16 v[188:191], a[76:79], a[60:63], v[188:191]
    ds_read_b64_tr_b16 a[32:33], v88 offset:16640
    v_mfma_f32_16x16x32_bf16 v[192:195], a[80:83], a[48:51], v[192:195]
    buffer_load_dwordx4 v5, s[8:11], s52 offen offset:3072 lds
    s_lshl_b32 s52, s89, 7
    v_mfma_f32_16x16x32_bf16 v[196:199], a[80:83], a[52:55], v[196:199]
    ds_read_b64_tr_b16 a[34:35], v88 offset:18432
    v_mfma_f32_16x16x32_bf16 v[200:203], a[80:83], a[56:59], v[200:203]
    ds_read_b64_tr_b16 a[36:37], v91 offset:16640
    v_mfma_f32_16x16x32_bf16 v[204:207], a[80:83], a[60:63], v[204:207]
    ds_read_b64_tr_b16 a[38:39], v91 offset:18432
    v_mfma_f32_16x16x32_bf16 v[208:211], a[84:87], a[48:51], v[208:211]
    ds_read_b64_tr_b16 a[40:41], v97 offset:16448
    s_add_u32 m0, s55, 106496
    v_mfma_f32_16x16x32_bf16 v[212:215], a[84:87], a[52:55], v[212:215]
    buffer_load_dwordx4 v6, s[16:19], s53 offen offset:0 lds
    v_mfma_f32_16x16x32_bf16 v[216:219], a[84:87], a[56:59], v[216:219]
    ds_read_b64_tr_b16 a[42:43], v97 offset:18240
    v_mfma_f32_16x16x32_bf16 v[220:223], a[84:87], a[60:63], v[220:223]
    ds_read_b64_tr_b16 a[44:45], v94 offset:16704
    v_mfma_f32_16x16x32_bf16 v[224:227], a[88:91], a[48:51], v[224:227]
    ds_read_b64_tr_b16 a[46:47], v94 offset:18496
    v_mfma_f32_16x16x32_bf16 v[228:231], a[88:91], a[52:55], v[228:231]
    buffer_load_dwordx4 v7, s[16:19], s53 offen offset:1024 lds
    v_mfma_f32_16x16x32_bf16 v[232:235], a[92:95], a[48:51], v[232:235]
    v_mfma_f32_16x16x32_bf16 v[236:239], a[92:95], a[52:55], v[236:239]
    s_waitcnt lgkmcnt(0)
    s_mov_b32 s98, 3
.p2align 3
LOOP_p1b_1:
    v_mfma_f32_16x16x32_bf16 v[128:131], a[16:19], a[0:3], v[128:131]
    ds_read_b64_tr_b16 a[64:65], v88 offset:30720
    v_mfma_f32_16x16x32_bf16 v[132:135], a[16:19], a[4:7], v[132:135]
    ds_read_b64_tr_b16 a[66:67], v88 offset:32512
    v_mfma_f32_16x16x32_bf16 v[136:139], a[16:19], a[8:11], v[136:139]
    buffer_load_dwordx4 v8, s[16:19], s53 offen offset:2048 lds
    v_mfma_f32_16x16x32_bf16 v[140:143], a[16:19], a[12:15], v[140:143]
    ds_read_b128 a[48:51], v103 offset:0
    v_mfma_f32_16x16x32_bf16 v[144:147], a[20:23], a[0:3], v[144:147]
    ds_read_b128 a[52:55], v103 offset:2048
    v_mfma_f32_16x16x32_bf16 v[148:151], a[20:23], a[4:7], v[148:151]
    ds_read_b128 a[56:59], v109 offset:0
    v_mfma_f32_16x16x32_bf16 v[152:155], a[20:23], a[8:11], v[152:155]
    ds_read_b128 a[60:63], v109 offset:2048
    v_mfma_f32_16x16x32_bf16 v[156:159], a[20:23], a[12:15], v[156:159]
    ds_read_b64_tr_b16 a[68:69], v91 offset:30720
    v_mfma_f32_16x16x32_bf16 v[160:163], a[24:27], a[0:3], v[160:163]
    buffer_load_dwordx4 v9, s[16:19], s53 offen offset:3072 lds
    v_mfma_f32_16x16x32_bf16 v[164:167], a[24:27], a[4:7], v[164:167]
    ds_read_b64_tr_b16 a[70:71], v91 offset:32512
    v_mfma_f32_16x16x32_bf16 v[168:171], a[24:27], a[8:11], v[168:171]
    ds_read_b64_tr_b16 a[72:73], v88 offset:30784
    v_mfma_f32_16x16x32_bf16 v[172:175], a[24:27], a[12:15], v[172:175]
    ds_read_b64_tr_b16 a[74:75], v88 offset:32576
    v_mfma_f32_16x16x32_bf16 v[176:179], a[28:31], a[0:3], v[176:179]
    ds_read_b64_tr_b16 a[76:77], v91 offset:30912
    v_mfma_f32_16x16x32_bf16 v[180:183], a[28:31], a[4:7], v[180:183]
    ds_read_b64_tr_b16 a[78:79], v91 offset:32704
    s_add_u32 m0, s55, 110592
    v_mfma_f32_16x16x32_bf16 v[184:187], a[28:31], a[8:11], v[184:187]
    buffer_load_dwordx4 v10, s[16:19], s53 offen offset:0 lds
    v_mfma_f32_16x16x32_bf16 v[188:191], a[28:31], a[12:15], v[188:191]
    ds_read_b64_tr_b16 a[80:81], v88 offset:30976
    v_mfma_f32_16x16x32_bf16 v[192:195], a[32:35], a[0:3], v[192:195]
    ds_read_b64_tr_b16 a[82:83], v88 offset:32768
    v_mfma_f32_16x16x32_bf16 v[196:199], a[32:35], a[4:7], v[196:199]
    ds_read_b64_tr_b16 a[84:85], v91 offset:30976
    v_mfma_f32_16x16x32_bf16 v[200:203], a[32:35], a[8:11], v[200:203]
    ds_read_b64_tr_b16 a[86:87], v91 offset:32768
    v_mfma_f32_16x16x32_bf16 v[204:207], a[32:35], a[12:15], v[204:207]
    buffer_load_dwordx4 v11, s[16:19], s53 offen offset:1024 lds
    v_mfma_f32_16x16x32_bf16 v[208:211], a[36:39], a[0:3], v[208:211]
    ds_read_b64_tr_b16 a[88:89], v97 offset:30784
    v_mfma_f32_16x16x32_bf16 v[212:215], a[36:39], a[4:7], v[212:215]
    ds_read_b64_tr_b16 a[90:91], v97 offset:32576
    v_mfma_f32_16x16x32_bf16 v[216:219], a[36:39], a[8:11], v[216:219]
    ds_read_b64_tr_b16 a[92:93], v94 offset:31040
    v_mfma_f32_16x16x32_bf16 v[220:223], a[36:39], a[12:15], v[220:223]
    ds_read_b64_tr_b16 a[94:95], v94 offset:32832
    v_mfma_f32_16x16x32_bf16 v[224:227], a[40:43], a[0:3], v[224:227]
    v_mfma_f32_16x16x32_bf16 v[228:231], a[40:43], a[4:7], v[228:231]
    buffer_load_dwordx4 v12, s[16:19], s53 offen offset:2048 lds
    s_mul_i32 s53, s89, 458752
    v_mfma_f32_16x16x32_bf16 v[232:235], a[44:47], a[0:3], v[232:235]
    v_mfma_f32_16x16x32_bf16 v[236:239], a[44:47], a[4:7], v[236:239]
    s_waitcnt vmcnt(11) lgkmcnt(0)
    s_barrier
    v_mfma_f32_16x16x32_bf16 v[128:131], a[64:67], a[48:51], v[128:131]
    ds_read_b64_tr_b16 a[16:17], v88 offset:61440
    v_mfma_f32_16x16x32_bf16 v[132:135], a[64:67], a[52:55], v[132:135]
    ds_read_b64_tr_b16 a[18:19], v88 offset:63232
    s_add_u32 m0, s54, 0
    v_mfma_f32_16x16x32_bf16 v[136:139], a[64:67], a[56:59], v[136:139]
    buffer_load_dwordx4 v2, s[8:11], s52 offen offset:0 lds
    s_add_u32 s88, s88, 1
    v_mfma_f32_16x16x32_bf16 v[140:143], a[64:67], a[60:63], v[140:143]
    ds_read_b128 a[0:3], v100 offset:45056
    s_add_u32 s89, s88, s101
    v_mfma_f32_16x16x32_bf16 v[144:147], a[68:71], a[48:51], v[144:147]
    ds_read_b128 a[4:7], v100 offset:47104
    v_mfma_f32_16x16x32_bf16 v[148:151], a[68:71], a[52:55], v[148:151]
    ds_read_b128 a[8:11], v106 offset:45056
    v_mfma_f32_16x16x32_bf16 v[152:155], a[68:71], a[56:59], v[152:155]
    ds_read_b128 a[12:15], v106 offset:47104
    v_mfma_f32_16x16x32_bf16 v[156:159], a[68:71], a[60:63], v[156:159]
    buffer_load_dwordx4 v3, s[8:11], s52 offen offset:1024 lds
    s_and_b32 s89, s89, 3
    v_mfma_f32_16x16x32_bf16 v[160:163], a[72:75], a[48:51], v[160:163]
    ds_read_b64_tr_b16 a[20:21], v91 offset:61440
    s_andn2_b32 s90, s88, 3
    v_mfma_f32_16x16x32_bf16 v[164:167], a[72:75], a[52:55], v[164:167]
    ds_read_b64_tr_b16 a[22:23], v91 offset:63232
    v_mfma_f32_16x16x32_bf16 v[168:171], a[72:75], a[56:59], v[168:171]
    ds_read_b64_tr_b16 a[24:25], v88 offset:61504
    v_mfma_f32_16x16x32_bf16 v[172:175], a[72:75], a[60:63], v[172:175]
    buffer_load_dwordx4 v4, s[8:11], s52 offen offset:2048 lds
    s_or_b32 s89, s89, s90
    v_mfma_f32_16x16x32_bf16 v[176:179], a[76:79], a[48:51], v[176:179]
    ds_read_b64_tr_b16 a[26:27], v88 offset:63296
    v_mfma_f32_16x16x32_bf16 v[180:183], a[76:79], a[52:55], v[180:183]
    ds_read_b64_tr_b16 a[28:29], v91 offset:61632
    v_mfma_f32_16x16x32_bf16 v[184:187], a[76:79], a[56:59], v[184:187]
    ds_read_b64_tr_b16 a[30:31], v91 offset:63424
    v_mfma_f32_16x16x32_bf16 v[188:191], a[76:79], a[60:63], v[188:191]
    ds_read_b64_tr_b16 a[32:33], v88 offset:61696
    v_mfma_f32_16x16x32_bf16 v[192:195], a[80:83], a[48:51], v[192:195]
    buffer_load_dwordx4 v5, s[8:11], s52 offen offset:3072 lds
    s_lshl_b32 s52, s89, 7
    v_mfma_f32_16x16x32_bf16 v[196:199], a[80:83], a[52:55], v[196:199]
    ds_read_b64_tr_b16 a[34:35], v88 offset:63488
    v_mfma_f32_16x16x32_bf16 v[200:203], a[80:83], a[56:59], v[200:203]
    ds_read_b64_tr_b16 a[36:37], v91 offset:61696
    v_mfma_f32_16x16x32_bf16 v[204:207], a[80:83], a[60:63], v[204:207]
    ds_read_b64_tr_b16 a[38:39], v91 offset:63488
    v_mfma_f32_16x16x32_bf16 v[208:211], a[84:87], a[48:51], v[208:211]
    ds_read_b64_tr_b16 a[40:41], v97 offset:61504
    s_add_u32 m0, s55, 16384
    v_mfma_f32_16x16x32_bf16 v[212:215], a[84:87], a[52:55], v[212:215]
    buffer_load_dwordx4 v6, s[16:19], s53 offen offset:0 lds
    v_mfma_f32_16x16x32_bf16 v[216:219], a[84:87], a[56:59], v[216:219]
    ds_read_b64_tr_b16 a[42:43], v97 offset:63296
    v_mfma_f32_16x16x32_bf16 v[220:223], a[84:87], a[60:63], v[220:223]
    ds_read_b64_tr_b16 a[44:45], v94 offset:61760
    v_mfma_f32_16x16x32_bf16 v[224:227], a[88:91], a[48:51], v[224:227]
    ds_read_b64_tr_b16 a[46:47], v94 offset:63552
    v_mfma_f32_16x16x32_bf16 v[228:231], a[88:91], a[52:55], v[228:231]
    buffer_load_dwordx4 v7, s[16:19], s53 offen offset:1024 lds
    v_mfma_f32_16x16x32_bf16 v[232:235], a[92:95], a[48:51], v[232:235]
    v_mfma_f32_16x16x32_bf16 v[236:239], a[92:95], a[52:55], v[236:239]
    s_waitcnt lgkmcnt(0)
    v_mfma_f32_16x16x32_bf16 v[128:131], a[16:19], a[0:3], v[128:131]
    ds_read_b64_tr_b16 a[64:65], v89 offset:10240
    v_mfma_f32_16x16x32_bf16 v[132:135], a[16:19], a[4:7], v[132:135]
    ds_read_b64_tr_b16 a[66:67], v89 offset:12032
    v_mfma_f32_16x16x32_bf16 v[136:139], a[16:19], a[8:11], v[136:139]
    buffer_load_dwordx4 v8, s[16:19], s53 offen offset:2048 lds
    v_mfma_f32_16x16x32_bf16 v[140:143], a[16:19], a[12:15], v[140:143]
    ds_read_b128 a[48:51], v103 offset:45056
    v_mfma_f32_16x16x32_bf16 v[144:147], a[20:23], a[0:3], v[144:147]
    ds_read_b128 a[52:55], v103 offset:47104
    v_mfma_f32_16x16x32_bf16 v[148:151], a[20:23], a[4:7], v[148:151]
    ds_read_b128 a[56:59], v109 offset:45056
    v_mfma_f32_16x16x32_bf16 v[152:155], a[20:23], a[8:11], v[152:155]
    ds_read_b128 a[60:63], v109 offset:47104
    v_mfma_f32_16x16x32_bf16 v[156:159], a[20:23], a[12:15], v[156:159]
    ds_read_b64_tr_b16 a[68:69], v92 offset:10240
    v_mfma_f32_16x16x32_bf16 v[160:163], a[24:27], a[0:3], v[160:163]
    buffer_load_dwordx4 v9, s[16:19], s53 offen offset:3072 lds
    v_mfma_f32_16x16x32_bf16 v[164:167], a[24:27], a[4:7], v[164:167]
    ds_read_b64_tr_b16 a[70:71], v92 offset:12032
    v_mfma_f32_16x16x32_bf16 v[168:171], a[24:27], a[8:11], v[168:171]
    ds_read_b64_tr_b16 a[72:73], v89 offset:10304
    v_mfma_f32_16x16x32_bf16 v[172:175], a[24:27], a[12:15], v[172:175]
    ds_read_b64_tr_b16 a[74:75], v89 offset:12096
    v_mfma_f32_16x16x32_bf16 v[176:179], a[28:31], a[0:3], v[176:179]
    ds_read_b64_tr_b16 a[76:77], v92 offset:10432
    v_mfma_f32_16x16x32_bf16 v[180:183], a[28:31], a[4:7], v[180:183]
    ds_read_b64_tr_b16 a[78:79], v92 offset:12224
    s_add_u32 m0, s55, 20480
    v_mfma_f32_16x16x32_bf16 v[184:187], a[28:31], a[8:11], v[184:187]
    buffer_load_dwordx4 v10, s[16:19], s53 offen offset:0 lds
    v_mfma_f32_16x16x32_bf16 v[188:191], a[28:31], a[12:15], v[188:191]
    ds_read_b64_tr_b16 a[80:81], v89 offset:10496
    v_mfma_f32_16x16x32_bf16 v[192:195], a[32:35], a[0:3], v[192:195]
    ds_read_b64_tr_b16 a[82:83], v89 offset:12288
    v_mfma_f32_16x16x32_bf16 v[196:199], a[32:35], a[4:7], v[196:199]
    ds_read_b64_tr_b16 a[84:85], v92 offset:10496
    v_mfma_f32_16x16x32_bf16 v[200:203], a[32:35], a[8:11], v[200:203]
    ds_read_b64_tr_b16 a[86:87], v92 offset:12288
    v_mfma_f32_16x16x32_bf16 v[204:207], a[32:35], a[12:15], v[204:207]
    buffer_load_dwordx4 v11, s[16:19], s53 offen offset:1024 lds
    v_mfma_f32_16x16x32_bf16 v[208:211], a[36:39], a[0:3], v[208:211]
    ds_read_b64_tr_b16 a[88:89], v98 offset:10304
    v_mfma_f32_16x16x32_bf16 v[212:215], a[36:39], a[4:7], v[212:215]
    ds_read_b64_tr_b16 a[90:91], v98 offset:12096
    v_mfma_f32_16x16x32_bf16 v[216:219], a[36:39], a[8:11], v[216:219]
    ds_read_b64_tr_b16 a[92:93], v95 offset:10560
    v_mfma_f32_16x16x32_bf16 v[220:223], a[36:39], a[12:15], v[220:223]
    ds_read_b64_tr_b16 a[94:95], v95 offset:12352
    v_mfma_f32_16x16x32_bf16 v[224:227], a[40:43], a[0:3], v[224:227]
    v_mfma_f32_16x16x32_bf16 v[228:231], a[40:43], a[4:7], v[228:231]
    buffer_load_dwordx4 v12, s[16:19], s53 offen offset:2048 lds
    s_mul_i32 s53, s89, 458752
    v_mfma_f32_16x16x32_bf16 v[232:235], a[44:47], a[0:3], v[232:235]
    v_mfma_f32_16x16x32_bf16 v[236:239], a[44:47], a[4:7], v[236:239]
    s_waitcnt vmcnt(11) lgkmcnt(0)
    s_barrier
    v_mfma_f32_16x16x32_bf16 v[128:131], a[64:67], a[48:51], v[128:131]
    ds_read_b64_tr_b16 a[16:17], v89 offset:40960
    v_mfma_f32_16x16x32_bf16 v[132:135], a[64:67], a[52:55], v[132:135]
    ds_read_b64_tr_b16 a[18:19], v89 offset:42752
    s_add_u32 m0, s54, 45056
    v_mfma_f32_16x16x32_bf16 v[136:139], a[64:67], a[56:59], v[136:139]
    buffer_load_dwordx4 v2, s[8:11], s52 offen offset:0 lds
    s_add_u32 s88, s88, 1
    v_mfma_f32_16x16x32_bf16 v[140:143], a[64:67], a[60:63], v[140:143]
    ds_read_b128 a[0:3], v101 offset:24576
    s_add_u32 s89, s88, s101
    v_mfma_f32_16x16x32_bf16 v[144:147], a[68:71], a[48:51], v[144:147]
    ds_read_b128 a[4:7], v101 offset:26624
    v_mfma_f32_16x16x32_bf16 v[148:151], a[68:71], a[52:55], v[148:151]
    ds_read_b128 a[8:11], v107 offset:24576
    v_mfma_f32_16x16x32_bf16 v[152:155], a[68:71], a[56:59], v[152:155]
    ds_read_b128 a[12:15], v107 offset:26624
    v_mfma_f32_16x16x32_bf16 v[156:159], a[68:71], a[60:63], v[156:159]
    buffer_load_dwordx4 v3, s[8:11], s52 offen offset:1024 lds
    s_and_b32 s89, s89, 3
    v_mfma_f32_16x16x32_bf16 v[160:163], a[72:75], a[48:51], v[160:163]
    ds_read_b64_tr_b16 a[20:21], v92 offset:40960
    s_andn2_b32 s90, s88, 3
    v_mfma_f32_16x16x32_bf16 v[164:167], a[72:75], a[52:55], v[164:167]
    ds_read_b64_tr_b16 a[22:23], v92 offset:42752
    v_mfma_f32_16x16x32_bf16 v[168:171], a[72:75], a[56:59], v[168:171]
    ds_read_b64_tr_b16 a[24:25], v89 offset:41024
    v_mfma_f32_16x16x32_bf16 v[172:175], a[72:75], a[60:63], v[172:175]
    buffer_load_dwordx4 v4, s[8:11], s52 offen offset:2048 lds
    s_or_b32 s89, s89, s90
    v_mfma_f32_16x16x32_bf16 v[176:179], a[76:79], a[48:51], v[176:179]
    ds_read_b64_tr_b16 a[26:27], v89 offset:42816
    v_mfma_f32_16x16x32_bf16 v[180:183], a[76:79], a[52:55], v[180:183]
    ds_read_b64_tr_b16 a[28:29], v92 offset:41152
    v_mfma_f32_16x16x32_bf16 v[184:187], a[76:79], a[56:59], v[184:187]
    ds_read_b64_tr_b16 a[30:31], v92 offset:42944
    v_mfma_f32_16x16x32_bf16 v[188:191], a[76:79], a[60:63], v[188:191]
    ds_read_b64_tr_b16 a[32:33], v89 offset:41216
    v_mfma_f32_16x16x32_bf16 v[192:195], a[80:83], a[48:51], v[192:195]
    buffer_load_dwordx4 v5, s[8:11], s52 offen offset:3072 lds
    s_lshl_b32 s52, s89, 7
    v_mfma_f32_16x16x32_bf16 v[196:199], a[80:83], a[52:55], v[196:199]
    ds_read_b64_tr_b16 a[34:35], v89 offset:43008
    v_mfma_f32_16x16x32_bf16 v[200:203], a[80:83], a[56:59], v[200:203]
    ds_read_b64_tr_b16 a[36:37], v92 offset:41216
    v_mfma_f32_16x16x32_bf16 v[204:207], a[80:83], a[60:63], v[204:207]
    ds_read_b64_tr_b16 a[38:39], v92 offset:43008
    v_mfma_f32_16x16x32_bf16 v[208:211], a[84:87], a[48:51], v[208:211]
    ds_read_b64_tr_b16 a[40:41], v98 offset:41024
    s_add_u32 m0, s55, 61440
    v_mfma_f32_16x16x32_bf16 v[212:215], a[84:87], a[52:55], v[212:215]
    buffer_load_dwordx4 v6, s[16:19], s53 offen offset:0 lds
    v_mfma_f32_16x16x32_bf16 v[216:219], a[84:87], a[56:59], v[216:219]
    ds_read_b64_tr_b16 a[42:43], v98 offset:42816
    v_mfma_f32_16x16x32_bf16 v[220:223], a[84:87], a[60:63], v[220:223]
    ds_read_b64_tr_b16 a[44:45], v95 offset:41280
    v_mfma_f32_16x16x32_bf16 v[224:227], a[88:91], a[48:51], v[224:227]
    ds_read_b64_tr_b16 a[46:47], v95 offset:43072
    v_mfma_f32_16x16x32_bf16 v[228:231], a[88:91], a[52:55], v[228:231]
    buffer_load_dwordx4 v7, s[16:19], s53 offen offset:1024 lds
    v_mfma_f32_16x16x32_bf16 v[232:235], a[92:95], a[48:51], v[232:235]
    v_mfma_f32_16x16x32_bf16 v[236:239], a[92:95], a[52:55], v[236:239]
    s_waitcnt lgkmcnt(0)
    v_mfma_f32_16x16x32_bf16 v[128:131], a[16:19], a[0:3], v[128:131]
    ds_read_b64_tr_b16 a[64:65], v89 offset:55296
    v_mfma_f32_16x16x32_bf16 v[132:135], a[16:19], a[4:7], v[132:135]
    ds_read_b64_tr_b16 a[66:67], v89 offset:57088
    v_mfma_f32_16x16x32_bf16 v[136:139], a[16:19], a[8:11], v[136:139]
    buffer_load_dwordx4 v8, s[16:19], s53 offen offset:2048 lds
    v_mfma_f32_16x16x32_bf16 v[140:143], a[16:19], a[12:15], v[140:143]
    ds_read_b128 a[48:51], v104 offset:24576
    v_mfma_f32_16x16x32_bf16 v[144:147], a[20:23], a[0:3], v[144:147]
    ds_read_b128 a[52:55], v104 offset:26624
    v_mfma_f32_16x16x32_bf16 v[148:151], a[20:23], a[4:7], v[148:151]
    ds_read_b128 a[56:59], v110 offset:24576
    v_mfma_f32_16x16x32_bf16 v[152:155], a[20:23], a[8:11], v[152:155]
    ds_read_b128 a[60:63], v110 offset:26624
    v_mfma_f32_16x16x32_bf16 v[156:159], a[20:23], a[12:15], v[156:159]
    ds_read_b64_tr_b16 a[68:69], v92 offset:55296
    v_mfma_f32_16x16x32_bf16 v[160:163], a[24:27], a[0:3], v[160:163]
    buffer_load_dwordx4 v9, s[16:19], s53 offen offset:3072 lds
    v_mfma_f32_16x16x32_bf16 v[164:167], a[24:27], a[4:7], v[164:167]
    ds_read_b64_tr_b16 a[70:71], v92 offset:57088
    v_mfma_f32_16x16x32_bf16 v[168:171], a[24:27], a[8:11], v[168:171]
    ds_read_b64_tr_b16 a[72:73], v89 offset:55360
    v_mfma_f32_16x16x32_bf16 v[172:175], a[24:27], a[12:15], v[172:175]
    ds_read_b64_tr_b16 a[74:75], v89 offset:57152
    v_mfma_f32_16x16x32_bf16 v[176:179], a[28:31], a[0:3], v[176:179]
    ds_read_b64_tr_b16 a[76:77], v92 offset:55488
    v_mfma_f32_16x16x32_bf16 v[180:183], a[28:31], a[4:7], v[180:183]
    ds_read_b64_tr_b16 a[78:79], v92 offset:57280
    s_add_u32 m0, s55, 65536
    v_mfma_f32_16x16x32_bf16 v[184:187], a[28:31], a[8:11], v[184:187]
    buffer_load_dwordx4 v10, s[16:19], s53 offen offset:0 lds
    v_mfma_f32_16x16x32_bf16 v[188:191], a[28:31], a[12:15], v[188:191]
    ds_read_b64_tr_b16 a[80:81], v89 offset:55552
    v_mfma_f32_16x16x32_bf16 v[192:195], a[32:35], a[0:3], v[192:195]
    ds_read_b64_tr_b16 a[82:83], v89 offset:57344
    v_mfma_f32_16x16x32_bf16 v[196:199], a[32:35], a[4:7], v[196:199]
    ds_read_b64_tr_b16 a[84:85], v92 offset:55552
    v_mfma_f32_16x16x32_bf16 v[200:203], a[32:35], a[8:11], v[200:203]
    ds_read_b64_tr_b16 a[86:87], v92 offset:57344
    v_mfma_f32_16x16x32_bf16 v[204:207], a[32:35], a[12:15], v[204:207]
    buffer_load_dwordx4 v11, s[16:19], s53 offen offset:1024 lds
    v_mfma_f32_16x16x32_bf16 v[208:211], a[36:39], a[0:3], v[208:211]
    ds_read_b64_tr_b16 a[88:89], v98 offset:55360
    v_mfma_f32_16x16x32_bf16 v[212:215], a[36:39], a[4:7], v[212:215]
    ds_read_b64_tr_b16 a[90:91], v98 offset:57152
    v_mfma_f32_16x16x32_bf16 v[216:219], a[36:39], a[8:11], v[216:219]
    ds_read_b64_tr_b16 a[92:93], v95 offset:55616
    v_mfma_f32_16x16x32_bf16 v[220:223], a[36:39], a[12:15], v[220:223]
    ds_read_b64_tr_b16 a[94:95], v95 offset:57408
    v_mfma_f32_16x16x32_bf16 v[224:227], a[40:43], a[0:3], v[224:227]
    v_mfma_f32_16x16x32_bf16 v[228:231], a[40:43], a[4:7], v[228:231]
    buffer_load_dwordx4 v12, s[16:19], s53 offen offset:2048 lds
    s_mul_i32 s53, s89, 458752
    v_mfma_f32_16x16x32_bf16 v[232:235], a[44:47], a[0:3], v[232:235]
    v_mfma_f32_16x16x32_bf16 v[236:239], a[44:47], a[4:7], v[236:239]
    s_waitcnt vmcnt(11) lgkmcnt(0)
    s_barrier
    v_mfma_f32_16x16x32_bf16 v[128:131], a[64:67], a[48:51], v[128:131]
    ds_read_b64_tr_b16 a[16:17], v88 offset:16384
    v_mfma_f32_16x16x32_bf16 v[132:135], a[64:67], a[52:55], v[132:135]
    ds_read_b64_tr_b16 a[18:19], v88 offset:18176
    s_add_u32 m0, s54, 90112
    v_mfma_f32_16x16x32_bf16 v[136:139], a[64:67], a[56:59], v[136:139]
    buffer_load_dwordx4 v2, s[8:11], s52 offen offset:0 lds
    s_add_u32 s88, s88, 1
    v_mfma_f32_16x16x32_bf16 v[140:143], a[64:67], a[60:63], v[140:143]
    ds_read_b128 a[0:3], v100 offset:0
    s_add_u32 s89, s88, s101
    v_mfma_f32_16x16x32_bf16 v[144:147], a[68:71], a[48:51], v[144:147]
    ds_read_b128 a[4:7], v100 offset:2048
    v_mfma_f32_16x16x32_bf16 v[148:151], a[68:71], a[52:55], v[148:151]
    ds_read_b128 a[8:11], v106 offset:0
    v_mfma_f32_16x16x32_bf16 v[152:155], a[68:71], a[56:59], v[152:155]
    ds_read_b128 a[12:15], v106 offset:2048
    v_mfma_f32_16x16x32_bf16 v[156:159], a[68:71], a[60:63], v[156:159]
    buffer_load_dwordx4 v3, s[8:11], s52 offen offset:1024 lds
    s_and_b32 s89, s89, 3
    v_mfma_f32_16x16x32_bf16 v[160:163], a[72:75], a[48:51], v[160:163]
    ds_read_b64_tr_b16 a[20:21], v91 offset:16384
    s_andn2_b32 s90, s88, 3
    v_mfma_f32_16x16x32_bf16 v[164:167], a[72:75], a[52:55], v[164:167]
    ds_read_b64_tr_b16 a[22:23], v91 offset:18176
    v_mfma_f32_16x16x32_bf16 v[168:171], a[72:75], a[56:59], v[168:171]
    ds_read_b64_tr_b16 a[24:25], v88 offset:16448
    v_mfma_f32_16x16x32_bf16 v[172:175], a[72:75], a[60:63], v[172:175]
    buffer_load_dwordx4 v4, s[8:11], s52 offen offset:2048 lds
    s_or_b32 s89, s89, s90
    v_mfma_f32_16x16x32_bf16 v[176:179], a[76:79], a[48:51], v[176:179]
    ds_read_b64_tr_b16 a[26:27], v88 offset:18240
    v_mfma_f32_16x16x32_bf16 v[180:183], a[76:79], a[52:55], v[180:183]
    ds_read_b64_tr_b16 a[28:29], v91 offset:16576
    v_mfma_f32_16x16x32_bf16 v[184:187], a[76:79], a[56:59], v[184:187]
    ds_read_b64_tr_b16 a[30:31], v91 offset:18368
    v_mfma_f32_16x16x32_bf16 v[188:191], a[76:79], a[60:63], v[188:191]
    ds_read_b64_tr_b16 a[32:33], v88 offset:16640
    v_mfma_f32_16x16x32_bf16 v[192:195], a[80:83], a[48:51], v[192:195]
    buffer_load_dwordx4 v5, s[8:11], s52 offen offset:3072 lds
    s_lshl_b32 s52, s89, 7
    v_mfma_f32_16x16x32_bf16 v[196:199], a[80:83], a[52:55], v[196:199]
    ds_read_b64_tr_b16 a[34:35], v88 offset:18432
    v_mfma_f32_16x16x32_bf16 v[200:203], a[80:83], a[56:59], v[200:203]
    ds_read_b64_tr_b16 a[36:37], v91 offset:16640
    v_mfma_f32_16x16x32_bf16 v[204:207], a[80:83], a[60:63], v[204:207]
    ds_read_b64_tr_b16 a[38:39], v91 offset:18432
    v_mfma_f32_16x16x32_bf16 v[208:211], a[84:87], a[48:51], v[208:211]
    ds_read_b64_tr_b16 a[40:41], v97 offset:16448
    s_add_u32 m0, s55, 106496
    v_mfma_f32_16x16x32_bf16 v[212:215], a[84:87], a[52:55], v[212:215]
    buffer_load_dwordx4 v6, s[16:19], s53 offen offset:0 lds
    v_mfma_f32_16x16x32_bf16 v[216:219], a[84:87], a[56:59], v[216:219]
    ds_read_b64_tr_b16 a[42:43], v97 offset:18240
    v_mfma_f32_16x16x32_bf16 v[220:223], a[84:87], a[60:63], v[220:223]
    ds_read_b64_tr_b16 a[44:45], v94 offset:16704
    v_mfma_f32_16x16x32_bf16 v[224:227], a[88:91], a[48:51], v[224:227]
    ds_read_b64_tr_b16 a[46:47], v94 offset:18496
    v_mfma_f32_16x16x32_bf16 v[228:231], a[88:91], a[52:55], v[228:231]
    buffer_load_dwordx4 v7, s[16:19], s53 offen offset:1024 lds
    v_mfma_f32_16x16x32_bf16 v[232:235], a[92:95], a[48:51], v[232:235]
    v_mfma_f32_16x16x32_bf16 v[236:239], a[92:95], a[52:55], v[236:239]
    s_waitcnt lgkmcnt(0)
    s_sub_u32 s98, s98, 1
    s_cmp_lg_u32 s98, 0
    s_cbranch_scc1 LOOP_p1b_1
    v_mfma_f32_16x16x32_bf16 v[128:131], a[16:19], a[0:3], v[128:131]
    ds_read_b64_tr_b16 a[64:65], v88 offset:30720
    v_mfma_f32_16x16x32_bf16 v[132:135], a[16:19], a[4:7], v[132:135]
    ds_read_b64_tr_b16 a[66:67], v88 offset:32512
    v_mfma_f32_16x16x32_bf16 v[136:139], a[16:19], a[8:11], v[136:139]
    buffer_load_dwordx4 v8, s[16:19], s53 offen offset:2048 lds
    v_mfma_f32_16x16x32_bf16 v[140:143], a[16:19], a[12:15], v[140:143]
    ds_read_b128 a[48:51], v103 offset:0
    v_mfma_f32_16x16x32_bf16 v[144:147], a[20:23], a[0:3], v[144:147]
    ds_read_b128 a[52:55], v103 offset:2048
    v_mfma_f32_16x16x32_bf16 v[148:151], a[20:23], a[4:7], v[148:151]
    ds_read_b128 a[56:59], v109 offset:0
    v_mfma_f32_16x16x32_bf16 v[152:155], a[20:23], a[8:11], v[152:155]
    ds_read_b128 a[60:63], v109 offset:2048
    v_mfma_f32_16x16x32_bf16 v[156:159], a[20:23], a[12:15], v[156:159]
    ds_read_b64_tr_b16 a[68:69], v91 offset:30720
    v_mfma_f32_16x16x32_bf16 v[160:163], a[24:27], a[0:3], v[160:163]
    buffer_load_dwordx4 v9, s[16:19], s53 offen offset:3072 lds
    v_mfma_f32_16x16x32_bf16 v[164:167], a[24:27], a[4:7], v[164:167]
    ds_read_b64_tr_b16 a[70:71], v91 offset:32512
    v_mfma_f32_16x16x32_bf16 v[168:171], a[24:27], a[8:11], v[168:171]
    ds_read_b64_tr_b16 a[72:73], v88 offset:30784
    v_mfma_f32_16x16x32_bf16 v[172:175], a[24:27], a[12:15], v[172:175]
    ds_read_b64_tr_b16 a[74:75], v88 offset:32576
    v_mfma_f32_16x16x32_bf16 v[176:179], a[28:31], a[0:3], v[176:179]
    ds_read_b64_tr_b16 a[76:77], v91 offset:30912
    v_mfma_f32_16x16x32_bf16 v[180:183], a[28:31], a[4:7], v[180:183]
    ds_read_b64_tr_b16 a[78:79], v91 offset:32704
    s_add_u32 m0, s55, 110592
    v_mfma_f32_16x16x32_bf16 v[184:187], a[28:31], a[8:11], v[184:187]
    buffer_load_dwordx4 v10, s[16:19], s53 offen offset:0 lds
    v_mfma_f32_16x16x32_bf16 v[188:191], a[28:31], a[12:15], v[188:191]
    ds_read_b64_tr_b16 a[80:81], v88 offset:30976
    v_mfma_f32_16x16x32_bf16 v[192:195], a[32:35], a[0:3], v[192:195]
    ds_read_b64_tr_b16 a[82:83], v88 offset:32768
    v_mfma_f32_16x16x32_bf16 v[196:199], a[32:35], a[4:7], v[196:199]
    ds_read_b64_tr_b16 a[84:85], v91 offset:30976
    v_mfma_f32_16x16x32_bf16 v[200:203], a[32:35], a[8:11], v[200:203]
    ds_read_b64_tr_b16 a[86:87], v91 offset:32768
    v_mfma_f32_16x16x32_bf16 v[204:207], a[32:35], a[12:15], v[204:207]
    buffer_load_dwordx4 v11, s[16:19], s53 offen offset:1024 lds
    v_mfma_f32_16x16x32_bf16 v[208:211], a[36:39], a[0:3], v[208:211]
    ds_read_b64_tr_b16 a[88:89], v97 offset:30784
    v_mfma_f32_16x16x32_bf16 v[212:215], a[36:39], a[4:7], v[212:215]
    ds_read_b64_tr_b16 a[90:91], v97 offset:32576
    v_mfma_f32_16x16x32_bf16 v[216:219], a[36:39], a[8:11], v[216:219]
    ds_read_b64_tr_b16 a[92:93], v94 offset:31040
    v_mfma_f32_16x16x32_bf16 v[220:223], a[36:39], a[12:15], v[220:223]
    ds_read_b64_tr_b16 a[94:95], v94 offset:32832
    v_mfma_f32_16x16x32_bf16 v[224:227], a[40:43], a[0:3], v[224:227]
    v_mfma_f32_16x16x32_bf16 v[228:231], a[40:43], a[4:7], v[228:231]
    buffer_load_dwordx4 v12, s[16:19], s53 offen offset:2048 lds
    s_mul_i32 s53, s89, 458752
    v_mfma_f32_16x16x32_bf16 v[232:235], a[44:47], a[0:3], v[232:235]
    v_mfma_f32_16x16x32_bf16 v[236:239], a[44:47], a[4:7], v[236:239]
    s_waitcnt vmcnt(11) lgkmcnt(0)
    s_barrier
    v_mfma_f32_16x16x32_bf16 v[128:131], a[64:67], a[48:51], v[128:131]
    ds_read_b64_tr_b16 a[16:17], v88 offset:61440
    v_mfma_f32_16x16x32_bf16 v[132:135], a[64:67], a[52:55], v[132:135]
    ds_read_b64_tr_b16 a[18:19], v88 offset:63232
    s_add_u32 m0, s54, 0
    v_mfma_f32_16x16x32_bf16 v[136:139], a[64:67], a[56:59], v[136:139]
    buffer_load_dwordx4 v2, s[8:11], s52 offen offset:0 lds
    s_add_u32 s88, s88, 1
    v_mfma_f32_16x16x32_bf16 v[140:143], a[64:67], a[60:63], v[140:143]
    ds_read_b128 a[0:3], v100 offset:45056
    s_add_u32 s89, s88, s101
    v_mfma_f32_16x16x32_bf16 v[144:147], a[68:71], a[48:51], v[144:147]
    ds_read_b128 a[4:7], v100 offset:47104
    v_mfma_f32_16x16x32_bf16 v[148:151], a[68:71], a[52:55], v[148:151]
    ds_read_b128 a[8:11], v106 offset:45056
    v_mfma_f32_16x16x32_bf16 v[152:155], a[68:71], a[56:59], v[152:155]
    ds_read_b128 a[12:15], v106 offset:47104
    v_mfma_f32_16x16x32_bf16 v[156:159], a[68:71], a[60:63], v[156:159]
    buffer_load_dwordx4 v3, s[8:11], s52 offen offset:1024 lds
    s_and_b32 s89, s89, 3
    v_mfma_f32_16x16x32_bf16 v[160:163], a[72:75], a[48:51], v[160:163]
    ds_read_b64_tr_b16 a[20:21], v91 offset:61440
    s_andn2_b32 s90, s88, 3
    v_mfma_f32_16x16x32_bf16 v[164:167], a[72:75], a[52:55], v[164:167]
    ds_read_b64_tr_b16 a[22:23], v91 offset:63232
    v_mfma_f32_16x16x32_bf16 v[168:171], a[72:75], a[56:59], v[168:171]
    ds_read_b64_tr_b16 a[24:25], v88 offset:61504
    v_mfma_f32_16x16x32_bf16 v[172:175], a[72:75], a[60:63], v[172:175]
    buffer_load_dwordx4 v4, s[8:11], s52 offen offset:2048 lds
    s_or_b32 s89, s89, s90
    v_mfma_f32_16x16x32_bf16 v[176:179], a[76:79], a[48:51], v[176:179]
    ds_read_b64_tr_b16 a[26:27], v88 offset:63296
    v_mfma_f32_16x16x32_bf16 v[180:183], a[76:79], a[52:55], v[180:183]
    ds_read_b64_tr_b16 a[28:29], v91 offset:61632
    v_mfma_f32_16x16x32_bf16 v[184:187], a[76:79], a[56:59], v[184:187]
    ds_read_b64_tr_b16 a[30:31], v91 offset:63424
    v_mfma_f32_16x16x32_bf16 v[188:191], a[76:79], a[60:63], v[188:191]
    ds_read_b64_tr_b16 a[32:33], v88 offset:61696
    v_mfma_f32_16x16x32_bf16 v[192:195], a[80:83], a[48:51], v[192:195]
    buffer_load_dwordx4 v5, s[8:11], s52 offen offset:3072 lds
    s_lshl_b32 s52, s89, 7
    v_mfma_f32_16x16x32_bf16 v[196:199], a[80:83], a[52:55], v[196:199]
    ds_read_b64_tr_b16 a[34:35], v88 offset:63488
    v_mfma_f32_16x16x32_bf16 v[200:203], a[80:83], a[56:59], v[200:203]
    ds_read_b64_tr_b16 a[36:37], v91 offset:61696
    v_mfma_f32_16x16x32_bf16 v[204:207], a[80:83], a[60:63], v[204:207]
    ds_read_b64_tr_b16 a[38:39], v91 offset:63488
    v_mfma_f32_16x16x32_bf16 v[208:211], a[84:87], a[48:51], v[208:211]
    ds_read_b64_tr_b16 a[40:41], v97 offset:61504
    s_add_u32 m0, s55, 16384
    v_mfma_f32_16x16x32_bf16 v[212:215], a[84:87], a[52:55], v[212:215]
    buffer_load_dwordx4 v6, s[16:19], s53 offen offset:0 lds
    v_mfma_f32_16x16x32_bf16 v[216:219], a[84:87], a[56:59], v[216:219]
    ds_read_b64_tr_b16 a[42:43], v97 offset:63296
    v_mfma_f32_16x16x32_bf16 v[220:223], a[84:87], a[60:63], v[220:223]
    ds_read_b64_tr_b16 a[44:45], v94 offset:61760
    v_mfma_f32_16x16x32_bf16 v[224:227], a[88:91], a[48:51], v[224:227]
    ds_read_b64_tr_b16 a[46:47], v94 offset:63552
    v_mfma_f32_16x16x32_bf16 v[228:231], a[88:91], a[52:55], v[228:231]
    buffer_load_dwordx4 v7, s[16:19], s53 offen offset:1024 lds
    v_mfma_f32_16x16x32_bf16 v[232:235], a[92:95], a[48:51], v[232:235]
    v_mfma_f32_16x16x32_bf16 v[236:239], a[92:95], a[52:55], v[236:239]
    s_waitcnt lgkmcnt(0)
    buffer_load_dword v252, v254, s[32:35], 0 offen sc1
    v_mfma_f32_16x16x32_bf16 v[128:131], a[16:19], a[0:3], v[128:131]
    ds_read_b64_tr_b16 a[64:65], v89 offset:10240
    v_mfma_f32_16x16x32_bf16 v[132:135], a[16:19], a[4:7], v[132:135]
    ds_read_b64_tr_b16 a[66:67], v89 offset:12032
    v_mfma_f32_16x16x32_bf16 v[136:139], a[16:19], a[8:11], v[136:139]
    buffer_load_dwordx4 v8, s[16:19], s53 offen offset:2048 lds
    v_mfma_f32_16x16x32_bf16 v[140:143], a[16:19], a[12:15], v[140:143]
    ds_read_b128 a[48:51], v103 offset:45056
    v_mfma_f32_16x16x32_bf16 v[144:147], a[20:23], a[0:3], v[144:147]
    ds_read_b128 a[52:55], v103 offset:47104
    v_mfma_f32_16x16x32_bf16 v[148:151], a[20:23], a[4:7], v[148:151]
    ds_read_b128 a[56:59], v109 offset:45056
    v_mfma_f32_16x16x32_bf16 v[152:155], a[20:23], a[8:11], v[152:155]
    ds_read_b128 a[60:63], v109 offset:47104
    v_mfma_f32_16x16x32_bf16 v[156:159], a[20:23], a[12:15], v[156:159]
    ds_read_b64_tr_b16 a[68:69], v92 offset:10240
    v_mfma_f32_16x16x32_bf16 v[160:163], a[24:27], a[0:3], v[160:163]
    buffer_load_dwordx4 v9, s[16:19], s53 offen offset:3072 lds
    v_mfma_f32_16x16x32_bf16 v[164:167], a[24:27], a[4:7], v[164:167]
    ds_read_b64_tr_b16 a[70:71], v92 offset:12032
    v_mfma_f32_16x16x32_bf16 v[168:171], a[24:27], a[8:11], v[168:171]
    ds_read_b64_tr_b16 a[72:73], v89 offset:10304
    v_mfma_f32_16x16x32_bf16 v[172:175], a[24:27], a[12:15], v[172:175]
    ds_read_b64_tr_b16 a[74:75], v89 offset:12096
    v_mfma_f32_16x16x32_bf16 v[176:179], a[28:31], a[0:3], v[176:179]
    ds_read_b64_tr_b16 a[76:77], v92 offset:10432
    v_mfma_f32_16x16x32_bf16 v[180:183], a[28:31], a[4:7], v[180:183]
    ds_read_b64_tr_b16 a[78:79], v92 offset:12224
    s_add_u32 m0, s55, 20480
    v_mfma_f32_16x16x32_bf16 v[184:187], a[28:31], a[8:11], v[184:187]
    buffer_load_dwordx4 v10, s[16:19], s53 offen offset:0 lds
    v_mfma_f32_16x16x32_bf16 v[188:191], a[28:31], a[12:15], v[188:191]
    ds_read_b64_tr_b16 a[80:81], v89 offset:10496
    v_mfma_f32_16x16x32_bf16 v[192:195], a[32:35], a[0:3], v[192:195]
    ds_read_b64_tr_b16 a[82:83], v89 offset:12288
    v_mfma_f32_16x16x32_bf16 v[196:199], a[32:35], a[4:7], v[196:199]
    ds_read_b64_tr_b16 a[84:85], v92 offset:10496
    v_mfma_f32_16x16x32_bf16 v[200:203], a[32:35], a[8:11], v[200:203]
    ds_read_b64_tr_b16 a[86:87], v92 offset:12288
    v_mfma_f32_16x16x32_bf16 v[204:207], a[32:35], a[12:15], v[204:207]
    buffer_load_dwordx4 v11, s[16:19], s53 offen offset:1024 lds
    v_mfma_f32_16x16x32_bf16 v[208:211], a[36:39], a[0:3], v[208:211]
    ds_read_b64_tr_b16 a[88:89], v98 offset:10304
    v_mfma_f32_16x16x32_bf16 v[212:215], a[36:39], a[4:7], v[212:215]
    ds_read_b64_tr_b16 a[90:91], v98 offset:12096
    v_mfma_f32_16x16x32_bf16 v[216:219], a[36:39], a[8:11], v[216:219]
    ds_read_b64_tr_b16 a[92:93], v95 offset:10560
    v_mfma_f32_16x16x32_bf16 v[220:223], a[36:39], a[12:15], v[220:223]
    ds_read_b64_tr_b16 a[94:95], v95 offset:12352
    v_mfma_f32_16x16x32_bf16 v[224:227], a[40:43], a[0:3], v[224:227]
    v_mfma_f32_16x16x32_bf16 v[228:231], a[40:43], a[4:7], v[228:231]
    buffer_load_dwordx4 v12, s[16:19], s53 offen offset:2048 lds
    s_mul_i32 s53, s89, 458752
    v_mfma_f32_16x16x32_bf16 v[232:235], a[44:47], a[0:3], v[232:235]
    v_mfma_f32_16x16x32_bf16 v[236:239], a[44:47], a[4:7], v[236:239]
    s_waitcnt vmcnt(12) lgkmcnt(0)
    s_barrier
    v_mfma_f32_16x16x32_bf16 v[128:131], a[64:67], a[48:51], v[128:131]
    ds_read_b64_tr_b16 a[16:17], v89 offset:40960
    v_mfma_f32_16x16x32_bf16 v[132:135], a[64:67], a[52:55], v[132:135]
    ds_read_b64_tr_b16 a[18:19], v89 offset:42752
    v_mfma_f32_16x16x32_bf16 v[136:139], a[64:67], a[56:59], v[136:139]
    ds_read_b128 a[0:3], v101 offset:24576
    v_mfma_f32_16x16x32_bf16 v[140:143], a[64:67], a[60:63], v[140:143]
    ds_read_b128 a[4:7], v101 offset:26624
    v_mfma_f32_16x16x32_bf16 v[144:147], a[68:71], a[48:51], v[144:147]
    ds_read_b128 a[8:11], v107 offset:24576
    v_mfma_f32_16x16x32_bf16 v[148:151], a[68:71], a[52:55], v[148:151]
    ds_read_b128 a[12:15], v107 offset:26624
    v_mfma_f32_16x16x32_bf16 v[152:155], a[68:71], a[56:59], v[152:155]
    ds_read_b64_tr_b16 a[20:21], v92 offset:40960
    v_mfma_f32_16x16x32_bf16 v[156:159], a[68:71], a[60:63], v[156:159]
    ds_read_b64_tr_b16 a[22:23], v92 offset:42752
    v_mfma_f32_16x16x32_bf16 v[160:163], a[72:75], a[48:51], v[160:163]
    ds_read_b64_tr_b16 a[24:25], v89 offset:41024
    v_mfma_f32_16x16x32_bf16 v[164:167], a[72:75], a[52:55], v[164:167]
    ds_read_b64_tr_b16 a[26:27], v89 offset:42816
    v_mfma_f32_16x16x32_bf16 v[168:171], a[72:75], a[56:59], v[168:171]
    ds_read_b64_tr_b16 a[28:29], v92 offset:41152
    v_mfma_f32_16x16x32_bf16 v[172:175], a[72:75], a[60:63], v[172:175]
    ds_read_b64_tr_b16 a[30:31], v92 offset:42944
    v_mfma_f32_16x16x32_bf16 v[176:179], a[76:79], a[48:51], v[176:179]
    ds_read_b64_tr_b16 a[32:33], v89 offset:41216
    v_mfma_f32_16x16x32_bf16 v[180:183], a[76:79], a[52:55], v[180:183]
    ds_read_b64_tr_b16 a[34:35], v89 offset:43008
    v_mfma_f32_16x16x32_bf16 v[184:187], a[76:79], a[56:59], v[184:187]
    ds_read_b64_tr_b16 a[36:37], v92 offset:41216
    v_mfma_f32_16x16x32_bf16 v[188:191], a[76:79], a[60:63], v[188:191]
    ds_read_b64_tr_b16 a[38:39], v92 offset:43008
    v_mfma_f32_16x16x32_bf16 v[192:195], a[80:83], a[48:51], v[192:195]
    ds_read_b64_tr_b16 a[40:41], v98 offset:41024
    v_mfma_f32_16x16x32_bf16 v[196:199], a[80:83], a[52:55], v[196:199]
    ds_read_b64_tr_b16 a[42:43], v98 offset:42816
    v_mfma_f32_16x16x32_bf16 v[200:203], a[80:83], a[56:59], v[200:203]
    ds_read_b64_tr_b16 a[44:45], v95 offset:41280
    v_mfma_f32_16x16x32_bf16 v[204:207], a[80:83], a[60:63], v[204:207]
    ds_read_b64_tr_b16 a[46:47], v95 offset:43072
    v_mfma_f32_16x16x32_bf16 v[208:211], a[84:87], a[48:51], v[208:211]
    v_mfma_f32_16x16x32_bf16 v[212:215], a[84:87], a[52:55], v[212:215]
    v_mfma_f32_16x16x32_bf16 v[216:219], a[84:87], a[56:59], v[216:219]
    v_mfma_f32_16x16x32_bf16 v[220:223], a[84:87], a[60:63], v[220:223]
    v_mfma_f32_16x16x32_bf16 v[224:227], a[88:91], a[48:51], v[224:227]
    v_mfma_f32_16x16x32_bf16 v[228:231], a[88:91], a[52:55], v[228:231]
    v_mfma_f32_16x16x32_bf16 v[232:235], a[92:95], a[48:51], v[232:235]
    v_mfma_f32_16x16x32_bf16 v[236:239], a[92:95], a[52:55], v[236:239]
    s_waitcnt lgkmcnt(0)
    v_mfma_f32_16x16x32_bf16 v[128:131], a[16:19], a[0:3], v[128:131]
    ds_read_b64_tr_b16 a[64:65], v89 offset:55296
    v_mfma_f32_16x16x32_bf16 v[132:135], a[16:19], a[4:7], v[132:135]
    ds_read_b64_tr_b16 a[66:67], v89 offset:57088
    v_mfma_f32_16x16x32_bf16 v[136:139], a[16:19], a[8:11], v[136:139]
    ds_read_b128 a[48:51], v104 offset:24576
    v_mfma_f32_16x16x32_bf16 v[140:143], a[16:19], a[12:15], v[140:143]
    ds_read_b128 a[52:55], v104 offset:26624
    v_mfma_f32_16x16x32_bf16 v[144:147], a[20:23], a[0:3], v[144:147]
    ds_read_b128 a[56:59], v110 offset:24576
    v_mfma_f32_16x16x32_bf16 v[148:151], a[20:23], a[4:7], v[148:151]
    ds_read_b128 a[60:63], v110 offset:26624
    v_mfma_f32_16x16x32_bf16 v[152:155], a[20:23], a[8:11], v[152:155]
    ds_read_b64_tr_b16 a[68:69], v92 offset:55296
    v_mfma_f32_16x16x32_bf16 v[156:159], a[20:23], a[12:15], v[156:159]
    ds_read_b64_tr_b16 a[70:71], v92 offset:57088
    v_mfma_f32_16x16x32_bf16 v[160:163], a[24:27], a[0:3], v[160:163]
    ds_read_b64_tr_b16 a[72:73], v89 offset:55360
    v_mfma_f32_16x16x32_bf16 v[164:167], a[24:27], a[4:7], v[164:167]
    ds_read_b64_tr_b16 a[74:75], v89 offset:57152
    v_mfma_f32_16x16x32_bf16 v[168:171], a[24:27], a[8:11], v[168:171]
    ds_read_b64_tr_b16 a[76:77], v92 offset:55488
    v_mfma_f32_16x16x32_bf16 v[172:175], a[24:27], a[12:15], v[172:175]
    ds_read_b64_tr_b16 a[78:79], v92 offset:57280
    v_mfma_f32_16x16x32_bf16 v[176:179], a[28:31], a[0:3], v[176:179]
    ds_read_b64_tr_b16 a[80:81], v89 offset:55552
    v_mfma_f32_16x16x32_bf16 v[180:183], a[28:31], a[4:7], v[180:183]
    ds_read_b64_tr_b16 a[82:83], v89 offset:57344
    v_mfma_f32_16x16x32_bf16 v[184:187], a[28:31], a[8:11], v[184:187]
    ds_read_b64_tr_b16 a[84:85], v92 offset:55552
    v_mfma_f32_16x16x32_bf16 v[188:191], a[28:31], a[12:15], v[188:191]
    ds_read_b64_tr_b16 a[86:87], v92 offset:57344
    v_mfma_f32_16x16x32_bf16 v[192:195], a[32:35], a[0:3], v[192:195]
    ds_read_b64_tr_b16 a[88:89], v98 offset:55360
    v_mfma_f32_16x16x32_bf16 v[196:199], a[32:35], a[4:7], v[196:199]
    ds_read_b64_tr_b16 a[90:91], v98 offset:57152
    v_mfma_f32_16x16x32_bf16 v[200:203], a[32:35], a[8:11], v[200:203]
    ds_read_b64_tr_b16 a[92:93], v95 offset:55616
    v_mfma_f32_16x16x32_bf16 v[204:207], a[32:35], a[12:15], v[204:207]
    ds_read_b64_tr_b16 a[94:95], v95 offset:57408
    v_mfma_f32_16x16x32_bf16 v[208:211], a[36:39], a[0:3], v[208:211]
    v_mfma_f32_16x16x32_bf16 v[212:215], a[36:39], a[4:7], v[212:215]
    v_mfma_f32_16x16x32_bf16 v[216:219], a[36:39], a[8:11], v[216:219]
    v_mfma_f32_16x16x32_bf16 v[220:223], a[36:39], a[12:15], v[220:223]
    v_mfma_f32_16x16x32_bf16 v[224:227], a[40:43], a[0:3], v[224:227]
    v_mfma_f32_16x16x32_bf16 v[228:231], a[40:43], a[4:7], v[228:231]
    v_mfma_f32_16x16x32_bf16 v[232:235], a[44:47], a[0:3], v[232:235]
    v_mfma_f32_16x16x32_bf16 v[236:239], a[44:47], a[4:7], v[236:239]
    s_waitcnt vmcnt(0) lgkmcnt(0)
    s_barrier
    v_mfma_f32_16x16x32_bf16 v[128:131], a[64:67], a[48:51], v[128:131]
    ds_read_b64_tr_b16 a[16:17], v88 offset:16384
    v_mfma_f32_16x16x32_bf16 v[132:135], a[64:67], a[52:55], v[132:135]
    ds_read_b64_tr_b16 a[18:19], v88 offset:18176
    v_mfma_f32_16x16x32_bf16 v[136:139], a[64:67], a[56:59], v[136:139]
    ds_read_b128 a[0:3], v100 offset:0
    v_mfma_f32_16x16x32_bf16 v[140:143], a[64:67], a[60:63], v[140:143]
    ds_read_b128 a[4:7], v100 offset:2048
    v_mfma_f32_16x16x32_bf16 v[144:147], a[68:71], a[48:51], v[144:147]
    ds_read_b128 a[8:11], v106 offset:0
    v_mfma_f32_16x16x32_bf16 v[148:151], a[68:71], a[52:55], v[148:151]
    ds_read_b128 a[12:15], v106 offset:2048
    v_mfma_f32_16x16x32_bf16 v[152:155], a[68:71], a[56:59], v[152:155]
    ds_read_b64_tr_b16 a[20:21], v91 offset:16384
    v_mfma_f32_16x16x32_bf16 v[156:159], a[68:71], a[60:63], v[156:159]
    ds_read_b64_tr_b16 a[22:23], v91 offset:18176
    v_mfma_f32_16x16x32_bf16 v[160:163], a[72:75], a[48:51], v[160:163]
    ds_read_b64_tr_b16 a[24:25], v88 offset:16448
    v_mfma_f32_16x16x32_bf16 v[164:167], a[72:75], a[52:55], v[164:167]
    ds_read_b64_tr_b16 a[26:27], v88 offset:18240
    v_mfma_f32_16x16x32_bf16 v[168:171], a[72:75], a[56:59], v[168:171]
    ds_read_b64_tr_b16 a[28:29], v91 offset:16576
    v_mfma_f32_16x16x32_bf16 v[172:175], a[72:75], a[60:63], v[172:175]
    ds_read_b64_tr_b16 a[30:31], v91 offset:18368
    v_mfma_f32_16x16x32_bf16 v[176:179], a[76:79], a[48:51], v[176:179]
    ds_read_b64_tr_b16 a[32:33], v88 offset:16640
    v_mfma_f32_16x16x32_bf16 v[180:183], a[76:79], a[52:55], v[180:183]
    ds_read_b64_tr_b16 a[34:35], v88 offset:18432
    v_mfma_f32_16x16x32_bf16 v[184:187], a[76:79], a[56:59], v[184:187]
    ds_read_b64_tr_b16 a[36:37], v91 offset:16640
    v_mfma_f32_16x16x32_bf16 v[188:191], a[76:79], a[60:63], v[188:191]
    ds_read_b64_tr_b16 a[38:39], v91 offset:18432
    v_mfma_f32_16x16x32_bf16 v[192:195], a[80:83], a[48:51], v[192:195]
    ds_read_b64_tr_b16 a[40:41], v97 offset:16448
    v_mfma_f32_16x16x32_bf16 v[196:199], a[80:83], a[52:55], v[196:199]
    ds_read_b64_tr_b16 a[42:43], v97 offset:18240
    v_mfma_f32_16x16x32_bf16 v[200:203], a[80:83], a[56:59], v[200:203]
    ds_read_b64_tr_b16 a[44:45], v94 offset:16704
    v_mfma_f32_16x16x32_bf16 v[204:207], a[80:83], a[60:63], v[204:207]
    ds_read_b64_tr_b16 a[46:47], v94 offset:18496
    v_mfma_f32_16x16x32_bf16 v[208:211], a[84:87], a[48:51], v[208:211]
    v_mfma_f32_16x16x32_bf16 v[212:215], a[84:87], a[52:55], v[212:215]
    v_mfma_f32_16x16x32_bf16 v[216:219], a[84:87], a[56:59], v[216:219]
    v_mfma_f32_16x16x32_bf16 v[220:223], a[84:87], a[60:63], v[220:223]
    v_mfma_f32_16x16x32_bf16 v[224:227], a[88:91], a[48:51], v[224:227]
    v_mfma_f32_16x16x32_bf16 v[228:231], a[88:91], a[52:55], v[228:231]
    v_mfma_f32_16x16x32_bf16 v[232:235], a[92:95], a[48:51], v[232:235]
    v_mfma_f32_16x16x32_bf16 v[236:239], a[92:95], a[52:55], v[236:239]
    s_waitcnt lgkmcnt(0)
    s_add_u32 s91, s94, 1
    v_subrev_u32 v252, s91, v252
    v_cmp_lt_u32 vcc, 6, v252
    s_nop 4
    s_cbranch_vccz POK_2
    s_mov_b32 s99, 0x8000
PSPIN_3:
    s_sleep 2
    buffer_load_dword v252, v254, s[32:35], 0 offen sc1
    s_sub_u32 s99, s99, 1
    s_cbranch_scc1 POK_2
    s_waitcnt vmcnt(0)
    v_subrev_u32 v252, s91, v252
    v_cmp_lt_u32 vcc, 6, v252
    s_nop 4
    s_cbranch_vccnz PSPIN_3
POK_2:
    v_mfma_f32_16x16x32_bf16 v[128:131], a[16:19], a[0:3], v[128:131]
    ds_read_b64_tr_b16 a[64:65], v88 offset:30720
    v_mfma_f32_16x16x32_bf16 v[132:135], a[16:19], a[4:7], v[132:135]
    ds_read_b64_tr_b16 a[66:67], v88 offset:32512
    v_mfma_f32_16x16x32_bf16 v[136:139], a[16:19], a[8:11], v[136:139]
    ds_read_b128 a[48:51], v103 offset:0
    v_mfma_f32_16x16x32_bf16 v[140:143], a[16:19], a[12:15], v[140:143]
    ds_read_b128 a[52:55], v103 offset:2048
    v_mfma_f32_16x16x32_bf16 v[144:147], a[20:23], a[0:3], v[144:147]
    ds_read_b128 a[56:59], v109 offset:0
    v_mfma_f32_16x16x32_bf16 v[148:151], a[20:23], a[4:7], v[148:151]
    ds_read_b128 a[60:63], v109 offset:2048
    v_mfma_f32_16x16x32_bf16 v[152:155], a[20:23], a[8:11], v[152:155]
    ds_read_b64_tr_b16 a[68:69], v91 offset:30720
    v_mfma_f32_16x16x32_bf16 v[156:159], a[20:23], a[12:15], v[156:159]
    ds_read_b64_tr_b16 a[70:71], v91 offset:32512
    v_mfma_f32_16x16x32_bf16 v[160:163], a[24:27], a[0:3], v[160:163]
    ds_read_b64_tr_b16 a[72:73], v88 offset:30784
    v_mfma_f32_16x16x32_bf16 v[164:167], a[24:27], a[4:7], v[164:167]
    ds_read_b64_tr_b16 a[74:75], v88 offset:32576
    v_mfma_f32_16x16x32_bf16 v[168:171], a[24:27], a[8:11], v[168:171]
    ds_read_b64_tr_b16 a[76:77], v91 offset:30912
    v_mfma_f32_16x16x32_bf16 v[172:175], a[24:27], a[12:15], v[172:175]
    ds_read_b64_tr_b16 a[78:79], v91 offset:32704
    v_mfma_f32_16x16x32_bf16 v[176:179], a[28:31], a[0:3], v[176:179]
    ds_read_b64_tr_b16 a[80:81], v88 offset:30976
    v_mfma_f32_16x16x32_bf16 v[180:183], a[28:31], a[4:7], v[180:183]
    ds_read_b64_tr_b16 a[82:83], v88 offset:32768
    v_mfma_f32_16x16x32_bf16 v[184:187], a[28:31], a[8:11], v[184:187]
    ds_read_b64_tr_b16 a[84:85], v91 offset:30976
    v_mfma_f32_16x16x32_bf16 v[188:191], a[28:31], a[12:15], v[188:191]
    ds_read_b64_tr_b16 a[86:87], v91 offset:32768
    v_mfma_f32_16x16x32_bf16 v[192:195], a[32:35], a[0:3], v[192:195]
    ds_read_b64_tr_b16 a[88:89], v97 offset:30784
    v_mfma_f32_16x16x32_bf16 v[196:199], a[32:35], a[4:7], v[196:199]
    ds_read_b64_tr_b16 a[90:91], v97 offset:32576
    v_mfma_f32_16x16x32_bf16 v[200:203], a[32:35], a[8:11], v[200:203]
    ds_read_b64_tr_b16 a[92:93], v94 offset:31040
    v_mfma_f32_16x16x32_bf16 v[204:207], a[32:35], a[12:15], v[204:207]
    ds_read_b64_tr_b16 a[94:95], v94 offset:32832
    v_mfma_f32_16x16x32_bf16 v[208:211], a[36:39], a[0:3], v[208:211]
    v_mfma_f32_16x16x32_bf16 v[212:215], a[36:39], a[4:7], v[212:215]
    v_mfma_f32_16x16x32_bf16 v[216:219], a[36:39], a[8:11], v[216:219]
    v_mfma_f32_16x16x32_bf16 v[220:223], a[36:39], a[12:15], v[220:223]
    v_mfma_f32_16x16x32_bf16 v[224:227], a[40:43], a[0:3], v[224:227]
    v_mfma_f32_16x16x32_bf16 v[228:231], a[40:43], a[4:7], v[228:231]
    v_mfma_f32_16x16x32_bf16 v[232:235], a[44:47], a[0:3], v[232:235]
    v_mfma_f32_16x16x32_bf16 v[236:239], a[44:47], a[4:7], v[236:239]
    s_waitcnt lgkmcnt(0)
    s_barrier
    v_lshlrev_b32 v20, 4, v1
    s_lshl_b32 s64, s6, 14
    s_sub_u32 s64, s64, 4096
    s_and_b32 s64, s64, 0x3ffff
    v_add_u32 v18, s65, v20
    v_mfma_f32_16x16x32_bf16 v[128:131], a[64:67], a[48:51], v[128:131]
    v_mfma_f32_16x16x32_bf16 v[132:135], a[64:67], a[52:55], v[132:135]
    v_mfma_f32_16x16x32_bf16 v[136:139], a[64:67], a[56:59], v[136:139]
    v_mfma_f32_16x16x32_bf16 v[140:143], a[64:67], a[60:63], v[140:143]
    buffer_load_dwordx4 a[168:171], v18, s[32:35], s64 offen offset:2048
    v_mfma_f32_16x16x32_bf16 v[144:147], a[68:71], a[48:51], v[144:147]
    v_mfma_f32_16x16x32_bf16 v[148:151], a[68:71], a[52:55], v[148:151]
    v_mfma_f32_16x16x32_bf16 v[152:155], a[68:71], a[56:59], v[152:155]
    v_mfma_f32_16x16x32_bf16 v[156:159], a[68:71], a[60:63], v[156:159]
    v_mfma_f32_16x16x32_bf16 v[160:163], a[72:75], a[48:51], v[160:163]
    v_mfma_f32_16x16x32_bf16 v[164:167], a[72:75], a[52:55], v[164:167]
    v_mfma_f32_16x16x32_bf16 v[168:171], a[72:75], a[56:59], v[168:171]
    buffer_load_dwordx4 a[172:175], v18, s[32:35], s64 offen offset:3072
    s_add_u32 s64, s64, 4096
    v_mfma_f32_16x16x32_bf16 v[172:175], a[72:75], a[60:63], v[172:175]
    s_and_b32 s64, s64, 0x3ffff
    v_mfma_f32_16x16x32_bf16 v[176:179], a[76:79], a[48:51], v[176:179]
    v_mfma_f32_16x16x32_bf16 v[180:183], a[76:79], a[52:55], v[180:183]
    v_mfma_f32_16x16x32_bf16 v[184:187], a[76:79], a[56:59], v[184:187]
    v_mfma_f32_16x16x32_bf16 v[188:191], a[76:79], a[60:63], v[188:191]
    v_mfma_f32_16x16x32_bf16 v[192:195], a[80:83], a[48:51], v[192:195]
    v_mfma_f32_16x16x32_bf16 v[196:199], a[80:83], a[52:55], v[196:199]
    buffer_load_dwordx4 a[0:3], v18, s[32:35], s64 offen offset:0
    v_mfma_f32_16x16x32_bf16 v[200:203], a[80:83], a[56:59], v[200:203]
    v_mfma_f32_16x16x32_bf16 v[204:207], a[80:83], a[60:63], v[204:207]
    v_mfma_f32_16x16x32_bf16 v[208:211], a[84:87], a[48:51], v[208:211]
    v_mfma_f32_16x16x32_bf16 v[212:215], a[84:87], a[52:55], v[212:215]
    v_mfma_f32_16x16x32_bf16 v[216:219], a[84:87], a[56:59], v[216:219]
    v_mfma_f32_16x16x32_bf16 v[220:223], a[84:87], a[60:63], v[220:223]
    v_mfma_f32_16x16x32_bf16 v[224:227], a[88:91], a[48:51], v[224:227]
    buffer_load_dwordx4 a[4:7], v18, s[32:35], s64 offen offset:1024
    v_mfma_f32_16x16x32_bf16 v[228:231], a[88:91], a[52:55], v[228:231]
    v_mfma_f32_16x16x32_bf16 v[232:235], a[92:95], a[48:51], v[232:235]
    v_mfma_f32_16x16x32_bf16 v[236:239], a[92:95], a[52:55], v[236:239]
    s_mov_b32 s56, 3222493025
    buffer_load_dwordx4 a[8:11], v18, s[32:35], s64 offen offset:2048
    s_mov_b32 s58, 3184710632
    s_mov_b32 s59, s58
    s_mov_b32 s60, 1.0
    s_mov_b32 s61, 1.0
    v_mov_b32 v26, s56
    v_mov_b32 v27, s56
    v_pk_mul_f32 v[96:97], v[128:129], v[128:129]
    v_pk_mul_f32 v[98:99], v[130:131], v[130:131]
    v_pk_mul_f32 v[100:101], v[132:133], v[132:133]
    v_pk_mul_f32 v[102:103], v[134:135], v[134:135]
    v_pk_fma_f32 v[96:97], v[96:97], s[58:59], v[26:27]
    v_pk_fma_f32 v[98:99], v[98:99], s[58:59], v[26:27]
    v_pk_fma_f32 v[100:101], v[100:101], s[58:59], v[26:27]
    v_pk_fma_f32 v[102:103], v[102:103], s[58:59], v[26:27]
    v_pk_mul_f32 v[96:97], v[96:97], v[128:129]
    v_pk_mul_f32 v[98:99], v[98:99], v[130:131]
    buffer_load_dwordx4 a[12:15], v18, s[32:35], s64 offen offset:3072
    v_pk_mul_f32 v[100:101], v[100:101], v[132:133]
    v_pk_mul_f32 v[102:103], v[102:103], v[134:135]
    v_exp_f32 v96, v96
    v_exp_f32 v97, v97
    v_exp_f32 v98, v98
    v_exp_f32 v99, v99
    v_exp_f32 v100, v100
    v_exp_f32 v101, v101
    v_exp_f32 v102, v102
    v_exp_f32 v103, v103
    v_pk_add_f32 v[96:97], v[96:97], s[60:61]
    v_pk_add_f32 v[98:99], v[98:99], s[60:61]
    v_pk_add_f32 v[100:101], v[100:101], s[60:61]
    v_pk_add_f32 v[102:103], v[102:103], s[60:61]
    v_rcp_f32 v96, v96
    v_rcp_f32 v97, v97
    s_add_u32 s64, s64, 4096
    s_and_b32 s64, s64, 0x3ffff
    buffer_load_dwordx4 a[16:19], v18, s[32:35], s64 offen offset:0
    v_rcp_f32 v98, v98
    v_rcp_f32 v99, v99
    v_rcp_f32 v100, v100
    v_rcp_f32 v101, v101
    v_rcp_f32 v102, v102
    v_rcp_f32 v103, v103
    v_pk_mul_f32 v[128:129], v[96:97], v[128:129]
    v_pk_mul_f32 v[130:131], v[98:99], v[130:131]
    v_pk_mul_f32 v[132:133], v[100:101], v[132:133]
    v_pk_mul_f32 v[134:135], v[102:103], v[134:135]
    v_cvt_pk_bf16_f32 v32, v128, v129
    v_cvt_pk_bf16_f32 v33, v130, v131
    v_cvt_pk_bf16_f32 v34, v132, v133
    v_cvt_pk_bf16_f32 v35, v134, v135
    v_pk_mul_f32 v[104:105], v[136:137], v[136:137]
    v_pk_mul_f32 v[106:107], v[138:139], v[138:139]
    buffer_load_dwordx4 a[20:23], v18, s[32:35], s64 offen offset:1024
    v_pk_mul_f32 v[108:109], v[140:141], v[140:141]
    v_pk_mul_f32 v[110:111], v[142:143], v[142:143]
    v_pk_fma_f32 v[104:105], v[104:105], s[58:59], v[26:27]
    v_pk_fma_f32 v[106:107], v[106:107], s[58:59], v[26:27]
    v_pk_fma_f32 v[108:109], v[108:109], s[58:59], v[26:27]
    v_pk_fma_f32 v[110:111], v[110:111], s[58:59], v[26:27]
    v_pk_mul_f32 v[104:105], v[104:105], v[136:137]
    v_pk_mul_f32 v[106:107], v[106:107], v[138:139]
    v_pk_mul_f32 v[108:109], v[108:109], v[140:141]
    v_pk_mul_f32 v[110:111], v[110:111], v[142:143]
    v_exp_f32 v104, v104
    v_exp_f32 v105, v105
    v_exp_f32 v106, v106
    v_exp_f32 v107, v107
    v_exp_f32 v108, v108
    v_exp_f32 v109, v109
    buffer_load_dwordx4 a[24:27], v18, s[32:35], s64 offen offset:2048
    v_exp_f32 v110, v110
    v_exp_f32 v111, v111
    v_pk_add_f32 v[104:105], v[104:105], s[60:61]
    v_pk_add_f32 v[106:107], v[106:107], s[60:61]
    v_pk_add_f32 v[108:109], v[108:109], s[60:61]
    v_pk_add_f32 v[110:111], v[110:111], s[60:61]
    v_rcp_f32 v104, v104
    v_rcp_f32 v105, v105
    v_rcp_f32 v106, v106
    v_rcp_f32 v107, v107
    v_rcp_f32 v108, v108
    v_rcp_f32 v109, v109
    v_rcp_f32 v110, v110
    v_rcp_f32 v111, v111
    v_pk_mul_f32 v[136:137], v[104:105], v[136:137]
    v_pk_mul_f32 v[138:139], v[106:107], v[138:139]
    buffer_load_dwordx4 a[28:31], v18, s[32:35], s64 offen offset:3072
    v_pk_mul_f32 v[140:141], v[108:109], v[140:141]
    v_pk_mul_f32 v[142:143], v[110:111], v[142:143]
    v_cvt_pk_bf16_f32 v36, v136, v137
    v_cvt_pk_bf16_f32 v37, v138, v139
    v_cvt_pk_bf16_f32 v38, v140, v141
    v_cvt_pk_bf16_f32 v39, v142, v143
    v_pk_mul_f32 v[96:97], v[144:145], v[144:145]
    v_pk_mul_f32 v[98:99], v[146:147], v[146:147]
    v_pk_mul_f32 v[100:101], v[148:149], v[148:149]
    v_pk_mul_f32 v[102:103], v[150:151], v[150:151]
    v_pk_fma_f32 v[96:97], v[96:97], s[58:59], v[26:27]
    v_pk_fma_f32 v[98:99], v[98:99], s[58:59], v[26:27]
    v_pk_fma_f32 v[100:101], v[100:101], s[58:59], v[26:27]
    v_pk_fma_f32 v[102:103], v[102:103], s[58:59], v[26:27]
    v_pk_mul_f32 v[96:97], v[96:97], v[144:145]
    v_pk_mul_f32 v[98:99], v[98:99], v[146:147]
    s_add_u32 s64, s64, 4096
    s_and_b32 s64, s64, 0x3ffff
    buffer_load_dwordx4 a[32:35], v18, s[32:35], s64 offen offset:0
    v_pk_mul_f32 v[100:101], v[100:101], v[148:149]
    v_pk_mul_f32 v[102:103], v[102:103], v[150:151]
    v_exp_f32 v96, v96
    v_exp_f32 v97, v97
    v_exp_f32 v98, v98
    v_exp_f32 v99, v99
    v_exp_f32 v100, v100
    v_exp_f32 v101, v101
    v_exp_f32 v102, v102
    v_exp_f32 v103, v103
    v_pk_add_f32 v[96:97], v[96:97], s[60:61]
    v_pk_add_f32 v[98:99], v[98:99], s[60:61]
    v_pk_add_f32 v[100:101], v[100:101], s[60:61]
    v_pk_add_f32 v[102:103], v[102:103], s[60:61]
    v_rcp_f32 v96, v96
    v_rcp_f32 v97, v97
    buffer_load_dwordx4 a[36:39], v18, s[32:35], s64 offen offset:1024
    v_rcp_f32 v98, v98
    v_rcp_f32 v99, v99
    v_rcp_f32 v100, v100
    v_rcp_f32 v101, v101
    v_rcp_f32 v102, v102
    v_rcp_f32 v103, v103
    v_pk_mul_f32 v[144:145], v[96:97], v[144:145]
    v_pk_mul_f32 v[146:147], v[98:99], v[146:147]
    v_pk_mul_f32 v[148:149], v[100:101], v[148:149]
    v_pk_mul_f32 v[150:151], v[102:103], v[150:151]
    v_cvt_pk_bf16_f32 v40, v144, v145
    v_cvt_pk_bf16_f32 v41, v146, v147
    v_cvt_pk_bf16_f32 v42, v148, v149
    v_cvt_pk_bf16_f32 v43, v150, v151
    v_pk_mul_f32 v[104:105], v[152:153], v[152:153]
    v_pk_mul_f32 v[106:107], v[154:155], v[154:155]
    buffer_load_dwordx4 a[40:43], v18, s[32:35], s64 offen offset:2048
    v_pk_mul_f32 v[108:109], v[156:157], v[156:157]
    v_pk_mul_f32 v[110:111], v[158:159], v[158:159]
    v_pk_fma_f32 v[104:105], v[104:105], s[58:59], v[26:27]
    v_pk_fma_f32 v[106:107], v[106:107], s[58:59], v[26:27]
    v_pk_fma_f32 v[108:109], v[108:109], s[58:59], v[26:27]
    v_pk_fma_f32 v[110:111], v[110:111], s[58:59], v[26:27]
    v_pk_mul_f32 v[104:105], v[104:105], v[152:153]
    v_pk_mul_f32 v[106:107], v[106:107], v[154:155]
    v_pk_mul_f32 v[108:109], v[108:109], v[156:157]
    v_pk_mul_f32 v[110:111], v[110:111], v[158:159]
    v_exp_f32 v104, v104
    v_exp_f32 v105, v105
    v_exp_f32 v106, v106
    v_exp_f32 v107, v107
    v_exp_f32 v108, v108
    v_exp_f32 v109, v109
    buffer_load_dwordx4 a[44:47], v18, s[32:35], s64 offen offset:3072
    v_exp_f32 v110, v110
    v_exp_f32 v111, v111
    v_pk_add_f32 v[104:105], v[104:105], s[60:61]
    v_pk_add_f32 v[106:107], v[106:107], s[60:61]
    v_pk_add_f32 v[108:109], v[108:109], s[60:61]
    v_pk_add_f32 v[110:111], v[110:111], s[60:61]
    v_rcp_f32 v104, v104
    v_rcp_f32 v105, v105
    v_rcp_f32 v106, v106
    v_rcp_f32 v107, v107
    v_rcp_f32 v108, v108
    v_rcp_f32 v109, v109
    v_rcp_f32 v110, v110
    v_rcp_f32 v111, v111
    v_pk_mul_f32 v[152:153], v[104:105], v[152:153]
    v_pk_mul_f32 v[154:155], v[106:107], v[154:155]
    s_add_u32 s64, s64, 4096
    s_and_b32 s64, s64, 0x3ffff
    buffer_load_dwordx4 a[96:99], v18, s[32:35], s64 offen offset:0
    v_pk_mul_f32 v[156:157], v[108:109], v[156:157]
    v_pk_mul_f32 v[158:159], v[110:111], v[158:159]
    v_cvt_pk_bf16_f32 v44, v152, v153
    v_cvt_pk_bf16_f32 v45, v154, v155
    v_cvt_pk_bf16_f32 v46, v156, v157
    v_cvt_pk_bf16_f32 v47, v158, v159
    v_pk_mul_f32 v[96:97], v[160:161], v[160:161]
    v_pk_mul_f32 v[98:99], v[162:163], v[162:163]
    v_pk_mul_f32 v[100:101], v[164:165], v[164:165]
    v_pk_mul_f32 v[102:103], v[166:167], v[166:167]
    v_pk_fma_f32 v[96:97], v[96:97], s[58:59], v[26:27]
    v_pk_fma_f32 v[98:99], v[98:99], s[58:59], v[26:27]
    v_pk_fma_f32 v[100:101], v[100:101], s[58:59], v[26:27]
    v_pk_fma_f32 v[102:103], v[102:103], s[58:59], v[26:27]
    v_pk_mul_f32 v[96:97], v[96:97], v[160:161]
    v_pk_mul_f32 v[98:99], v[98:99], v[162:163]
    buffer_load_dwordx4 a[100:103], v18, s[32:35], s64 offen offset:1024
    v_pk_mul_f32 v[100:101], v[100:101], v[164:165]
    v_pk_mul_f32 v[102:103], v[102:103], v[166:167]
    v_exp_f32 v96, v96
    v_exp_f32 v97, v97
    v_exp_f32 v98, v98
    v_exp_f32 v99, v99
    v_exp_f32 v100, v100
    v_exp_f32 v101, v101
    v_exp_f32 v102, v102
    v_exp_f32 v103, v103
    v_pk_add_f32 v[96:97], v[96:97], s[60:61]
    v_pk_add_f32 v[98:99], v[98:99], s[60:61]
    v_pk_add_f32 v[100:101], v[100:101], s[60:61]
    v_pk_add_f32 v[102:103], v[102:103], s[60:61]
    v_rcp_f32 v96, v96
    v_rcp_f32 v97, v97
    buffer_load_dwordx4 a[104:107], v18, s[32:35], s64 offen offset:2048
    v_rcp_f32 v98, v98
    v_rcp_f32 v99, v99
    v_rcp_f32 v100, v100
    v_rcp_f32 v101, v101
    v_rcp_f32 v102, v102
    v_rcp_f32 v103, v103
    v_pk_mul_f32 v[160:161], v[96:97], v[160:161]
    v_pk_mul_f32 v[162:163], v[98:99], v[162:163]
    v_pk_mul_f32 v[164:165], v[100:101], v[164:165]
    v_pk_mul_f32 v[166:167], v[102:103], v[166:167]
    v_cvt_pk_bf16_f32 v48, v160, v161
    v_cvt_pk_bf16_f32 v49, v162, v163
    v_cvt_pk_bf16_f32 v50, v164, v165
    v_cvt_pk_bf16_f32 v51, v166, v167
    v_pk_mul_f32 v[104:105], v[168:169], v[168:169]
    v_pk_mul_f32 v[106:107], v[170:171], v[170:171]
    buffer_load_dwordx4 a[108:111], v18, s[32:35], s64 offen offset:3072
    v_pk_mul_f32 v[108:109], v[172:173], v[172:173]
    v_pk_mul_f32 v[110:111], v[174:175], v[174:175]
    v_pk_fma_f32 v[104:105], v[104:105], s[58:59], v[26:27]
    v_pk_fma_f32 v[106:107], v[106:107], s[58:59], v[26:27]
    v_pk_fma_f32 v[108:109], v[108:109], s[58:59], v[26:27]
    v_pk_fma_f32 v[110:111], v[110:111], s[58:59], v[26:27]
    v_pk_mul_f32 v[104:105], v[104:105], v[168:169]
    v_pk_mul_f32 v[106:107], v[106:107], v[170:171]
    v_pk_mul_f32 v[108:109], v[108:109], v[172:173]
    v_pk_mul_f32 v[110:111], v[110:111], v[174:175]
    v_exp_f32 v104, v104
    v_exp_f32 v105, v105
    v_exp_f32 v106, v106
    v_exp_f32 v107, v107
    v_exp_f32 v108, v108
    v_exp_f32 v109, v109
    s_add_u32 s64, s64, 4096
    s_and_b32 s64, s64, 0x3ffff
    buffer_load_dwordx4 a[112:115], v18, s[32:35], s64 offen offset:0
    v_exp_f32 v110, v110
    v_exp_f32 v111, v111
    v_pk_add_f32 v[104:105], v[104:105], s[60:61]
    v_pk_add_f32 v[106:107], v[106:107], s[60:61]
    v_pk_add_f32 v[108:109], v[108:109], s[60:61]
    v_pk_add_f32 v[110:111], v[110:111], s[60:61]
    v_rcp_f32 v104, v104
    v_rcp_f32 v105, v105
    v_rcp_f32 v106, v106
    v_rcp_f32 v107, v107
    v_rcp_f32 v108, v108
    v_rcp_f32 v109, v109
    v_rcp_f32 v110, v110
    v_rcp_f32 v111, v111
    v_pk_mul_f32 v[168:169], v[104:105], v[168:169]
    v_pk_mul_f32 v[170:171], v[106:107], v[170:171]
    buffer_load_dwordx4 a[116:119], v18, s[32:35], s64 offen offset:1024
    v_pk_mul_f32 v[172:173], v[108:109], v[172:173]
    v_pk_mul_f32 v[174:175], v[110:111], v[174:175]
    v_cvt_pk_bf16_f32 v52, v168, v169
    v_cvt_pk_bf16_f32 v53, v170, v171
    v_cvt_pk_bf16_f32 v54, v172, v173
    v_cvt_pk_bf16_f32 v55, v174, v175
    v_pk_mul_f32 v[96:97], v[176:177], v[176:177]
    v_pk_mul_f32 v[98:99], v[178:179], v[178:179]
    v_pk_mul_f32 v[100:101], v[180:181], v[180:181]
    v_pk_mul_f32 v[102:103], v[182:183], v[182:183]
    v_pk_fma_f32 v[96:97], v[96:97], s[58:59], v[26:27]
    v_pk_fma_f32 v[98:99], v[98:99], s[58:59], v[26:27]
    v_pk_fma_f32 v[100:101], v[100:101], s[58:59], v[26:27]
    v_pk_fma_f32 v[102:103], v[102:103], s[58:59], v[26:27]
    v_pk_mul_f32 v[96:97], v[96:97], v[176:177]
    v_pk_mul_f32 v[98:99], v[98:99], v[178:179]
    buffer_load_dwordx4 a[120:123], v18, s[32:35], s64 offen offset:2048
    v_pk_mul_f32 v[100:101], v[100:101], v[180:181]
    v_pk_mul_f32 v[102:103], v[102:103], v[182:183]
    v_exp_f32 v96, v96
    v_exp_f32 v97, v97
    v_exp_f32 v98, v98
    v_exp_f32 v99, v99
    v_exp_f32 v100, v100
    v_exp_f32 v101, v101
    v_exp_f32 v102, v102
    v_exp_f32 v103, v103
    v_pk_add_f32 v[96:97], v[96:97], s[60:61]
    v_pk_add_f32 v[98:99], v[98:99], s[60:61]
    v_pk_add_f32 v[100:101], v[100:101], s[60:61]
    v_pk_add_f32 v[102:103], v[102:103], s[60:61]
    v_rcp_f32 v96, v96
    v_rcp_f32 v97, v97
    buffer_load_dwordx4 a[124:127], v18, s[32:35], s64 offen offset:3072
    v_rcp_f32 v98, v98
    v_rcp_f32 v99, v99
    v_rcp_f32 v100, v100
    v_rcp_f32 v101, v101
    v_rcp_f32 v102, v102
    v_rcp_f32 v103, v103
    v_pk_mul_f32 v[176:177], v[96:97], v[176:177]
    v_pk_mul_f32 v[178:179], v[98:99], v[178:179]
    v_pk_mul_f32 v[180:181], v[100:101], v[180:181]
    v_pk_mul_f32 v[182:183], v[102:103], v[182:183]
    v_cvt_pk_bf16_f32 v56, v176, v177
    v_cvt_pk_bf16_f32 v57, v178, v179
    v_cvt_pk_bf16_f32 v58, v180, v181
    v_cvt_pk_bf16_f32 v59, v182, v183
    v_pk_mul_f32 v[104:105], v[184:185], v[184:185]
    v_pk_mul_f32 v[106:107], v[186:187], v[186:187]
    s_add_u32 s64, s64, 4096
    s_and_b32 s64, s64, 0x3ffff
    buffer_load_dwordx4 a[128:131], v18, s[32:35], s64 offen offset:0
    v_pk_mul_f32 v[108:109], v[188:189], v[188:189]
    v_pk_mul_f32 v[110:111], v[190:191], v[190:191]
    v_pk_fma_f32 v[104:105], v[104:105], s[58:59], v[26:27]
    v_pk_fma_f32 v[106:107], v[106:107], s[58:59], v[26:27]
    v_pk_fma_f32 v[108:109], v[108:109], s[58:59], v[26:27]
    v_pk_fma_f32 v[110:111], v[110:111], s[58:59], v[26:27]
    v_pk_mul_f32 v[104:105], v[104:105], v[184:185]
    v_pk_mul_f32 v[106:107], v[106:107], v[186:187]
    v_pk_mul_f32 v[108:109], v[108:109], v[188:189]
    v_pk_mul_f32 v[110:111], v[110:111], v[190:191]
    v_exp_f32 v104, v104
    v_exp_f32 v105, v105
    v_exp_f32 v106, v106
    v_exp_f32 v107, v107
    v_exp_f32 v108, v108
    v_exp_f32 v109, v109
    buffer_load_dwordx4 a[132:135], v18, s[32:35], s64 offen offset:1024
    v_exp_f32 v110, v110
    v_exp_f32 v111, v111
    v_pk_add_f32 v[104:105], v[104:105], s[60:61]
    v_pk_add_f32 v[106:107], v[106:107], s[60:61]
    v_pk_add_f32 v[108:109], v[108:109], s[60:61]
    v_pk_add_f32 v[110:111], v[110:111], s[60:61]
    v_rcp_f32 v104, v104
    v_rcp_f32 v105, v105
    v_rcp_f32 v106, v106
    v_rcp_f32 v107, v107
    v_rcp_f32 v108, v108
    v_rcp_f32 v109, v109
    v_rcp_f32 v110, v110
    v_rcp_f32 v111, v111
    v_pk_mul_f32 v[184:185], v[104:105], v[184:185]
    v_pk_mul_f32 v[186:187], v[106:107], v[186:187]
    buffer_load_dwordx4 a[136:139], v18, s[32:35], s64 offen offset:2048
    v_pk_mul_f32 v[188:189], v[108:109], v[188:189]
    v_pk_mul_f32 v[190:191], v[110:111], v[190:191]
    v_cvt_pk_bf16_f32 v60, v184, v185
    v_cvt_pk_bf16_f32 v61, v186, v187
    v_cvt_pk_bf16_f32 v62, v188, v189
    v_cvt_pk_bf16_f32 v63, v190, v191
    v_pk_mul_f32 v[96:97], v[192:193], v[192:193]
    v_pk_mul_f32 v[98:99], v[194:195], v[194:195]
    v_pk_mul_f32 v[100:101], v[196:197], v[196:197]
    v_pk_mul_f32 v[102:103], v[198:199], v[198:199]
    v_pk_fma_f32 v[96:97], v[96:97], s[58:59], v[26:27]
    v_pk_fma_f32 v[98:99], v[98:99], s[58:59], v[26:27]
    v_pk_fma_f32 v[100:101], v[100:101], s[58:59], v[26:27]
    v_pk_fma_f32 v[102:103], v[102:103], s[58:59], v[26:27]
    v_pk_mul_f32 v[96:97], v[96:97], v[192:193]
    v_pk_mul_f32 v[98:99], v[98:99], v[194:195]
    buffer_load_dwordx4 a[140:143], v18, s[32:35], s64 offen offset:3072
    v_pk_mul_f32 v[100:101], v[100:101], v[196:197]
    v_pk_mul_f32 v[102:103], v[102:103], v[198:199]
    v_exp_f32 v96, v96
    v_exp_f32 v97, v97
    v_exp_f32 v98, v98
    v_exp_f32 v99, v99
    v_exp_f32 v100, v100
    v_exp_f32 v101, v101
    v_exp_f32 v102, v102
    v_exp_f32 v103, v103
    v_pk_add_f32 v[96:97], v[96:97], s[60:61]
    v_pk_add_f32 v[98:99], v[98:99], s[60:61]
    v_pk_add_f32 v[100:101], v[100:101], s[60:61]
    v_pk_add_f32 v[102:103], v[102:103], s[60:61]
    v_rcp_f32 v96, v96
    v_rcp_f32 v97, v97
    s_add_u32 s64, s64, 4096
    s_and_b32 s64, s64, 0x3ffff
    buffer_load_dwordx4 a[144:147], v18, s[32:35], s64 offen offset:0
    v_rcp_f32 v98, v98
    v_rcp_f32 v99, v99
    v_rcp_f32 v100, v100
    v_rcp_f32 v101, v101
    v_rcp_f32 v102, v102
    v_rcp_f32 v103, v103
    v_pk_mul_f32 v[192:193], v[96:97], v[192:193]
    v_pk_mul_f32 v[194:195], v[98:99], v[194:195]
    v_pk_mul_f32 v[196:197], v[100:101], v[196:197]
    v_pk_mul_f32 v[198:199], v[102:103], v[198:199]
    v_cvt_pk_bf16_f32 v64, v192, v193
    v_cvt_pk_bf16_f32 v65, v194, v195
    v_cvt_pk_bf16_f32 v66, v196, v197
    v_cvt_pk_bf16_f32 v67, v198, v199
    v_pk_mul_f32 v[104:105], v[200:201], v[200:201]
    v_pk_mul_f32 v[106:107], v[202:203], v[202:203]
    buffer_load_dwordx4 a[148:151], v18, s[32:35], s64 offen offset:1024
    v_pk_mul_f32 v[108:109], v[204:205], v[204:205]
    v_pk_mul_f32 v[110:111], v[206:207], v[206:207]
    v_pk_fma_f32 v[104:105], v[104:105], s[58:59], v[26:27]
    v_pk_fma_f32 v[106:107], v[106:107], s[58:59], v[26:27]
    v_pk_fma_f32 v[108:109], v[108:109], s[58:59], v[26:27]
    v_pk_fma_f32 v[110:111], v[110:111], s[58:59], v[26:27]
    v_pk_mul_f32 v[104:105], v[104:105], v[200:201]
    v_pk_mul_f32 v[106:107], v[106:107], v[202:203]
    v_pk_mul_f32 v[108:109], v[108:109], v[204:205]
    v_pk_mul_f32 v[110:111], v[110:111], v[206:207]
    v_exp_f32 v104, v104
    v_exp_f32 v105, v105
    v_exp_f32 v106, v106
    v_exp_f32 v107, v107
    v_exp_f32 v108, v108
    v_exp_f32 v109, v109
    buffer_load_dwordx4 a[152:155], v18, s[32:35], s64 offen offset:2048
    v_exp_f32 v110, v110
    v_exp_f32 v111, v111
    v_pk_add_f32 v[104:105], v[104:105], s[60:61]
    v_pk_add_f32 v[106:107], v[106:107], s[60:61]
    v_pk_add_f32 v[108:109], v[108:109], s[60:61]
    v_pk_add_f32 v[110:111], v[110:111], s[60:61]
    v_rcp_f32 v104, v104
    v_rcp_f32 v105, v105
    v_rcp_f32 v106, v106
    v_rcp_f32 v107, v107
    v_rcp_f32 v108, v108
    v_rcp_f32 v109, v109
    v_rcp_f32 v110, v110
    v_rcp_f32 v111, v111
    v_pk_mul_f32 v[200:201], v[104:105], v[200:201]
    v_pk_mul_f32 v[202:203], v[106:107], v[202:203]
    buffer_load_dwordx4 a[156:159], v18, s[32:35], s64 offen offset:3072
    v_pk_mul_f32 v[204:205], v[108:109], v[204:205]
    v_pk_mul_f32 v[206:207], v[110:111], v[206:207]
    v_cvt_pk_bf16_f32 v68, v200, v201
    v_cvt_pk_bf16_f32 v69, v202, v203
    v_cvt_pk_bf16_f32 v70, v204, v205
    v_cvt_pk_bf16_f32 v71, v206, v207
    v_pk_mul_f32 v[96:97], v[208:209], v[208:209]
    v_pk_mul_f32 v[98:99], v[210:211], v[210:211]
    v_pk_mul_f32 v[100:101], v[212:213], v[212:213]
    v_pk_mul_f32 v[102:103], v[214:215], v[214:215]
    v_pk_fma_f32 v[96:97], v[96:97], s[58:59], v[26:27]
    v_pk_fma_f32 v[98:99], v[98:99], s[58:59], v[26:27]
    v_pk_fma_f32 v[100:101], v[100:101], s[58:59], v[26:27]
    v_pk_fma_f32 v[102:103], v[102:103], s[58:59], v[26:27]
    v_pk_mul_f32 v[96:97], v[96:97], v[208:209]
    v_pk_mul_f32 v[98:99], v[98:99], v[210:211]
    s_add_u32 s64, s64, 4096
    s_and_b32 s64, s64, 0x3ffff
    v_pk_mul_f32 v[100:101], v[100:101], v[212:213]
    v_pk_mul_f32 v[102:103], v[102:103], v[214:215]
    v_exp_f32 v96, v96
    v_exp_f32 v97, v97
    v_exp_f32 v98, v98
    v_exp_f32 v99, v99
    v_exp_f32 v100, v100
    v_exp_f32 v101, v101
    v_exp_f32 v102, v102
    v_exp_f32 v103, v103
    v_pk_add_f32 v[96:97], v[96:97], s[60:61]
    v_pk_add_f32 v[98:99], v[98:99], s[60:61]
    v_pk_add_f32 v[100:101], v[100:101], s[60:61]
    v_pk_add_f32 v[102:103], v[102:103], s[60:61]
    v_rcp_f32 v96, v96
    v_rcp_f32 v97, v97
    v_rcp_f32 v98, v98
    v_rcp_f32 v99, v99
    v_rcp_f32 v100, v100
    v_rcp_f32 v101, v101
    v_rcp_f32 v102, v102
    v_rcp_f32 v103, v103
    v_pk_mul_f32 v[208:209], v[96:97], v[208:209]
    v_pk_mul_f32 v[210:211], v[98:99], v[210:211]
    v_pk_mul_f32 v[212:213], v[100:101], v[212:213]
    v_pk_mul_f32 v[214:215], v[102:103], v[214:215]
    v_cvt_pk_bf16_f32 v72, v208, v209
    v_cvt_pk_bf16_f32 v73, v210, v211
    v_cvt_pk_bf16_f32 v74, v212, v213
    v_cvt_pk_bf16_f32 v75, v214, v215
    v_pk_mul_f32 v[104:105], v[216:217], v[216:217]
    v_pk_mul_f32 v[106:107], v[218:219], v[218:219]
    v_pk_mul_f32 v[108:109], v[220:221], v[220:221]
    v_pk_mul_f32 v[110:111], v[222:223], v[222:223]
    v_pk_fma_f32 v[104:105], v[104:105], s[58:59], v[26:27]
    v_pk_fma_f32 v[106:107], v[106:107], s[58:59], v[26:27]
    v_pk_fma_f32 v[108:109], v[108:109], s[58:59], v[26:27]
    v_pk_fma_f32 v[110:111], v[110:111], s[58:59], v[26:27]
    v_pk_mul_f32 v[104:105], v[104:105], v[216:217]
    v_pk_mul_f32 v[106:107], v[106:107], v[218:219]
    v_pk_mul_f32 v[108:109], v[108:109], v[220:221]
    v_pk_mul_f32 v[110:111], v[110:111], v[222:223]
    v_exp_f32 v104, v104
    v_exp_f32 v105, v105
    v_exp_f32 v106, v106
    v_exp_f32 v107, v107
    v_exp_f32 v108, v108
    v_exp_f32 v109, v109
    v_exp_f32 v110, v110
    v_exp_f32 v111, v111
    v_pk_add_f32 v[104:105], v[104:105], s[60:61]
    v_pk_add_f32 v[106:107], v[106:107], s[60:61]
    v_pk_add_f32 v[108:109], v[108:109], s[60:61]
    v_pk_add_f32 v[110:111], v[110:111], s[60:61]
    v_rcp_f32 v104, v104
    v_rcp_f32 v105, v105
    v_rcp_f32 v106, v106
    v_rcp_f32 v107, v107
    v_rcp_f32 v108, v108
    v_rcp_f32 v109, v109
    v_rcp_f32 v110, v110
    v_rcp_f32 v111, v111
    v_pk_mul_f32 v[216:217], v[104:105], v[216:217]
    v_pk_mul_f32 v[218:219], v[106:107], v[218:219]
    v_pk_mul_f32 v[220:221], v[108:109], v[220:221]
    v_pk_mul_f32 v[222:223], v[110:111], v[222:223]
    v_cvt_pk_bf16_f32 v76, v216, v217
    v_cvt_pk_bf16_f32 v77, v218, v219
    v_cvt_pk_bf16_f32 v78, v220, v221
    v_cvt_pk_bf16_f32 v79, v222, v223
    v_pk_mul_f32 v[96:97], v[224:225], v[224:225]
    v_pk_mul_f32 v[98:99], v[226:227], v[226:227]
    v_pk_mul_f32 v[100:101], v[228:229], v[228:229]
    v_pk_mul_f32 v[102:103], v[230:231], v[230:231]
    v_pk_fma_f32 v[96:97], v[96:97], s[58:59], v[26:27]
    v_pk_fma_f32 v[98:99], v[98:99], s[58:59], v[26:27]
    v_pk_fma_f32 v[100:101], v[100:101], s[58:59], v[26:27]
    v_pk_fma_f32 v[102:103], v[102:103], s[58:59], v[26:27]
    v_pk_mul_f32 v[96:97], v[96:97], v[224:225]
    v_pk_mul_f32 v[98:99], v[98:99], v[226:227]
    v_pk_mul_f32 v[100:101], v[100:101], v[228:229]
    v_pk_mul_f32 v[102:103], v[102:103], v[230:231]
    v_exp_f32 v96, v96
    v_exp_f32 v97, v97
    v_exp_f32 v98, v98
    v_exp_f32 v99, v99
    v_exp_f32 v100, v100
    v_exp_f32 v101, v101
    v_exp_f32 v102, v102
    v_exp_f32 v103, v103
    v_pk_add_f32 v[96:97], v[96:97], s[60:61]
    v_pk_add_f32 v[98:99], v[98:99], s[60:61]
    v_pk_add_f32 v[100:101], v[100:101], s[60:61]
    v_pk_add_f32 v[102:103], v[102:103], s[60:61]
    v_rcp_f32 v96, v96
    v_rcp_f32 v97, v97
    v_rcp_f32 v98, v98
    v_rcp_f32 v99, v99
    v_rcp_f32 v100, v100
    v_rcp_f32 v101, v101
    v_rcp_f32 v102, v102
    v_rcp_f32 v103, v103
    v_pk_mul_f32 v[224:225], v[96:97], v[224:225]
    v_pk_mul_f32 v[226:227], v[98:99], v[226:227]
    v_pk_mul_f32 v[228:229], v[100:101], v[228:229]
    v_pk_mul_f32 v[230:231], v[102:103], v[230:231]
    v_cvt_pk_bf16_f32 v80, v224, v225
    v_cvt_pk_bf16_f32 v81, v226, v227
    v_cvt_pk_bf16_f32 v82, v228, v229
    v_cvt_pk_bf16_f32 v83, v230, v231
    v_pk_mul_f32 v[104:105], v[232:233], v[232:233]
    v_pk_mul_f32 v[106:107], v[234:235], v[234:235]
    v_pk_mul_f32 v[108:109], v[236:237], v[236:237]
    v_pk_mul_f32 v[110:111], v[238:239], v[238:239]
    v_pk_fma_f32 v[104:105], v[104:105], s[58:59], v[26:27]
    v_pk_fma_f32 v[106:107], v[106:107], s[58:59], v[26:27]
    v_pk_fma_f32 v[108:109], v[108:109], s[58:59], v[26:27]
    v_pk_fma_f32 v[110:111], v[110:111], s[58:59], v[26:27]
    v_pk_mul_f32 v[104:105], v[104:105], v[232:233]
    v_pk_mul_f32 v[106:107], v[106:107], v[234:235]
    v_pk_mul_f32 v[108:109], v[108:109], v[236:237]
    v_pk_mul_f32 v[110:111], v[110:111], v[238:239]
    v_exp_f32 v104, v104
    v_exp_f32 v105, v105
    v_exp_f32 v106, v106
    v_exp_f32 v107, v107
    v_exp_f32 v108, v108
    v_exp_f32 v109, v109
    v_exp_f32 v110, v110
    v_exp_f32 v111, v111
    v_pk_add_f32 v[104:105], v[104:105], s[60:61]
    v_pk_add_f32 v[106:107], v[106:107], s[60:61]
    v_pk_add_f32 v[108:109], v[108:109], s[60:61]
    v_pk_add_f32 v[110:111], v[110:111], s[60:61]
    v_rcp_f32 v104, v104
    v_rcp_f32 v105, v105
    v_rcp_f32 v106, v106
    v_rcp_f32 v107, v107
    v_rcp_f32 v108, v108
    v_rcp_f32 v109, v109
    v_rcp_f32 v110, v110
    v_rcp_f32 v111, v111
    v_pk_mul_f32 v[232:233], v[104:105], v[232:233]
    v_pk_mul_f32 v[234:235], v[106:107], v[234:235]
    v_pk_mul_f32 v[236:237], v[108:109], v[236:237]
    v_pk_mul_f32 v[238:239], v[110:111], v[238:239]
    v_cvt_pk_bf16_f32 v84, v232, v233
    v_cvt_pk_bf16_f32 v85, v234, v235
    v_cvt_pk_bf16_f32 v86, v236, v237
    v_cvt_pk_bf16_f32 v87, v238, v239
    v_pk_add_f32 v[104:105], v[176:177], v[178:179]
    v_pk_add_f32 v[106:107], v[180:181], v[182:183]
    v_pk_add_f32 v[108:109], v[184:185], v[186:187]
    v_pk_add_f32 v[110:111], v[188:189], v[190:191]
    v_pk_add_f32 v[104:105], v[104:105], v[192:193]
    v_pk_add_f32 v[106:107], v[106:107], v[196:197]
    v_pk_add_f32 v[108:109], v[108:109], v[200:201]
    v_pk_add_f32 v[110:111], v[110:111], v[204:205]
    v_pk_add_f32 v[104:105], v[104:105], v[194:195]
    v_pk_add_f32 v[106:107], v[106:107], v[198:199]
    v_pk_add_f32 v[108:109], v[108:109], v[202:203]
    v_pk_add_f32 v[110:111], v[110:111], v[206:207]
    v_pk_add_f32 v[104:105], v[104:105], v[208:209]
    v_pk_add_f32 v[106:107], v[106:107], v[212:213]
    v_pk_add_f32 v[108:109], v[108:109], v[216:217]
    v_pk_add_f32 v[110:111], v[110:111], v[220:221]
    v_pk_add_f32 v[104:105], v[104:105], v[210:211]
    v_pk_add_f32 v[106:107], v[106:107], v[214:215]
    v_pk_add_f32 v[108:109], v[108:109], v[218:219]
    v_pk_add_f32 v[110:111], v[110:111], v[222:223]
    v_pk_add_f32 v[104:105], v[104:105], v[232:233]
    v_pk_add_f32 v[106:107], v[106:107], v[236:237]
    v_pk_add_f32 v[104:105], v[104:105], v[234:235]
    v_pk_add_f32 v[106:107], v[106:107], v[238:239]
    v_add_f32 v96, v104, v105
    v_add_f32 v97, v106, v107
    v_add_f32 v98, v108, v109
    v_add_f32 v99, v110, v111
    v_mov_b32 v112, v96
    v_mov_b32 v113, v97
    v_mov_b32 v114, v98
    v_mov_b32 v115, v99
    v_permlane16_swap_b32 v96, v112
    v_permlane16_swap_b32 v97, v113
    v_permlane16_swap_b32 v98, v114
    v_permlane16_swap_b32 v99, v115
    v_add_f32 v96, v96, v112
    v_add_f32 v97, v97, v113
    v_add_f32 v98, v98, v114
    v_add_f32 v99, v99, v115
    v_mov_b32 v112, v96
    v_mov_b32 v113, v97
    v_mov_b32 v114, v98
    v_mov_b32 v115, v99
    v_permlane32_swap_b32 v96, v112
    v_permlane32_swap_b32 v97, v113
    v_permlane32_swap_b32 v98, v114
    v_permlane32_swap_b32 v99, v115
    v_add_f32 v96, v96, v112
    v_add_f32 v97, v97, v113
    v_add_f32 v98, v98, v114
    v_add_f32 v99, v99, v115
    v_mul_f32 v112, 3162505216, v96
    v_mul_f32 v114, 3162505216, v97
    v_mul_f32 v116, 3165301419, v98
    v_mul_f32 v118, 3165301419, v99
    v_sub_f32 v96, 0, v112
    v_sub_f32 v97, 0, v114
    v_sub_f32 v98, 0, v116
    v_sub_f32 v99, 0, v118
    v_pk_add_f32 v[176:177], v[176:177], v[112:113] op_sel_hi:[1,0]
    v_pk_add_f32 v[178:179], v[178:179], v[112:113] op_sel_hi:[1,0]
    v_pk_add_f32 v[192:193], v[192:193], v[112:113] op_sel_hi:[1,0]
    v_pk_add_f32 v[194:195], v[194:195], v[112:113] op_sel_hi:[1,0]
    v_pk_add_f32 v[208:209], v[208:209], v[112:113] op_sel_hi:[1,0]
    v_pk_add_f32 v[210:211], v[210:211], v[112:113] op_sel_hi:[1,0]
    v_pk_add_f32 v[232:233], v[232:233], v[112:113] op_sel_hi:[1,0]
    v_pk_add_f32 v[234:235], v[234:235], v[112:113] op_sel_hi:[1,0]
    v_pk_add_f32 v[180:181], v[180:181], v[114:115] op_sel_hi:[1,0]
    v_pk_add_f32 v[182:183], v[182:183], v[114:115] op_sel_hi:[1,0]
    v_pk_add_f32 v[196:197], v[196:197], v[114:115] op_sel_hi:[1,0]
    v_pk_add_f32 v[198:199], v[198:199], v[114:115] op_sel_hi:[1,0]
    v_pk_add_f32 v[212:213], v[212:213], v[114:115] op_sel_hi:[1,0]
    v_pk_add_f32 v[214:215], v[214:215], v[114:115] op_sel_hi:[1,0]
    v_pk_add_f32 v[236:237], v[236:237], v[114:115] op_sel_hi:[1,0]
    v_pk_add_f32 v[238:239], v[238:239], v[114:115] op_sel_hi:[1,0]
    v_pk_add_f32 v[184:185], v[184:185], v[116:117] op_sel_hi:[1,0]
    v_pk_add_f32 v[186:187], v[186:187], v[116:117] op_sel_hi:[1,0]
    v_pk_add_f32 v[200:201], v[200:201], v[116:117] op_sel_hi:[1,0]
    v_pk_add_f32 v[202:203], v[202:203], v[116:117] op_sel_hi:[1,0]
    v_pk_add_f32 v[216:217], v[216:217], v[116:117] op_sel_hi:[1,0]
    v_pk_add_f32 v[218:219], v[218:219], v[116:117] op_sel_hi:[1,0]
    v_pk_add_f32 v[188:189], v[188:189], v[118:119] op_sel_hi:[1,0]
    v_pk_add_f32 v[190:191], v[190:191], v[118:119] op_sel_hi:[1,0]
    v_pk_add_f32 v[204:205], v[204:205], v[118:119] op_sel_hi:[1,0]
    v_pk_add_f32 v[206:207], v[206:207], v[118:119] op_sel_hi:[1,0]
    v_pk_add_f32 v[220:221], v[220:221], v[118:119] op_sel_hi:[1,0]
    v_pk_add_f32 v[222:223], v[222:223], v[118:119] op_sel_hi:[1,0]
    v_pk_mul_f32 v[104:105], v[176:177], v[176:177]
    v_pk_mul_f32 v[106:107], v[180:181], v[180:181]
    v_pk_mul_f32 v[108:109], v[184:185], v[184:185]
    v_pk_mul_f32 v[110:111], v[188:189], v[188:189]
    v_pk_fma_f32 v[104:105], v[178:179], v[178:179], v[104:105]
    v_pk_fma_f32 v[106:107], v[182:183], v[182:183], v[106:107]
    v_pk_fma_f32 v[108:109], v[186:187], v[186:187], v[108:109]
    v_pk_fma_f32 v[110:111], v[190:191], v[190:191], v[110:111]
    v_pk_fma_f32 v[104:105], v[192:193], v[192:193], v[104:105]
    v_pk_fma_f32 v[106:107], v[196:197], v[196:197], v[106:107]
    v_pk_fma_f32 v[108:109], v[200:201], v[200:201], v[108:109]
    v_pk_fma_f32 v[110:111], v[204:205], v[204:205], v[110:111]
    v_pk_fma_f32 v[104:105], v[194:195], v[194:195], v[104:105]
    v_pk_fma_f32 v[106:107], v[198:199], v[198:199], v[106:107]
    v_pk_fma_f32 v[108:109], v[202:203], v[202:203], v[108:109]
    v_pk_fma_f32 v[110:111], v[206:207], v[206:207], v[110:111]
    v_pk_fma_f32 v[104:105], v[208:209], v[208:209], v[104:105]
    v_pk_fma_f32 v[106:107], v[212:213], v[212:213], v[106:107]
    v_pk_fma_f32 v[108:109], v[216:217], v[216:217], v[108:109]
    v_pk_fma_f32 v[110:111], v[220:221], v[220:221], v[110:111]
    v_pk_fma_f32 v[104:105], v[210:211], v[210:211], v[104:105]
    v_pk_fma_f32 v[106:107], v[214:215], v[214:215], v[106:107]
    v_pk_fma_f32 v[108:109], v[218:219], v[218:219], v[108:109]
    v_pk_fma_f32 v[110:111], v[222:223], v[222:223], v[110:111]
    v_pk_fma_f32 v[104:105], v[232:233], v[232:233], v[104:105]
    v_pk_fma_f32 v[106:107], v[236:237], v[236:237], v[106:107]
    v_pk_fma_f32 v[104:105], v[234:235], v[234:235], v[104:105]
    v_pk_fma_f32 v[106:107], v[238:239], v[238:239], v[106:107]
    v_add_f32 v100, v104, v105
    v_add_f32 v101, v106, v107
    v_add_f32 v102, v108, v109
    v_add_f32 v103, v110, v111
    v_mov_b32 v112, v100
    v_mov_b32 v113, v101
    v_mov_b32 v114, v102
    v_mov_b32 v115, v103
    v_permlane16_swap_b32 v100, v112
    v_permlane16_swap_b32 v101, v113
    v_permlane16_swap_b32 v102, v114
    v_permlane16_swap_b32 v103, v115
    v_add_f32 v100, v100, v112
    v_add_f32 v101, v101, v113
    v_add_f32 v102, v102, v114
    v_add_f32 v103, v103, v115
    v_mov_b32 v112, v100
    v_mov_b32 v113, v101
    v_mov_b32 v114, v102
    v_mov_b32 v115, v103
    v_permlane32_swap_b32 v100, v112
    v_permlane32_swap_b32 v101, v113
    v_permlane32_swap_b32 v102, v114
    v_permlane32_swap_b32 v103, v115
    v_add_f32 v100, v100, v112
    v_add_f32 v101, v101, v113
    v_add_f32 v102, v102, v114
    v_add_f32 v103, v103, v115
    v_lshrrev_b32 v26, 4, v1
    v_cmp_eq_u32 vcc, 1, v26
    s_nop 1
    v_cndmask_b32 v96, v96, v97, vcc
    v_cndmask_b32 v100, v100, v101, vcc
    v_cmp_eq_u32 vcc, 2, v26
    s_nop 1
    v_cndmask_b32 v96, v96, v98, vcc
    v_cndmask_b32 v100, v100, v102, vcc
    v_cmp_eq_u32 vcc, 3, v26
    s_nop 1
    v_cndmask_b32 v96, v96, v99, vcc
    v_cndmask_b32 v100, v100, v103, vcc
    s_lshl_b32 s56, s6, 4
    s_add_u32 s56, s56, s7
    s_lshl_b32 s56, s56, 11
    s_lshl_b32 s57, s4, 10
    s_add_u32 s56, s56, s57
    s_lshl_b32 s57, s5, 2
    s_add_u32 s56, s56, s57
    s_add_u32 s56, s56, 37748736
    s_lshl_b32 s57, s5, 9
    v_xor_b32 v26, s57, v20
    buffer_store_dword v96, v26, s[32:35], s56 offen sc1
    buffer_store_dword v100, v26, s[32:35], s56 offen offset:8 sc1
    v_bfe_u32 v212, v1, 4, 1
    v_lshlrev_b32 v212, 2, v212
    v_and_b32 v213, 7, v1
    v_cmp_eq_u32 vcc, v212, v213
    v_mov_b32 v212, 0x3f803f80
    s_nop 0
    v_cndmask_b32 v208, 0, v212, vcc
    v_mov_b32 v209, v208
    v_mov_b32 v210, v208
    v_mov_b32 v211, v208
    s_waitcnt vmcnt(30)
    v_mfma_f32_32x32x16_bf16 v[88:103], a[168:171], a[176:179], 0
    v_mfma_f32_32x32x16_bf16 v[88:103], a[172:175], a[180:183], v[88:103]
    v_mfma_f32_32x32x16_bf16 v[104:119], a[168:171], a[184:187], 0
    v_mfma_f32_32x32x16_bf16 v[104:119], a[172:175], a[188:191], v[104:119]
    s_nop 9
    v_max3_f32 v212, v88, v89, v90
    v_max3_f32 v212, v91, v92, v212
    v_max3_f32 v212, v93, v94, v212
    v_max3_f32 v212, v95, v96, v212
    v_max3_f32 v212, v97, v98, v212
    v_max3_f32 v212, v99, v100, v212
    v_max3_f32 v212, v101, v102, v212
    v_max_f32 v212, v103, v212
    v_mov_b32 v213, v212
    s_nop 1
    v_permlane32_swap_b32 v212, v213
    v_max_f32 v212, v212, v213
    v_sub_f32 v120, 0, v212
    v_sub_f32 v121, 0, v212
    v_sub_f32 v122, 0, v212
    v_sub_f32 v123, 0, v212
    v_sub_f32 v124, 0, v212
    v_sub_f32 v125, 0, v212
    v_sub_f32 v126, 0, v212
    v_sub_f32 v127, 0, v212
    v_sub_f32 v128, 0, v212
    v_sub_f32 v129, 0, v212
    v_sub_f32 v130, 0, v212
    v_sub_f32 v131, 0, v212
    v_sub_f32 v132, 0, v212
    v_sub_f32 v133, 0, v212
    v_sub_f32 v134, 0, v212
    v_sub_f32 v135, 0, v212
    s_nop 1
    v_mfma_f32_32x32x16_bf16 v[88:103], a[168:171], a[176:179], v[120:135]
    v_mfma_f32_32x32x16_bf16 v[88:103], a[172:175], a[180:183], v[88:103]
    v_max3_f32 v214, v104, v105, v106
    v_max3_f32 v214, v107, v108, v214
    v_max3_f32 v214, v109, v110, v214
    v_max3_f32 v214, v111, v112, v214
    v_max3_f32 v214, v113, v114, v214
    v_max3_f32 v214, v115, v116, v214
    v_max3_f32 v214, v117, v118, v214
    v_max_f32 v214, v119, v214
    v_mov_b32 v215, v214
    s_nop 1
    v_permlane32_swap_b32 v214, v215
    v_max_f32 v214, v214, v215
    v_sub_f32 v136, 0, v214
    v_sub_f32 v137, 0, v214
    v_sub_f32 v138, 0, v214
    v_sub_f32 v139, 0, v214
    v_sub_f32 v140, 0, v214
    v_sub_f32 v141, 0, v214
    v_sub_f32 v142, 0, v214
    v_sub_f32 v143, 0, v214
    v_sub_f32 v144, 0, v214
    v_sub_f32 v145, 0, v214
    v_sub_f32 v146, 0, v214
    v_sub_f32 v147, 0, v214
    v_sub_f32 v148, 0, v214
    v_sub_f32 v149, 0, v214
    v_sub_f32 v150, 0, v214
    v_sub_f32 v151, 0, v214
    s_nop 1
    v_mfma_f32_32x32x16_bf16 v[104:119], a[168:171], a[184:187], v[136:151]
    v_exp_f32 v88, v88
    v_exp_f32 v89, v89
    v_exp_f32 v90, v90
    v_exp_f32 v91, v91
    v_cvt_pk_bf16_f32 v184, v88, v89
    v_exp_f32 v92, v92
    v_exp_f32 v93, v93
    v_cvt_pk_bf16_f32 v185, v90, v91
    v_exp_f32 v94, v94
    v_exp_f32 v95, v95
    v_cvt_pk_bf16_f32 v186, v92, v93
    v_exp_f32 v96, v96
    v_mfma_f32_32x32x16_bf16 v[104:119], a[172:175], a[188:191], v[104:119]
    v_exp_f32 v97, v97
    v_cvt_pk_bf16_f32 v187, v94, v95
    v_exp_f32 v98, v98
    v_exp_f32 v99, v99
    v_cvt_pk_bf16_f32 v188, v96, v97
    v_exp_f32 v100, v100
    v_exp_f32 v101, v101
    v_cvt_pk_bf16_f32 v189, v98, v99
    v_exp_f32 v102, v102
    v_exp_f32 v103, v103
    v_cvt_pk_bf16_f32 v190, v100, v101
    v_cvt_pk_bf16_f32 v191, v102, v103
    s_waitcnt vmcnt(26)
    v_mfma_f32_32x32x16_bf16 v[88:103], a[8:11], a[176:179], v[120:135]
    buffer_load_dwordx4 a[160:163], v18, s[32:35], s64 offen offset:0
    v_exp_f32 v104, v104
    v_exp_f32 v105, v105
    v_exp_f32 v106, v106
    v_exp_f32 v107, v107
    v_mfma_f32_32x32x16_bf16 v[88:103], a[12:15], a[180:183], v[88:103]
    buffer_load_dwordx4 a[164:167], v18, s[32:35], s64 offen offset:1024
    v_cvt_pk_bf16_f32 v192, v104, v105
    v_exp_f32 v108, v108
    v_exp_f32 v109, v109
    v_cvt_pk_bf16_f32 v193, v106, v107
    v_mfma_f32_32x32x16_bf16 v[152:167], a[0:3], v[184:187], 0
    buffer_load_dwordx4 a[168:171], v18, s[32:35], s64 offen offset:2048
    v_exp_f32 v110, v110
    v_exp_f32 v111, v111
    v_cvt_pk_bf16_f32 v194, v108, v109
    v_exp_f32 v112, v112
    v_mfma_f32_16x16x32_bf16 v[200:203], v[208:211], v[184:187], 0
    buffer_load_dwordx4 a[172:175], v18, s[32:35], s64 offen offset:3072
    v_exp_f32 v113, v113
    v_cvt_pk_bf16_f32 v195, v110, v111
    v_exp_f32 v114, v114
    v_exp_f32 v115, v115
    v_mfma_f32_32x32x16_bf16 v[152:167], a[4:7], v[188:191], v[152:167]
    s_add_u32 s64, s64, 4096
    s_and_b32 s64, s64, 0x3ffff
    v_cvt_pk_bf16_f32 v196, v112, v113
    v_exp_f32 v116, v116
    v_exp_f32 v117, v117
    v_cvt_pk_bf16_f32 v197, v114, v115
    v_mfma_f32_16x16x32_bf16 v[200:203], v[208:211], v[188:191], v[200:203]
    v_exp_f32 v118, v118
    v_exp_f32 v119, v119
    v_cvt_pk_bf16_f32 v198, v116, v117
    v_cvt_pk_bf16_f32 v199, v118, v119
    v_and_b32 v21, 15, v1
    v_lshlrev_b32 v21, 7, v21
    v_accvgpr_read_b32 v2, a192
    v_accvgpr_read_b32 v3, a193
    v_accvgpr_read_b32 v4, a194
    v_accvgpr_read_b32 v5, a195
    s_mov_b32 s52, 0
    v_mfma_f32_32x32x16_bf16 v[104:119], a[8:11], a[184:187], v[136:151]
    v_exp_f32 v88, v88
    v_exp_f32 v89, v89
    v_exp_f32 v90, v90
    v_exp_f32 v91, v91
    v_mfma_f32_32x32x16_bf16 v[104:119], a[12:15], a[188:191], v[104:119]
    v_cvt_pk_bf16_f32 v184, v88, v89
    v_exp_f32 v92, v92
    v_exp_f32 v93, v93
    v_cvt_pk_bf16_f32 v185, v90, v91
    v_mfma_f32_32x32x16_bf16 v[168:183], a[0:3], v[192:195], 0
    v_exp_f32 v94, v94
    v_exp_f32 v95, v95
    v_cvt_pk_bf16_f32 v186, v92, v93
    v_exp_f32 v96, v96
    v_mfma_f32_16x16x32_bf16 v[204:207], v[208:211], v[192:195], 0
    v_exp_f32 v97, v97
    v_cvt_pk_bf16_f32 v187, v94, v95
    v_exp_f32 v98, v98
    v_exp_f32 v99, v99
    v_mfma_f32_32x32x16_bf16 v[168:183], a[4:7], v[196:199], v[168:183]
    v_cvt_pk_bf16_f32 v188, v96, v97
    v_exp_f32 v100, v100
    v_exp_f32 v101, v101
    v_cvt_pk_bf16_f32 v189, v98, v99
    v_mfma_f32_16x16x32_bf16 v[204:207], v[208:211], v[196:199], v[204:207]
    v_exp_f32 v102, v102
    v_exp_f32 v103, v103
    v_cvt_pk_bf16_f32 v190, v100, v101
    v_cvt_pk_bf16_f32 v191, v102, v103
    s_waitcnt vmcnt(26)
    v_mfma_f32_32x32x16_bf16 v[88:103], a[24:27], a[176:179], v[120:135]
    buffer_load_dwordx4 a[0:3], v18, s[32:35], s64 offen offset:0
    v_exp_f32 v104, v104
    v_exp_f32 v105, v105
    v_exp_f32 v106, v106
    v_exp_f32 v107, v107
    v_mfma_f32_32x32x16_bf16 v[88:103], a[28:31], a[180:183], v[88:103]
    buffer_load_dwordx4 a[4:7], v18, s[32:35], s64 offen offset:1024
    v_cvt_pk_bf16_f32 v192, v104, v105
    v_exp_f32 v108, v108
    v_exp_f32 v109, v109
    v_cvt_pk_bf16_f32 v193, v106, v107
    v_mfma_f32_32x32x16_bf16 v[152:167], a[16:19], v[184:187], v[152:167]
    buffer_load_dwordx4 a[8:11], v18, s[32:35], s64 offen offset:2048
    v_exp_f32 v110, v110
    v_exp_f32 v111, v111
    v_cvt_pk_bf16_f32 v194, v108, v109
    v_exp_f32 v112, v112
    v_mfma_f32_16x16x32_bf16 v[200:203], v[208:211], v[184:187], v[200:203]
    buffer_load_dwordx4 a[12:15], v18, s[32:35], s64 offen offset:3072
    v_exp_f32 v113, v113
    v_cvt_pk_bf16_f32 v195, v110, v111
    v_exp_f32 v114, v114
    v_exp_f32 v115, v115
    v_mfma_f32_32x32x16_bf16 v[152:167], a[20:23], v[188:191], v[152:167]
    s_add_u32 s64, s64, 4096
    s_and_b32 s64, s64, 0x3ffff
    v_cvt_pk_bf16_f32 v196, v112, v113
    v_exp_f32 v116, v116
    v_exp_f32 v117, v117
    v_cvt_pk_bf16_f32 v197, v114, v115
    v_mfma_f32_16x16x32_bf16 v[200:203], v[208:211], v[188:191], v[200:203]
    v_exp_f32 v118, v118
    v_exp_f32 v119, v119
    v_cvt_pk_bf16_f32 v198, v116, v117
    v_cvt_pk_bf16_f32 v199, v118, v119
    v_mfma_f32_32x32x16_bf16 v[104:119], a[24:27], a[184:187], v[136:151]
    v_exp_f32 v88, v88
    v_exp_f32 v89, v89
    v_exp_f32 v90, v90
    v_exp_f32 v91, v91
    v_mfma_f32_32x32x16_bf16 v[104:119], a[28:31], a[188:191], v[104:119]
    v_cvt_pk_bf16_f32 v184, v88, v89
    v_exp_f32 v92, v92
    v_exp_f32 v93, v93
    v_cvt_pk_bf16_f32 v185, v90, v91
    v_mfma_f32_32x32x16_bf16 v[168:183], a[16:19], v[192:195], v[168:183]
    v_exp_f32 v94, v94
    v_exp_f32 v95, v95
    v_cvt_pk_bf16_f32 v186, v92, v93
    v_exp_f32 v96, v96
    v_mfma_f32_16x16x32_bf16 v[204:207], v[208:211], v[192:195], v[204:207]
    v_exp_f32 v97, v97
    v_cvt_pk_bf16_f32 v187, v94, v95
    v_exp_f32 v98, v98
    v_exp_f32 v99, v99
    v_mfma_f32_32x32x16_bf16 v[168:183], a[20:23], v[196:199], v[168:183]
    v_cvt_pk_bf16_f32 v188, v96, v97
    v_exp_f32 v100, v100
    v_exp_f32 v101, v101
    v_cvt_pk_bf16_f32 v189, v98, v99
    v_mfma_f32_16x16x32_bf16 v[204:207], v[208:211], v[196:199], v[204:207]
    v_exp_f32 v102, v102
    v_exp_f32 v103, v103
    v_cvt_pk_bf16_f32 v190, v100, v101
    v_cvt_pk_bf16_f32 v191, v102, v103
    s_waitcnt vmcnt(26)
    v_mfma_f32_32x32x16_bf16 v[88:103], a[40:43], a[176:179], v[120:135]
    buffer_load_dwordx4 a[16:19], v18, s[32:35], s64 offen offset:0
    v_exp_f32 v104, v104
    v_exp_f32 v105, v105
    v_exp_f32 v106, v106
    v_exp_f32 v107, v107
    v_mfma_f32_32x32x16_bf16 v[88:103], a[44:47], a[180:183], v[88:103]
    buffer_load_dwordx4 a[20:23], v18, s[32:35], s64 offen offset:1024
    v_cvt_pk_bf16_f32 v192, v104, v105
    v_exp_f32 v108, v108
    v_exp_f32 v109, v109
    v_cvt_pk_bf16_f32 v193, v106, v107
    v_mfma_f32_32x32x16_bf16 v[152:167], a[32:35], v[184:187], v[152:167]
    buffer_load_dwordx4 a[24:27], v18, s[32:35], s64 offen offset:2048
    v_exp_f32 v110, v110
    v_exp_f32 v111, v111
    v_cvt_pk_bf16_f32 v194, v108, v109
    v_exp_f32 v112, v112
    v_mfma_f32_16x16x32_bf16 v[200:203], v[208:211], v[184:187], v[200:203]
    buffer_load_dwordx4 a[28:31], v18, s[32:35], s64 offen offset:3072
    v_exp_f32 v113, v113
    v_cvt_pk_bf16_f32 v195, v110, v111
    v_exp_f32 v114, v114
    v_exp_f32 v115, v115
    v_mfma_f32_32x32x16_bf16 v[152:167], a[36:39], v[188:191], v[152:167]
    s_add_u32 s64, s64, 4096
    s_and_b32 s64, s64, 0x3ffff
    v_cvt_pk_bf16_f32 v196, v112, v113
    v_exp_f32 v116, v116
    v_exp_f32 v117, v117
    v_cvt_pk_bf16_f32 v197, v114, v115
    v_mfma_f32_16x16x32_bf16 v[200:203], v[208:211], v[188:191], v[200:203]
    v_exp_f32 v118, v118
    v_exp_f32 v119, v119
    v_cvt_pk_bf16_f32 v198, v116, v117
    v_cvt_pk_bf16_f32 v199, v118, v119
    v_mfma_f32_32x32x16_bf16 v[104:119], a[40:43], a[184:187], v[136:151]
    v_exp_f32 v88, v88
    v_exp_f32 v89, v89
    v_exp_f32 v90, v90
    v_exp_f32 v91, v91
    v_mfma_f32_32x32x16_bf16 v[104:119], a[44:47], a[188:191], v[104:119]
    v_cvt_pk_bf16_f32 v184, v88, v89
    v_exp_f32 v92, v92
    v_exp_f32 v93, v93
    v_cvt_pk_bf16_f32 v185, v90, v91
    v_mfma_f32_32x32x16_bf16 v[168:183], a[32:35], v[192:195], v[168:183]
    v_exp_f32 v94, v94
    v_exp_f32 v95, v95
    v_cvt_pk_bf16_f32 v186, v92, v93
    v_exp_f32 v96, v96
    v_mfma_f32_16x16x32_bf16 v[204:207], v[208:211], v[192:195], v[204:207]
    v_exp_f32 v97, v97
    v_cvt_pk_bf16_f32 v187, v94, v95
    v_exp_f32 v98, v98
    v_exp_f32 v99, v99
    v_mfma_f32_32x32x16_bf16 v[168:183], a[36:39], v[196:199], v[168:183]
    v_cvt_pk_bf16_f32 v188, v96, v97
    v_exp_f32 v100, v100
    v_exp_f32 v101, v101
    v_cvt_pk_bf16_f32 v189, v98, v99
    v_mfma_f32_16x16x32_bf16 v[204:207], v[208:211], v[196:199], v[204:207]
    v_exp_f32 v102, v102
    v_exp_f32 v103, v103
    v_cvt_pk_bf16_f32 v190, v100, v101
    v_cvt_pk_bf16_f32 v191, v102, v103
    s_waitcnt vmcnt(26)
    v_mfma_f32_32x32x16_bf16 v[88:103], a[104:107], a[176:179], v[120:135]
    buffer_load_dwordx4 a[32:35], v18, s[32:35], s64 offen offset:0
    v_exp_f32 v104, v104
    v_exp_f32 v105, v105
    v_exp_f32 v106, v106
    v_exp_f32 v107, v107
    v_mfma_f32_32x32x16_bf16 v[88:103], a[108:111], a[180:183], v[88:103]
    buffer_load_dwordx4 a[36:39], v18, s[32:35], s64 offen offset:1024
    v_cvt_pk_bf16_f32 v192, v104, v105
    v_exp_f32 v108, v108
    v_exp_f32 v109, v109
    v_cvt_pk_bf16_f32 v193, v106, v107
    v_mfma_f32_32x32x16_bf16 v[152:167], a[96:99], v[184:187], v[152:167]
    buffer_load_dwordx4 a[40:43], v18, s[32:35], s64 offen offset:2048
    v_exp_f32 v110, v110
    v_exp_f32 v111, v111
    v_cvt_pk_bf16_f32 v194, v108, v109
    v_exp_f32 v112, v112
    v_mfma_f32_16x16x32_bf16 v[200:203], v[208:211], v[184:187], v[200:203]
    buffer_load_dwordx4 a[44:47], v18, s[32:35], s64 offen offset:3072
    v_exp_f32 v113, v113
    v_cvt_pk_bf16_f32 v195, v110, v111
    v_exp_f32 v114, v114
    v_exp_f32 v115, v115
    v_mfma_f32_32x32x16_bf16 v[152:167], a[100:103], v[188:191], v[152:167]
    s_add_u32 s64, s64, 4096
    s_and_b32 s64, s64, 0x3ffff
    v_cvt_pk_bf16_f32 v196, v112, v113
    v_exp_f32 v116, v116
    v_exp_f32 v117, v117
    v_cvt_pk_bf16_f32 v197, v114, v115
    v_mfma_f32_16x16x32_bf16 v[200:203], v[208:211], v[188:191], v[200:203]
    v_exp_f32 v118, v118
    v_exp_f32 v119, v119
    v_cvt_pk_bf16_f32 v198, v116, v117
    v_cvt_pk_bf16_f32 v199, v118, v119
    v_mfma_f32_32x32x16_bf16 v[104:119], a[104:107], a[184:187], v[136:151]
    s_mul_i32 s66, s100, 2048
    s_add_u32 s66, s66, 0
    buffer_load_dword v19, v21, s[20:23], s66 offen
    v_exp_f32 v88, v88
    v_exp_f32 v89, v89
    v_exp_f32 v90, v90
    v_exp_f32 v91, v91
    v_mfma_f32_32x32x16_bf16 v[104:119], a[108:111], a[188:191], v[104:119]
    v_cvt_pk_bf16_f32 v184, v88, v89
    v_exp_f32 v92, v92
    v_exp_f32 v93, v93
    v_cvt_pk_bf16_f32 v185, v90, v91
    v_mfma_f32_32x32x16_bf16 v[168:183], a[96:99], v[192:195], v[168:183]
    v_exp_f32 v94, v94
    v_exp_f32 v95, v95
    v_cvt_pk_bf16_f32 v186, v92, v93
    v_exp_f32 v96, v96
    v_mfma_f32_16x16x32_bf16 v[204:207], v[208:211], v[192:195], v[204:207]
    v_exp_f32 v97, v97
    v_cvt_pk_bf16_f32 v187, v94, v95
    v_exp_f32 v98, v98
    v_exp_f32 v99, v99
    v_mfma_f32_32x32x16_bf16 v[168:183], a[100:103], v[196:199], v[168:183]
    v_cvt_pk_bf16_f32 v188, v96, v97
    v_exp_f32 v100, v100
    v_exp_f32 v101, v101
    v_cvt_pk_bf16_f32 v189, v98, v99
    v_mfma_f32_16x16x32_bf16 v[204:207], v[208:211], v[196:199], v[204:207]
    v_exp_f32 v102, v102
    v_exp_f32 v103, v103
    v_cvt_pk_bf16_f32 v190, v100, v101
    v_cvt_pk_bf16_f32 v191, v102, v103
    s_waitcnt vmcnt(27)
    v_mfma_f32_32x32x16_bf16 v[88:103], a[120:123], a[176:179], v[120:135]
    buffer_load_dwordx4 a[96:99], v18, s[32:35], s64 offen offset:0
    v_exp_f32 v104, v104
    v_exp_f32 v105, v105
    v_exp_f32 v106, v106
    v_exp_f32 v107, v107
    v_mfma_f32_32x32x16_bf16 v[88:103], a[124:127], a[180:183], v[88:103]
    buffer_load_dwordx4 a[100:103], v18, s[32:35], s64 offen offset:1024
    v_cvt_pk_bf16_f32 v192, v104, v105
    v_exp_f32 v108, v108
    v_exp_f32 v109, v109
    v_cvt_pk_bf16_f32 v193, v106, v107
    v_mfma_f32_32x32x16_bf16 v[152:167], a[112:115], v[184:187], v[152:167]
    buffer_load_dwordx4 a[104:107], v18, s[32:35], s64 offen offset:2048
    v_exp_f32 v110, v110
    v_exp_f32 v111, v111
    v_cvt_pk_bf16_f32 v194, v108, v109
    v_exp_f32 v112, v112
    v_mfma_f32_16x16x32_bf16 v[200:203], v[208:211], v[184:187], v[200:203]
    buffer_load_dwordx4 a[108:111], v18, s[32:35], s64 offen offset:3072
    v_exp_f32 v113, v113
    v_cvt_pk_bf16_f32 v195, v110, v111
    v_exp_f32 v114, v114
    v_exp_f32 v115, v115
    v_mfma_f32_32x32x16_bf16 v[152:167], a[116:119], v[188:191], v[152:167]
    s_add_u32 s64, s64, 4096
    s_and_b32 s64, s64, 0x3ffff
    v_cvt_pk_bf16_f32 v196, v112, v113
    v_exp_f32 v116, v116
    v_exp_f32 v117, v117
    v_cvt_pk_bf16_f32 v197, v114, v115
    v_mfma_f32_16x16x32_bf16 v[200:203], v[208:211], v[188:191], v[200:203]
    v_exp_f32 v118, v118
    v_exp_f32 v119, v119
    v_cvt_pk_bf16_f32 v198, v116, v117
    v_cvt_pk_bf16_f32 v199, v118, v119
    s_waitcnt vmcnt(21)
    s_barrier
    s_cmp_lg_u32 s3, 1
    s_cbranch_scc1 PUB_4
    s_add_u32 s99, s94, 2
    v_mov_b32 v0, s99
    s_mov_b64 exec, 1
    buffer_store_dword v0, v255, s[32:35], s92 offen sc1
    s_mov_b64 exec, -1
PUB_4:
    v_mfma_f32_32x32x16_bf16 v[104:119], a[120:123], a[184:187], v[136:151]
    v_exp_f32 v88, v88
    v_exp_f32 v89, v89
    v_exp_f32 v90, v90
    v_exp_f32 v91, v91
    v_mfma_f32_32x32x16_bf16 v[104:119], a[124:127], a[188:191], v[104:119]
    v_cvt_pk_bf16_f32 v184, v88, v89
    v_exp_f32 v92, v92
    v_exp_f32 v93, v93
    v_cvt_pk_bf16_f32 v185, v90, v91
    v_mfma_f32_32x32x16_bf16 v[168:183], a[112:115], v[192:195], v[168:183]
    v_exp_f32 v94, v94
    v_exp_f32 v95, v95
    v_cvt_pk_bf16_f32 v186, v92, v93
    v_exp_f32 v96, v96
    v_mfma_f32_16x16x32_bf16 v[204:207], v[208:211], v[192:195], v[204:207]
    v_exp_f32 v97, v97
    v_cvt_pk_bf16_f32 v187, v94, v95
    v_exp_f32 v98, v98
    v_exp_f32 v99, v99
    v_mfma_f32_32x32x16_bf16 v[168:183], a[116:119], v[196:199], v[168:183]
    v_cvt_pk_bf16_f32 v188, v96, v97
    v_exp_f32 v100, v100
    v_exp_f32 v101, v101
    v_cvt_pk_bf16_f32 v189, v98, v99
    v_mfma_f32_16x16x32_bf16 v[204:207], v[208:211], v[196:199], v[204:207]
    v_exp_f32 v102, v102
    v_exp_f32 v103, v103
    v_cvt_pk_bf16_f32 v190, v100, v101
    v_cvt_pk_bf16_f32 v191, v102, v103
    v_mfma_f32_32x32x16_bf16 v[88:103], a[136:139], a[176:179], v[120:135]
    buffer_load_dwordx4 a[112:115], v18, s[32:35], s64 offen offset:0
    v_exp_f32 v104, v104
    v_exp_f32 v105, v105
    v_exp_f32 v106, v106
    v_exp_f32 v107, v107
    v_mfma_f32_32x32x16_bf16 v[88:103], a[140:143], a[180:183], v[88:103]
    buffer_load_dwordx4 a[116:119], v18, s[32:35], s64 offen offset:1024
    v_cvt_pk_bf16_f32 v192, v104, v105
    v_exp_f32 v108, v108
    v_exp_f32 v109, v109
    v_cvt_pk_bf16_f32 v193, v106, v107
    v_mfma_f32_32x32x16_bf16 v[152:167], a[128:131], v[184:187], v[152:167]
    buffer_load_dwordx4 a[120:123], v18, s[32:35], s64 offen offset:2048
    v_exp_f32 v110, v110
    v_exp_f32 v111, v111
    v_cvt_pk_bf16_f32 v194, v108, v109
    v_exp_f32 v112, v112
    v_mfma_f32_16x16x32_bf16 v[200:203], v[208:211], v[184:187], v[200:203]
    buffer_load_dwordx4 a[124:127], v18, s[32:35], s64 offen offset:3072
    v_exp_f32 v113, v113
    v_cvt_pk_bf16_f32 v195, v110, v111
    v_exp_f32 v114, v114
    v_exp_f32 v115, v115
    v_mfma_f32_32x32x16_bf16 v[152:167], a[132:135], v[188:191], v[152:167]
    s_add_u32 s64, s64, 4096
    s_and_b32 s64, s64, 0x3ffff
    v_cvt_pk_bf16_f32 v196, v112, v113
    v_exp_f32 v116, v116
    v_exp_f32 v117, v117
    v_cvt_pk_bf16_f32 v197, v114, v115
    v_mfma_f32_16x16x32_bf16 v[200:203], v[208:211], v[188:191], v[200:203]
    v_exp_f32 v118, v118
    v_exp_f32 v119, v119
    v_cvt_pk_bf16_f32 v198, v116, v117
    v_cvt_pk_bf16_f32 v199, v118, v119
    v_mfma_f32_32x32x16_bf16 v[104:119], a[136:139], a[184:187], v[136:151]
    v_exp_f32 v88, v88
    v_exp_f32 v89, v89
    v_exp_f32 v90, v90
    v_exp_f32 v91, v91
    v_mfma_f32_32x32x16_bf16 v[104:119], a[140:143], a[188:191], v[104:119]
    v_cvt_pk_bf16_f32 v184, v88, v89
    v_exp_f32 v92, v92
    v_exp_f32 v93, v93
    v_cvt_pk_bf16_f32 v185, v90, v91
    v_mfma_f32_32x32x16_bf16 v[168:183], a[128:131], v[192:195], v[168:183]
    v_exp_f32 v94, v94
    v_exp_f32 v95, v95
    v_cvt_pk_bf16_f32 v186, v92, v93
    v_exp_f32 v96, v96
    v_mfma_f32_16x16x32_bf16 v[204:207], v[208:211], v[192:195], v[204:207]
    v_exp_f32 v97, v97
    v_cvt_pk_bf16_f32 v187, v94, v95
    v_exp_f32 v98, v98
    v_exp_f32 v99, v99
    v_mfma_f32_32x32x16_bf16 v[168:183], a[132:135], v[196:199], v[168:183]
    v_cvt_pk_bf16_f32 v188, v96, v97
    v_exp_f32 v100, v100
    v_exp_f32 v101, v101
    v_cvt_pk_bf16_f32 v189, v98, v99
    v_mfma_f32_16x16x32_bf16 v[204:207], v[208:211], v[196:199], v[204:207]
    v_exp_f32 v102, v102
    v_exp_f32 v103, v103
    v_cvt_pk_bf16_f32 v190, v100, v101
    v_cvt_pk_bf16_f32 v191, v102, v103
    v_mfma_f32_32x32x16_bf16 v[88:103], a[152:155], a[176:179], v[120:135]
    buffer_load_dwordx4 a[128:131], v18, s[32:35], s64 offen offset:0
    v_exp_f32 v104, v104
    v_exp_f32 v105, v105
    v_exp_f32 v106, v106
    v_exp_f32 v107, v107
    v_mfma_f32_32x32x16_bf16 v[88:103], a[156:159], a[180:183], v[88:103]
    buffer_load_dwordx4 a[132:135], v18, s[32:35], s64 offen offset:1024
    v_cvt_pk_bf16_f32 v192, v104, v105
    v_exp_f32 v108, v108
    v_exp_f32 v109, v109
    v_cvt_pk_bf16_f32 v193, v106, v107
    v_mfma_f32_32x32x16_bf16 v[152:167], a[144:147], v[184:187], v[152:167]
    buffer_load_dwordx4 a[136:139], v18, s[32:35], s64 offen offset:2048
    v_exp_f32 v110, v110
    v_exp_f32 v111, v111
    v_cvt_pk_bf16_f32 v194, v108, v109
    v_exp_f32 v112, v112
    v_mfma_f32_16x16x32_bf16 v[200:203], v[208:211], v[184:187], v[200:203]
    buffer_load_dwordx4 a[140:143], v18, s[32:35], s64 offen offset:3072
    v_exp_f32 v113, v113
    v_cvt_pk_bf16_f32 v195, v110, v111
    v_exp_f32 v114, v114
    v_exp_f32 v115, v115
    v_mfma_f32_32x32x16_bf16 v[152:167], a[148:151], v[188:191], v[152:167]
    s_add_u32 s64, s64, 4096
    s_and_b32 s64, s64, 0x3ffff
    v_cvt_pk_bf16_f32 v196, v112, v113
    v_exp_f32 v116, v116
    v_exp_f32 v117, v117
    v_cvt_pk_bf16_f32 v197, v114, v115
    v_mfma_f32_16x16x32_bf16 v[200:203], v[208:211], v[188:191], v[200:203]
    v_exp_f32 v118, v118
    v_exp_f32 v119, v119
    v_cvt_pk_bf16_f32 v198, v116, v117
    v_cvt_pk_bf16_f32 v199, v118, v119
    v_mfma_f32_32x32x16_bf16 v[104:119], a[152:155], a[184:187], v[136:151]
    v_exp_f32 v88, v88
    v_exp_f32 v89, v89
    v_exp_f32 v90, v90
    v_exp_f32 v91, v91
    v_mfma_f32_32x32x16_bf16 v[104:119], a[156:159], a[188:191], v[104:119]
    v_cvt_pk_bf16_f32 v184, v88, v89
    v_exp_f32 v92, v92
    v_exp_f32 v93, v93
    v_cvt_pk_bf16_f32 v185, v90, v91
    v_mfma_f32_32x32x16_bf16 v[168:183], a[144:147], v[192:195], v[168:183]
    v_exp_f32 v94, v94
    v_exp_f32 v95, v95
    v_cvt_pk_bf16_f32 v186, v92, v93
    v_exp_f32 v96, v96
    v_mfma_f32_16x16x32_bf16 v[204:207], v[208:211], v[192:195], v[204:207]
    v_exp_f32 v97, v97
    v_cvt_pk_bf16_f32 v187, v94, v95
    v_exp_f32 v98, v98
    v_exp_f32 v99, v99
    v_mfma_f32_32x32x16_bf16 v[168:183], a[148:151], v[196:199], v[168:183]
    v_cvt_pk_bf16_f32 v188, v96, v97
    v_exp_f32 v100, v100
    v_exp_f32 v101, v101
    v_cvt_pk_bf16_f32 v189, v98, v99
    v_mfma_f32_16x16x32_bf16 v[204:207], v[208:211], v[196:199], v[204:207]
    v_exp_f32 v102, v102
    v_exp_f32 v103, v103
    v_cvt_pk_bf16_f32 v190, v100, v101
    v_cvt_pk_bf16_f32 v191, v102, v103
    s_waitcnt vmcnt(25)
    v_mfma_f32_32x32x16_bf16 v[88:103], a[168:171], a[176:179], v[120:135]
    buffer_load_dwordx4 a[144:147], v18, s[32:35], s64 offen offset:0
    v_exp_f32 v104, v104
    v_exp_f32 v105, v105
    v_exp_f32 v106, v106
    v_exp_f32 v107, v107
    v_mfma_f32_32x32x16_bf16 v[88:103], a[172:175], a[180:183], v[88:103]
    buffer_load_dwordx4 a[148:151], v18, s[32:35], s64 offen offset:1024
    v_cvt_pk_bf16_f32 v192, v104, v105
    v_exp_f32 v108, v108
    v_exp_f32 v109, v109
    v_cvt_pk_bf16_f32 v193, v106, v107
    v_mfma_f32_32x32x16_bf16 v[152:167], a[160:163], v[184:187], v[152:167]
    buffer_load_dwordx4 a[152:155], v18, s[32:35], s64 offen offset:2048
    v_exp_f32 v110, v110
    v_exp_f32 v111, v111
    v_cvt_pk_bf16_f32 v194, v108, v109
    v_exp_f32 v112, v112
    v_mfma_f32_16x16x32_bf16 v[200:203], v[208:211], v[184:187], v[200:203]
    buffer_load_dwordx4 a[156:159], v18, s[32:35], s64 offen offset:3072
    v_exp_f32 v113, v113
    v_cvt_pk_bf16_f32 v195, v110, v111
    v_exp_f32 v114, v114
    v_exp_f32 v115, v115
    v_mfma_f32_32x32x16_bf16 v[152:167], a[164:167], v[188:191], v[152:167]
    s_add_u32 s64, s64, 4096
    s_and_b32 s64, s64, 0x3ffff
    v_cvt_pk_bf16_f32 v196, v112, v113
    v_exp_f32 v116, v116
    v_exp_f32 v117, v117
    v_cvt_pk_bf16_f32 v197, v114, v115
    v_mfma_f32_16x16x32_bf16 v[200:203], v[208:211], v[188:191], v[200:203]
    v_exp_f32 v118, v118
    v_exp_f32 v119, v119
    v_cvt_pk_bf16_f32 v198, v116, v117
    v_cvt_pk_bf16_f32 v199, v118, v119
    v_mfma_f32_32x32x16_bf16 v[104:119], a[168:171], a[184:187], v[136:151]
    s_mul_i32 s66, s100, 2048
    s_add_u32 s66, s66, 2097152
    buffer_load_dword v19, v21, s[20:23], s66 offen
    v_exp_f32 v88, v88
    v_exp_f32 v89, v89
    v_exp_f32 v90, v90
    v_exp_f32 v91, v91
    v_mfma_f32_32x32x16_bf16 v[104:119], a[172:175], a[188:191], v[104:119]
    v_cvt_pk_bf16_f32 v184, v88, v89
    v_exp_f32 v92, v92
    v_exp_f32 v93, v93
    v_cvt_pk_bf16_f32 v185, v90, v91
    v_mfma_f32_32x32x16_bf16 v[168:183], a[160:163], v[192:195], v[168:183]
    v_exp_f32 v94, v94
    v_exp_f32 v95, v95
    v_cvt_pk_bf16_f32 v186, v92, v93
    v_exp_f32 v96, v96
    v_mfma_f32_16x16x32_bf16 v[204:207], v[208:211], v[192:195], v[204:207]
    v_exp_f32 v97, v97
    v_cvt_pk_bf16_f32 v187, v94, v95
    v_exp_f32 v98, v98
    v_exp_f32 v99, v99
    v_mfma_f32_32x32x16_bf16 v[168:183], a[164:167], v[196:199], v[168:183]
    v_cvt_pk_bf16_f32 v188, v96, v97
    v_exp_f32 v100, v100
    v_exp_f32 v101, v101
    v_cvt_pk_bf16_f32 v189, v98, v99
    v_mfma_f32_16x16x32_bf16 v[204:207], v[208:211], v[196:199], v[204:207]
    v_exp_f32 v102, v102
    v_exp_f32 v103, v103
    v_cvt_pk_bf16_f32 v190, v100, v101
    v_cvt_pk_bf16_f32 v191, v102, v103
    s_waitcnt vmcnt(26)
    v_mfma_f32_32x32x16_bf16 v[88:103], a[8:11], a[176:179], v[120:135]
    buffer_load_dwordx4 a[160:163], v18, s[32:35], s64 offen offset:0
    v_exp_f32 v104, v104
    v_exp_f32 v105, v105
    v_exp_f32 v106, v106
    v_exp_f32 v107, v107
    v_mfma_f32_32x32x16_bf16 v[88:103], a[12:15], a[180:183], v[88:103]
    buffer_load_dwordx4 a[164:167], v18, s[32:35], s64 offen offset:1024
    v_cvt_pk_bf16_f32 v192, v104, v105
    v_exp_f32 v108, v108
    v_exp_f32 v109, v109
    v_cvt_pk_bf16_f32 v193, v106, v107
    v_mfma_f32_32x32x16_bf16 v[152:167], a[0:3], v[184:187], v[152:167]
    buffer_load_dwordx4 a[168:171], v18, s[32:35], s64 offen offset:2048
    v_exp_f32 v110, v110
    v_exp_f32 v111, v111
    v_cvt_pk_bf16_f32 v194, v108, v109
    v_exp_f32 v112, v112
    v_mfma_f32_16x16x32_bf16 v[200:203], v[208:211], v[184:187], v[200:203]
    buffer_load_dwordx4 a[172:175], v18, s[32:35], s64 offen offset:3072
    v_exp_f32 v113, v113
    v_cvt_pk_bf16_f32 v195, v110, v111
    v_exp_f32 v114, v114
    v_exp_f32 v115, v115
    v_mfma_f32_32x32x16_bf16 v[152:167], a[4:7], v[188:191], v[152:167]
    s_add_u32 s64, s64, 4096
    s_and_b32 s64, s64, 0x3ffff
    v_cvt_pk_bf16_f32 v196, v112, v113
    v_exp_f32 v116, v116
    v_exp_f32 v117, v117
    v_cvt_pk_bf16_f32 v197, v114, v115
    v_mfma_f32_16x16x32_bf16 v[200:203], v[208:211], v[188:191], v[200:203]
    v_exp_f32 v118, v118
    v_exp_f32 v119, v119
    v_cvt_pk_bf16_f32 v198, v116, v117
    v_cvt_pk_bf16_f32 v199, v118, v119
    v_mfma_f32_32x32x16_bf16 v[104:119], a[8:11], a[184:187], v[136:151]
    v_exp_f32 v88, v88
    v_exp_f32 v89, v89
    v_exp_f32 v90, v90
    v_exp_f32 v91, v91
    v_mfma_f32_32x32x16_bf16 v[104:119], a[12:15], a[188:191], v[104:119]
    v_cvt_pk_bf16_f32 v184, v88, v89
    v_exp_f32 v92, v92
    v_exp_f32 v93, v93
    v_cvt_pk_bf16_f32 v185, v90, v91
    v_mfma_f32_32x32x16_bf16 v[168:183], a[0:3], v[192:195], v[168:183]
    v_exp_f32 v94, v94
    v_exp_f32 v95, v95
    v_cvt_pk_bf16_f32 v186, v92, v93
    v_exp_f32 v96, v96
    v_mfma_f32_16x16x32_bf16 v[204:207], v[208:211], v[192:195], v[204:207]
    v_exp_f32 v97, v97
    v_cvt_pk_bf16_f32 v187, v94, v95
    v_exp_f32 v98, v98
    v_exp_f32 v99, v99
    v_mfma_f32_32x32x16_bf16 v[168:183], a[4:7], v[196:199], v[168:183]
    v_cvt_pk_bf16_f32 v188, v96, v97
    v_exp_f32 v100, v100
    v_exp_f32 v101, v101
    v_cvt_pk_bf16_f32 v189, v98, v99
    v_mfma_f32_16x16x32_bf16 v[204:207], v[208:211], v[196:199], v[204:207]
    v_exp_f32 v102, v102
    v_exp_f32 v103, v103
    v_cvt_pk_bf16_f32 v190, v100, v101
    v_cvt_pk_bf16_f32 v191, v102, v103
    s_waitcnt vmcnt(26)
    v_mfma_f32_32x32x16_bf16 v[88:103], a[24:27], a[176:179], v[120:135]
    buffer_load_dwordx4 a[0:3], v18, s[32:35], s64 offen offset:0
    v_exp_f32 v104, v104
    v_exp_f32 v105, v105
    v_exp_f32 v106, v106
    v_exp_f32 v107, v107
    v_mfma_f32_32x32x16_bf16 v[88:103], a[28:31], a[180:183], v[88:103]
    buffer_load_dwordx4 a[4:7], v18, s[32:35], s64 offen offset:1024
    v_cvt_pk_bf16_f32 v192, v104, v105
    v_exp_f32 v108, v108
    v_exp_f32 v109, v109
    v_cvt_pk_bf16_f32 v193, v106, v107
    v_mfma_f32_32x32x16_bf16 v[152:167], a[16:19], v[184:187], v[152:167]
    buffer_load_dwordx4 a[8:11], v18, s[32:35], s64 offen offset:2048
    v_exp_f32 v110, v110
    v_exp_f32 v111, v111
    v_cvt_pk_bf16_f32 v194, v108, v109
    v_exp_f32 v112, v112
    v_mfma_f32_16x16x32_bf16 v[200:203], v[208:211], v[184:187], v[200:203]
    buffer_load_dwordx4 a[12:15], v18, s[32:35], s64 offen offset:3072
    v_exp_f32 v113, v113
    v_cvt_pk_bf16_f32 v195, v110, v111
    v_exp_f32 v114, v114
    v_exp_f32 v115, v115
    v_mfma_f32_32x32x16_bf16 v[152:167], a[20:23], v[188:191], v[152:167]
    s_add_u32 s64, s64, 4096
    s_and_b32 s64, s64, 0x3ffff
    v_cvt_pk_bf16_f32 v196, v112, v113
    v_exp_f32 v116, v116
    v_exp_f32 v117, v117
    v_cvt_pk_bf16_f32 v197, v114, v115
    v_mfma_f32_16x16x32_bf16 v[200:203], v[208:211], v[188:191], v[200:203]
    v_exp_f32 v118, v118
    v_exp_f32 v119, v119
    v_cvt_pk_bf16_f32 v198, v116, v117
    v_cvt_pk_bf16_f32 v199, v118, v119
    v_mfma_f32_32x32x16_bf16 v[104:119], a[24:27], a[184:187], v[136:151]
    v_exp_f32 v88, v88
    v_exp_f32 v89, v89
    v_exp_f32 v90, v90
    v_exp_f32 v91, v91
    v_mfma_f32_32x32x16_bf16 v[104:119], a[28:31], a[188:191], v[104:119]
    v_cvt_pk_bf16_f32 v184, v88, v89
    v_exp_f32 v92, v92
    v_exp_f32 v93, v93
    v_cvt_pk_bf16_f32 v185, v90, v91
    v_mfma_f32_32x32x16_bf16 v[168:183], a[16:19], v[192:195], v[168:183]
    v_exp_f32 v94, v94
    v_exp_f32 v95, v95
    v_cvt_pk_bf16_f32 v186, v92, v93
    v_exp_f32 v96, v96
    v_mfma_f32_16x16x32_bf16 v[204:207], v[208:211], v[192:195], v[204:207]
    v_exp_f32 v97, v97
    v_cvt_pk_bf16_f32 v187, v94, v95
    v_exp_f32 v98, v98
    v_exp_f32 v99, v99
    v_mfma_f32_32x32x16_bf16 v[168:183], a[20:23], v[196:199], v[168:183]
    v_cvt_pk_bf16_f32 v188, v96, v97
    v_exp_f32 v100, v100
    v_exp_f32 v101, v101
    v_cvt_pk_bf16_f32 v189, v98, v99
    v_mfma_f32_16x16x32_bf16 v[204:207], v[208:211], v[196:199], v[204:207]
    v_exp_f32 v102, v102
    v_exp_f32 v103, v103
    v_cvt_pk_bf16_f32 v190, v100, v101
    v_cvt_pk_bf16_f32 v191, v102, v103
    s_waitcnt vmcnt(26)
    v_mfma_f32_32x32x16_bf16 v[88:103], a[40:43], a[176:179], v[120:135]
    buffer_load_dwordx4 a[16:19], v18, s[32:35], s64 offen offset:0
    v_exp_f32 v104, v104
    v_exp_f32 v105, v105
    v_exp_f32 v106, v106
    v_exp_f32 v107, v107
    v_mfma_f32_32x32x16_bf16 v[88:103], a[44:47], a[180:183], v[88:103]
    buffer_load_dwordx4 a[20:23], v18, s[32:35], s64 offen offset:1024
    v_cvt_pk_bf16_f32 v192, v104, v105
    v_exp_f32 v108, v108
    v_exp_f32 v109, v109
    v_cvt_pk_bf16_f32 v193, v106, v107
    v_mfma_f32_32x32x16_bf16 v[152:167], a[32:35], v[184:187], v[152:167]
    buffer_load_dwordx4 a[24:27], v18, s[32:35], s64 offen offset:2048
    v_exp_f32 v110, v110
    v_exp_f32 v111, v111
    v_cvt_pk_bf16_f32 v194, v108, v109
    v_exp_f32 v112, v112
    v_mfma_f32_16x16x32_bf16 v[200:203], v[208:211], v[184:187], v[200:203]
    buffer_load_dwordx4 a[28:31], v18, s[32:35], s64 offen offset:3072
    v_exp_f32 v113, v113
    v_cvt_pk_bf16_f32 v195, v110, v111
    v_exp_f32 v114, v114
    v_exp_f32 v115, v115
    v_mfma_f32_32x32x16_bf16 v[152:167], a[36:39], v[188:191], v[152:167]
    s_add_u32 s64, s64, 4096
    s_and_b32 s64, s64, 0x3ffff
    v_cvt_pk_bf16_f32 v196, v112, v113
    v_exp_f32 v116, v116
    v_exp_f32 v117, v117
    v_cvt_pk_bf16_f32 v197, v114, v115
    v_mfma_f32_16x16x32_bf16 v[200:203], v[208:211], v[188:191], v[200:203]
    v_exp_f32 v118, v118
    v_exp_f32 v119, v119
    v_cvt_pk_bf16_f32 v198, v116, v117
    v_cvt_pk_bf16_f32 v199, v118, v119
    v_mfma_f32_32x32x16_bf16 v[104:119], a[40:43], a[184:187], v[136:151]
    v_exp_f32 v88, v88
    v_exp_f32 v89, v89
    v_exp_f32 v90, v90
    v_exp_f32 v91, v91
    v_mfma_f32_32x32x16_bf16 v[104:119], a[44:47], a[188:191], v[104:119]
    v_cvt_pk_bf16_f32 v184, v88, v89
    v_exp_f32 v92, v92
    v_exp_f32 v93, v93
    v_cvt_pk_bf16_f32 v185, v90, v91
    v_mfma_f32_32x32x16_bf16 v[168:183], a[32:35], v[192:195], v[168:183]
    v_exp_f32 v94, v94
    v_exp_f32 v95, v95
    v_cvt_pk_bf16_f32 v186, v92, v93
    v_exp_f32 v96, v96
    v_mfma_f32_16x16x32_bf16 v[204:207], v[208:211], v[192:195], v[204:207]
    v_exp_f32 v97, v97
    v_cvt_pk_bf16_f32 v187, v94, v95
    v_exp_f32 v98, v98
    v_exp_f32 v99, v99
    v_mfma_f32_32x32x16_bf16 v[168:183], a[36:39], v[196:199], v[168:183]
    v_cvt_pk_bf16_f32 v188, v96, v97
    v_exp_f32 v100, v100
    v_exp_f32 v101, v101
    v_cvt_pk_bf16_f32 v189, v98, v99
    v_mfma_f32_16x16x32_bf16 v[204:207], v[208:211], v[196:199], v[204:207]
    v_exp_f32 v102, v102
    v_exp_f32 v103, v103
    v_cvt_pk_bf16_f32 v190, v100, v101
    v_cvt_pk_bf16_f32 v191, v102, v103
    s_waitcnt vmcnt(25)
    v_mfma_f32_32x32x16_bf16 v[88:103], a[104:107], a[176:179], v[120:135]
    buffer_load_dwordx4 a[32:35], v18, s[32:35], s64 offen offset:0
    v_exp_f32 v104, v104
    v_exp_f32 v105, v105
    v_exp_f32 v106, v106
    v_exp_f32 v107, v107
    v_mfma_f32_32x32x16_bf16 v[88:103], a[108:111], a[180:183], v[88:103]
    buffer_load_dwordx4 a[36:39], v18, s[32:35], s64 offen offset:1024
    v_cvt_pk_bf16_f32 v192, v104, v105
    v_exp_f32 v108, v108
    v_exp_f32 v109, v109
    v_cvt_pk_bf16_f32 v193, v106, v107
    v_mfma_f32_32x32x16_bf16 v[152:167], a[96:99], v[184:187], v[152:167]
    buffer_load_dwordx4 a[40:43], v18, s[32:35], s64 offen offset:2048
    v_exp_f32 v110, v110
    v_exp_f32 v111, v111
    v_cvt_pk_bf16_f32 v194, v108, v109
    v_exp_f32 v112, v112
    v_mfma_f32_16x16x32_bf16 v[200:203], v[208:211], v[184:187], v[200:203]
    buffer_load_dwordx4 a[44:47], v18, s[32:35], s64 offen offset:3072
    v_exp_f32 v113, v113
    v_cvt_pk_bf16_f32 v195, v110, v111
    v_exp_f32 v114, v114
    v_exp_f32 v115, v115
    v_mfma_f32_32x32x16_bf16 v[152:167], a[100:103], v[188:191], v[152:167]
    s_add_u32 s64, s64, 4096
    s_and_b32 s64, s64, 0x3ffff
    v_cvt_pk_bf16_f32 v196, v112, v113
    v_exp_f32 v116, v116
    v_exp_f32 v117, v117
    v_cvt_pk_bf16_f32 v197, v114, v115
    v_mfma_f32_16x16x32_bf16 v[200:203], v[208:211], v[188:191], v[200:203]
    v_exp_f32 v118, v118
    v_exp_f32 v119, v119
    v_cvt_pk_bf16_f32 v198, v116, v117
    v_cvt_pk_bf16_f32 v199, v118, v119
    v_mfma_f32_32x32x16_bf16 v[104:119], a[104:107], a[184:187], v[136:151]
    s_mul_i32 s66, s100, 2048
    s_add_u32 s66, s66, 4194304
    buffer_load_dword v19, v21, s[20:23], s66 offen
    v_exp_f32 v88, v88
    v_exp_f32 v89, v89
    v_exp_f32 v90, v90
    v_exp_f32 v91, v91
    v_mfma_f32_32x32x16_bf16 v[104:119], a[108:111], a[188:191], v[104:119]
    v_cvt_pk_bf16_f32 v184, v88, v89
    v_exp_f32 v92, v92
    v_exp_f32 v93, v93
    v_cvt_pk_bf16_f32 v185, v90, v91
    v_mfma_f32_32x32x16_bf16 v[168:183], a[96:99], v[192:195], v[168:183]
    v_exp_f32 v94, v94
    v_exp_f32 v95, v95
    v_cvt_pk_bf16_f32 v186, v92, v93
    v_exp_f32 v96, v96
    v_mfma_f32_16x16x32_bf16 v[204:207], v[208:211], v[192:195], v[204:207]
    v_exp_f32 v97, v97
    v_cvt_pk_bf16_f32 v187, v94, v95
    v_exp_f32 v98, v98
    v_exp_f32 v99, v99
    v_mfma_f32_32x32x16_bf16 v[168:183], a[100:103], v[196:199], v[168:183]
    v_cvt_pk_bf16_f32 v188, v96, v97
    v_exp_f32 v100, v100
    v_exp_f32 v101, v101
    v_cvt_pk_bf16_f32 v189, v98, v99
    v_mfma_f32_16x16x32_bf16 v[204:207], v[208:211], v[196:199], v[204:207]
    v_exp_f32 v102, v102
    v_exp_f32 v103, v103
    v_cvt_pk_bf16_f32 v190, v100, v101
    v_cvt_pk_bf16_f32 v191, v102, v103
    s_waitcnt vmcnt(26)
    v_mfma_f32_32x32x16_bf16 v[88:103], a[120:123], a[176:179], v[120:135]
    buffer_load_dwordx4 a[96:99], v18, s[32:35], s64 offen offset:0
    v_exp_f32 v104, v104
    v_exp_f32 v105, v105
    v_exp_f32 v106, v106
    v_exp_f32 v107, v107
    v_mfma_f32_32x32x16_bf16 v[88:103], a[124:127], a[180:183], v[88:103]
    buffer_load_dwordx4 a[100:103], v18, s[32:35], s64 offen offset:1024
    v_cvt_pk_bf16_f32 v192, v104, v105
    v_exp_f32 v108, v108
    v_exp_f32 v109, v109
    v_cvt_pk_bf16_f32 v193, v106, v107
    v_mfma_f32_32x32x16_bf16 v[152:167], a[112:115], v[184:187], v[152:167]
    buffer_load_dwordx4 a[104:107], v18, s[32:35], s64 offen offset:2048
    v_exp_f32 v110, v110
    v_exp_f32 v111, v111
    v_cvt_pk_bf16_f32 v194, v108, v109
    v_exp_f32 v112, v112
    v_mfma_f32_16x16x32_bf16 v[200:203], v[208:211], v[184:187], v[200:203]
    buffer_load_dwordx4 a[108:111], v18, s[32:35], s64 offen offset:3072
    v_exp_f32 v113, v113
    v_cvt_pk_bf16_f32 v195, v110, v111
    v_exp_f32 v114, v114
    v_exp_f32 v115, v115
    v_mfma_f32_32x32x16_bf16 v[152:167], a[116:119], v[188:191], v[152:167]
    s_add_u32 s64, s64, 4096
    s_and_b32 s64, s64, 0x3ffff
    v_cvt_pk_bf16_f32 v196, v112, v113
    v_exp_f32 v116, v116
    v_exp_f32 v117, v117
    v_cvt_pk_bf16_f32 v197, v114, v115
    v_mfma_f32_16x16x32_bf16 v[200:203], v[208:211], v[188:191], v[200:203]
    v_exp_f32 v118, v118
    v_exp_f32 v119, v119
    v_cvt_pk_bf16_f32 v198, v116, v117
    v_cvt_pk_bf16_f32 v199, v118, v119
    v_mfma_f32_32x32x16_bf16 v[104:119], a[120:123], a[184:187], v[136:151]
    v_exp_f32 v88, v88
    v_exp_f32 v89, v89
    v_exp_f32 v90, v90
    v_exp_f32 v91, v91
    v_mfma_f32_32x32x16_bf16 v[104:119], a[124:127], a[188:191], v[104:119]
    v_cvt_pk_bf16_f32 v184, v88, v89
    v_exp_f32 v92, v92
    v_exp_f32 v93, v93
    v_cvt_pk_bf16_f32 v185, v90, v91
    v_mfma_f32_32x32x16_bf16 v[168:183], a[112:115], v[192:195], v[168:183]
    v_exp_f32 v94, v94
    v_exp_f32 v95, v95
    v_cvt_pk_bf16_f32 v186, v92, v93
    v_exp_f32 v96, v96
    v_mfma_f32_16x16x32_bf16 v[204:207], v[208:211], v[192:195], v[204:207]
    v_exp_f32 v97, v97
    v_cvt_pk_bf16_f32 v187, v94, v95
    v_exp_f32 v98, v98
    v_exp_f32 v99, v99
    v_mfma_f32_32x32x16_bf16 v[168:183], a[116:119], v[196:199], v[168:183]
    v_cvt_pk_bf16_f32 v188, v96, v97
    v_exp_f32 v100, v100
    v_exp_f32 v101, v101
    v_cvt_pk_bf16_f32 v189, v98, v99
    v_mfma_f32_16x16x32_bf16 v[204:207], v[208:211], v[196:199], v[204:207]
    v_exp_f32 v102, v102
    v_exp_f32 v103, v103
    v_cvt_pk_bf16_f32 v190, v100, v101
    v_cvt_pk_bf16_f32 v191, v102, v103
    s_waitcnt vmcnt(26)
    v_mfma_f32_32x32x16_bf16 v[88:103], a[136:139], a[176:179], v[120:135]
    buffer_load_dwordx4 a[112:115], v18, s[32:35], s64 offen offset:0
    v_exp_f32 v104, v104
    v_exp_f32 v105, v105
    v_exp_f32 v106, v106
    v_exp_f32 v107, v107
    v_mfma_f32_32x32x16_bf16 v[88:103], a[140:143], a[180:183], v[88:103]
    buffer_load_dwordx4 a[116:119], v18, s[32:35], s64 offen offset:1024
    v_cvt_pk_bf16_f32 v192, v104, v105
    v_exp_f32 v108, v108
    v_exp_f32 v109, v109
    v_cvt_pk_bf16_f32 v193, v106, v107
    v_mfma_f32_32x32x16_bf16 v[152:167], a[128:131], v[184:187], v[152:167]
    buffer_load_dwordx4 a[120:123], v18, s[32:35], s64 offen offset:2048
    v_exp_f32 v110, v110
    v_exp_f32 v111, v111
    v_cvt_pk_bf16_f32 v194, v108, v109
    v_exp_f32 v112, v112
    v_mfma_f32_16x16x32_bf16 v[200:203], v[208:211], v[184:187], v[200:203]
    buffer_load_dwordx4 a[124:127], v18, s[32:35], s64 offen offset:3072
    v_exp_f32 v113, v113
    v_cvt_pk_bf16_f32 v195, v110, v111
    v_exp_f32 v114, v114
    v_exp_f32 v115, v115
    v_mfma_f32_32x32x16_bf16 v[152:167], a[132:135], v[188:191], v[152:167]
    s_add_u32 s64, s64, 4096
    s_and_b32 s64, s64, 0x3ffff
    v_cvt_pk_bf16_f32 v196, v112, v113
    v_exp_f32 v116, v116
    v_exp_f32 v117, v117
    v_cvt_pk_bf16_f32 v197, v114, v115
    v_mfma_f32_16x16x32_bf16 v[200:203], v[208:211], v[188:191], v[200:203]
    v_exp_f32 v118, v118
    v_exp_f32 v119, v119
    v_cvt_pk_bf16_f32 v198, v116, v117
    v_cvt_pk_bf16_f32 v199, v118, v119
    buffer_load_dword v252, v253, s[32:35], 0 offen sc1
    v_mfma_f32_32x32x16_bf16 v[104:119], a[136:139], a[184:187], v[136:151]
    v_exp_f32 v88, v88
    v_exp_f32 v89, v89
    v_exp_f32 v90, v90
    v_exp_f32 v91, v91
    v_mfma_f32_32x32x16_bf16 v[104:119], a[140:143], a[188:191], v[104:119]
    v_cvt_pk_bf16_f32 v184, v88, v89
    v_exp_f32 v92, v92
    v_exp_f32 v93, v93
    v_cvt_pk_bf16_f32 v185, v90, v91
    v_mfma_f32_32x32x16_bf16 v[168:183], a[128:131], v[192:195], v[168:183]
    v_exp_f32 v94, v94
    v_exp_f32 v95, v95
    v_cvt_pk_bf16_f32 v186, v92, v93
    v_exp_f32 v96, v96
    v_mfma_f32_16x16x32_bf16 v[204:207], v[208:211], v[192:195], v[204:207]
    v_exp_f32 v97, v97
    v_cvt_pk_bf16_f32 v187, v94, v95
    v_exp_f32 v98, v98
    v_exp_f32 v99, v99
    v_mfma_f32_32x32x16_bf16 v[168:183], a[132:135], v[196:199], v[168:183]
    v_cvt_pk_bf16_f32 v188, v96, v97
    v_exp_f32 v100, v100
    v_exp_f32 v101, v101
    v_cvt_pk_bf16_f32 v189, v98, v99
    v_mfma_f32_16x16x32_bf16 v[204:207], v[208:211], v[196:199], v[204:207]
    v_exp_f32 v102, v102
    v_exp_f32 v103, v103
    v_cvt_pk_bf16_f32 v190, v100, v101
    v_cvt_pk_bf16_f32 v191, v102, v103
    s_waitcnt vmcnt(27)
    v_mfma_f32_32x32x16_bf16 v[88:103], a[152:155], a[176:179], v[120:135]
    buffer_load_dwordx4 a[128:131], v18, s[32:35], s64 offen offset:0
    v_exp_f32 v104, v104
    v_exp_f32 v105, v105
    v_exp_f32 v106, v106
    v_exp_f32 v107, v107
    v_mfma_f32_32x32x16_bf16 v[88:103], a[156:159], a[180:183], v[88:103]
    buffer_load_dwordx4 a[132:135], v18, s[32:35], s64 offen offset:1024
    v_cvt_pk_bf16_f32 v192, v104, v105
    v_exp_f32 v108, v108
    v_exp_f32 v109, v109
    v_cvt_pk_bf16_f32 v193, v106, v107
    v_mfma_f32_32x32x16_bf16 v[152:167], a[144:147], v[184:187], v[152:167]
    buffer_load_dwordx4 a[136:139], v18, s[32:35], s64 offen offset:2048
    v_exp_f32 v110, v110
    v_exp_f32 v111, v111
    v_cvt_pk_bf16_f32 v194, v108, v109
    v_exp_f32 v112, v112
    v_mfma_f32_16x16x32_bf16 v[200:203], v[208:211], v[184:187], v[200:203]
    buffer_load_dwordx4 a[140:143], v18, s[32:35], s64 offen offset:3072
    v_exp_f32 v113, v113
    v_cvt_pk_bf16_f32 v195, v110, v111
    v_exp_f32 v114, v114
    v_exp_f32 v115, v115
    v_mfma_f32_32x32x16_bf16 v[152:167], a[148:151], v[188:191], v[152:167]
    s_add_u32 s64, s64, 4096
    s_and_b32 s64, s64, 0x3ffff
    v_cvt_pk_bf16_f32 v196, v112, v113
    v_exp_f32 v116, v116
    v_exp_f32 v117, v117
    v_cvt_pk_bf16_f32 v197, v114, v115
    v_mfma_f32_16x16x32_bf16 v[200:203], v[208:211], v[188:191], v[200:203]
    v_exp_f32 v118, v118
    v_exp_f32 v119, v119
    v_cvt_pk_bf16_f32 v198, v116, v117
    v_cvt_pk_bf16_f32 v199, v118, v119
    v_mfma_f32_32x32x16_bf16 v[104:119], a[152:155], a[184:187], v[136:151]
    v_exp_f32 v88, v88
    v_exp_f32 v89, v89
    v_exp_f32 v90, v90
    v_exp_f32 v91, v91
    v_mfma_f32_32x32x16_bf16 v[104:119], a[156:159], a[188:191], v[104:119]
    v_cvt_pk_bf16_f32 v184, v88, v89
    v_exp_f32 v92, v92
    v_exp_f32 v93, v93
    v_cvt_pk_bf16_f32 v185, v90, v91
    v_mfma_f32_32x32x16_bf16 v[168:183], a[144:147], v[192:195], v[168:183]
    v_exp_f32 v94, v94
    v_exp_f32 v95, v95
    v_cvt_pk_bf16_f32 v186, v92, v93
    v_exp_f32 v96, v96
    v_mfma_f32_16x16x32_bf16 v[204:207], v[208:211], v[192:195], v[204:207]
    v_exp_f32 v97, v97
    v_cvt_pk_bf16_f32 v187, v94, v95
    v_exp_f32 v98, v98
    v_exp_f32 v99, v99
    v_mfma_f32_32x32x16_bf16 v[168:183], a[148:151], v[196:199], v[168:183]
    v_cvt_pk_bf16_f32 v188, v96, v97
    v_exp_f32 v100, v100
    v_exp_f32 v101, v101
    v_cvt_pk_bf16_f32 v189, v98, v99
    v_mfma_f32_16x16x32_bf16 v[204:207], v[208:211], v[196:199], v[204:207]
    v_exp_f32 v102, v102
    v_exp_f32 v103, v103
    v_cvt_pk_bf16_f32 v190, v100, v101
    v_cvt_pk_bf16_f32 v191, v102, v103
    s_waitcnt vmcnt(26)
    v_mfma_f32_32x32x16_bf16 v[88:103], a[168:171], a[176:179], v[120:135]
    buffer_load_dwordx4 a[144:147], v18, s[32:35], s64 offen offset:0
    v_exp_f32 v104, v104
    v_exp_f32 v105, v105
    v_exp_f32 v106, v106
    v_exp_f32 v107, v107
    v_mfma_f32_32x32x16_bf16 v[88:103], a[172:175], a[180:183], v[88:103]
    buffer_load_dwordx4 a[148:151], v18, s[32:35], s64 offen offset:1024
    v_cvt_pk_bf16_f32 v192, v104, v105
    v_exp_f32 v108, v108
    v_exp_f32 v109, v109
    v_cvt_pk_bf16_f32 v193, v106, v107
    v_mfma_f32_32x32x16_bf16 v[152:167], a[160:163], v[184:187], v[152:167]
    buffer_load_dwordx4 a[152:155], v18, s[32:35], s64 offen offset:2048
    v_exp_f32 v110, v110
    v_exp_f32 v111, v111
    v_cvt_pk_bf16_f32 v194, v108, v109
    v_exp_f32 v112, v112
    v_mfma_f32_16x16x32_bf16 v[200:203], v[208:211], v[184:187], v[200:203]
    buffer_load_dwordx4 a[156:159], v18, s[32:35], s64 offen offset:3072
    v_exp_f32 v113, v113
    v_cvt_pk_bf16_f32 v195, v110, v111
    v_exp_f32 v114, v114
    v_exp_f32 v115, v115
    v_mfma_f32_32x32x16_bf16 v[152:167], a[164:167], v[188:191], v[152:167]
    s_add_u32 s64, s64, 4096
    s_and_b32 s64, s64, 0x3ffff
    v_cvt_pk_bf16_f32 v196, v112, v113
    v_exp_f32 v116, v116
    v_exp_f32 v117, v117
    v_cvt_pk_bf16_f32 v197, v114, v115
    v_mfma_f32_16x16x32_bf16 v[200:203], v[208:211], v[188:191], v[200:203]
    v_exp_f32 v118, v118
    v_exp_f32 v119, v119
    v_cvt_pk_bf16_f32 v198, v116, v117
    v_cvt_pk_bf16_f32 v199, v118, v119
    v_mfma_f32_32x32x16_bf16 v[104:119], a[168:171], a[184:187], v[136:151]
    s_mul_i32 s66, s100, 2048
    s_add_u32 s66, s66, 6291456
    buffer_load_dword v19, v21, s[20:23], s66 offen
    v_exp_f32 v88, v88
    v_exp_f32 v89, v89
    v_exp_f32 v90, v90
    v_exp_f32 v91, v91
    v_mfma_f32_32x32x16_bf16 v[104:119], a[172:175], a[188:191], v[104:119]
    v_cvt_pk_bf16_f32 v184, v88, v89
    v_exp_f32 v92, v92
    v_exp_f32 v93, v93
    v_cvt_pk_bf16_f32 v185, v90, v91
    v_mfma_f32_32x32x16_bf16 v[168:183], a[160:163], v[192:195], v[168:183]
    v_exp_f32 v94, v94
    v_exp_f32 v95, v95
    v_cvt_pk_bf16_f32 v186, v92, v93
    v_exp_f32 v96, v96
    v_mfma_f32_16x16x32_bf16 v[204:207], v[208:211], v[192:195], v[204:207]
    v_exp_f32 v97, v97
    v_cvt_pk_bf16_f32 v187, v94, v95
    v_exp_f32 v98, v98
    v_exp_f32 v99, v99
    v_mfma_f32_32x32x16_bf16 v[168:183], a[164:167], v[196:199], v[168:183]
    v_cvt_pk_bf16_f32 v188, v96, v97
    v_exp_f32 v100, v100
    v_exp_f32 v101, v101
    v_cvt_pk_bf16_f32 v189, v98, v99
    v_mfma_f32_16x16x32_bf16 v[204:207], v[208:211], v[196:199], v[204:207]
    v_exp_f32 v102, v102
    v_exp_f32 v103, v103
    v_cvt_pk_bf16_f32 v190, v100, v101
    v_cvt_pk_bf16_f32 v191, v102, v103
    s_waitcnt vmcnt(27)
    v_mfma_f32_32x32x16_bf16 v[88:103], a[8:11], a[176:179], v[120:135]
    buffer_load_dwordx4 a[160:163], v18, s[32:35], s64 offen offset:0
    v_exp_f32 v104, v104
    v_exp_f32 v105, v105
    v_exp_f32 v106, v106
    v_exp_f32 v107, v107
    v_mfma_f32_32x32x16_bf16 v[88:103], a[12:15], a[180:183], v[88:103]
    buffer_load_dwordx4 a[164:167], v18, s[32:35], s64 offen offset:1024
    v_cvt_pk_bf16_f32 v192, v104, v105
    v_exp_f32 v108, v108
    v_exp_f32 v109, v109
    v_cvt_pk_bf16_f32 v193, v106, v107
    v_mfma_f32_32x32x16_bf16 v[152:167], a[0:3], v[184:187], v[152:167]
    buffer_load_dwordx4 a[168:171], v18, s[32:35], s64 offen offset:2048
    v_exp_f32 v110, v110
    v_exp_f32 v111, v111
    v_cvt_pk_bf16_f32 v194, v108, v109
    v_exp_f32 v112, v112
    v_mfma_f32_16x16x32_bf16 v[200:203], v[208:211], v[184:187], v[200:203]
    buffer_load_dwordx4 a[172:175], v18, s[32:35], s64 offen offset:3072
    v_exp_f32 v113, v113
    v_cvt_pk_bf16_f32 v195, v110, v111
    v_exp_f32 v114, v114
    v_exp_f32 v115, v115
    v_mfma_f32_32x32x16_bf16 v[152:167], a[4:7], v[188:191], v[152:167]
    s_add_u32 s64, s64, 4096
    s_and_b32 s64, s64, 0x3ffff
    v_cvt_pk_bf16_f32 v196, v112, v113
    v_exp_f32 v116, v116
    v_exp_f32 v117, v117
    v_cvt_pk_bf16_f32 v197, v114, v115
    v_mfma_f32_16x16x32_bf16 v[200:203], v[208:211], v[188:191], v[200:203]
    v_exp_f32 v118, v118
    v_exp_f32 v119, v119
    v_cvt_pk_bf16_f32 v198, v116, v117
    v_cvt_pk_bf16_f32 v199, v118, v119
    s_waitcnt vmcnt(13)
    s_add_u32 s91, s94, 2
    v_subrev_u32 v252, s91, v252
    v_cmp_lt_u32 vcc, 5, v252
    s_nop 4
    s_cbranch_vccz POK_5
    s_mov_b32 s99, 0x8000
PSPIN_6:
    s_sleep 2
    buffer_load_dword v252, v253, s[32:35], 0 offen sc1
    s_sub_u32 s99, s99, 1
    s_cbranch_scc1 POK_5
    s_waitcnt vmcnt(0)
    v_subrev_u32 v252, s91, v252
    v_cmp_lt_u32 vcc, 5, v252
    s_nop 4
    s_cbranch_vccnz PSPIN_6
POK_5:
    s_lshl_b32 s56, s6, 15
    s_lshl_b32 s57, s4, 10
    s_add_u32 s56, s56, s57
    s_add_u32 s56, s56, 37748736
    buffer_load_dwordx4 v[212:215], v20, s[32:35], s56 offen offset:0 sc1
    buffer_load_dwordx4 v[216:219], v20, s[32:35], s56 offen offset:2048 sc1
    s_add_u32 s56, s56, 4096
    buffer_load_dwordx4 v[220:223], v20, s[32:35], s56 offen offset:0 sc1
    buffer_load_dwordx4 v[224:227], v20, s[32:35], s56 offen offset:2048 sc1
    s_add_u32 s56, s56, 4096
    buffer_load_dwordx4 v[228:231], v20, s[32:35], s56 offen offset:0 sc1
    buffer_load_dwordx4 v[232:235], v20, s[32:35], s56 offen offset:2048 sc1
    s_add_u32 s56, s56, 4096
    buffer_load_dwordx4 v[236:239], v20, s[32:35], s56 offen offset:0 sc1
    buffer_load_dwordx4 v[240:243], v20, s[32:35], s56 offen offset:2048 sc1
    v_mfma_f32_32x32x16_bf16 v[104:119], a[8:11], a[184:187], v[136:151]
    v_exp_f32 v88, v88
    v_exp_f32 v89, v89
    v_exp_f32 v90, v90
    v_exp_f32 v91, v91
    v_mfma_f32_32x32x16_bf16 v[104:119], a[12:15], a[188:191], v[104:119]
    v_cvt_pk_bf16_f32 v184, v88, v89
    v_exp_f32 v92, v92
    v_exp_f32 v93, v93
    v_cvt_pk_bf16_f32 v185, v90, v91
    v_mfma_f32_32x32x16_bf16 v[168:183], a[0:3], v[192:195], v[168:183]
    v_exp_f32 v94, v94
    v_exp_f32 v95, v95
    v_cvt_pk_bf16_f32 v186, v92, v93
    v_exp_f32 v96, v96
    v_mfma_f32_16x16x32_bf16 v[204:207], v[208:211], v[192:195], v[204:207]
    v_exp_f32 v97, v97
    v_cvt_pk_bf16_f32 v187, v94, v95
    v_exp_f32 v98, v98
    v_exp_f32 v99, v99
    v_mfma_f32_32x32x16_bf16 v[168:183], a[4:7], v[196:199], v[168:183]
    v_cvt_pk_bf16_f32 v188, v96, v97
    v_exp_f32 v100, v100
    v_exp_f32 v101, v101
    v_cvt_pk_bf16_f32 v189, v98, v99
    v_mfma_f32_16x16x32_bf16 v[204:207], v[208:211], v[196:199], v[204:207]
    v_exp_f32 v102, v102
    v_exp_f32 v103, v103
    v_cvt_pk_bf16_f32 v190, v100, v101
    v_cvt_pk_bf16_f32 v191, v102, v103
    v_mfma_f32_32x32x16_bf16 v[88:103], a[24:27], a[176:179], v[120:135]
    buffer_load_dwordx4 a[0:3], v18, s[32:35], s64 offen offset:0
    v_exp_f32 v104, v104
    v_exp_f32 v105, v105
    v_exp_f32 v106, v106
    v_exp_f32 v107, v107
    v_mfma_f32_32x32x16_bf16 v[88:103], a[28:31], a[180:183], v[88:103]
    buffer_load_dwordx4 a[4:7], v18, s[32:35], s64 offen offset:1024
    v_cvt_pk_bf16_f32 v192, v104, v105
    v_exp_f32 v108, v108
    v_exp_f32 v109, v109
    v_cvt_pk_bf16_f32 v193, v106, v107
    v_mfma_f32_32x32x16_bf16 v[152:167], a[16:19], v[184:187], v[152:167]
    buffer_load_dwordx4 a[8:11], v18, s[32:35], s64 offen offset:2048
    v_exp_f32 v110, v110
    v_exp_f32 v111, v111
    v_cvt_pk_bf16_f32 v194, v108, v109
    v_exp_f32 v112, v112
    v_mfma_f32_16x16x32_bf16 v[200:203], v[208:211], v[184:187], v[200:203]
    buffer_load_dwordx4 a[12:15], v18, s[32:35], s64 offen offset:3072
    v_exp_f32 v113, v113
    v_cvt_pk_bf16_f32 v195, v110, v111
    v_exp_f32 v114, v114
    v_exp_f32 v115, v115
    v_mfma_f32_32x32x16_bf16 v[152:167], a[20:23], v[188:191], v[152:167]
    s_add_u32 s64, s64, 4096
    s_and_b32 s64, s64, 0x3ffff
    v_cvt_pk_bf16_f32 v196, v112, v113
    v_exp_f32 v116, v116
    v_exp_f32 v117, v117
    v_cvt_pk_bf16_f32 v197, v114, v115
    v_mfma_f32_16x16x32_bf16 v[200:203], v[208:211], v[188:191], v[200:203]
    v_exp_f32 v118, v118
    v_exp_f32 v119, v119
    v_cvt_pk_bf16_f32 v198, v116, v117
    v_cvt_pk_bf16_f32 v199, v118, v119
    v_mfma_f32_32x32x16_bf16 v[104:119], a[24:27], a[184:187], v[136:151]
    v_exp_f32 v88, v88
    v_exp_f32 v89, v89
    v_exp_f32 v90, v90
    v_exp_f32 v91, v91
    v_mfma_f32_32x32x16_bf16 v[104:119], a[28:31], a[188:191], v[104:119]
    v_cvt_pk_bf16_f32 v184, v88, v89
    v_exp_f32 v92, v92
    v_exp_f32 v93, v93
    v_cvt_pk_bf16_f32 v185, v90, v91
    v_mfma_f32_32x32x16_bf16 v[168:183], a[16:19], v[192:195], v[168:183]
    v_exp_f32 v94, v94
    v_exp_f32 v95, v95
    v_cvt_pk_bf16_f32 v186, v92, v93
    v_exp_f32 v96, v96
    v_mfma_f32_16x16x32_bf16 v[204:207], v[208:211], v[192:195], v[204:207]
    v_exp_f32 v97, v97
    v_cvt_pk_bf16_f32 v187, v94, v95
    v_exp_f32 v98, v98
    v_exp_f32 v99, v99
    v_mfma_f32_32x32x16_bf16 v[168:183], a[20:23], v[196:199], v[168:183]
    v_cvt_pk_bf16_f32 v188, v96, v97
    v_exp_f32 v100, v100
    v_exp_f32 v101, v101
    v_cvt_pk_bf16_f32 v189, v98, v99
    v_mfma_f32_16x16x32_bf16 v[204:207], v[208:211], v[196:199], v[204:207]
    v_exp_f32 v102, v102
    v_exp_f32 v103, v103
    v_cvt_pk_bf16_f32 v190, v100, v101
    v_cvt_pk_bf16_f32 v191, v102, v103
    v_mfma_f32_32x32x16_bf16 v[88:103], a[40:43], a[176:179], v[120:135]
    buffer_load_dwordx4 a[16:19], v18, s[32:35], s64 offen offset:0
    v_exp_f32 v104, v104
    v_exp_f32 v105, v105
    v_exp_f32 v106, v106
    v_exp_f32 v107, v107
    v_mfma_f32_32x32x16_bf16 v[88:103], a[44:47], a[180:183], v[88:103]
    buffer_load_dwordx4 a[20:23], v18, s[32:35], s64 offen offset:1024
    v_cvt_pk_bf16_f32 v192, v104, v105
    v_exp_f32 v108, v108
    v_exp_f32 v109, v109
    v_cvt_pk_bf16_f32 v193, v106, v107
    v_mfma_f32_32x32x16_bf16 v[152:167], a[32:35], v[184:187], v[152:167]
    buffer_load_dwordx4 a[24:27], v18, s[32:35], s64 offen offset:2048
    v_exp_f32 v110, v110
    v_exp_f32 v111, v111
    v_cvt_pk_bf16_f32 v194, v108, v109
    v_exp_f32 v112, v112
    v_mfma_f32_16x16x32_bf16 v[200:203], v[208:211], v[184:187], v[200:203]
    buffer_load_dwordx4 a[28:31], v18, s[32:35], s64 offen offset:3072
    v_exp_f32 v113, v113
    v_cvt_pk_bf16_f32 v195, v110, v111
    v_exp_f32 v114, v114
    v_exp_f32 v115, v115
    v_mfma_f32_32x32x16_bf16 v[152:167], a[36:39], v[188:191], v[152:167]
    s_add_u32 s64, s64, 4096
    s_and_b32 s64, s64, 0x3ffff
    v_cvt_pk_bf16_f32 v196, v112, v113
    v_exp_f32 v116, v116
    v_exp_f32 v117, v117
    v_cvt_pk_bf16_f32 v197, v114, v115
    v_mfma_f32_16x16x32_bf16 v[200:203], v[208:211], v[188:191], v[200:203]
    v_exp_f32 v118, v118
    v_exp_f32 v119, v119
    v_cvt_pk_bf16_f32 v198, v116, v117
    v_cvt_pk_bf16_f32 v199, v118, v119
    v_mfma_f32_32x32x16_bf16 v[104:119], a[40:43], a[184:187], v[136:151]
    s_mul_i32 s66, s100, 1792
    s_add_u32 s66, s66, 0
    buffer_load_dword v19, v21, s[28:31], s66 offen
    v_exp_f32 v88, v88
    v_exp_f32 v89, v89
    v_exp_f32 v90, v90
    v_exp_f32 v91, v91
    v_mfma_f32_32x32x16_bf16 v[104:119], a[44:47], a[188:191], v[104:119]
    v_cvt_pk_bf16_f32 v184, v88, v89
    v_exp_f32 v92, v92
    v_exp_f32 v93, v93
    v_cvt_pk_bf16_f32 v185, v90, v91
    v_mfma_f32_32x32x16_bf16 v[168:183], a[32:35], v[192:195], v[168:183]
    v_exp_f32 v94, v94
    v_exp_f32 v95, v95
    v_cvt_pk_bf16_f32 v186, v92, v93
    v_exp_f32 v96, v96
    v_mfma_f32_16x16x32_bf16 v[204:207], v[208:211], v[192:195], v[204:207]
    v_exp_f32 v97, v97
    v_cvt_pk_bf16_f32 v187, v94, v95
    v_exp_f32 v98, v98
    v_exp_f32 v99, v99
    v_mfma_f32_32x32x16_bf16 v[168:183], a[36:39], v[196:199], v[168:183]
    v_cvt_pk_bf16_f32 v188, v96, v97
    v_exp_f32 v100, v100
    v_exp_f32 v101, v101
    v_cvt_pk_bf16_f32 v189, v98, v99
    v_mfma_f32_16x16x32_bf16 v[204:207], v[208:211], v[196:199], v[204:207]
    v_exp_f32 v102, v102
    v_exp_f32 v103, v103
    v_cvt_pk_bf16_f32 v190, v100, v101
    v_cvt_pk_bf16_f32 v191, v102, v103
    v_mfma_f32_32x32x16_bf16 v[88:103], a[104:107], a[176:179], v[120:135]
    buffer_load_dwordx4 a[32:35], v18, s[32:35], s64 offen offset:0
    v_exp_f32 v104, v104
    v_exp_f32 v105, v105
    v_exp_f32 v106, v106
    v_exp_f32 v107, v107
    v_mfma_f32_32x32x16_bf16 v[88:103], a[108:111], a[180:183], v[88:103]
    buffer_load_dwordx4 a[36:39], v18, s[32:35], s64 offen offset:1024
    v_cvt_pk_bf16_f32 v192, v104, v105
    v_exp_f32 v108, v108
    v_exp_f32 v109, v109
    v_cvt_pk_bf16_f32 v193, v106, v107
    v_mfma_f32_32x32x16_bf16 v[152:167], a[96:99], v[184:187], v[152:167]
    buffer_load_dwordx4 a[40:43], v18, s[32:35], s64 offen offset:2048
    v_exp_f32 v110, v110
    v_exp_f32 v111, v111
    v_cvt_pk_bf16_f32 v194, v108, v109
    v_exp_f32 v112, v112
    v_mfma_f32_16x16x32_bf16 v[200:203], v[208:211], v[184:187], v[200:203]
    buffer_load_dwordx4 a[44:47], v18, s[32:35], s64 offen offset:3072
    v_exp_f32 v113, v113
    v_cvt_pk_bf16_f32 v195, v110, v111
    v_exp_f32 v114, v114
    v_exp_f32 v115, v115
    v_mfma_f32_32x32x16_bf16 v[152:167], a[100:103], v[188:191], v[152:167]
    s_add_u32 s64, s64, 4096
    s_and_b32 s64, s64, 0x3ffff
    v_cvt_pk_bf16_f32 v196, v112, v113
    v_exp_f32 v116, v116
    v_exp_f32 v117, v117
    v_cvt_pk_bf16_f32 v197, v114, v115
    v_mfma_f32_16x16x32_bf16 v[200:203], v[208:211], v[188:191], v[200:203]
    v_exp_f32 v118, v118
    v_exp_f32 v119, v119
    v_cvt_pk_bf16_f32 v198, v116, v117
    v_cvt_pk_bf16_f32 v199, v118, v119
    s_waitcnt vmcnt(13)
    v_sub_f32 v24, 0, v212
    v_mov_b32 v26, 0
    v_mov_b32 v27, 0
    v_mov_b32 v28, 0
    v_mov_b32 v29, 0
    v_mov_b32 v30, 0
    v_mov_b32 v31, 0
    v_pk_add_f32 v[212:213], v[212:213], v[24:25] op_sel_hi:[1,0]
    v_pk_add_f32 v[216:217], v[216:217], v[24:25] op_sel_hi:[1,0]
    v_pk_add_f32 v[220:221], v[220:221], v[24:25] op_sel_hi:[1,0]
    v_pk_add_f32 v[224:225], v[224:225], v[24:25] op_sel_hi:[1,0]
    v_pk_add_f32 v[228:229], v[228:229], v[24:25] op_sel_hi:[1,0]
    v_pk_add_f32 v[232:233], v[232:233], v[24:25] op_sel_hi:[1,0]
    v_pk_add_f32 v[236:237], v[236:237], v[24:25] op_sel_hi:[1,0]
    v_pk_add_f32 v[240:241], v[240:241], v[24:25] op_sel_hi:[1,0]
    v_pk_add_f32 v[26:27], v[26:27], v[212:213]
    v_pk_fma_f32 v[28:29], v[212:213], v[212:213], v[28:29]
    v_pk_add_f32 v[30:31], v[30:31], v[214:215]
    v_pk_add_f32 v[26:27], v[26:27], v[216:217]
    v_pk_fma_f32 v[28:29], v[216:217], v[216:217], v[28:29]
    v_pk_add_f32 v[30:31], v[30:31], v[218:219]
    v_pk_add_f32 v[26:27], v[26:27], v[220:221]
    v_pk_fma_f32 v[28:29], v[220:221], v[220:221], v[28:29]
    v_pk_add_f32 v[30:31], v[30:31], v[222:223]
    v_pk_add_f32 v[26:27], v[26:27], v[224:225]
    v_pk_fma_f32 v[28:29], v[224:225], v[224:225], v[28:29]
    v_pk_add_f32 v[30:31], v[30:31], v[226:227]
    v_pk_add_f32 v[26:27], v[26:27], v[228:229]
    v_pk_fma_f32 v[28:29], v[228:229], v[228:229], v[28:29]
    v_pk_add_f32 v[30:31], v[30:31], v[230:231]
    v_pk_add_f32 v[26:27], v[26:27], v[232:233]
    v_pk_fma_f32 v[28:29], v[232:233], v[232:233], v[28:29]
    v_pk_add_f32 v[30:31], v[30:31], v[234:235]
    v_pk_add_f32 v[26:27], v[26:27], v[236:237]
    v_pk_fma_f32 v[28:29], v[236:237], v[236:237], v[28:29]
    v_pk_add_f32 v[30:31], v[30:31], v[238:239]
    v_pk_add_f32 v[26:27], v[26:27], v[240:241]
    v_pk_fma_f32 v[28:29], v[240:241], v[240:241], v[28:29]
    v_pk_add_f32 v[30:31], v[30:31], v[242:243]
    s_lshl_b32 s56, s6, 15
    s_lshl_b32 s57, s4, 10
    s_add_u32 s56, s56, s57
    s_add_u32 s56, s56, 37765120
    buffer_load_dwordx4 v[212:215], v20, s[32:35], s56 offen offset:0 sc1
    buffer_load_dwordx4 v[216:219], v20, s[32:35], s56 offen offset:2048 sc1
    s_add_u32 s56, s56, 4096
    buffer_load_dwordx4 v[220:223], v20, s[32:35], s56 offen offset:0 sc1
    buffer_load_dwordx4 v[224:227], v20, s[32:35], s56 offen offset:2048 sc1
    s_add_u32 s56, s56, 4096
    buffer_load_dwordx4 v[228:231], v20, s[32:35], s56 offen offset:0 sc1
    buffer_load_dwordx4 v[232:235], v20, s[32:35], s56 offen offset:2048 sc1
    s_add_u32 s56, s56, 4096
    buffer_load_dwordx4 v[236:239], v20, s[32:35], s56 offen offset:0 sc1
    buffer_load_dwordx4 v[240:243], v20, s[32:35], s56 offen offset:2048 sc1
    v_mfma_f32_32x32x16_bf16 v[104:119], a[104:107], a[184:187], v[136:151]
    v_exp_f32 v88, v88
    v_exp_f32 v89, v89
    v_exp_f32 v90, v90
    v_exp_f32 v91, v91
    v_mfma_f32_32x32x16_bf16 v[104:119], a[108:111], a[188:191], v[104:119]
    v_cvt_pk_bf16_f32 v184, v88, v89
    v_exp_f32 v92, v92
    v_exp_f32 v93, v93
    v_cvt_pk_bf16_f32 v185, v90, v91
    v_mfma_f32_32x32x16_bf16 v[168:183], a[96:99], v[192:195], v[168:183]
    v_exp_f32 v94, v94
    v_exp_f32 v95, v95
    v_cvt_pk_bf16_f32 v186, v92, v93
    v_exp_f32 v96, v96
    v_mfma_f32_16x16x32_bf16 v[204:207], v[208:211], v[192:195], v[204:207]
    v_exp_f32 v97, v97
    v_cvt_pk_bf16_f32 v187, v94, v95
    v_exp_f32 v98, v98
    v_exp_f32 v99, v99
    v_mfma_f32_32x32x16_bf16 v[168:183], a[100:103], v[196:199], v[168:183]
    v_cvt_pk_bf16_f32 v188, v96, v97
    v_exp_f32 v100, v100
    v_exp_f32 v101, v101
    v_cvt_pk_bf16_f32 v189, v98, v99
    v_mfma_f32_16x16x32_bf16 v[204:207], v[208:211], v[196:199], v[204:207]
    v_exp_f32 v102, v102
    v_exp_f32 v103, v103
    v_cvt_pk_bf16_f32 v190, v100, v101
    v_cvt_pk_bf16_f32 v191, v102, v103
    v_mfma_f32_32x32x16_bf16 v[88:103], a[120:123], a[176:179], v[120:135]
    buffer_load_dwordx4 a[96:99], v18, s[32:35], s64 offen offset:0
    v_exp_f32 v104, v104
    v_exp_f32 v105, v105
    v_exp_f32 v106, v106
    v_exp_f32 v107, v107
    v_mfma_f32_32x32x16_bf16 v[88:103], a[124:127], a[180:183], v[88:103]
    buffer_load_dwordx4 a[100:103], v18, s[32:35], s64 offen offset:1024
    v_cvt_pk_bf16_f32 v192, v104, v105
    v_exp_f32 v108, v108
    v_exp_f32 v109, v109
    v_cvt_pk_bf16_f32 v193, v106, v107
    v_mfma_f32_32x32x16_bf16 v[152:167], a[112:115], v[184:187], v[152:167]
    buffer_load_dwordx4 a[104:107], v18, s[32:35], s64 offen offset:2048
    v_exp_f32 v110, v110
    v_exp_f32 v111, v111
    v_cvt_pk_bf16_f32 v194, v108, v109
    v_exp_f32 v112, v112
    v_mfma_f32_16x16x32_bf16 v[200:203], v[208:211], v[184:187], v[200:203]
    buffer_load_dwordx4 a[108:111], v18, s[32:35], s64 offen offset:3072
    v_exp_f32 v113, v113
    v_cvt_pk_bf16_f32 v195, v110, v111
    v_exp_f32 v114, v114
    v_exp_f32 v115, v115
    v_mfma_f32_32x32x16_bf16 v[152:167], a[116:119], v[188:191], v[152:167]
    s_add_u32 s64, s64, 4096
    s_and_b32 s64, s64, 0x3ffff
    v_cvt_pk_bf16_f32 v196, v112, v113
    v_exp_f32 v116, v116
    v_exp_f32 v117, v117
    v_cvt_pk_bf16_f32 v197, v114, v115
    v_mfma_f32_16x16x32_bf16 v[200:203], v[208:211], v[188:191], v[200:203]
    v_exp_f32 v118, v118
    v_exp_f32 v119, v119
    v_cvt_pk_bf16_f32 v198, v116, v117
    v_cvt_pk_bf16_f32 v199, v118, v119
    v_mfma_f32_32x32x16_bf16 v[104:119], a[120:123], a[184:187], v[136:151]
    v_exp_f32 v88, v88
    v_exp_f32 v89, v89
    v_exp_f32 v90, v90
    v_exp_f32 v91, v91
    v_mfma_f32_32x32x16_bf16 v[104:119], a[124:127], a[188:191], v[104:119]
    v_cvt_pk_bf16_f32 v184, v88, v89
    v_exp_f32 v92, v92
    v_exp_f32 v93, v93
    v_cvt_pk_bf16_f32 v185, v90, v91
    v_mfma_f32_32x32x16_bf16 v[168:183], a[112:115], v[192:195], v[168:183]
    v_exp_f32 v94, v94
    v_exp_f32 v95, v95
    v_cvt_pk_bf16_f32 v186, v92, v93
    v_exp_f32 v96, v96
    v_mfma_f32_16x16x32_bf16 v[204:207], v[208:211], v[192:195], v[204:207]
    v_exp_f32 v97, v97
    v_cvt_pk_bf16_f32 v187, v94, v95
    v_exp_f32 v98, v98
    v_exp_f32 v99, v99
    v_mfma_f32_32x32x16_bf16 v[168:183], a[116:119], v[196:199], v[168:183]
    v_cvt_pk_bf16_f32 v188, v96, v97
    v_exp_f32 v100, v100
    v_exp_f32 v101, v101
    v_cvt_pk_bf16_f32 v189, v98, v99
    v_mfma_f32_16x16x32_bf16 v[204:207], v[208:211], v[196:199], v[204:207]
    v_exp_f32 v102, v102
    v_exp_f32 v103, v103
    v_cvt_pk_bf16_f32 v190, v100, v101
    v_cvt_pk_bf16_f32 v191, v102, v103
    v_mfma_f32_32x32x16_bf16 v[88:103], a[136:139], a[176:179], v[120:135]
    buffer_load_dwordx4 a[112:115], v18, s[32:35], s64 offen offset:0
    v_exp_f32 v104, v104
    v_exp_f32 v105, v105
    v_exp_f32 v106, v106
    v_exp_f32 v107, v107
    v_mfma_f32_32x32x16_bf16 v[88:103], a[140:143], a[180:183], v[88:103]
    buffer_load_dwordx4 a[116:119], v18, s[32:35], s64 offen offset:1024
    v_cvt_pk_bf16_f32 v192, v104, v105
    v_exp_f32 v108, v108
    v_exp_f32 v109, v109
    v_cvt_pk_bf16_f32 v193, v106, v107
    v_mfma_f32_32x32x16_bf16 v[152:167], a[128:131], v[184:187], v[152:167]
    buffer_load_dwordx4 a[120:123], v18, s[32:35], s64 offen offset:2048
    v_exp_f32 v110, v110
    v_exp_f32 v111, v111
    v_cvt_pk_bf16_f32 v194, v108, v109
    v_exp_f32 v112, v112
    v_mfma_f32_16x16x32_bf16 v[200:203], v[208:211], v[184:187], v[200:203]
    buffer_load_dwordx4 a[124:127], v18, s[32:35], s64 offen offset:3072
    v_exp_f32 v113, v113
    v_cvt_pk_bf16_f32 v195, v110, v111
    v_exp_f32 v114, v114
    v_exp_f32 v115, v115
    v_mfma_f32_32x32x16_bf16 v[152:167], a[132:135], v[188:191], v[152:167]
    s_add_u32 s64, s64, 4096
    s_and_b32 s64, s64, 0x3ffff
    v_cvt_pk_bf16_f32 v196, v112, v113
    v_exp_f32 v116, v116
    v_exp_f32 v117, v117
    v_cvt_pk_bf16_f32 v197, v114, v115
    v_mfma_f32_16x16x32_bf16 v[200:203], v[208:211], v[188:191], v[200:203]
    v_exp_f32 v118, v118
    v_exp_f32 v119, v119
    v_cvt_pk_bf16_f32 v198, v116, v117
    v_cvt_pk_bf16_f32 v199, v118, v119
    v_mfma_f32_32x32x16_bf16 v[104:119], a[136:139], a[184:187], v[136:151]
    v_exp_f32 v88, v88
    v_exp_f32 v89, v89
    v_exp_f32 v90, v90
    v_exp_f32 v91, v91
    v_mfma_f32_32x32x16_bf16 v[104:119], a[140:143], a[188:191], v[104:119]
    v_cvt_pk_bf16_f32 v184, v88, v89
    v_exp_f32 v92, v92
    v_exp_f32 v93, v93
    v_cvt_pk_bf16_f32 v185, v90, v91
    v_mfma_f32_32x32x16_bf16 v[168:183], a[128:131], v[192:195], v[168:183]
    v_exp_f32 v94, v94
    v_exp_f32 v95, v95
    v_cvt_pk_bf16_f32 v186, v92, v93
    v_exp_f32 v96, v96
    v_mfma_f32_16x16x32_bf16 v[204:207], v[208:211], v[192:195], v[204:207]
    v_exp_f32 v97, v97
    v_cvt_pk_bf16_f32 v187, v94, v95
    v_exp_f32 v98, v98
    v_exp_f32 v99, v99
    v_mfma_f32_32x32x16_bf16 v[168:183], a[132:135], v[196:199], v[168:183]
    v_cvt_pk_bf16_f32 v188, v96, v97
    v_exp_f32 v100, v100
    v_exp_f32 v101, v101
    v_cvt_pk_bf16_f32 v189, v98, v99
    v_mfma_f32_16x16x32_bf16 v[204:207], v[208:211], v[196:199], v[204:207]
    v_exp_f32 v102, v102
    v_exp_f32 v103, v103
    v_cvt_pk_bf16_f32 v190, v100, v101
    v_cvt_pk_bf16_f32 v191, v102, v103
    v_mfma_f32_32x32x16_bf16 v[88:103], a[152:155], a[176:179], v[120:135]
    buffer_load_dwordx4 a[128:131], v18, s[32:35], s64 offen offset:0
    v_exp_f32 v104, v104
    v_exp_f32 v105, v105
    v_exp_f32 v106, v106
    v_exp_f32 v107, v107
    v_mfma_f32_32x32x16_bf16 v[88:103], a[156:159], a[180:183], v[88:103]
    buffer_load_dwordx4 a[132:135], v18, s[32:35], s64 offen offset:1024
    v_cvt_pk_bf16_f32 v192, v104, v105
    v_exp_f32 v108, v108
    v_exp_f32 v109, v109
    v_cvt_pk_bf16_f32 v193, v106, v107
    v_mfma_f32_32x32x16_bf16 v[152:167], a[144:147], v[184:187], v[152:167]
    buffer_load_dwordx4 a[136:139], v18, s[32:35], s64 offen offset:2048
    v_exp_f32 v110, v110
    v_exp_f32 v111, v111
    v_cvt_pk_bf16_f32 v194, v108, v109
    v_exp_f32 v112, v112
    v_mfma_f32_16x16x32_bf16 v[200:203], v[208:211], v[184:187], v[200:203]
    buffer_load_dwordx4 a[140:143], v18, s[32:35], s64 offen offset:3072
    v_exp_f32 v113, v113
    v_cvt_pk_bf16_f32 v195, v110, v111
    v_exp_f32 v114, v114
    v_exp_f32 v115, v115
    v_mfma_f32_32x32x16_bf16 v[152:167], a[148:151], v[188:191], v[152:167]
    s_add_u32 s64, s64, 4096
    s_and_b32 s64, s64, 0x3ffff
    v_cvt_pk_bf16_f32 v196, v112, v113
    v_exp_f32 v116, v116
    v_exp_f32 v117, v117
    v_cvt_pk_bf16_f32 v197, v114, v115
    v_mfma_f32_16x16x32_bf16 v[200:203], v[208:211], v[188:191], v[200:203]
    v_exp_f32 v118, v118
    v_exp_f32 v119, v119
    v_cvt_pk_bf16_f32 v198, v116, v117
    v_cvt_pk_bf16_f32 v199, v118, v119
    s_waitcnt vmcnt(12)
    v_pk_add_f32 v[212:213], v[212:213], v[24:25] op_sel_hi:[1,0]
    v_pk_add_f32 v[216:217], v[216:217], v[24:25] op_sel_hi:[1,0]
    v_pk_add_f32 v[220:221], v[220:221], v[24:25] op_sel_hi:[1,0]
    v_pk_add_f32 v[224:225], v[224:225], v[24:25] op_sel_hi:[1,0]
    v_pk_add_f32 v[228:229], v[228:229], v[24:25] op_sel_hi:[1,0]
    v_pk_add_f32 v[232:233], v[232:233], v[24:25] op_sel_hi:[1,0]
    v_pk_add_f32 v[236:237], v[236:237], v[24:25] op_sel_hi:[1,0]
    v_pk_add_f32 v[240:241], v[240:241], v[24:25] op_sel_hi:[1,0]
    v_pk_add_f32 v[26:27], v[26:27], v[212:213]
    v_pk_fma_f32 v[28:29], v[212:213], v[212:213], v[28:29]
    v_pk_add_f32 v[30:31], v[30:31], v[214:215]
    v_pk_add_f32 v[26:27], v[26:27], v[216:217]
    v_pk_fma_f32 v[28:29], v[216:217], v[216:217], v[28:29]
    v_pk_add_f32 v[30:31], v[30:31], v[218:219]
    v_pk_add_f32 v[26:27], v[26:27], v[220:221]
    v_pk_fma_f32 v[28:29], v[220:221], v[220:221], v[28:29]
    v_pk_add_f32 v[30:31], v[30:31], v[222:223]
    v_pk_add_f32 v[26:27], v[26:27], v[224:225]
    v_pk_fma_f32 v[28:29], v[224:225], v[224:225], v[28:29]
    v_pk_add_f32 v[30:31], v[30:31], v[226:227]
    v_pk_add_f32 v[26:27], v[26:27], v[228:229]
    v_pk_fma_f32 v[28:29], v[228:229], v[228:229], v[28:29]
    v_pk_add_f32 v[30:31], v[30:31], v[230:231]
    v_pk_add_f32 v[26:27], v[26:27], v[232:233]
    v_pk_fma_f32 v[28:29], v[232:233], v[232:233], v[28:29]
    v_pk_add_f32 v[30:31], v[30:31], v[234:235]
    v_pk_add_f32 v[26:27], v[26:27], v[236:237]
    v_pk_fma_f32 v[28:29], v[236:237], v[236:237], v[28:29]
    v_pk_add_f32 v[30:31], v[30:31], v[238:239]
    v_pk_add_f32 v[26:27], v[26:27], v[240:241]
    v_pk_fma_f32 v[28:29], v[240:241], v[240:241], v[28:29]
    v_pk_add_f32 v[30:31], v[30:31], v[242:243]
    v_cmp_gt_u32 vcc, 32, v1
    v_mov_b32 v212, 1111490560
    v_mov_b32 v213, 1115684864
    v_cndmask_b32 v214, v212, v213, vcc
    v_cndmask_b32 v215, v213, v212, vcc
    v_pk_mul_f32 v[26:27], v[26:27], v[214:215]
    v_pk_fma_f32 v[30:31], v[28:29], v[214:215], v[30:31]
    v_add_f32 v26, v26, v27
    v_add_f32 v30, v30, v31
    v_mul_f32 v27, 974276901, v26
    v_fma_f32 v30, -v26, v27, v30
    v_mul_f32 v30, 974276901, v30
    v_max_f32 v30, 0, v30
    v_add_f32 v30, 925353388, v30
    v_rsq_f32 v30, v30
    v_sub_f32 v26, v24, v27
    v_mul_f32 v26, v26, v30
    s_lshl_b32 s57, s5, 7
    v_and_b32 v28, 15, v1
    v_lshlrev_b32 v28, 2, v28
    v_or_b32 v28, s57, v28
    v_xor_b32 v29, 128, v28
    ds_bpermute_b32 v212, v28, v30 offset:0
    ds_bpermute_b32 v213, v28, v26 offset:0
    ds_bpermute_b32 v214, v28, v30 offset:64
    ds_bpermute_b32 v215, v28, v26 offset:64
    ds_bpermute_b32 v216, v29, v30 offset:0
    ds_bpermute_b32 v217, v29, v26 offset:0
    ds_bpermute_b32 v218, v29, v30 offset:64
    ds_bpermute_b32 v219, v29, v26 offset:64
    v_bfe_u32 v28, v1, 2, 1
    v_lshlrev_b32 v28, 9, v28
    v_bfe_u32 v29, v1, 3, 1
    v_lshl_or_b32 v28, v29, 7, v28
    v_and_b32 v29, 3, v1
    v_lshl_or_b32 v28, v29, 5, v28
    v_lshrrev_b32 v29, 4, v1
    v_lshl_or_b32 v28, v29, 3, v28
    s_mul_i32 s60, s7, 458752
    s_lshl_b32 s57, s6, 1
    s_add_u32 s57, s57, s4
    s_mul_i32 s57, s57, 14336
    s_add_u32 s60, s60, s57
    s_add_u32 s60, s60, 16777216
    s_mul_i32 s57, s5, 7168
    s_add_u32 s61, s60, 7168
    s_sub_u32 s61, s61, s57
    s_add_u32 s60, s60, s57
    s_add_u32 s62, s60, 3072
    s_lshl_b32 s57, s5, 12
    s_add_u32 s60, s60, s57
    s_add_u32 s61, s61, s57
    s_mov_b32 s59, 0xffff0000
    s_waitcnt lgkmcnt(0)
    v_lshlrev_b32 v220, 16, v56
    v_and_b32 v221, s59, v56
    v_lshlrev_b32 v222, 16, v57
    v_and_b32 v223, s59, v57
    v_pk_fma_f32 v[220:221], v[220:221], v[212:213], v[212:213] op_sel:[0,0,1] op_sel_hi:[1,0,1]
    v_pk_fma_f32 v[222:223], v[222:223], v[212:213], v[212:213] op_sel:[0,0,1] op_sel_hi:[1,0,1]
    v_cvt_pk_bf16_f32 v56, v220, v221
    v_cvt_pk_bf16_f32 v57, v222, v223
    v_lshlrev_b32 v224, 16, v58
    v_and_b32 v225, s59, v58
    v_lshlrev_b32 v226, 16, v59
    v_and_b32 v227, s59, v59
    v_pk_fma_f32 v[224:225], v[224:225], v[214:215], v[214:215] op_sel:[0,0,1] op_sel_hi:[1,0,1]
    v_pk_fma_f32 v[226:227], v[226:227], v[214:215], v[214:215] op_sel:[0,0,1] op_sel_hi:[1,0,1]
    v_cvt_pk_bf16_f32 v58, v224, v225
    v_cvt_pk_bf16_f32 v59, v226, v227
    v_lshlrev_b32 v228, 16, v60
    v_and_b32 v229, s59, v60
    v_lshlrev_b32 v230, 16, v61
    v_and_b32 v231, s59, v61
    v_pk_fma_f32 v[228:229], v[228:229], v[216:217], v[216:217] op_sel:[0,0,1] op_sel_hi:[1,0,1]
    v_pk_fma_f32 v[230:231], v[230:231], v[216:217], v[216:217] op_sel:[0,0,1] op_sel_hi:[1,0,1]
    v_cvt_pk_bf16_f32 v60, v228, v229
    v_cvt_pk_bf16_f32 v61, v230, v231
    v_lshlrev_b32 v232, 16, v62
    v_and_b32 v233, s59, v62
    v_lshlrev_b32 v234, 16, v63
    v_and_b32 v235, s59, v63
    v_pk_fma_f32 v[232:233], v[232:233], v[218:219], v[218:219] op_sel:[0,0,1] op_sel_hi:[1,0,1]
    v_pk_fma_f32 v[234:235], v[234:235], v[218:219], v[218:219] op_sel:[0,0,1] op_sel_hi:[1,0,1]
    v_cvt_pk_bf16_f32 v62, v232, v233
    v_cvt_pk_bf16_f32 v63, v234, v235
    v_lshlrev_b32 v220, 16, v64
    v_and_b32 v221, s59, v64
    v_lshlrev_b32 v222, 16, v65
    v_and_b32 v223, s59, v65
    v_pk_fma_f32 v[220:221], v[220:221], v[212:213], v[212:213] op_sel:[0,0,1] op_sel_hi:[1,0,1]
    v_pk_fma_f32 v[222:223], v[222:223], v[212:213], v[212:213] op_sel:[0,0,1] op_sel_hi:[1,0,1]
    v_cvt_pk_bf16_f32 v64, v220, v221
    v_cvt_pk_bf16_f32 v65, v222, v223
    v_lshlrev_b32 v224, 16, v66
    v_and_b32 v225, s59, v66
    v_lshlrev_b32 v226, 16, v67
    v_and_b32 v227, s59, v67
    v_pk_fma_f32 v[224:225], v[224:225], v[214:215], v[214:215] op_sel:[0,0,1] op_sel_hi:[1,0,1]
    v_pk_fma_f32 v[226:227], v[226:227], v[214:215], v[214:215] op_sel:[0,0,1] op_sel_hi:[1,0,1]
    v_cvt_pk_bf16_f32 v66, v224, v225
    v_cvt_pk_bf16_f32 v67, v226, v227
    v_lshlrev_b32 v228, 16, v68
    v_and_b32 v229, s59, v68
    v_lshlrev_b32 v230, 16, v69
    v_and_b32 v231, s59, v69
    v_pk_fma_f32 v[228:229], v[228:229], v[216:217], v[216:217] op_sel:[0,0,1] op_sel_hi:[1,0,1]
    v_pk_fma_f32 v[230:231], v[230:231], v[216:217], v[216:217] op_sel:[0,0,1] op_sel_hi:[1,0,1]
    v_cvt_pk_bf16_f32 v68, v228, v229
    v_cvt_pk_bf16_f32 v69, v230, v231
    v_lshlrev_b32 v232, 16, v70
    v_and_b32 v233, s59, v70
    v_lshlrev_b32 v234, 16, v71
    v_and_b32 v235, s59, v71
    v_pk_fma_f32 v[232:233], v[232:233], v[218:219], v[218:219] op_sel:[0,0,1] op_sel_hi:[1,0,1]
    v_pk_fma_f32 v[234:235], v[234:235], v[218:219], v[218:219] op_sel:[0,0,1] op_sel_hi:[1,0,1]
    v_cvt_pk_bf16_f32 v70, v232, v233
    v_cvt_pk_bf16_f32 v71, v234, v235
    v_lshlrev_b32 v220, 16, v72
    v_and_b32 v221, s59, v72
    v_lshlrev_b32 v222, 16, v73
    v_and_b32 v223, s59, v73
    v_pk_fma_f32 v[220:221], v[220:221], v[212:213], v[212:213] op_sel:[0,0,1] op_sel_hi:[1,0,1]
    v_pk_fma_f32 v[222:223], v[222:223], v[212:213], v[212:213] op_sel:[0,0,1] op_sel_hi:[1,0,1]
    v_cvt_pk_bf16_f32 v72, v220, v221
    v_cvt_pk_bf16_f32 v73, v222, v223
    v_lshlrev_b32 v224, 16, v74
    v_and_b32 v225, s59, v74
    v_lshlrev_b32 v226, 16, v75
    v_and_b32 v227, s59, v75
    v_pk_fma_f32 v[224:225], v[224:225], v[214:215], v[214:215] op_sel:[0,0,1] op_sel_hi:[1,0,1]
    v_pk_fma_f32 v[226:227], v[226:227], v[214:215], v[214:215] op_sel:[0,0,1] op_sel_hi:[1,0,1]
    v_cvt_pk_bf16_f32 v74, v224, v225
    v_cvt_pk_bf16_f32 v75, v226, v227
    v_lshlrev_b32 v228, 16, v76
    v_and_b32 v229, s59, v76
    v_lshlrev_b32 v230, 16, v77
    v_and_b32 v231, s59, v77
    v_pk_fma_f32 v[228:229], v[228:229], v[216:217], v[216:217] op_sel:[0,0,1] op_sel_hi:[1,0,1]
    v_pk_fma_f32 v[230:231], v[230:231], v[216:217], v[216:217] op_sel:[0,0,1] op_sel_hi:[1,0,1]
    v_cvt_pk_bf16_f32 v76, v228, v229
    v_cvt_pk_bf16_f32 v77, v230, v231
    v_lshlrev_b32 v232, 16, v78
    v_and_b32 v233, s59, v78
    v_lshlrev_b32 v234, 16, v79
    v_and_b32 v235, s59, v79
    v_pk_fma_f32 v[232:233], v[232:233], v[218:219], v[218:219] op_sel:[0,0,1] op_sel_hi:[1,0,1]
    v_pk_fma_f32 v[234:235], v[234:235], v[218:219], v[218:219] op_sel:[0,0,1] op_sel_hi:[1,0,1]
    v_cvt_pk_bf16_f32 v78, v232, v233
    v_cvt_pk_bf16_f32 v79, v234, v235
    v_lshlrev_b32 v220, 16, v84
    v_and_b32 v221, s59, v84
    v_lshlrev_b32 v222, 16, v85
    v_and_b32 v223, s59, v85
    v_pk_fma_f32 v[220:221], v[220:221], v[212:213], v[212:213] op_sel:[0,0,1] op_sel_hi:[1,0,1]
    v_pk_fma_f32 v[222:223], v[222:223], v[212:213], v[212:213] op_sel:[0,0,1] op_sel_hi:[1,0,1]
    v_cvt_pk_bf16_f32 v84, v220, v221
    v_cvt_pk_bf16_f32 v85, v222, v223
    v_lshlrev_b32 v224, 16, v86
    v_and_b32 v225, s59, v86
    v_lshlrev_b32 v226, 16, v87
    v_and_b32 v227, s59, v87
    v_pk_fma_f32 v[224:225], v[224:225], v[214:215], v[214:215] op_sel:[0,0,1] op_sel_hi:[1,0,1]
    v_pk_fma_f32 v[226:227], v[226:227], v[214:215], v[214:215] op_sel:[0,0,1] op_sel_hi:[1,0,1]
    v_cvt_pk_bf16_f32 v86, v224, v225
    v_cvt_pk_bf16_f32 v87, v226, v227
    v_mfma_f32_32x32x16_bf16 v[104:119], a[152:155], a[184:187], v[136:151]
    v_exp_f32 v88, v88
    v_exp_f32 v89, v89
    v_exp_f32 v90, v90
    v_exp_f32 v91, v91
    v_mfma_f32_32x32x16_bf16 v[104:119], a[156:159], a[188:191], v[104:119]
    v_cvt_pk_bf16_f32 v184, v88, v89
    v_exp_f32 v92, v92
    v_exp_f32 v93, v93
    v_cvt_pk_bf16_f32 v185, v90, v91
    v_mfma_f32_32x32x16_bf16 v[168:183], a[144:147], v[192:195], v[168:183]
    v_exp_f32 v94, v94
    v_exp_f32 v95, v95
    v_cvt_pk_bf16_f32 v186, v92, v93
    v_exp_f32 v96, v96
    v_mfma_f32_16x16x32_bf16 v[204:207], v[208:211], v[192:195], v[204:207]
    v_exp_f32 v97, v97
    v_cvt_pk_bf16_f32 v187, v94, v95
    v_exp_f32 v98, v98
    v_exp_f32 v99, v99
    v_mfma_f32_32x32x16_bf16 v[168:183], a[148:151], v[196:199], v[168:183]
    v_cvt_pk_bf16_f32 v188, v96, v97
    v_exp_f32 v100, v100
    v_exp_f32 v101, v101
    v_cvt_pk_bf16_f32 v189, v98, v99
    v_mfma_f32_16x16x32_bf16 v[204:207], v[208:211], v[196:199], v[204:207]
    v_exp_f32 v102, v102
    v_exp_f32 v103, v103
    v_cvt_pk_bf16_f32 v190, v100, v101
    v_cvt_pk_bf16_f32 v191, v102, v103
    v_mfma_f32_32x32x16_bf16 v[88:103], a[168:171], a[176:179], v[120:135]
    buffer_load_dwordx4 a[144:147], v18, s[32:35], s64 offen offset:0
    v_exp_f32 v104, v104
    v_exp_f32 v105, v105
    v_exp_f32 v106, v106
    v_exp_f32 v107, v107
    v_mfma_f32_32x32x16_bf16 v[88:103], a[172:175], a[180:183], v[88:103]
    buffer_load_dwordx4 a[148:151], v18, s[32:35], s64 offen offset:1024
    v_cvt_pk_bf16_f32 v192, v104, v105
    v_exp_f32 v108, v108
    v_exp_f32 v109, v109
    v_cvt_pk_bf16_f32 v193, v106, v107
    v_mfma_f32_32x32x16_bf16 v[152:167], a[160:163], v[184:187], v[152:167]
    buffer_load_dwordx4 a[152:155], v18, s[32:35], s64 offen offset:2048
    v_exp_f32 v110, v110
    v_exp_f32 v111, v111
    v_cvt_pk_bf16_f32 v194, v108, v109
    v_exp_f32 v112, v112
    v_mfma_f32_16x16x32_bf16 v[200:203], v[208:211], v[184:187], v[200:203]
    buffer_load_dwordx4 a[156:159], v18, s[32:35], s64 offen offset:3072
    v_exp_f32 v113, v113
    v_cvt_pk_bf16_f32 v195, v110, v111
    v_exp_f32 v114, v114
    v_exp_f32 v115, v115
    v_mfma_f32_32x32x16_bf16 v[152:167], a[164:167], v[188:191], v[152:167]
    s_add_u32 s64, s64, 4096
    s_and_b32 s64, s64, 0x3ffff
    v_cvt_pk_bf16_f32 v196, v112, v113
    v_exp_f32 v116, v116
    v_exp_f32 v117, v117
    v_cvt_pk_bf16_f32 v197, v114, v115
    v_mfma_f32_16x16x32_bf16 v[200:203], v[208:211], v[188:191], v[200:203]
    v_exp_f32 v118, v118
    v_exp_f32 v119, v119
    v_cvt_pk_bf16_f32 v198, v116, v117
    v_cvt_pk_bf16_f32 v199, v118, v119
    v_mfma_f32_32x32x16_bf16 v[104:119], a[168:171], a[184:187], v[136:151]
    buffer_store_dwordx2 v[56:57], v28, s[32:35], s60 offen offset:0 sc1
    v_exp_f32 v88, v88
    v_exp_f32 v89, v89
    v_exp_f32 v90, v90
    v_exp_f32 v91, v91
    v_mfma_f32_32x32x16_bf16 v[104:119], a[172:175], a[188:191], v[104:119]
    buffer_store_dwordx2 v[58:59], v28, s[32:35], s60 offen offset:256 sc1
    v_cvt_pk_bf16_f32 v184, v88, v89
    v_exp_f32 v92, v92
    v_exp_f32 v93, v93
    v_cvt_pk_bf16_f32 v185, v90, v91
    v_mfma_f32_32x32x16_bf16 v[168:183], a[160:163], v[192:195], v[168:183]
    v_exp_f32 v94, v94
    v_exp_f32 v95, v95
    v_cvt_pk_bf16_f32 v186, v92, v93
    v_exp_f32 v96, v96
    v_mfma_f32_16x16x32_bf16 v[204:207], v[208:211], v[192:195], v[204:207]
    v_exp_f32 v97, v97
    v_cvt_pk_bf16_f32 v187, v94, v95
    v_exp_f32 v98, v98
    v_exp_f32 v99, v99
    v_mfma_f32_32x32x16_bf16 v[168:183], a[164:167], v[196:199], v[168:183]
    v_cvt_pk_bf16_f32 v188, v96, v97
    v_exp_f32 v100, v100
    v_exp_f32 v101, v101
    v_cvt_pk_bf16_f32 v189, v98, v99
    v_mfma_f32_16x16x32_bf16 v[204:207], v[208:211], v[196:199], v[204:207]
    v_exp_f32 v102, v102
    v_exp_f32 v103, v103
    v_cvt_pk_bf16_f32 v190, v100, v101
    v_cvt_pk_bf16_f32 v191, v102, v103
    v_mfma_f32_32x32x16_bf16 v[88:103], a[8:11], a[176:179], v[120:135]
    buffer_load_dwordx4 a[160:163], v18, s[32:35], s64 offen offset:0
    v_exp_f32 v104, v104
    v_exp_f32 v105, v105
    v_exp_f32 v106, v106
    v_exp_f32 v107, v107
    v_mfma_f32_32x32x16_bf16 v[88:103], a[12:15], a[180:183], v[88:103]
    buffer_load_dwordx4 a[164:167], v18, s[32:35], s64 offen offset:1024
    v_cvt_pk_bf16_f32 v192, v104, v105
    v_exp_f32 v108, v108
    v_exp_f32 v109, v109
    v_cvt_pk_bf16_f32 v193, v106, v107
    v_mfma_f32_32x32x16_bf16 v[152:167], a[0:3], v[184:187], v[152:167]
    buffer_load_dwordx4 a[168:171], v18, s[32:35], s64 offen offset:2048
    v_exp_f32 v110, v110
    v_exp_f32 v111, v111
    v_cvt_pk_bf16_f32 v194, v108, v109
    v_exp_f32 v112, v112
    v_mfma_f32_16x16x32_bf16 v[200:203], v[208:211], v[184:187], v[200:203]
    buffer_load_dwordx4 a[172:175], v18, s[32:35], s64 offen offset:3072
    v_exp_f32 v113, v113
    v_cvt_pk_bf16_f32 v195, v110, v111
    v_exp_f32 v114, v114
    v_exp_f32 v115, v115
    v_mfma_f32_32x32x16_bf16 v[152:167], a[4:7], v[188:191], v[152:167]
    s_add_u32 s64, s64, 4096
    s_and_b32 s64, s64, 0x3ffff
    v_cvt_pk_bf16_f32 v196, v112, v113
    v_exp_f32 v116, v116
    v_exp_f32 v117, v117
    v_cvt_pk_bf16_f32 v197, v114, v115
    v_mfma_f32_16x16x32_bf16 v[200:203], v[208:211], v[188:191], v[200:203]
    v_exp_f32 v118, v118
    v_exp_f32 v119, v119
    v_cvt_pk_bf16_f32 v198, v116, v117
    v_cvt_pk_bf16_f32 v199, v118, v119
    v_mfma_f32_32x32x16_bf16 v[104:119], a[8:11], a[184:187], v[136:151]
    buffer_store_dwordx2 v[60:61], v28, s[32:35], s61 offen offset:0 sc1
    v_exp_f32 v88, v88
    v_exp_f32 v89, v89
    v_exp_f32 v90, v90
    v_exp_f32 v91, v91
    v_mfma_f32_32x32x16_bf16 v[104:119], a[12:15], a[188:191], v[104:119]
    buffer_store_dwordx2 v[62:63], v28, s[32:35], s61 offen offset:256 sc1
    v_cvt_pk_bf16_f32 v184, v88, v89
    v_exp_f32 v92, v92
    v_exp_f32 v93, v93
    v_cvt_pk_bf16_f32 v185, v90, v91
    v_mfma_f32_32x32x16_bf16 v[168:183], a[0:3], v[192:195], v[168:183]
    v_exp_f32 v94, v94
    v_exp_f32 v95, v95
    v_cvt_pk_bf16_f32 v186, v92, v93
    v_exp_f32 v96, v96
    v_mfma_f32_16x16x32_bf16 v[204:207], v[208:211], v[192:195], v[204:207]
    v_exp_f32 v97, v97
    v_cvt_pk_bf16_f32 v187, v94, v95
    v_exp_f32 v98, v98
    v_exp_f32 v99, v99
    v_mfma_f32_32x32x16_bf16 v[168:183], a[4:7], v[196:199], v[168:183]
    v_cvt_pk_bf16_f32 v188, v96, v97
    v_exp_f32 v100, v100
    v_exp_f32 v101, v101
    v_cvt_pk_bf16_f32 v189, v98, v99
    v_mfma_f32_16x16x32_bf16 v[204:207], v[208:211], v[196:199], v[204:207]
    v_exp_f32 v102, v102
    v_exp_f32 v103, v103
    v_cvt_pk_bf16_f32 v190, v100, v101
    v_cvt_pk_bf16_f32 v191, v102, v103
    v_mfma_f32_32x32x16_bf16 v[88:103], a[24:27], a[176:179], v[120:135]
    buffer_load_dwordx4 a[0:3], v18, s[32:35], s64 offen offset:0
    v_exp_f32 v104, v104
    v_exp_f32 v105, v105
    v_exp_f32 v106, v106
    v_exp_f32 v107, v107
    v_mfma_f32_32x32x16_bf16 v[88:103], a[28:31], a[180:183], v[88:103]
    buffer_load_dwordx4 a[4:7], v18, s[32:35], s64 offen offset:1024
    v_cvt_pk_bf16_f32 v192, v104, v105
    v_exp_f32 v108, v108
    v_exp_f32 v109, v109
    v_cvt_pk_bf16_f32 v193, v106, v107
    v_mfma_f32_32x32x16_bf16 v[152:167], a[16:19], v[184:187], v[152:167]
    buffer_load_dwordx4 a[8:11], v18, s[32:35], s64 offen offset:2048
    v_exp_f32 v110, v110
    v_exp_f32 v111, v111
    v_cvt_pk_bf16_f32 v194, v108, v109
    v_exp_f32 v112, v112
    v_mfma_f32_16x16x32_bf16 v[200:203], v[208:211], v[184:187], v[200:203]
    buffer_load_dwordx4 a[12:15], v18, s[32:35], s64 offen offset:3072
    v_exp_f32 v113, v113
    v_cvt_pk_bf16_f32 v195, v110, v111
    v_exp_f32 v114, v114
    v_exp_f32 v115, v115
    v_mfma_f32_32x32x16_bf16 v[152:167], a[20:23], v[188:191], v[152:167]
    s_add_u32 s64, s64, 4096
    s_and_b32 s64, s64, 0x3ffff
    v_cvt_pk_bf16_f32 v196, v112, v113
    v_exp_f32 v116, v116
    v_exp_f32 v117, v117
    v_cvt_pk_bf16_f32 v197, v114, v115
    v_mfma_f32_16x16x32_bf16 v[200:203], v[208:211], v[188:191], v[200:203]
    v_exp_f32 v118, v118
    v_exp_f32 v119, v119
    v_cvt_pk_bf16_f32 v198, v116, v117
    v_cvt_pk_bf16_f32 v199, v118, v119
    v_mfma_f32_32x32x16_bf16 v[104:119], a[24:27], a[184:187], v[136:151]
    buffer_store_dwordx2 v[64:65], v28, s[32:35], s60 offen offset:1024 sc1
    v_exp_f32 v88, v88
    v_exp_f32 v89, v89
    v_exp_f32 v90, v90
    v_exp_f32 v91, v91
    v_mfma_f32_32x32x16_bf16 v[104:119], a[28:31], a[188:191], v[104:119]
    buffer_store_dwordx2 v[66:67], v28, s[32:35], s60 offen offset:1280 sc1
    v_cvt_pk_bf16_f32 v184, v88, v89
    v_exp_f32 v92, v92
    v_exp_f32 v93, v93
    v_cvt_pk_bf16_f32 v185, v90, v91
    v_mfma_f32_32x32x16_bf16 v[168:183], a[16:19], v[192:195], v[168:183]
    v_exp_f32 v94, v94
    v_exp_f32 v95, v95
    v_cvt_pk_bf16_f32 v186, v92, v93
    v_exp_f32 v96, v96
    v_mfma_f32_16x16x32_bf16 v[204:207], v[208:211], v[192:195], v[204:207]
    v_exp_f32 v97, v97
    v_cvt_pk_bf16_f32 v187, v94, v95
    v_exp_f32 v98, v98
    v_exp_f32 v99, v99
    v_mfma_f32_32x32x16_bf16 v[168:183], a[20:23], v[196:199], v[168:183]
    v_cvt_pk_bf16_f32 v188, v96, v97
    v_exp_f32 v100, v100
    v_exp_f32 v101, v101
    v_cvt_pk_bf16_f32 v189, v98, v99
    v_mfma_f32_16x16x32_bf16 v[204:207], v[208:211], v[196:199], v[204:207]
    v_exp_f32 v102, v102
    v_exp_f32 v103, v103
    v_cvt_pk_bf16_f32 v190, v100, v101
    v_cvt_pk_bf16_f32 v191, v102, v103
    v_mfma_f32_32x32x16_bf16 v[88:103], a[40:43], a[176:179], v[120:135]
    buffer_load_dwordx4 a[16:19], v18, s[32:35], s64 offen offset:0
    v_exp_f32 v104, v104
    v_exp_f32 v105, v105
    v_exp_f32 v106, v106
    v_exp_f32 v107, v107
    v_mfma_f32_32x32x16_bf16 v[88:103], a[44:47], a[180:183], v[88:103]
    buffer_load_dwordx4 a[20:23], v18, s[32:35], s64 offen offset:1024
    v_cvt_pk_bf16_f32 v192, v104, v105
    v_exp_f32 v108, v108
    v_exp_f32 v109, v109
    v_cvt_pk_bf16_f32 v193, v106, v107
    v_mfma_f32_32x32x16_bf16 v[152:167], a[32:35], v[184:187], v[152:167]
    buffer_load_dwordx4 a[24:27], v18, s[32:35], s64 offen offset:2048
    v_exp_f32 v110, v110
    v_exp_f32 v111, v111
    v_cvt_pk_bf16_f32 v194, v108, v109
    v_exp_f32 v112, v112
    v_mfma_f32_16x16x32_bf16 v[200:203], v[208:211], v[184:187], v[200:203]
    buffer_load_dwordx4 a[28:31], v18, s[32:35], s64 offen offset:3072
    v_exp_f32 v113, v113
    v_cvt_pk_bf16_f32 v195, v110, v111
    v_exp_f32 v114, v114
    v_exp_f32 v115, v115
    v_mfma_f32_32x32x16_bf16 v[152:167], a[36:39], v[188:191], v[152:167]
    s_add_u32 s64, s64, 4096
    s_and_b32 s64, s64, 0x3ffff
    v_cvt_pk_bf16_f32 v196, v112, v113
    v_exp_f32 v116, v116
    v_exp_f32 v117, v117
    v_cvt_pk_bf16_f32 v197, v114, v115
    v_mfma_f32_16x16x32_bf16 v[200:203], v[208:211], v[188:191], v[200:203]
    v_exp_f32 v118, v118
    v_exp_f32 v119, v119
    v_cvt_pk_bf16_f32 v198, v116, v117
    v_cvt_pk_bf16_f32 v199, v118, v119
    v_mfma_f32_32x32x16_bf16 v[104:119], a[40:43], a[184:187], v[136:151]
    buffer_store_dwordx2 v[68:69], v28, s[32:35], s61 offen offset:1024 sc1
    v_exp_f32 v88, v88
    v_exp_f32 v89, v89
    v_exp_f32 v90, v90
    v_exp_f32 v91, v91
    v_mfma_f32_32x32x16_bf16 v[104:119], a[44:47], a[188:191], v[104:119]
    buffer_store_dwordx2 v[70:71], v28, s[32:35], s61 offen offset:1280 sc1
    v_cvt_pk_bf16_f32 v184, v88, v89
    v_exp_f32 v92, v92
    v_exp_f32 v93, v93
    v_cvt_pk_bf16_f32 v185, v90, v91
    v_mfma_f32_32x32x16_bf16 v[168:183], a[32:35], v[192:195], v[168:183]
    v_exp_f32 v94, v94
    v_exp_f32 v95, v95
    v_cvt_pk_bf16_f32 v186, v92, v93
    v_exp_f32 v96, v96
    v_mfma_f32_16x16x32_bf16 v[204:207], v[208:211], v[192:195], v[204:207]
    v_exp_f32 v97, v97
    v_cvt_pk_bf16_f32 v187, v94, v95
    v_exp_f32 v98, v98
    v_exp_f32 v99, v99
    v_mfma_f32_32x32x16_bf16 v[168:183], a[36:39], v[196:199], v[168:183]
    v_cvt_pk_bf16_f32 v188, v96, v97
    v_exp_f32 v100, v100
    v_exp_f32 v101, v101
    v_cvt_pk_bf16_f32 v189, v98, v99
    v_mfma_f32_16x16x32_bf16 v[204:207], v[208:211], v[196:199], v[204:207]
    v_exp_f32 v102, v102
    v_exp_f32 v103, v103
    v_cvt_pk_bf16_f32 v190, v100, v101
    v_cvt_pk_bf16_f32 v191, v102, v103
    s_waitcnt vmcnt(32)
    v_mfma_f32_32x32x16_bf16 v[88:103], a[104:107], a[176:179], v[120:135]
    buffer_load_dwordx4 a[32:35], v18, s[32:35], s64 offen offset:0
    v_exp_f32 v104, v104
    v_exp_f32 v105, v105
    v_exp_f32 v106, v106
    v_exp_f32 v107, v107
    v_mfma_f32_32x32x16_bf16 v[88:103], a[108:111], a[180:183], v[88:103]
    buffer_load_dwordx4 a[36:39], v18, s[32:35], s64 offen offset:1024
    v_cvt_pk_bf16_f32 v192, v104, v105
    v_exp_f32 v108, v108
    v_exp_f32 v109, v109
    v_cvt_pk_bf16_f32 v193, v106, v107
    v_mfma_f32_32x32x16_bf16 v[152:167], a[96:99], v[184:187], v[152:167]
    buffer_load_dwordx4 a[40:43], v18, s[32:35], s64 offen offset:2048
    v_exp_f32 v110, v110
    v_exp_f32 v111, v111
    v_cvt_pk_bf16_f32 v194, v108, v109
    v_exp_f32 v112, v112
    v_mfma_f32_16x16x32_bf16 v[200:203], v[208:211], v[184:187], v[200:203]
    buffer_load_dwordx4 a[44:47], v18, s[32:35], s64 offen offset:3072
    v_exp_f32 v113, v113
    v_cvt_pk_bf16_f32 v195, v110, v111
    v_exp_f32 v114, v114
    v_exp_f32 v115, v115
    v_mfma_f32_32x32x16_bf16 v[152:167], a[100:103], v[188:191], v[152:167]
    s_add_u32 s64, s64, 4096
    s_and_b32 s64, s64, 0x3ffff
    v_cvt_pk_bf16_f32 v196, v112, v113
    v_exp_f32 v116, v116
    v_exp_f32 v117, v117
    v_cvt_pk_bf16_f32 v197, v114, v115
    v_mfma_f32_16x16x32_bf16 v[200:203], v[208:211], v[188:191], v[200:203]
    v_exp_f32 v118, v118
    v_exp_f32 v119, v119
    v_cvt_pk_bf16_f32 v198, v116, v117
    v_cvt_pk_bf16_f32 v199, v118, v119
    v_mfma_f32_32x32x16_bf16 v[104:119], a[104:107], a[184:187], v[136:151]
    buffer_store_dwordx2 v[72:73], v28, s[32:35], s60 offen offset:2048 sc1
    v_exp_f32 v88, v88
    v_exp_f32 v89, v89
    v_exp_f32 v90, v90
    v_exp_f32 v91, v91
    v_mfma_f32_32x32x16_bf16 v[104:119], a[108:111], a[188:191], v[104:119]
    buffer_store_dwordx2 v[74:75], v28, s[32:35], s60 offen offset:2304 sc1
    v_cvt_pk_bf16_f32 v184, v88, v89
    v_exp_f32 v92, v92
    v_exp_f32 v93, v93
    v_cvt_pk_bf16_f32 v185, v90, v91
    v_mfma_f32_32x32x16_bf16 v[168:183], a[96:99], v[192:195], v[168:183]
    v_exp_f32 v94, v94
    v_exp_f32 v95, v95
    v_cvt_pk_bf16_f32 v186, v92, v93
    v_exp_f32 v96, v96
    v_mfma_f32_16x16x32_bf16 v[204:207], v[208:211], v[192:195], v[204:207]
    v_exp_f32 v97, v97
    v_cvt_pk_bf16_f32 v187, v94, v95
    v_exp_f32 v98, v98
    v_exp_f32 v99, v99
    v_mfma_f32_32x32x16_bf16 v[168:183], a[100:103], v[196:199], v[168:183]
    v_cvt_pk_bf16_f32 v188, v96, v97
    v_exp_f32 v100, v100
    v_exp_f32 v101, v101
    v_cvt_pk_bf16_f32 v189, v98, v99
    v_mfma_f32_16x16x32_bf16 v[204:207], v[208:211], v[196:199], v[204:207]
    v_exp_f32 v102, v102
    v_exp_f32 v103, v103
    v_cvt_pk_bf16_f32 v190, v100, v101
    v_cvt_pk_bf16_f32 v191, v102, v103
    s_waitcnt vmcnt(34)
    v_mfma_f32_32x32x16_bf16 v[88:103], a[120:123], a[176:179], v[120:135]
    buffer_load_dwordx4 a[96:99], v18, s[32:35], s64 offen offset:0
    v_exp_f32 v104, v104
    v_exp_f32 v105, v105
    v_exp_f32 v106, v106
    v_exp_f32 v107, v107
    v_mfma_f32_32x32x16_bf16 v[88:103], a[124:127], a[180:183], v[88:103]
    buffer_load_dwordx4 a[100:103], v18, s[32:35], s64 offen offset:1024
    v_cvt_pk_bf16_f32 v192, v104, v105
    v_exp_f32 v108, v108
    v_exp_f32 v109, v109
    v_cvt_pk_bf16_f32 v193, v106, v107
    v_mfma_f32_32x32x16_bf16 v[152:167], a[112:115], v[184:187], v[152:167]
    buffer_load_dwordx4 a[104:107], v18, s[32:35], s64 offen offset:2048
    v_exp_f32 v110, v110
    v_exp_f32 v111, v111
    v_cvt_pk_bf16_f32 v194, v108, v109
    v_exp_f32 v112, v112
    v_mfma_f32_16x16x32_bf16 v[200:203], v[208:211], v[184:187], v[200:203]
    buffer_load_dwordx4 a[108:111], v18, s[32:35], s64 offen offset:3072
    v_exp_f32 v113, v113
    v_cvt_pk_bf16_f32 v195, v110, v111
    v_exp_f32 v114, v114
    v_exp_f32 v115, v115
    v_mfma_f32_32x32x16_bf16 v[152:167], a[116:119], v[188:191], v[152:167]
    s_add_u32 s64, s64, 4096
    s_and_b32 s64, s64, 0x3ffff
    v_cvt_pk_bf16_f32 v196, v112, v113
    v_exp_f32 v116, v116
    v_exp_f32 v117, v117
    v_cvt_pk_bf16_f32 v197, v114, v115
    v_mfma_f32_16x16x32_bf16 v[200:203], v[208:211], v[188:191], v[200:203]
    v_exp_f32 v118, v118
    v_exp_f32 v119, v119
    v_cvt_pk_bf16_f32 v198, v116, v117
    v_cvt_pk_bf16_f32 v199, v118, v119
    v_mfma_f32_32x32x16_bf16 v[104:119], a[120:123], a[184:187], v[136:151]
    buffer_store_dwordx2 v[76:77], v28, s[32:35], s61 offen offset:2048 sc1
    v_exp_f32 v88, v88
    v_exp_f32 v89, v89
    v_exp_f32 v90, v90
    v_exp_f32 v91, v91
    v_mfma_f32_32x32x16_bf16 v[104:119], a[124:127], a[188:191], v[104:119]
    buffer_store_dwordx2 v[78:79], v28, s[32:35], s61 offen offset:2304 sc1
    v_cvt_pk_bf16_f32 v184, v88, v89
    v_exp_f32 v92, v92
    v_exp_f32 v93, v93
    v_cvt_pk_bf16_f32 v185, v90, v91
    v_mfma_f32_32x32x16_bf16 v[168:183], a[112:115], v[192:195], v[168:183]
    v_exp_f32 v94, v94
    v_exp_f32 v95, v95
    v_cvt_pk_bf16_f32 v186, v92, v93
    v_exp_f32 v96, v96
    v_mfma_f32_16x16x32_bf16 v[204:207], v[208:211], v[192:195], v[204:207]
    v_exp_f32 v97, v97
    v_cvt_pk_bf16_f32 v187, v94, v95
    v_exp_f32 v98, v98
    v_exp_f32 v99, v99
    v_mfma_f32_32x32x16_bf16 v[168:183], a[116:119], v[196:199], v[168:183]
    v_cvt_pk_bf16_f32 v188, v96, v97
    v_exp_f32 v100, v100
    v_exp_f32 v101, v101
    v_cvt_pk_bf16_f32 v189, v98, v99
    v_mfma_f32_16x16x32_bf16 v[204:207], v[208:211], v[196:199], v[204:207]
    v_exp_f32 v102, v102
    v_exp_f32 v103, v103
    v_cvt_pk_bf16_f32 v190, v100, v101
    v_cvt_pk_bf16_f32 v191, v102, v103
    s_waitcnt vmcnt(36)
    v_mfma_f32_32x32x16_bf16 v[88:103], a[136:139], a[176:179], v[120:135]
    buffer_load_dwordx4 a[112:115], v18, s[32:35], s64 offen offset:0
    v_exp_f32 v104, v104
    v_exp_f32 v105, v105
    v_exp_f32 v106, v106
    v_exp_f32 v107, v107
    v_mfma_f32_32x32x16_bf16 v[88:103], a[140:143], a[180:183], v[88:103]
    buffer_load_dwordx4 a[116:119], v18, s[32:35], s64 offen offset:1024
    v_cvt_pk_bf16_f32 v192, v104, v105
    v_exp_f32 v108, v108
    v_exp_f32 v109, v109
    v_cvt_pk_bf16_f32 v193, v106, v107
    v_mfma_f32_32x32x16_bf16 v[152:167], a[128:131], v[184:187], v[152:167]
    buffer_load_dwordx4 a[120:123], v18, s[32:35], s64 offen offset:2048
    v_exp_f32 v110, v110
    v_exp_f32 v111, v111
    v_cvt_pk_bf16_f32 v194, v108, v109
    v_exp_f32 v112, v112
    v_mfma_f32_16x16x32_bf16 v[200:203], v[208:211], v[184:187], v[200:203]
    buffer_load_dwordx4 a[124:127], v18, s[32:35], s64 offen offset:3072
    v_exp_f32 v113, v113
    v_cvt_pk_bf16_f32 v195, v110, v111
    v_exp_f32 v114, v114
    v_exp_f32 v115, v115
    v_mfma_f32_32x32x16_bf16 v[152:167], a[132:135], v[188:191], v[152:167]
    s_add_u32 s64, s64, 4096
    s_and_b32 s64, s64, 0x3ffff
    v_cvt_pk_bf16_f32 v196, v112, v113
    v_exp_f32 v116, v116
    v_exp_f32 v117, v117
    v_cvt_pk_bf16_f32 v197, v114, v115
    v_mfma_f32_16x16x32_bf16 v[200:203], v[208:211], v[188:191], v[200:203]
    v_exp_f32 v118, v118
    v_exp_f32 v119, v119
    v_cvt_pk_bf16_f32 v198, v116, v117
    v_cvt_pk_bf16_f32 v199, v118, v119
    v_mfma_f32_32x32x16_bf16 v[104:119], a[136:139], a[184:187], v[136:151]
    buffer_store_dwordx2 v[84:85], v28, s[32:35], s62 offen offset:0 sc1
    v_exp_f32 v88, v88
    v_exp_f32 v89, v89
    v_exp_f32 v90, v90
    v_exp_f32 v91, v91
    v_mfma_f32_32x32x16_bf16 v[104:119], a[140:143], a[188:191], v[104:119]
    buffer_store_dwordx2 v[86:87], v28, s[32:35], s62 offen offset:256 sc1
    v_cvt_pk_bf16_f32 v184, v88, v89
    v_exp_f32 v92, v92
    v_exp_f32 v93, v93
    v_cvt_pk_bf16_f32 v185, v90, v91
    v_mfma_f32_32x32x16_bf16 v[168:183], a[128:131], v[192:195], v[168:183]
    v_exp_f32 v94, v94
    v_exp_f32 v95, v95
    v_cvt_pk_bf16_f32 v186, v92, v93
    v_exp_f32 v96, v96
    v_mfma_f32_16x16x32_bf16 v[204:207], v[208:211], v[192:195], v[204:207]
    v_exp_f32 v97, v97
    v_cvt_pk_bf16_f32 v187, v94, v95
    v_exp_f32 v98, v98
    v_exp_f32 v99, v99
    v_mfma_f32_32x32x16_bf16 v[168:183], a[132:135], v[196:199], v[168:183]
    v_cvt_pk_bf16_f32 v188, v96, v97
    v_exp_f32 v100, v100
    v_exp_f32 v101, v101
    v_cvt_pk_bf16_f32 v189, v98, v99
    v_mfma_f32_16x16x32_bf16 v[204:207], v[208:211], v[196:199], v[204:207]
    v_exp_f32 v102, v102
    v_exp_f32 v103, v103
    v_cvt_pk_bf16_f32 v190, v100, v101
    v_cvt_pk_bf16_f32 v191, v102, v103
    s_waitcnt vmcnt(38)
    v_mfma_f32_32x32x16_bf16 v[88:103], a[152:155], a[176:179], v[120:135]
    buffer_load_dwordx4 a[128:131], v18, s[32:35], s64 offen offset:0
    v_exp_f32 v104, v104
    v_exp_f32 v105, v105
    v_exp_f32 v106, v106
    v_exp_f32 v107, v107
    v_mfma_f32_32x32x16_bf16 v[88:103], a[156:159], a[180:183], v[88:103]
    buffer_load_dwordx4 a[132:135], v18, s[32:35], s64 offen offset:1024
    v_cvt_pk_bf16_f32 v192, v104, v105
    v_exp_f32 v108, v108
    v_exp_f32 v109, v109
    v_cvt_pk_bf16_f32 v193, v106, v107
    v_mfma_f32_32x32x16_bf16 v[152:167], a[144:147], v[184:187], v[152:167]
    buffer_load_dwordx4 a[136:139], v18, s[32:35], s64 offen offset:2048
    v_exp_f32 v110, v110
    v_exp_f32 v111, v111
    v_cvt_pk_bf16_f32 v194, v108, v109
    v_exp_f32 v112, v112
    v_mfma_f32_16x16x32_bf16 v[200:203], v[208:211], v[184:187], v[200:203]
    buffer_load_dwordx4 a[140:143], v18, s[32:35], s64 offen offset:3072
    v_exp_f32 v113, v113
    v_cvt_pk_bf16_f32 v195, v110, v111
    v_exp_f32 v114, v114
    v_exp_f32 v115, v115
    v_mfma_f32_32x32x16_bf16 v[152:167], a[148:151], v[188:191], v[152:167]
    s_add_u32 s64, s64, 4096
    s_and_b32 s64, s64, 0x3ffff
    v_cvt_pk_bf16_f32 v196, v112, v113
    v_exp_f32 v116, v116
    v_exp_f32 v117, v117
    v_cvt_pk_bf16_f32 v197, v114, v115
    v_mfma_f32_16x16x32_bf16 v[200:203], v[208:211], v[188:191], v[200:203]
    v_exp_f32 v118, v118
    v_exp_f32 v119, v119
    v_cvt_pk_bf16_f32 v198, v116, v117
    v_cvt_pk_bf16_f32 v199, v118, v119
    v_mfma_f32_32x32x16_bf16 v[104:119], a[152:155], a[184:187], v[136:151]
    v_exp_f32 v88, v88
    v_exp_f32 v89, v89
    v_exp_f32 v90, v90
    v_exp_f32 v91, v91
    v_mfma_f32_32x32x16_bf16 v[104:119], a[156:159], a[188:191], v[104:119]
    v_cvt_pk_bf16_f32 v184, v88, v89
    v_exp_f32 v92, v92
    v_exp_f32 v93, v93
    v_cvt_pk_bf16_f32 v185, v90, v91
    v_mfma_f32_32x32x16_bf16 v[168:183], a[144:147], v[192:195], v[168:183]
    v_exp_f32 v94, v94
    v_exp_f32 v95, v95
    v_cvt_pk_bf16_f32 v186, v92, v93
    v_exp_f32 v96, v96
    v_mfma_f32_16x16x32_bf16 v[204:207], v[208:211], v[192:195], v[204:207]
    v_exp_f32 v97, v97
    v_cvt_pk_bf16_f32 v187, v94, v95
    v_exp_f32 v98, v98
    v_exp_f32 v99, v99
    v_mfma_f32_32x32x16_bf16 v[168:183], a[148:151], v[196:199], v[168:183]
    v_cvt_pk_bf16_f32 v188, v96, v97
    v_exp_f32 v100, v100
    v_exp_f32 v101, v101
    v_cvt_pk_bf16_f32 v189, v98, v99
    v_mfma_f32_16x16x32_bf16 v[204:207], v[208:211], v[196:199], v[204:207]
    v_exp_f32 v102, v102
    v_exp_f32 v103, v103
    v_cvt_pk_bf16_f32 v190, v100, v101
    v_cvt_pk_bf16_f32 v191, v102, v103
    s_waitcnt vmcnt(36)
    v_mfma_f32_32x32x16_bf16 v[88:103], a[168:171], a[176:179], v[120:135]
    buffer_load_dwordx4 a[144:147], v18, s[32:35], s64 offen offset:0
    v_exp_f32 v104, v104
    v_exp_f32 v105, v105
    v_exp_f32 v106, v106
    v_exp_f32 v107, v107
    v_mfma_f32_32x32x16_bf16 v[88:103], a[172:175], a[180:183], v[88:103]
    buffer_load_dwordx4 a[148:151], v18, s[32:35], s64 offen offset:1024
    v_cvt_pk_bf16_f32 v192, v104, v105
    v_exp_f32 v108, v108
    v_exp_f32 v109, v109
    v_cvt_pk_bf16_f32 v193, v106, v107
    v_mfma_f32_32x32x16_bf16 v[152:167], a[160:163], v[184:187], v[152:167]
    buffer_load_dwordx4 a[152:155], v18, s[32:35], s64 offen offset:2048
    v_exp_f32 v110, v110
    v_exp_f32 v111, v111
    v_cvt_pk_bf16_f32 v194, v108, v109
    v_exp_f32 v112, v112
    v_mfma_f32_16x16x32_bf16 v[200:203], v[208:211], v[184:187], v[200:203]
    buffer_load_dwordx4 a[156:159], v18, s[32:35], s64 offen offset:3072
    v_exp_f32 v113, v113
    v_cvt_pk_bf16_f32 v195, v110, v111
    v_exp_f32 v114, v114
    v_exp_f32 v115, v115
    v_mfma_f32_32x32x16_bf16 v[152:167], a[164:167], v[188:191], v[152:167]
    s_add_u32 s64, s64, 4096
    s_and_b32 s64, s64, 0x3ffff
    v_cvt_pk_bf16_f32 v196, v112, v113
    v_exp_f32 v116, v116
    v_exp_f32 v117, v117
    v_cvt_pk_bf16_f32 v197, v114, v115
    v_mfma_f32_16x16x32_bf16 v[200:203], v[208:211], v[188:191], v[200:203]
    v_exp_f32 v118, v118
    v_exp_f32 v119, v119
    v_cvt_pk_bf16_f32 v198, v116, v117
    v_cvt_pk_bf16_f32 v199, v118, v119
    v_mfma_f32_32x32x16_bf16 v[104:119], a[168:171], a[184:187], v[136:151]
    v_exp_f32 v88, v88
    v_exp_f32 v89, v89
    v_exp_f32 v90, v90
    v_exp_f32 v91, v91
    v_mfma_f32_32x32x16_bf16 v[104:119], a[172:175], a[188:191], v[104:119]
    v_cvt_pk_bf16_f32 v184, v88, v89
    v_exp_f32 v92, v92
    v_exp_f32 v93, v93
    v_cvt_pk_bf16_f32 v185, v90, v91
    v_mfma_f32_32x32x16_bf16 v[168:183], a[160:163], v[192:195], v[168:183]
    v_exp_f32 v94, v94
    v_exp_f32 v95, v95
    v_cvt_pk_bf16_f32 v186, v92, v93
    v_exp_f32 v96, v96
    v_mfma_f32_16x16x32_bf16 v[204:207], v[208:211], v[192:195], v[204:207]
    v_exp_f32 v97, v97
    v_cvt_pk_bf16_f32 v187, v94, v95
    v_exp_f32 v98, v98
    v_exp_f32 v99, v99
    v_mfma_f32_32x32x16_bf16 v[168:183], a[164:167], v[196:199], v[168:183]
    v_cvt_pk_bf16_f32 v188, v96, v97
    v_exp_f32 v100, v100
    v_exp_f32 v101, v101
    v_cvt_pk_bf16_f32 v189, v98, v99
    v_mfma_f32_16x16x32_bf16 v[204:207], v[208:211], v[196:199], v[204:207]
    v_exp_f32 v102, v102
    v_exp_f32 v103, v103
    v_cvt_pk_bf16_f32 v190, v100, v101
    v_cvt_pk_bf16_f32 v191, v102, v103
    s_waitcnt vmcnt(34)
    v_mfma_f32_32x32x16_bf16 v[88:103], a[8:11], a[176:179], v[120:135]
    buffer_load_dwordx4 a[160:163], v18, s[32:35], s64 offen offset:0
    v_exp_f32 v104, v104
    v_exp_f32 v105, v105
    v_exp_f32 v106, v106
    v_exp_f32 v107, v107
    v_mfma_f32_32x32x16_bf16 v[88:103], a[12:15], a[180:183], v[88:103]
    buffer_load_dwordx4 a[164:167], v18, s[32:35], s64 offen offset:1024
    v_cvt_pk_bf16_f32 v192, v104, v105
    v_exp_f32 v108, v108
    v_exp_f32 v109, v109
    v_cvt_pk_bf16_f32 v193, v106, v107
    v_mfma_f32_32x32x16_bf16 v[152:167], a[0:3], v[184:187], v[152:167]
    buffer_load_dwordx4 a[168:171], v18, s[32:35], s64 offen offset:2048
    v_exp_f32 v110, v110
    v_exp_f32 v111, v111
    v_cvt_pk_bf16_f32 v194, v108, v109
    v_exp_f32 v112, v112
    v_mfma_f32_16x16x32_bf16 v[200:203], v[208:211], v[184:187], v[200:203]
    buffer_load_dwordx4 a[172:175], v18, s[32:35], s64 offen offset:3072
    v_exp_f32 v113, v113
    v_cvt_pk_bf16_f32 v195, v110, v111
    v_exp_f32 v114, v114
    v_exp_f32 v115, v115
    v_mfma_f32_32x32x16_bf16 v[152:167], a[4:7], v[188:191], v[152:167]
    s_add_u32 s64, s64, 4096
    s_and_b32 s64, s64, 0x3ffff
    v_cvt_pk_bf16_f32 v196, v112, v113
    v_exp_f32 v116, v116
    v_exp_f32 v117, v117
    v_cvt_pk_bf16_f32 v197, v114, v115
    v_mfma_f32_16x16x32_bf16 v[200:203], v[208:211], v[188:191], v[200:203]
    v_exp_f32 v118, v118
    v_exp_f32 v119, v119
    v_cvt_pk_bf16_f32 v198, v116, v117
    v_cvt_pk_bf16_f32 v199, v118, v119
    v_mfma_f32_32x32x16_bf16 v[104:119], a[8:11], a[184:187], v[136:151]
    s_mul_i32 s66, s100, 1792
    s_add_u32 s66, s66, 1835008
    buffer_load_dword v19, v21, s[28:31], s66 offen
    v_exp_f32 v88, v88
    v_exp_f32 v89, v89
    v_exp_f32 v90, v90
    v_exp_f32 v91, v91
    v_mfma_f32_32x32x16_bf16 v[104:119], a[12:15], a[188:191], v[104:119]
    v_cvt_pk_bf16_f32 v184, v88, v89
    v_exp_f32 v92, v92
    v_exp_f32 v93, v93
    v_cvt_pk_bf16_f32 v185, v90, v91
    v_mfma_f32_32x32x16_bf16 v[168:183], a[0:3], v[192:195], v[168:183]
    v_exp_f32 v94, v94
    v_exp_f32 v95, v95
    v_cvt_pk_bf16_f32 v186, v92, v93
    v_exp_f32 v96, v96
    v_mfma_f32_16x16x32_bf16 v[204:207], v[208:211], v[192:195], v[204:207]
    v_exp_f32 v97, v97
    v_cvt_pk_bf16_f32 v187, v94, v95
    v_exp_f32 v98, v98
    v_exp_f32 v99, v99
    v_mfma_f32_32x32x16_bf16 v[168:183], a[4:7], v[196:199], v[168:183]
    v_cvt_pk_bf16_f32 v188, v96, v97
    v_exp_f32 v100, v100
    v_exp_f32 v101, v101
    v_cvt_pk_bf16_f32 v189, v98, v99
    v_mfma_f32_16x16x32_bf16 v[204:207], v[208:211], v[196:199], v[204:207]
    v_exp_f32 v102, v102
    v_exp_f32 v103, v103
    v_cvt_pk_bf16_f32 v190, v100, v101
    v_cvt_pk_bf16_f32 v191, v102, v103
    s_waitcnt vmcnt(33)
    v_mfma_f32_32x32x16_bf16 v[88:103], a[24:27], a[176:179], v[120:135]
    buffer_load_dwordx4 a[0:3], v18, s[32:35], s64 offen offset:0
    v_exp_f32 v104, v104
    v_exp_f32 v105, v105
    v_exp_f32 v106, v106
    v_exp_f32 v107, v107
    v_mfma_f32_32x32x16_bf16 v[88:103], a[28:31], a[180:183], v[88:103]
    buffer_load_dwordx4 a[4:7], v18, s[32:35], s64 offen offset:1024
    v_cvt_pk_bf16_f32 v192, v104, v105
    v_exp_f32 v108, v108
    v_exp_f32 v109, v109
    v_cvt_pk_bf16_f32 v193, v106, v107
    v_mfma_f32_32x32x16_bf16 v[152:167], a[16:19], v[184:187], v[152:167]
    buffer_load_dwordx4 a[8:11], v18, s[32:35], s64 offen offset:2048
    v_exp_f32 v110, v110
    v_exp_f32 v111, v111
    v_cvt_pk_bf16_f32 v194, v108, v109
    v_exp_f32 v112, v112
    v_mfma_f32_16x16x32_bf16 v[200:203], v[208:211], v[184:187], v[200:203]
    buffer_load_dwordx4 a[12:15], v18, s[32:35], s64 offen offset:3072
    v_exp_f32 v113, v113
    v_cvt_pk_bf16_f32 v195, v110, v111
    v_exp_f32 v114, v114
    v_exp_f32 v115, v115
    v_mfma_f32_32x32x16_bf16 v[152:167], a[20:23], v[188:191], v[152:167]
    s_add_u32 s64, s64, 4096
    s_and_b32 s64, s64, 0x3ffff
    v_cvt_pk_bf16_f32 v196, v112, v113
    v_exp_f32 v116, v116
    v_exp_f32 v117, v117
    v_cvt_pk_bf16_f32 v197, v114, v115
    v_mfma_f32_16x16x32_bf16 v[200:203], v[208:211], v[188:191], v[200:203]
    v_exp_f32 v118, v118
    v_exp_f32 v119, v119
    v_cvt_pk_bf16_f32 v198, v116, v117
    v_cvt_pk_bf16_f32 v199, v118, v119
    v_mfma_f32_32x32x16_bf16 v[104:119], a[24:27], a[184:187], v[136:151]
    v_exp_f32 v88, v88
    v_exp_f32 v89, v89
    v_exp_f32 v90, v90
    v_exp_f32 v91, v91
    v_mfma_f32_32x32x16_bf16 v[104:119], a[28:31], a[188:191], v[104:119]
    v_cvt_pk_bf16_f32 v184, v88, v89
    v_exp_f32 v92, v92
    v_exp_f32 v93, v93
    v_cvt_pk_bf16_f32 v185, v90, v91
    v_mfma_f32_32x32x16_bf16 v[168:183], a[16:19], v[192:195], v[168:183]
    v_exp_f32 v94, v94
    v_exp_f32 v95, v95
    v_cvt_pk_bf16_f32 v186, v92, v93
    v_exp_f32 v96, v96
    v_mfma_f32_16x16x32_bf16 v[204:207], v[208:211], v[192:195], v[204:207]
    v_exp_f32 v97, v97
    v_cvt_pk_bf16_f32 v187, v94, v95
    v_exp_f32 v98, v98
    v_exp_f32 v99, v99
    v_mfma_f32_32x32x16_bf16 v[168:183], a[20:23], v[196:199], v[168:183]
    v_cvt_pk_bf16_f32 v188, v96, v97
    v_exp_f32 v100, v100
    v_exp_f32 v101, v101
    v_cvt_pk_bf16_f32 v189, v98, v99
    v_mfma_f32_16x16x32_bf16 v[204:207], v[208:211], v[196:199], v[204:207]
    v_exp_f32 v102, v102
    v_exp_f32 v103, v103
    v_cvt_pk_bf16_f32 v190, v100, v101
    v_cvt_pk_bf16_f32 v191, v102, v103
    s_waitcnt vmcnt(31)
    v_mfma_f32_32x32x16_bf16 v[88:103], a[40:43], a[176:179], v[120:135]
    buffer_load_dwordx4 a[16:19], v18, s[32:35], s64 offen offset:0
    v_exp_f32 v104, v104
    v_exp_f32 v105, v105
    v_exp_f32 v106, v106
    v_exp_f32 v107, v107
    v_mfma_f32_32x32x16_bf16 v[88:103], a[44:47], a[180:183], v[88:103]
    buffer_load_dwordx4 a[20:23], v18, s[32:35], s64 offen offset:1024
    v_cvt_pk_bf16_f32 v192, v104, v105
    v_exp_f32 v108, v108
    v_exp_f32 v109, v109
    v_cvt_pk_bf16_f32 v193, v106, v107
    v_mfma_f32_32x32x16_bf16 v[152:167], a[32:35], v[184:187], v[152:167]
    buffer_load_dwordx4 a[24:27], v18, s[32:35], s64 offen offset:2048
    v_exp_f32 v110, v110
    v_exp_f32 v111, v111
    v_cvt_pk_bf16_f32 v194, v108, v109
    v_exp_f32 v112, v112
    v_mfma_f32_16x16x32_bf16 v[200:203], v[208:211], v[184:187], v[200:203]
    buffer_load_dwordx4 a[28:31], v18, s[32:35], s64 offen offset:3072
    v_exp_f32 v113, v113
    v_cvt_pk_bf16_f32 v195, v110, v111
    v_exp_f32 v114, v114
    v_exp_f32 v115, v115
    v_mfma_f32_32x32x16_bf16 v[152:167], a[36:39], v[188:191], v[152:167]
    s_add_u32 s64, s64, 4096
    s_and_b32 s64, s64, 0x3ffff
    v_cvt_pk_bf16_f32 v196, v112, v113
    v_exp_f32 v116, v116
    v_exp_f32 v117, v117
    v_cvt_pk_bf16_f32 v197, v114, v115
    v_mfma_f32_16x16x32_bf16 v[200:203], v[208:211], v[188:191], v[200:203]
    v_exp_f32 v118, v118
    v_exp_f32 v119, v119
    v_cvt_pk_bf16_f32 v198, v116, v117
    v_cvt_pk_bf16_f32 v199, v118, v119
    s_waitcnt vmcnt(21)
    s_barrier
    s_cmp_lg_u32 s3, 1
    s_cbranch_scc1 PUB_7
    s_add_u32 s99, s94, 3
    v_mov_b32 v0, s99
    s_mov_b64 exec, 1
    buffer_store_dword v0, v255, s[32:35], s93 offen sc1
    s_mov_b64 exec, -1
PUB_7:
    v_mfma_f32_32x32x16_bf16 v[104:119], a[40:43], a[184:187], v[136:151]
    v_exp_f32 v88, v88
    v_exp_f32 v89, v89
    v_exp_f32 v90, v90
    v_exp_f32 v91, v91
    v_mfma_f32_32x32x16_bf16 v[104:119], a[44:47], a[188:191], v[104:119]
    v_cvt_pk_bf16_f32 v184, v88, v89
    v_exp_f32 v92, v92
    v_exp_f32 v93, v93
    v_cvt_pk_bf16_f32 v185, v90, v91
    v_mfma_f32_32x32x16_bf16 v[168:183], a[32:35], v[192:195], v[168:183]
    v_exp_f32 v94, v94
    v_exp_f32 v95, v95
    v_cvt_pk_bf16_f32 v186, v92, v93
    v_exp_f32 v96, v96
    v_mfma_f32_16x16x32_bf16 v[204:207], v[208:211], v[192:195], v[204:207]
    v_exp_f32 v97, v97
    v_cvt_pk_bf16_f32 v187, v94, v95
    v_exp_f32 v98, v98
    v_exp_f32 v99, v99
    v_mfma_f32_32x32x16_bf16 v[168:183], a[36:39], v[196:199], v[168:183]
    v_cvt_pk_bf16_f32 v188, v96, v97
    v_exp_f32 v100, v100
    v_exp_f32 v101, v101
    v_cvt_pk_bf16_f32 v189, v98, v99
    v_mfma_f32_16x16x32_bf16 v[204:207], v[208:211], v[196:199], v[204:207]
    v_exp_f32 v102, v102
    v_exp_f32 v103, v103
    v_cvt_pk_bf16_f32 v190, v100, v101
    v_cvt_pk_bf16_f32 v191, v102, v103
    v_mfma_f32_32x32x16_bf16 v[88:103], a[104:107], a[176:179], v[120:135]
    buffer_load_dwordx4 a[32:35], v18, s[32:35], s64 offen offset:0
    v_exp_f32 v104, v104
    v_exp_f32 v105, v105
    v_exp_f32 v106, v106
    v_exp_f32 v107, v107
    v_mfma_f32_32x32x16_bf16 v[88:103], a[108:111], a[180:183], v[88:103]
    buffer_load_dwordx4 a[36:39], v18, s[32:35], s64 offen offset:1024
    v_cvt_pk_bf16_f32 v192, v104, v105
    v_exp_f32 v108, v108
    v_exp_f32 v109, v109
    v_cvt_pk_bf16_f32 v193, v106, v107
    v_mfma_f32_32x32x16_bf16 v[152:167], a[96:99], v[184:187], v[152:167]
    buffer_load_dwordx4 a[40:43], v18, s[32:35], s64 offen offset:2048
    v_exp_f32 v110, v110
    v_exp_f32 v111, v111
    v_cvt_pk_bf16_f32 v194, v108, v109
    v_exp_f32 v112, v112
    v_mfma_f32_16x16x32_bf16 v[200:203], v[208:211], v[184:187], v[200:203]
    buffer_load_dwordx4 a[44:47], v18, s[32:35], s64 offen offset:3072
    v_exp_f32 v113, v113
    v_cvt_pk_bf16_f32 v195, v110, v111
    v_exp_f32 v114, v114
    v_exp_f32 v115, v115
    v_mfma_f32_32x32x16_bf16 v[152:167], a[100:103], v[188:191], v[152:167]
    s_add_u32 s64, s64, 4096
    s_and_b32 s64, s64, 0x3ffff
    v_cvt_pk_bf16_f32 v196, v112, v113
    v_exp_f32 v116, v116
    v_exp_f32 v117, v117
    v_cvt_pk_bf16_f32 v197, v114, v115
    v_mfma_f32_16x16x32_bf16 v[200:203], v[208:211], v[188:191], v[200:203]
    v_exp_f32 v118, v118
    v_exp_f32 v119, v119
    v_cvt_pk_bf16_f32 v198, v116, v117
    v_cvt_pk_bf16_f32 v199, v118, v119
    v_mfma_f32_32x32x16_bf16 v[104:119], a[104:107], a[184:187], v[136:151]
    v_exp_f32 v88, v88
    v_exp_f32 v89, v89
    v_exp_f32 v90, v90
    v_exp_f32 v91, v91
    v_mfma_f32_32x32x16_bf16 v[104:119], a[108:111], a[188:191], v[104:119]
    v_cvt_pk_bf16_f32 v184, v88, v89
    v_exp_f32 v92, v92
    v_exp_f32 v93, v93
    v_cvt_pk_bf16_f32 v185, v90, v91
    v_mfma_f32_32x32x16_bf16 v[168:183], a[96:99], v[192:195], v[168:183]
    v_exp_f32 v94, v94
    v_exp_f32 v95, v95
    v_cvt_pk_bf16_f32 v186, v92, v93
    v_exp_f32 v96, v96
    v_mfma_f32_16x16x32_bf16 v[204:207], v[208:211], v[192:195], v[204:207]
    v_exp_f32 v97, v97
    v_cvt_pk_bf16_f32 v187, v94, v95
    v_exp_f32 v98, v98
    v_exp_f32 v99, v99
    v_mfma_f32_32x32x16_bf16 v[168:183], a[100:103], v[196:199], v[168:183]
    v_cvt_pk_bf16_f32 v188, v96, v97
    v_exp_f32 v100, v100
    v_exp_f32 v101, v101
    v_cvt_pk_bf16_f32 v189, v98, v99
    v_mfma_f32_16x16x32_bf16 v[204:207], v[208:211], v[196:199], v[204:207]
    v_exp_f32 v102, v102
    v_exp_f32 v103, v103
    v_cvt_pk_bf16_f32 v190, v100, v101
    v_cvt_pk_bf16_f32 v191, v102, v103
    v_mfma_f32_32x32x16_bf16 v[88:103], a[120:123], a[176:179], v[120:135]
    buffer_load_dwordx4 a[96:99], v18, s[32:35], s64 offen offset:0
    v_exp_f32 v104, v104
    v_exp_f32 v105, v105
    v_exp_f32 v106, v106
    v_exp_f32 v107, v107
    v_mfma_f32_32x32x16_bf16 v[88:103], a[124:127], a[180:183], v[88:103]
    buffer_load_dwordx4 a[100:103], v18, s[32:35], s64 offen offset:1024
    v_cvt_pk_bf16_f32 v192, v104, v105
    v_exp_f32 v108, v108
    v_exp_f32 v109, v109
    v_cvt_pk_bf16_f32 v193, v106, v107
    v_mfma_f32_32x32x16_bf16 v[152:167], a[112:115], v[184:187], v[152:167]
    buffer_load_dwordx4 a[104:107], v18, s[32:35], s64 offen offset:2048
    v_exp_f32 v110, v110
    v_exp_f32 v111, v111
    v_cvt_pk_bf16_f32 v194, v108, v109
    v_exp_f32 v112, v112
    v_mfma_f32_16x16x32_bf16 v[200:203], v[208:211], v[184:187], v[200:203]
    buffer_load_dwordx4 a[108:111], v18, s[32:35], s64 offen offset:3072
    v_exp_f32 v113, v113
    v_cvt_pk_bf16_f32 v195, v110, v111
    v_exp_f32 v114, v114
    v_exp_f32 v115, v115
    v_mfma_f32_32x32x16_bf16 v[152:167], a[116:119], v[188:191], v[152:167]
    s_add_u32 s64, s64, 4096
    s_and_b32 s64, s64, 0x3ffff
    v_cvt_pk_bf16_f32 v196, v112, v113
    v_exp_f32 v116, v116
    v_exp_f32 v117, v117
    v_cvt_pk_bf16_f32 v197, v114, v115
    v_mfma_f32_16x16x32_bf16 v[200:203], v[208:211], v[188:191], v[200:203]
    v_exp_f32 v118, v118
    v_exp_f32 v119, v119
    v_cvt_pk_bf16_f32 v198, v116, v117
    v_cvt_pk_bf16_f32 v199, v118, v119
    v_mfma_f32_32x32x16_bf16 v[104:119], a[120:123], a[184:187], v[136:151]
    s_mul_i32 s66, s100, 2048
    s_add_u32 s66, s66, 0
    buffer_load_dword v19, v21, s[24:27], s66 offen
    v_exp_f32 v88, v88
    v_exp_f32 v89, v89
    v_exp_f32 v90, v90
    v_exp_f32 v91, v91
    v_mfma_f32_32x32x16_bf16 v[104:119], a[124:127], a[188:191], v[104:119]
    v_cvt_pk_bf16_f32 v184, v88, v89
    v_exp_f32 v92, v92
    v_exp_f32 v93, v93
    v_cvt_pk_bf16_f32 v185, v90, v91
    v_mfma_f32_32x32x16_bf16 v[168:183], a[112:115], v[192:195], v[168:183]
    v_exp_f32 v94, v94
    v_exp_f32 v95, v95
    v_cvt_pk_bf16_f32 v186, v92, v93
    v_exp_f32 v96, v96
    v_mfma_f32_16x16x32_bf16 v[204:207], v[208:211], v[192:195], v[204:207]
    v_exp_f32 v97, v97
    v_cvt_pk_bf16_f32 v187, v94, v95
    v_exp_f32 v98, v98
    v_exp_f32 v99, v99
    v_mfma_f32_32x32x16_bf16 v[168:183], a[116:119], v[196:199], v[168:183]
    v_cvt_pk_bf16_f32 v188, v96, v97
    v_exp_f32 v100, v100
    v_exp_f32 v101, v101
    v_cvt_pk_bf16_f32 v189, v98, v99
    v_mfma_f32_16x16x32_bf16 v[204:207], v[208:211], v[196:199], v[204:207]
    v_exp_f32 v102, v102
    v_exp_f32 v103, v103
    v_cvt_pk_bf16_f32 v190, v100, v101
    v_cvt_pk_bf16_f32 v191, v102, v103
    s_waitcnt vmcnt(26)
    v_mfma_f32_32x32x16_bf16 v[88:103], a[136:139], a[176:179], v[120:135]
    buffer_load_dwordx4 a[112:115], v18, s[32:35], s64 offen offset:0
    v_exp_f32 v104, v104
    v_exp_f32 v105, v105
    v_exp_f32 v106, v106
    v_exp_f32 v107, v107
    v_mfma_f32_32x32x16_bf16 v[88:103], a[140:143], a[180:183], v[88:103]
    buffer_load_dwordx4 a[116:119], v18, s[32:35], s64 offen offset:1024
    v_cvt_pk_bf16_f32 v192, v104, v105
    v_exp_f32 v108, v108
    v_exp_f32 v109, v109
    v_cvt_pk_bf16_f32 v193, v106, v107
    v_mfma_f32_32x32x16_bf16 v[152:167], a[128:131], v[184:187], v[152:167]
    buffer_load_dwordx4 a[120:123], v18, s[32:35], s64 offen offset:2048
    v_exp_f32 v110, v110
    v_exp_f32 v111, v111
    v_cvt_pk_bf16_f32 v194, v108, v109
    v_exp_f32 v112, v112
    v_mfma_f32_16x16x32_bf16 v[200:203], v[208:211], v[184:187], v[200:203]
    buffer_load_dwordx4 a[124:127], v18, s[32:35], s64 offen offset:3072
    v_exp_f32 v113, v113
    v_cvt_pk_bf16_f32 v195, v110, v111
    v_exp_f32 v114, v114
    v_exp_f32 v115, v115
    v_mfma_f32_32x32x16_bf16 v[152:167], a[132:135], v[188:191], v[152:167]
    s_add_u32 s64, s64, 4096
    s_and_b32 s64, s64, 0x3ffff
    v_cvt_pk_bf16_f32 v196, v112, v113
    v_exp_f32 v116, v116
    v_exp_f32 v117, v117
    v_cvt_pk_bf16_f32 v197, v114, v115
    v_mfma_f32_16x16x32_bf16 v[200:203], v[208:211], v[188:191], v[200:203]
    v_exp_f32 v118, v118
    v_exp_f32 v119, v119
    v_cvt_pk_bf16_f32 v198, v116, v117
    v_cvt_pk_bf16_f32 v199, v118, v119
    v_mfma_f32_32x32x16_bf16 v[104:119], a[136:139], a[184:187], v[136:151]
    v_exp_f32 v88, v88
    v_exp_f32 v89, v89
    v_exp_f32 v90, v90
    v_exp_f32 v91, v91
    v_mfma_f32_32x32x16_bf16 v[104:119], a[140:143], a[188:191], v[104:119]
    v_cvt_pk_bf16_f32 v184, v88, v89
    v_exp_f32 v92, v92
    v_exp_f32 v93, v93
    v_cvt_pk_bf16_f32 v185, v90, v91
    v_mfma_f32_32x32x16_bf16 v[168:183], a[128:131], v[192:195], v[168:183]
    v_exp_f32 v94, v94
    v_exp_f32 v95, v95
    v_cvt_pk_bf16_f32 v186, v92, v93
    v_exp_f32 v96, v96
    v_mfma_f32_16x16x32_bf16 v[204:207], v[208:211], v[192:195], v[204:207]
    v_exp_f32 v97, v97
    v_cvt_pk_bf16_f32 v187, v94, v95
    v_exp_f32 v98, v98
    v_exp_f32 v99, v99
    v_mfma_f32_32x32x16_bf16 v[168:183], a[132:135], v[196:199], v[168:183]
    v_cvt_pk_bf16_f32 v188, v96, v97
    v_exp_f32 v100, v100
    v_exp_f32 v101, v101
    v_cvt_pk_bf16_f32 v189, v98, v99
    v_mfma_f32_16x16x32_bf16 v[204:207], v[208:211], v[196:199], v[204:207]
    v_exp_f32 v102, v102
    v_exp_f32 v103, v103
    v_cvt_pk_bf16_f32 v190, v100, v101
    v_cvt_pk_bf16_f32 v191, v102, v103
    s_waitcnt vmcnt(26)
    v_mfma_f32_32x32x16_bf16 v[88:103], a[152:155], a[176:179], v[120:135]
    buffer_load_dwordx4 a[128:131], v18, s[32:35], s64 offen offset:0
    v_exp_f32 v104, v104
    v_exp_f32 v105, v105
    v_exp_f32 v106, v106
    v_exp_f32 v107, v107
    v_mfma_f32_32x32x16_bf16 v[88:103], a[156:159], a[180:183], v[88:103]
    buffer_load_dwordx4 a[132:135], v18, s[32:35], s64 offen offset:1024
    v_cvt_pk_bf16_f32 v192, v104, v105
    v_exp_f32 v108, v108
    v_exp_f32 v109, v109
    v_cvt_pk_bf16_f32 v193, v106, v107
    v_mfma_f32_32x32x16_bf16 v[152:167], a[144:147], v[184:187], v[152:167]
    buffer_load_dwordx4 a[136:139], v18, s[32:35], s64 offen offset:2048
    v_exp_f32 v110, v110
    v_exp_f32 v111, v111
    v_cvt_pk_bf16_f32 v194, v108, v109
    v_exp_f32 v112, v112
    v_mfma_f32_16x16x32_bf16 v[200:203], v[208:211], v[184:187], v[200:203]
    buffer_load_dwordx4 a[140:143], v18, s[32:35], s64 offen offset:3072
    v_exp_f32 v113, v113
    v_cvt_pk_bf16_f32 v195, v110, v111
    v_exp_f32 v114, v114
    v_exp_f32 v115, v115
    v_mfma_f32_32x32x16_bf16 v[152:167], a[148:151], v[188:191], v[152:167]
    s_add_u32 s64, s64, 4096
    s_and_b32 s64, s64, 0x3ffff
    v_cvt_pk_bf16_f32 v196, v112, v113
    v_exp_f32 v116, v116
    v_exp_f32 v117, v117
    v_cvt_pk_bf16_f32 v197, v114, v115
    v_mfma_f32_16x16x32_bf16 v[200:203], v[208:211], v[188:191], v[200:203]
    v_exp_f32 v118, v118
    v_exp_f32 v119, v119
    v_cvt_pk_bf16_f32 v198, v116, v117
    v_cvt_pk_bf16_f32 v199, v118, v119
    v_mfma_f32_32x32x16_bf16 v[104:119], a[152:155], a[184:187], v[136:151]
    s_add_u32 m0, s54, 0
    s_nop 0
    buffer_load_dwordx4 v2, s[20:23], s52 offen offset:0 lds
    v_exp_f32 v88, v88
    v_exp_f32 v89, v89
    v_exp_f32 v90, v90
    v_exp_f32 v91, v91
    v_mfma_f32_32x32x16_bf16 v[104:119], a[156:159], a[188:191], v[104:119]
    buffer_load_dwordx4 v3, s[20:23], s52 offen offset:1024 lds
    v_cvt_pk_bf16_f32 v184, v88, v89
    v_exp_f32 v92, v92
    v_exp_f32 v93, v93
    v_cvt_pk_bf16_f32 v185, v90, v91
    v_mfma_f32_32x32x16_bf16 v[168:183], a[144:147], v[192:195], v[168:183]
    v_exp_f32 v94, v94
    v_exp_f32 v95, v95
    v_cvt_pk_bf16_f32 v186, v92, v93
    v_exp_f32 v96, v96
    v_mfma_f32_16x16x32_bf16 v[204:207], v[208:211], v[192:195], v[204:207]
    v_exp_f32 v97, v97
    v_cvt_pk_bf16_f32 v187, v94, v95
    v_exp_f32 v98, v98
    v_exp_f32 v99, v99
    v_mfma_f32_32x32x16_bf16 v[168:183], a[148:151], v[196:199], v[168:183]
    v_cvt_pk_bf16_f32 v188, v96, v97
    v_exp_f32 v100, v100
    v_exp_f32 v101, v101
    v_cvt_pk_bf16_f32 v189, v98, v99
    v_mfma_f32_16x16x32_bf16 v[204:207], v[208:211], v[196:199], v[204:207]
    v_exp_f32 v102, v102
    v_exp_f32 v103, v103
    v_cvt_pk_bf16_f32 v190, v100, v101
    v_cvt_pk_bf16_f32 v191, v102, v103
    s_waitcnt vmcnt(28)
    v_mfma_f32_32x32x16_bf16 v[88:103], a[168:171], a[176:179], v[120:135]
    buffer_load_dwordx4 a[144:147], v18, s[32:35], s64 offen offset:0
    v_exp_f32 v104, v104
    v_exp_f32 v105, v105
    v_exp_f32 v106, v106
    v_exp_f32 v107, v107
    v_mfma_f32_32x32x16_bf16 v[88:103], a[172:175], a[180:183], v[88:103]
    buffer_load_dwordx4 a[148:151], v18, s[32:35], s64 offen offset:1024
    v_cvt_pk_bf16_f32 v192, v104, v105
    v_exp_f32 v108, v108
    v_exp_f32 v109, v109
    v_cvt_pk_bf16_f32 v193, v106, v107
    v_mfma_f32_32x32x16_bf16 v[152:167], a[160:163], v[184:187], v[152:167]
    buffer_load_dwordx4 a[152:155], v18, s[32:35], s64 offen offset:2048
    v_exp_f32 v110, v110
    v_exp_f32 v111, v111
    v_cvt_pk_bf16_f32 v194, v108, v109
    v_exp_f32 v112, v112
    v_mfma_f32_16x16x32_bf16 v[200:203], v[208:211], v[184:187], v[200:203]
    buffer_load_dwordx4 a[156:159], v18, s[32:35], s64 offen offset:3072
    v_exp_f32 v113, v113
    v_cvt_pk_bf16_f32 v195, v110, v111
    v_exp_f32 v114, v114
    v_exp_f32 v115, v115
    v_mfma_f32_32x32x16_bf16 v[152:167], a[164:167], v[188:191], v[152:167]
    s_add_u32 s64, s64, 4096
    s_and_b32 s64, s64, 0x3ffff
    v_cvt_pk_bf16_f32 v196, v112, v113
    v_exp_f32 v116, v116
    v_exp_f32 v117, v117
    v_cvt_pk_bf16_f32 v197, v114, v115
    v_mfma_f32_16x16x32_bf16 v[200:203], v[208:211], v[188:191], v[200:203]
    v_exp_f32 v118, v118
    v_exp_f32 v119, v119
    v_cvt_pk_bf16_f32 v198, v116, v117
    v_cvt_pk_bf16_f32 v199, v118, v119
    v_mfma_f32_32x32x16_bf16 v[104:119], a[168:171], a[184:187], v[136:151]
    buffer_load_dwordx4 v4, s[20:23], s52 offen offset:2048 lds
    v_exp_f32 v88, v88
    v_exp_f32 v89, v89
    v_exp_f32 v90, v90
    v_exp_f32 v91, v91
    v_mfma_f32_32x32x16_bf16 v[104:119], a[172:175], a[188:191], v[104:119]
    buffer_load_dwordx4 v5, s[20:23], s52 offen offset:3072 lds
    s_add_u32 s52, s52, 128
    v_cvt_pk_bf16_f32 v184, v88, v89
    v_exp_f32 v92, v92
    v_exp_f32 v93, v93
    v_cvt_pk_bf16_f32 v185, v90, v91
    v_mfma_f32_32x32x16_bf16 v[168:183], a[160:163], v[192:195], v[168:183]
    v_exp_f32 v94, v94
    v_exp_f32 v95, v95
    v_cvt_pk_bf16_f32 v186, v92, v93
    v_exp_f32 v96, v96
    v_mfma_f32_16x16x32_bf16 v[204:207], v[208:211], v[192:195], v[204:207]
    v_exp_f32 v97, v97
    v_cvt_pk_bf16_f32 v187, v94, v95
    v_exp_f32 v98, v98
    v_exp_f32 v99, v99
    v_mfma_f32_32x32x16_bf16 v[168:183], a[164:167], v[196:199], v[168:183]
    v_cvt_pk_bf16_f32 v188, v96, v97
    v_exp_f32 v100, v100
    v_exp_f32 v101, v101
    v_cvt_pk_bf16_f32 v189, v98, v99
    v_mfma_f32_16x16x32_bf16 v[204:207], v[208:211], v[196:199], v[204:207]
    v_exp_f32 v102, v102
    v_exp_f32 v103, v103
    v_cvt_pk_bf16_f32 v190, v100, v101
    v_cvt_pk_bf16_f32 v191, v102, v103
    s_waitcnt vmcnt(29)
    v_mfma_f32_32x32x16_bf16 v[88:103], a[8:11], a[176:179], v[120:135]
    buffer_load_dwordx4 a[160:163], v18, s[32:35], s64 offen offset:0
    v_exp_f32 v104, v104
    v_exp_f32 v105, v105
    v_exp_f32 v106, v106
    v_exp_f32 v107, v107
    v_mfma_f32_32x32x16_bf16 v[88:103], a[12:15], a[180:183], v[88:103]
    buffer_load_dwordx4 a[164:167], v18, s[32:35], s64 offen offset:1024
    v_cvt_pk_bf16_f32 v192, v104, v105
    v_exp_f32 v108, v108
    v_exp_f32 v109, v109
    v_cvt_pk_bf16_f32 v193, v106, v107
    v_mfma_f32_32x32x16_bf16 v[152:167], a[0:3], v[184:187], v[152:167]
    buffer_load_dwordx4 a[168:171], v18, s[32:35], s64 offen offset:2048
    v_exp_f32 v110, v110
    v_exp_f32 v111, v111
    v_cvt_pk_bf16_f32 v194, v108, v109
    v_exp_f32 v112, v112
    v_mfma_f32_16x16x32_bf16 v[200:203], v[208:211], v[184:187], v[200:203]
    buffer_load_dwordx4 a[172:175], v18, s[32:35], s64 offen offset:3072
    v_exp_f32 v113, v113
    v_cvt_pk_bf16_f32 v195, v110, v111
    v_exp_f32 v114, v114
    v_exp_f32 v115, v115
    v_mfma_f32_32x32x16_bf16 v[152:167], a[4:7], v[188:191], v[152:167]
    s_add_u32 s64, s64, 4096
    s_and_b32 s64, s64, 0x3ffff
    v_cvt_pk_bf16_f32 v196, v112, v113
    v_exp_f32 v116, v116
    v_exp_f32 v117, v117
    v_cvt_pk_bf16_f32 v197, v114, v115
    v_mfma_f32_16x16x32_bf16 v[200:203], v[208:211], v[188:191], v[200:203]
    v_exp_f32 v118, v118
    v_exp_f32 v119, v119
    v_cvt_pk_bf16_f32 v198, v116, v117
    v_cvt_pk_bf16_f32 v199, v118, v119
    v_mfma_f32_32x32x16_bf16 v[104:119], a[8:11], a[184:187], v[136:151]
    s_add_u32 m0, s54, 30720
    s_nop 0
    buffer_load_dwordx4 v2, s[20:23], s52 offen offset:0 lds
    v_exp_f32 v88, v88
    v_exp_f32 v89, v89
    v_exp_f32 v90, v90
    v_exp_f32 v91, v91
    v_mfma_f32_32x32x16_bf16 v[104:119], a[12:15], a[188:191], v[104:119]
    buffer_load_dwordx4 v3, s[20:23], s52 offen offset:1024 lds
    v_cvt_pk_bf16_f32 v184, v88, v89
    v_exp_f32 v92, v92
    v_exp_f32 v93, v93
    v_cvt_pk_bf16_f32 v185, v90, v91
    v_mfma_f32_32x32x16_bf16 v[168:183], a[0:3], v[192:195], v[168:183]
    v_exp_f32 v94, v94
    v_exp_f32 v95, v95
    v_cvt_pk_bf16_f32 v186, v92, v93
    v_exp_f32 v96, v96
    v_mfma_f32_16x16x32_bf16 v[204:207], v[208:211], v[192:195], v[204:207]
    v_exp_f32 v97, v97
    v_cvt_pk_bf16_f32 v187, v94, v95
    v_exp_f32 v98, v98
    v_exp_f32 v99, v99
    v_mfma_f32_32x32x16_bf16 v[168:183], a[4:7], v[196:199], v[168:183]
    v_cvt_pk_bf16_f32 v188, v96, v97
    v_exp_f32 v100, v100
    v_exp_f32 v101, v101
    v_cvt_pk_bf16_f32 v189, v98, v99
    v_mfma_f32_16x16x32_bf16 v[204:207], v[208:211], v[196:199], v[204:207]
    v_exp_f32 v102, v102
    v_exp_f32 v103, v103
    v_cvt_pk_bf16_f32 v190, v100, v101
    v_cvt_pk_bf16_f32 v191, v102, v103
    s_waitcnt vmcnt(31)
    v_mfma_f32_32x32x16_bf16 v[88:103], a[24:27], a[176:179], v[120:135]
    buffer_load_dwordx4 a[0:3], v18, s[32:35], s64 offen offset:0
    v_exp_f32 v104, v104
    v_exp_f32 v105, v105
    v_exp_f32 v106, v106
    v_exp_f32 v107, v107
    v_mfma_f32_32x32x16_bf16 v[88:103], a[28:31], a[180:183], v[88:103]
    buffer_load_dwordx4 a[4:7], v18, s[32:35], s64 offen offset:1024
    v_cvt_pk_bf16_f32 v192, v104, v105
    v_exp_f32 v108, v108
    v_exp_f32 v109, v109
    v_cvt_pk_bf16_f32 v193, v106, v107
    v_mfma_f32_32x32x16_bf16 v[152:167], a[16:19], v[184:187], v[152:167]
    buffer_load_dwordx4 a[8:11], v18, s[32:35], s64 offen offset:2048
    v_exp_f32 v110, v110
    v_exp_f32 v111, v111
    v_cvt_pk_bf16_f32 v194, v108, v109
    v_exp_f32 v112, v112
    v_mfma_f32_16x16x32_bf16 v[200:203], v[208:211], v[184:187], v[200:203]
    buffer_load_dwordx4 a[12:15], v18, s[32:35], s64 offen offset:3072
    v_exp_f32 v113, v113
    v_cvt_pk_bf16_f32 v195, v110, v111
    v_exp_f32 v114, v114
    v_exp_f32 v115, v115
    v_mfma_f32_32x32x16_bf16 v[152:167], a[20:23], v[188:191], v[152:167]
    s_add_u32 s64, s64, 4096
    s_and_b32 s64, s64, 0x3ffff
    v_cvt_pk_bf16_f32 v196, v112, v113
    v_exp_f32 v116, v116
    v_exp_f32 v117, v117
    v_cvt_pk_bf16_f32 v197, v114, v115
    v_mfma_f32_16x16x32_bf16 v[200:203], v[208:211], v[188:191], v[200:203]
    v_exp_f32 v118, v118
    v_exp_f32 v119, v119
    v_cvt_pk_bf16_f32 v198, v116, v117
    v_cvt_pk_bf16_f32 v199, v118, v119
    v_mfma_f32_32x32x16_bf16 v[104:119], a[24:27], a[184:187], v[136:151]
    buffer_load_dwordx4 v4, s[20:23], s52 offen offset:2048 lds
    v_exp_f32 v88, v88
    v_exp_f32 v89, v89
    v_exp_f32 v90, v90
    v_exp_f32 v91, v91
    v_mfma_f32_32x32x16_bf16 v[104:119], a[28:31], a[188:191], v[104:119]
    buffer_load_dwordx4 v5, s[20:23], s52 offen offset:3072 lds
    s_add_u32 s52, s52, 128
    v_cvt_pk_bf16_f32 v184, v88, v89
    v_exp_f32 v92, v92
    v_exp_f32 v93, v93
    v_cvt_pk_bf16_f32 v185, v90, v91
    v_mfma_f32_32x32x16_bf16 v[168:183], a[16:19], v[192:195], v[168:183]
    v_exp_f32 v94, v94
    v_exp_f32 v95, v95
    v_cvt_pk_bf16_f32 v186, v92, v93
    v_exp_f32 v96, v96
    v_mfma_f32_16x16x32_bf16 v[204:207], v[208:211], v[192:195], v[204:207]
    v_exp_f32 v97, v97
    v_cvt_pk_bf16_f32 v187, v94, v95
    v_exp_f32 v98, v98
    v_exp_f32 v99, v99
    v_mfma_f32_32x32x16_bf16 v[168:183], a[20:23], v[196:199], v[168:183]
    v_cvt_pk_bf16_f32 v188, v96, v97
    v_exp_f32 v100, v100
    v_exp_f32 v101, v101
    v_cvt_pk_bf16_f32 v189, v98, v99
    v_mfma_f32_16x16x32_bf16 v[204:207], v[208:211], v[196:199], v[204:207]
    v_exp_f32 v102, v102
    v_exp_f32 v103, v103
    v_cvt_pk_bf16_f32 v190, v100, v101
    v_cvt_pk_bf16_f32 v191, v102, v103
    s_waitcnt vmcnt(33)
    v_mfma_f32_32x32x16_bf16 v[88:103], a[40:43], a[176:179], v[120:135]
    buffer_load_dwordx4 a[16:19], v18, s[32:35], s64 offen offset:0
    v_exp_f32 v104, v104
    v_exp_f32 v105, v105
    v_exp_f32 v106, v106
    v_exp_f32 v107, v107
    v_mfma_f32_32x32x16_bf16 v[88:103], a[44:47], a[180:183], v[88:103]
    buffer_load_dwordx4 a[20:23], v18, s[32:35], s64 offen offset:1024
    v_cvt_pk_bf16_f32 v192, v104, v105
    v_exp_f32 v108, v108
    v_exp_f32 v109, v109
    v_cvt_pk_bf16_f32 v193, v106, v107
    v_mfma_f32_32x32x16_bf16 v[152:167], a[32:35], v[184:187], v[152:167]
    buffer_load_dwordx4 a[24:27], v18, s[32:35], s64 offen offset:2048
    v_exp_f32 v110, v110
    v_exp_f32 v111, v111
    v_cvt_pk_bf16_f32 v194, v108, v109
    v_exp_f32 v112, v112
    v_mfma_f32_16x16x32_bf16 v[200:203], v[208:211], v[184:187], v[200:203]
    buffer_load_dwordx4 a[28:31], v18, s[32:35], s64 offen offset:3072
    v_exp_f32 v113, v113
    v_cvt_pk_bf16_f32 v195, v110, v111
    v_exp_f32 v114, v114
    v_exp_f32 v115, v115
    v_mfma_f32_32x32x16_bf16 v[152:167], a[36:39], v[188:191], v[152:167]
    s_add_u32 s64, s64, 4096
    s_and_b32 s64, s64, 0x3ffff
    v_cvt_pk_bf16_f32 v196, v112, v113
    v_exp_f32 v116, v116
    v_exp_f32 v117, v117
    v_cvt_pk_bf16_f32 v197, v114, v115
    v_mfma_f32_16x16x32_bf16 v[200:203], v[208:211], v[188:191], v[200:203]
    v_exp_f32 v118, v118
    v_exp_f32 v119, v119
    v_cvt_pk_bf16_f32 v198, v116, v117
    v_cvt_pk_bf16_f32 v199, v118, v119
    v_mfma_f32_32x32x16_bf16 v[104:119], a[40:43], a[184:187], v[136:151]
    s_add_u32 m0, s54, 61440
    s_nop 0
    buffer_load_dwordx4 v2, s[20:23], s52 offen offset:0 lds
    v_exp_f32 v88, v88
    v_exp_f32 v89, v89
    v_exp_f32 v90, v90
    v_exp_f32 v91, v91
    v_mfma_f32_32x32x16_bf16 v[104:119], a[44:47], a[188:191], v[104:119]
    buffer_load_dwordx4 v3, s[20:23], s52 offen offset:1024 lds
    v_cvt_pk_bf16_f32 v184, v88, v89
    v_exp_f32 v92, v92
    v_exp_f32 v93, v93
    v_cvt_pk_bf16_f32 v185, v90, v91
    v_mfma_f32_32x32x16_bf16 v[168:183], a[32:35], v[192:195], v[168:183]
    v_exp_f32 v94, v94
    v_exp_f32 v95, v95
    v_cvt_pk_bf16_f32 v186, v92, v93
    v_exp_f32 v96, v96
    v_mfma_f32_16x16x32_bf16 v[204:207], v[208:211], v[192:195], v[204:207]
    v_exp_f32 v97, v97
    v_cvt_pk_bf16_f32 v187, v94, v95
    v_exp_f32 v98, v98
    v_exp_f32 v99, v99
    v_mfma_f32_32x32x16_bf16 v[168:183], a[36:39], v[196:199], v[168:183]
    v_cvt_pk_bf16_f32 v188, v96, v97
    v_exp_f32 v100, v100
    v_exp_f32 v101, v101
    v_cvt_pk_bf16_f32 v189, v98, v99
    v_mfma_f32_16x16x32_bf16 v[204:207], v[208:211], v[196:199], v[204:207]
    v_exp_f32 v102, v102
    v_exp_f32 v103, v103
    v_cvt_pk_bf16_f32 v190, v100, v101
    v_cvt_pk_bf16_f32 v191, v102, v103
    s_waitcnt vmcnt(35)
    v_mfma_f32_32x32x16_bf16 v[88:103], a[104:107], a[176:179], v[120:135]
    buffer_load_dwordx4 a[32:35], v18, s[32:35], s64 offen offset:0
    v_exp_f32 v104, v104
    v_exp_f32 v105, v105
    v_exp_f32 v106, v106
    v_exp_f32 v107, v107
    v_mfma_f32_32x32x16_bf16 v[88:103], a[108:111], a[180:183], v[88:103]
    buffer_load_dwordx4 a[36:39], v18, s[32:35], s64 offen offset:1024
    v_cvt_pk_bf16_f32 v192, v104, v105
    v_exp_f32 v108, v108
    v_exp_f32 v109, v109
    v_cvt_pk_bf16_f32 v193, v106, v107
    v_mfma_f32_32x32x16_bf16 v[152:167], a[96:99], v[184:187], v[152:167]
    buffer_load_dwordx4 a[40:43], v18, s[32:35], s64 offen offset:2048
    v_exp_f32 v110, v110
    v_exp_f32 v111, v111
    v_cvt_pk_bf16_f32 v194, v108, v109
    v_exp_f32 v112, v112
    v_mfma_f32_16x16x32_bf16 v[200:203], v[208:211], v[184:187], v[200:203]
    buffer_load_dwordx4 a[44:47], v18, s[32:35], s64 offen offset:3072
    v_exp_f32 v113, v113
    v_cvt_pk_bf16_f32 v195, v110, v111
    v_exp_f32 v114, v114
    v_exp_f32 v115, v115
    v_mfma_f32_32x32x16_bf16 v[152:167], a[100:103], v[188:191], v[152:167]
    s_add_u32 s64, s64, 4096
    s_and_b32 s64, s64, 0x3ffff
    v_cvt_pk_bf16_f32 v196, v112, v113
    v_exp_f32 v116, v116
    v_exp_f32 v117, v117
    v_cvt_pk_bf16_f32 v197, v114, v115
    v_mfma_f32_16x16x32_bf16 v[200:203], v[208:211], v[188:191], v[200:203]
    v_exp_f32 v118, v118
    v_exp_f32 v119, v119
    v_cvt_pk_bf16_f32 v198, v116, v117
    v_cvt_pk_bf16_f32 v199, v118, v119
    v_mfma_f32_32x32x16_bf16 v[104:119], a[104:107], a[184:187], v[136:151]
    buffer_load_dwordx4 v4, s[20:23], s52 offen offset:2048 lds
    v_exp_f32 v88, v88
    v_exp_f32 v89, v89
    v_exp_f32 v90, v90
    v_exp_f32 v91, v91
    v_mfma_f32_32x32x16_bf16 v[104:119], a[108:111], a[188:191], v[104:119]
    buffer_load_dwordx4 v5, s[20:23], s52 offen offset:3072 lds
    s_add_u32 s52, s52, 128
    v_cvt_pk_bf16_f32 v184, v88, v89
    v_exp_f32 v92, v92
    v_exp_f32 v93, v93
    v_cvt_pk_bf16_f32 v185, v90, v91
    v_mfma_f32_32x32x16_bf16 v[168:183], a[96:99], v[192:195], v[168:183]
    v_exp_f32 v94, v94
    v_exp_f32 v95, v95
    v_cvt_pk_bf16_f32 v186, v92, v93
    v_exp_f32 v96, v96
    v_mfma_f32_16x16x32_bf16 v[204:207], v[208:211], v[192:195], v[204:207]
    v_exp_f32 v97, v97
    v_cvt_pk_bf16_f32 v187, v94, v95
    v_exp_f32 v98, v98
    v_exp_f32 v99, v99
    v_mfma_f32_32x32x16_bf16 v[168:183], a[100:103], v[196:199], v[168:183]
    v_cvt_pk_bf16_f32 v188, v96, v97
    v_exp_f32 v100, v100
    v_exp_f32 v101, v101
    v_cvt_pk_bf16_f32 v189, v98, v99
    v_mfma_f32_16x16x32_bf16 v[204:207], v[208:211], v[196:199], v[204:207]
    v_exp_f32 v102, v102
    v_exp_f32 v103, v103
    v_cvt_pk_bf16_f32 v190, v100, v101
    v_cvt_pk_bf16_f32 v191, v102, v103
    s_waitcnt vmcnt(36)
    v_mfma_f32_32x32x16_bf16 v[88:103], a[120:123], a[176:179], v[120:135]
    buffer_load_dwordx4 a[96:99], v18, s[32:35], s64 offen offset:0
    v_exp_f32 v104, v104
    v_exp_f32 v105, v105
    v_exp_f32 v106, v106
    v_exp_f32 v107, v107
    v_mfma_f32_32x32x16_bf16 v[88:103], a[124:127], a[180:183], v[88:103]
    buffer_load_dwordx4 a[100:103], v18, s[32:35], s64 offen offset:1024
    v_cvt_pk_bf16_f32 v192, v104, v105
    v_exp_f32 v108, v108
    v_exp_f32 v109, v109
    v_cvt_pk_bf16_f32 v193, v106, v107
    v_mfma_f32_32x32x16_bf16 v[152:167], a[112:115], v[184:187], v[152:167]
    buffer_load_dwordx4 a[104:107], v18, s[32:35], s64 offen offset:2048
    v_exp_f32 v110, v110
    v_exp_f32 v111, v111
    v_cvt_pk_bf16_f32 v194, v108, v109
    v_exp_f32 v112, v112
    v_mfma_f32_16x16x32_bf16 v[200:203], v[208:211], v[184:187], v[200:203]
    buffer_load_dwordx4 a[108:111], v18, s[32:35], s64 offen offset:3072
    v_exp_f32 v113, v113
    v_cvt_pk_bf16_f32 v195, v110, v111
    v_exp_f32 v114, v114
    v_exp_f32 v115, v115
    v_mfma_f32_32x32x16_bf16 v[152:167], a[116:119], v[188:191], v[152:167]
    s_add_u32 s64, s64, 4096
    s_and_b32 s64, s64, 0x3ffff
    v_cvt_pk_bf16_f32 v196, v112, v113
    v_exp_f32 v116, v116
    v_exp_f32 v117, v117
    v_cvt_pk_bf16_f32 v197, v114, v115
    v_mfma_f32_16x16x32_bf16 v[200:203], v[208:211], v[188:191], v[200:203]
    v_exp_f32 v118, v118
    v_exp_f32 v119, v119
    v_cvt_pk_bf16_f32 v198, v116, v117
    v_cvt_pk_bf16_f32 v199, v118, v119
    v_mfma_f32_32x32x16_bf16 v[104:119], a[120:123], a[184:187], v[136:151]
    s_add_u32 m0, s54, 92160
    s_nop 0
    buffer_load_dwordx4 v2, s[20:23], s52 offen offset:0 lds
    v_exp_f32 v88, v88
    v_exp_f32 v89, v89
    v_exp_f32 v90, v90
    v_exp_f32 v91, v91
    v_mfma_f32_32x32x16_bf16 v[104:119], a[124:127], a[188:191], v[104:119]
    buffer_load_dwordx4 v3, s[20:23], s52 offen offset:1024 lds
    v_cvt_pk_bf16_f32 v184, v88, v89
    v_exp_f32 v92, v92
    v_exp_f32 v93, v93
    v_cvt_pk_bf16_f32 v185, v90, v91
    v_mfma_f32_32x32x16_bf16 v[168:183], a[112:115], v[192:195], v[168:183]
    v_exp_f32 v94, v94
    v_exp_f32 v95, v95
    v_cvt_pk_bf16_f32 v186, v92, v93
    v_exp_f32 v96, v96
    v_mfma_f32_16x16x32_bf16 v[204:207], v[208:211], v[192:195], v[204:207]
    v_exp_f32 v97, v97
    v_cvt_pk_bf16_f32 v187, v94, v95
    v_exp_f32 v98, v98
    v_exp_f32 v99, v99
    v_mfma_f32_32x32x16_bf16 v[168:183], a[116:119], v[196:199], v[168:183]
    v_cvt_pk_bf16_f32 v188, v96, v97
    v_exp_f32 v100, v100
    v_exp_f32 v101, v101
    v_cvt_pk_bf16_f32 v189, v98, v99
    v_mfma_f32_16x16x32_bf16 v[204:207], v[208:211], v[196:199], v[204:207]
    v_exp_f32 v102, v102
    v_exp_f32 v103, v103
    v_cvt_pk_bf16_f32 v190, v100, v101
    v_cvt_pk_bf16_f32 v191, v102, v103
    s_waitcnt vmcnt(38)
    v_mfma_f32_32x32x16_bf16 v[88:103], a[136:139], a[176:179], v[120:135]
    buffer_load_dwordx4 a[112:115], v18, s[32:35], s64 offen offset:0
    v_exp_f32 v104, v104
    v_exp_f32 v105, v105
    v_exp_f32 v106, v106
    v_exp_f32 v107, v107
    v_mfma_f32_32x32x16_bf16 v[88:103], a[140:143], a[180:183], v[88:103]
    buffer_load_dwordx4 a[116:119], v18, s[32:35], s64 offen offset:1024
    v_cvt_pk_bf16_f32 v192, v104, v105
    v_exp_f32 v108, v108
    v_exp_f32 v109, v109
    v_cvt_pk_bf16_f32 v193, v106, v107
    v_mfma_f32_32x32x16_bf16 v[152:167], a[128:131], v[184:187], v[152:167]
    buffer_load_dwordx4 a[120:123], v18, s[32:35], s64 offen offset:2048
    v_exp_f32 v110, v110
    v_exp_f32 v111, v111
    v_cvt_pk_bf16_f32 v194, v108, v109
    v_exp_f32 v112, v112
    v_mfma_f32_16x16x32_bf16 v[200:203], v[208:211], v[184:187], v[200:203]
    buffer_load_dwordx4 a[124:127], v18, s[32:35], s64 offen offset:3072
    v_exp_f32 v113, v113
    v_cvt_pk_bf16_f32 v195, v110, v111
    v_exp_f32 v114, v114
    v_exp_f32 v115, v115
    v_mfma_f32_32x32x16_bf16 v[152:167], a[132:135], v[188:191], v[152:167]
    s_add_u32 s64, s64, 4096
    s_and_b32 s64, s64, 0x3ffff
    v_cvt_pk_bf16_f32 v196, v112, v113
    v_exp_f32 v116, v116
    v_exp_f32 v117, v117
    v_cvt_pk_bf16_f32 v197, v114, v115
    v_mfma_f32_16x16x32_bf16 v[200:203], v[208:211], v[188:191], v[200:203]
    v_exp_f32 v118, v118
    v_exp_f32 v119, v119
    v_cvt_pk_bf16_f32 v198, v116, v117
    v_cvt_pk_bf16_f32 v199, v118, v119
    v_mfma_f32_32x32x16_bf16 v[104:119], a[136:139], a[184:187], v[136:151]
    buffer_load_dwordx4 v4, s[20:23], s52 offen offset:2048 lds
    v_exp_f32 v88, v88
    v_exp_f32 v89, v89
    v_exp_f32 v90, v90
    v_exp_f32 v91, v91
    v_mfma_f32_32x32x16_bf16 v[104:119], a[140:143], a[188:191], v[104:119]
    buffer_load_dwordx4 v5, s[20:23], s52 offen offset:3072 lds
    s_add_u32 s52, s52, 128
    v_cvt_pk_bf16_f32 v184, v88, v89
    v_exp_f32 v92, v92
    v_exp_f32 v93, v93
    v_cvt_pk_bf16_f32 v185, v90, v91
    v_mfma_f32_32x32x16_bf16 v[168:183], a[128:131], v[192:195], v[168:183]
    v_exp_f32 v94, v94
    v_exp_f32 v95, v95
    v_cvt_pk_bf16_f32 v186, v92, v93
    v_exp_f32 v96, v96
    v_mfma_f32_16x16x32_bf16 v[204:207], v[208:211], v[192:195], v[204:207]
    v_exp_f32 v97, v97
    v_cvt_pk_bf16_f32 v187, v94, v95
    v_exp_f32 v98, v98
    v_exp_f32 v99, v99
    v_mfma_f32_32x32x16_bf16 v[168:183], a[132:135], v[196:199], v[168:183]
    v_cvt_pk_bf16_f32 v188, v96, v97
    v_exp_f32 v100, v100
    v_exp_f32 v101, v101
    v_cvt_pk_bf16_f32 v189, v98, v99
    v_mfma_f32_16x16x32_bf16 v[204:207], v[208:211], v[196:199], v[204:207]
    v_exp_f32 v102, v102
    v_exp_f32 v103, v103
    v_cvt_pk_bf16_f32 v190, v100, v101
    v_cvt_pk_bf16_f32 v191, v102, v103
    s_waitcnt vmcnt(38)
    v_mfma_f32_32x32x16_bf16 v[88:103], a[152:155], a[176:179], v[120:135]
    buffer_load_dwordx4 a[128:131], v18, s[32:35], s64 offen offset:0
    v_exp_f32 v104, v104
    v_exp_f32 v105, v105
    v_exp_f32 v106, v106
    v_exp_f32 v107, v107
    v_mfma_f32_32x32x16_bf16 v[88:103], a[156:159], a[180:183], v[88:103]
    buffer_load_dwordx4 a[132:135], v18, s[32:35], s64 offen offset:1024
    v_cvt_pk_bf16_f32 v192, v104, v105
    v_exp_f32 v108, v108
    v_exp_f32 v109, v109
    v_cvt_pk_bf16_f32 v193, v106, v107
    v_mfma_f32_32x32x16_bf16 v[152:167], a[144:147], v[184:187], v[152:167]
    buffer_load_dwordx4 a[136:139], v18, s[32:35], s64 offen offset:2048
    v_exp_f32 v110, v110
    v_exp_f32 v111, v111
    v_cvt_pk_bf16_f32 v194, v108, v109
    v_exp_f32 v112, v112
    v_mfma_f32_16x16x32_bf16 v[200:203], v[208:211], v[184:187], v[200:203]
    buffer_load_dwordx4 a[140:143], v18, s[32:35], s64 offen offset:3072
    v_exp_f32 v113, v113
    v_cvt_pk_bf16_f32 v195, v110, v111
    v_exp_f32 v114, v114
    v_exp_f32 v115, v115
    v_mfma_f32_32x32x16_bf16 v[152:167], a[148:151], v[188:191], v[152:167]
    s_add_u32 s64, s64, 4096
    s_and_b32 s64, s64, 0x3ffff
    v_cvt_pk_bf16_f32 v196, v112, v113
    v_exp_f32 v116, v116
    v_exp_f32 v117, v117
    v_cvt_pk_bf16_f32 v197, v114, v115
    v_mfma_f32_16x16x32_bf16 v[200:203], v[208:211], v[188:191], v[200:203]
    v_exp_f32 v118, v118
    v_exp_f32 v119, v119
    v_cvt_pk_bf16_f32 v198, v116, v117
    v_cvt_pk_bf16_f32 v199, v118, v119
    v_mfma_f32_32x32x16_bf16 v[104:119], a[152:155], a[184:187], v[136:151]
    s_add_u32 m0, s54, 122880
    s_nop 0
    buffer_load_dwordx4 v2, s[20:23], s52 offen offset:0 lds
    v_exp_f32 v88, v88
    v_exp_f32 v89, v89
    v_exp_f32 v90, v90
    v_exp_f32 v91, v91
    v_mfma_f32_32x32x16_bf16 v[104:119], a[156:159], a[188:191], v[104:119]
    buffer_load_dwordx4 v3, s[20:23], s52 offen offset:1024 lds
    v_cvt_pk_bf16_f32 v184, v88, v89
    v_exp_f32 v92, v92
    v_exp_f32 v93, v93
    v_cvt_pk_bf16_f32 v185, v90, v91
    v_mfma_f32_32x32x16_bf16 v[168:183], a[144:147], v[192:195], v[168:183]
    v_exp_f32 v94, v94
    v_exp_f32 v95, v95
    v_cvt_pk_bf16_f32 v186, v92, v93
    v_exp_f32 v96, v96
    v_mfma_f32_16x16x32_bf16 v[204:207], v[208:211], v[192:195], v[204:207]
    v_exp_f32 v97, v97
    v_cvt_pk_bf16_f32 v187, v94, v95
    v_exp_f32 v98, v98
    v_exp_f32 v99, v99
    v_mfma_f32_32x32x16_bf16 v[168:183], a[148:151], v[196:199], v[168:183]
    v_cvt_pk_bf16_f32 v188, v96, v97
    v_exp_f32 v100, v100
    v_exp_f32 v101, v101
    v_cvt_pk_bf16_f32 v189, v98, v99
    v_mfma_f32_16x16x32_bf16 v[204:207], v[208:211], v[196:199], v[204:207]
    v_exp_f32 v102, v102
    v_exp_f32 v103, v103
    v_cvt_pk_bf16_f32 v190, v100, v101
    v_cvt_pk_bf16_f32 v191, v102, v103
    s_waitcnt vmcnt(38)
    v_mfma_f32_32x32x16_bf16 v[88:103], a[168:171], a[176:179], v[120:135]
    buffer_load_dwordx4 a[144:147], v18, s[32:35], s64 offen offset:0
    v_exp_f32 v104, v104
    v_exp_f32 v105, v105
    v_exp_f32 v106, v106
    v_exp_f32 v107, v107
    v_mfma_f32_32x32x16_bf16 v[88:103], a[172:175], a[180:183], v[88:103]
    buffer_load_dwordx4 a[148:151], v18, s[32:35], s64 offen offset:1024
    v_cvt_pk_bf16_f32 v192, v104, v105
    v_exp_f32 v108, v108
    v_exp_f32 v109, v109
    v_cvt_pk_bf16_f32 v193, v106, v107
    v_mfma_f32_32x32x16_bf16 v[152:167], a[160:163], v[184:187], v[152:167]
    buffer_load_dwordx4 a[152:155], v18, s[32:35], s64 offen offset:2048
    v_exp_f32 v110, v110
    v_exp_f32 v111, v111
    v_cvt_pk_bf16_f32 v194, v108, v109
    v_exp_f32 v112, v112
    v_mfma_f32_16x16x32_bf16 v[200:203], v[208:211], v[184:187], v[200:203]
    buffer_load_dwordx4 a[156:159], v18, s[32:35], s64 offen offset:3072
    v_exp_f32 v113, v113
    v_cvt_pk_bf16_f32 v195, v110, v111
    v_exp_f32 v114, v114
    v_exp_f32 v115, v115
    v_mfma_f32_32x32x16_bf16 v[152:167], a[164:167], v[188:191], v[152:167]
    s_add_u32 s64, s64, 4096
    s_and_b32 s64, s64, 0x3ffff
    v_cvt_pk_bf16_f32 v196, v112, v113
    v_exp_f32 v116, v116
    v_exp_f32 v117, v117
    v_cvt_pk_bf16_f32 v197, v114, v115
    v_mfma_f32_16x16x32_bf16 v[200:203], v[208:211], v[188:191], v[200:203]
    v_exp_f32 v118, v118
    v_exp_f32 v119, v119
    v_cvt_pk_bf16_f32 v198, v116, v117
    v_cvt_pk_bf16_f32 v199, v118, v119
    v_mfma_f32_32x32x16_bf16 v[104:119], a[168:171], a[184:187], v[136:151]
    buffer_load_dwordx4 v4, s[20:23], s52 offen offset:2048 lds
    v_exp_f32 v88, v88
    v_exp_f32 v89, v89
    v_exp_f32 v90, v90
    v_exp_f32 v91, v91
    v_mfma_f32_32x32x16_bf16 v[104:119], a[172:175], a[188:191], v[104:119]
    buffer_load_dwordx4 v5, s[20:23], s52 offen offset:3072 lds
    s_add_u32 s52, s52, 128
    v_cvt_pk_bf16_f32 v184, v88, v89
    v_exp_f32 v92, v92
    v_exp_f32 v93, v93
    v_cvt_pk_bf16_f32 v185, v90, v91
    v_mfma_f32_32x32x16_bf16 v[168:183], a[160:163], v[192:195], v[168:183]
    v_exp_f32 v94, v94
    v_exp_f32 v95, v95
    v_cvt_pk_bf16_f32 v186, v92, v93
    v_exp_f32 v96, v96
    v_mfma_f32_16x16x32_bf16 v[204:207], v[208:211], v[192:195], v[204:207]
    v_exp_f32 v97, v97
    v_cvt_pk_bf16_f32 v187, v94, v95
    v_exp_f32 v98, v98
    v_exp_f32 v99, v99
    v_mfma_f32_32x32x16_bf16 v[168:183], a[164:167], v[196:199], v[168:183]
    v_cvt_pk_bf16_f32 v188, v96, v97
    v_exp_f32 v100, v100
    v_exp_f32 v101, v101
    v_cvt_pk_bf16_f32 v189, v98, v99
    v_mfma_f32_16x16x32_bf16 v[204:207], v[208:211], v[196:199], v[204:207]
    v_exp_f32 v102, v102
    v_exp_f32 v103, v103
    v_cvt_pk_bf16_f32 v190, v100, v101
    v_cvt_pk_bf16_f32 v191, v102, v103
    s_waitcnt vmcnt(38)
    v_mfma_f32_32x32x16_bf16 v[88:103], a[8:11], a[176:179], v[120:135]
    buffer_load_dwordx4 a[160:163], v18, s[32:35], s64 offen offset:0
    v_exp_f32 v104, v104
    v_exp_f32 v105, v105
    v_exp_f32 v106, v106
    v_exp_f32 v107, v107
    v_mfma_f32_32x32x16_bf16 v[88:103], a[12:15], a[180:183], v[88:103]
    buffer_load_dwordx4 a[164:167], v18, s[32:35], s64 offen offset:1024
    v_cvt_pk_bf16_f32 v192, v104, v105
    v_exp_f32 v108, v108
    v_exp_f32 v109, v109
    v_cvt_pk_bf16_f32 v193, v106, v107
    v_mfma_f32_32x32x16_bf16 v[152:167], a[0:3], v[184:187], v[152:167]
    buffer_load_dwordx4 a[168:171], v18, s[32:35], s64 offen offset:2048
    v_exp_f32 v110, v110
    v_exp_f32 v111, v111
    v_cvt_pk_bf16_f32 v194, v108, v109
    v_exp_f32 v112, v112
    v_mfma_f32_16x16x32_bf16 v[200:203], v[208:211], v[184:187], v[200:203]
    buffer_load_dwordx4 a[172:175], v18, s[32:35], s64 offen offset:3072
    v_exp_f32 v113, v113
    v_cvt_pk_bf16_f32 v195, v110, v111
    v_exp_f32 v114, v114
    v_exp_f32 v115, v115
    v_mfma_f32_32x32x16_bf16 v[152:167], a[4:7], v[188:191], v[152:167]
    s_add_u32 s64, s64, 4096
    s_and_b32 s64, s64, 0x3ffff
    v_cvt_pk_bf16_f32 v196, v112, v113
    v_exp_f32 v116, v116
    v_exp_f32 v117, v117
    v_cvt_pk_bf16_f32 v197, v114, v115
    v_mfma_f32_16x16x32_bf16 v[200:203], v[208:211], v[188:191], v[200:203]
    v_exp_f32 v118, v118
    v_exp_f32 v119, v119
    v_cvt_pk_bf16_f32 v198, v116, v117
    v_cvt_pk_bf16_f32 v199, v118, v119
    buffer_load_dword v252, v254, s[32:35], 0 offen sc1
    v_mfma_f32_32x32x16_bf16 v[104:119], a[8:11], a[184:187], v[136:151]
    v_exp_f32 v88, v88
    v_exp_f32 v89, v89
    v_exp_f32 v90, v90
    v_exp_f32 v91, v91
    v_mfma_f32_32x32x16_bf16 v[104:119], a[12:15], a[188:191], v[104:119]
    v_cvt_pk_bf16_f32 v184, v88, v89
    v_exp_f32 v92, v92
    v_exp_f32 v93, v93
    v_cvt_pk_bf16_f32 v185, v90, v91
    v_mfma_f32_32x32x16_bf16 v[168:183], a[0:3], v[192:195], v[168:183]
    v_exp_f32 v94, v94
    v_exp_f32 v95, v95
    v_cvt_pk_bf16_f32 v186, v92, v93
    v_exp_f32 v96, v96
    v_mfma_f32_16x16x32_bf16 v[204:207], v[208:211], v[192:195], v[204:207]
    v_exp_f32 v97, v97
    v_cvt_pk_bf16_f32 v187, v94, v95
    v_exp_f32 v98, v98
    v_exp_f32 v99, v99
    v_mfma_f32_32x32x16_bf16 v[168:183], a[4:7], v[196:199], v[168:183]
    v_cvt_pk_bf16_f32 v188, v96, v97
    v_exp_f32 v100, v100
    v_exp_f32 v101, v101
    v_cvt_pk_bf16_f32 v189, v98, v99
    v_mfma_f32_16x16x32_bf16 v[204:207], v[208:211], v[196:199], v[204:207]
    v_exp_f32 v102, v102
    v_exp_f32 v103, v103
    v_cvt_pk_bf16_f32 v190, v100, v101
    v_cvt_pk_bf16_f32 v191, v102, v103
    s_waitcnt vmcnt(37)
    v_mfma_f32_32x32x16_bf16 v[88:103], a[24:27], a[176:179], v[120:135]
    buffer_load_dwordx4 a[0:3], v18, s[32:35], s64 offen offset:0
    v_exp_f32 v104, v104
    v_exp_f32 v105, v105
    v_exp_f32 v106, v106
    v_exp_f32 v107, v107
    v_mfma_f32_32x32x16_bf16 v[88:103], a[28:31], a[180:183], v[88:103]
    buffer_load_dwordx4 a[4:7], v18, s[32:35], s64 offen offset:1024
    v_cvt_pk_bf16_f32 v192, v104, v105
    v_exp_f32 v108, v108
    v_exp_f32 v109, v109
    v_cvt_pk_bf16_f32 v193, v106, v107
    v_mfma_f32_32x32x16_bf16 v[152:167], a[16:19], v[184:187], v[152:167]
    buffer_load_dwordx4 a[8:11], v18, s[32:35], s64 offen offset:2048
    v_exp_f32 v110, v110
    v_exp_f32 v111, v111
    v_cvt_pk_bf16_f32 v194, v108, v109
    v_exp_f32 v112, v112
    v_mfma_f32_16x16x32_bf16 v[200:203], v[208:211], v[184:187], v[200:203]
    buffer_load_dwordx4 a[12:15], v18, s[32:35], s64 offen offset:3072
    v_exp_f32 v113, v113
    v_cvt_pk_bf16_f32 v195, v110, v111
    v_exp_f32 v114, v114
    v_exp_f32 v115, v115
    v_mfma_f32_32x32x16_bf16 v[152:167], a[20:23], v[188:191], v[152:167]
    s_add_u32 s64, s64, 4096
    s_and_b32 s64, s64, 0x3ffff
    v_cvt_pk_bf16_f32 v196, v112, v113
    v_exp_f32 v116, v116
    v_exp_f32 v117, v117
    v_cvt_pk_bf16_f32 v197, v114, v115
    v_mfma_f32_16x16x32_bf16 v[200:203], v[208:211], v[188:191], v[200:203]
    v_exp_f32 v118, v118
    v_exp_f32 v119, v119
    v_cvt_pk_bf16_f32 v198, v116, v117
    v_cvt_pk_bf16_f32 v199, v118, v119
    v_mfma_f32_32x32x16_bf16 v[104:119], a[24:27], a[184:187], v[136:151]
    v_exp_f32 v88, v88
    v_exp_f32 v89, v89
    v_exp_f32 v90, v90
    v_exp_f32 v91, v91
    v_mfma_f32_32x32x16_bf16 v[104:119], a[28:31], a[188:191], v[104:119]
    v_cvt_pk_bf16_f32 v184, v88, v89
    v_exp_f32 v92, v92
    v_exp_f32 v93, v93
    v_cvt_pk_bf16_f32 v185, v90, v91
    v_mfma_f32_32x32x16_bf16 v[168:183], a[16:19], v[192:195], v[168:183]
    v_exp_f32 v94, v94
    v_exp_f32 v95, v95
    v_cvt_pk_bf16_f32 v186, v92, v93
    v_exp_f32 v96, v96
    v_mfma_f32_16x16x32_bf16 v[204:207], v[208:211], v[192:195], v[204:207]
    v_exp_f32 v97, v97
    v_cvt_pk_bf16_f32 v187, v94, v95
    v_exp_f32 v98, v98
    v_exp_f32 v99, v99
    v_mfma_f32_32x32x16_bf16 v[168:183], a[20:23], v[196:199], v[168:183]
    v_cvt_pk_bf16_f32 v188, v96, v97
    v_exp_f32 v100, v100
    v_exp_f32 v101, v101
    v_cvt_pk_bf16_f32 v189, v98, v99
    v_mfma_f32_16x16x32_bf16 v[204:207], v[208:211], v[196:199], v[204:207]
    v_exp_f32 v102, v102
    v_exp_f32 v103, v103
    v_cvt_pk_bf16_f32 v190, v100, v101
    v_cvt_pk_bf16_f32 v191, v102, v103
    s_waitcnt vmcnt(35)
    v_mfma_f32_32x32x16_bf16 v[88:103], a[40:43], a[176:179], v[120:135]
    buffer_load_dwordx4 a[16:19], v18, s[32:35], s64 offen offset:0
    v_exp_f32 v104, v104
    v_exp_f32 v105, v105
    v_exp_f32 v106, v106
    v_exp_f32 v107, v107
    v_mfma_f32_32x32x16_bf16 v[88:103], a[44:47], a[180:183], v[88:103]
    buffer_load_dwordx4 a[20:23], v18, s[32:35], s64 offen offset:1024
    v_cvt_pk_bf16_f32 v192, v104, v105
    v_exp_f32 v108, v108
    v_exp_f32 v109, v109
    v_cvt_pk_bf16_f32 v193, v106, v107
    v_mfma_f32_32x32x16_bf16 v[152:167], a[32:35], v[184:187], v[152:167]
    buffer_load_dwordx4 a[24:27], v18, s[32:35], s64 offen offset:2048
    v_exp_f32 v110, v110
    v_exp_f32 v111, v111
    v_cvt_pk_bf16_f32 v194, v108, v109
    v_exp_f32 v112, v112
    v_mfma_f32_16x16x32_bf16 v[200:203], v[208:211], v[184:187], v[200:203]
    buffer_load_dwordx4 a[28:31], v18, s[32:35], s64 offen offset:3072
    v_exp_f32 v113, v113
    v_cvt_pk_bf16_f32 v195, v110, v111
    v_exp_f32 v114, v114
    v_exp_f32 v115, v115
    v_mfma_f32_32x32x16_bf16 v[152:167], a[36:39], v[188:191], v[152:167]
    s_add_u32 s64, s64, 4096
    s_and_b32 s64, s64, 0x3ffff
    v_cvt_pk_bf16_f32 v196, v112, v113
    v_exp_f32 v116, v116
    v_exp_f32 v117, v117
    v_cvt_pk_bf16_f32 v197, v114, v115
    v_mfma_f32_16x16x32_bf16 v[200:203], v[208:211], v[188:191], v[200:203]
    v_exp_f32 v118, v118
    v_exp_f32 v119, v119
    v_cvt_pk_bf16_f32 v198, v116, v117
    v_cvt_pk_bf16_f32 v199, v118, v119
    v_mfma_f32_32x32x16_bf16 v[104:119], a[40:43], a[184:187], v[136:151]
    v_exp_f32 v88, v88
    v_exp_f32 v89, v89
    v_exp_f32 v90, v90
    v_exp_f32 v91, v91
    v_mfma_f32_32x32x16_bf16 v[104:119], a[44:47], a[188:191], v[104:119]
    v_cvt_pk_bf16_f32 v184, v88, v89
    v_exp_f32 v92, v92
    v_exp_f32 v93, v93
    v_cvt_pk_bf16_f32 v185, v90, v91
    v_mfma_f32_32x32x16_bf16 v[168:183], a[32:35], v[192:195], v[168:183]
    v_exp_f32 v94, v94
    v_exp_f32 v95, v95
    v_cvt_pk_bf16_f32 v186, v92, v93
    v_exp_f32 v96, v96
    v_mfma_f32_16x16x32_bf16 v[204:207], v[208:211], v[192:195], v[204:207]
    v_exp_f32 v97, v97
    v_cvt_pk_bf16_f32 v187, v94, v95
    v_exp_f32 v98, v98
    v_exp_f32 v99, v99
    v_mfma_f32_32x32x16_bf16 v[168:183], a[36:39], v[196:199], v[168:183]
    v_cvt_pk_bf16_f32 v188, v96, v97
    v_exp_f32 v100, v100
    v_exp_f32 v101, v101
    v_cvt_pk_bf16_f32 v189, v98, v99
    v_mfma_f32_16x16x32_bf16 v[204:207], v[208:211], v[196:199], v[204:207]
    v_exp_f32 v102, v102
    v_exp_f32 v103, v103
    v_cvt_pk_bf16_f32 v190, v100, v101
    v_cvt_pk_bf16_f32 v191, v102, v103
    s_waitcnt vmcnt(33)
    v_mfma_f32_32x32x16_bf16 v[88:103], a[104:107], a[176:179], v[120:135]
    buffer_load_dwordx4 a[32:35], v18, s[32:35], s64 offen offset:0
    v_exp_f32 v104, v104
    v_exp_f32 v105, v105
    v_exp_f32 v106, v106
    v_exp_f32 v107, v107
    v_mfma_f32_32x32x16_bf16 v[88:103], a[108:111], a[180:183], v[88:103]
    buffer_load_dwordx4 a[36:39], v18, s[32:35], s64 offen offset:1024
    v_cvt_pk_bf16_f32 v192, v104, v105
    v_exp_f32 v108, v108
    v_exp_f32 v109, v109
    v_cvt_pk_bf16_f32 v193, v106, v107
    v_mfma_f32_32x32x16_bf16 v[152:167], a[96:99], v[184:187], v[152:167]
    buffer_load_dwordx4 a[40:43], v18, s[32:35], s64 offen offset:2048
    v_exp_f32 v110, v110
    v_exp_f32 v111, v111
    v_cvt_pk_bf16_f32 v194, v108, v109
    v_exp_f32 v112, v112
    v_mfma_f32_16x16x32_bf16 v[200:203], v[208:211], v[184:187], v[200:203]
    buffer_load_dwordx4 a[44:47], v18, s[32:35], s64 offen offset:3072
    v_exp_f32 v113, v113
    v_cvt_pk_bf16_f32 v195, v110, v111
    v_exp_f32 v114, v114
    v_exp_f32 v115, v115
    v_mfma_f32_32x32x16_bf16 v[152:167], a[100:103], v[188:191], v[152:167]
    s_add_u32 s64, s64, 4096
    s_and_b32 s64, s64, 0x3ffff
    v_cvt_pk_bf16_f32 v196, v112, v113
    v_exp_f32 v116, v116
    v_exp_f32 v117, v117
    v_cvt_pk_bf16_f32 v197, v114, v115
    v_mfma_f32_16x16x32_bf16 v[200:203], v[208:211], v[188:191], v[200:203]
    v_exp_f32 v118, v118
    v_exp_f32 v119, v119
    v_cvt_pk_bf16_f32 v198, v116, v117
    v_cvt_pk_bf16_f32 v199, v118, v119
    s_waitcnt vmcnt(12)
    s_add_u32 s91, s94, 3
    v_subrev_u32 v252, s91, v252
    v_cmp_lt_u32 vcc, 4, v252
    s_nop 4
    s_cbranch_vccz POK_8
    s_mov_b32 s99, 0x8000
PSPIN_9:
    s_sleep 2
    buffer_load_dword v252, v254, s[32:35], 0 offen sc1
    s_sub_u32 s99, s99, 1
    s_cbranch_scc1 POK_8
    s_waitcnt vmcnt(0)
    v_subrev_u32 v252, s91, v252
    v_cmp_lt_u32 vcc, 4, v252
    s_nop 4
    s_cbranch_vccnz PSPIN_9
POK_8:
    s_mul_i32 s53, s7, 458752
    s_add_u32 s53, s53, 16777216
    v_lshlrev_b32 v6, 4, v1
    s_mul_i32 s55, s3, 3584
    s_add_u32 s53, s53, s55
    s_lshl_b32 s56, s6, 8
    s_lshl_b32 s57, s4, 7
    s_add_u32 s56, s56, s57
    s_lshl_b32 s57, s5, 6
    v_and_b32 v25, 15, v1
    v_lshlrev_b32 v25, 1, v25
    v_or_b32 v25, s57, v25
    v_xor_b32 v22, 64, v25
    buffer_load_ushort v248, v25, s[40:43], s56 offen offset:0
    buffer_load_ushort v249, v25, s[40:43], s56 offen offset:32
    buffer_load_ushort v250, v22, s[40:43], s56 offen offset:0
    buffer_load_ushort v251, v22, s[40:43], s56 offen offset:32
    v_mfma_f32_32x32x16_bf16 v[104:119], a[104:107], a[184:187], v[136:151]
    v_exp_f32 v88, v88
    v_exp_f32 v89, v89
    v_exp_f32 v90, v90
    v_exp_f32 v91, v91
    v_mfma_f32_32x32x16_bf16 v[104:119], a[108:111], a[188:191], v[104:119]
    v_cvt_pk_bf16_f32 v184, v88, v89
    v_exp_f32 v92, v92
    v_exp_f32 v93, v93
    v_cvt_pk_bf16_f32 v185, v90, v91
    v_mfma_f32_32x32x16_bf16 v[168:183], a[96:99], v[192:195], v[168:183]
    v_exp_f32 v94, v94
    v_exp_f32 v95, v95
    v_cvt_pk_bf16_f32 v186, v92, v93
    v_exp_f32 v96, v96
    v_mfma_f32_16x16x32_bf16 v[204:207], v[208:211], v[192:195], v[204:207]
    v_exp_f32 v97, v97
    v_cvt_pk_bf16_f32 v187, v94, v95
    v_exp_f32 v98, v98
    v_exp_f32 v99, v99
    v_mfma_f32_32x32x16_bf16 v[168:183], a[100:103], v[196:199], v[168:183]
    v_cvt_pk_bf16_f32 v188, v96, v97
    v_exp_f32 v100, v100
    v_exp_f32 v101, v101
    v_cvt_pk_bf16_f32 v189, v98, v99
    v_mfma_f32_16x16x32_bf16 v[204:207], v[208:211], v[196:199], v[204:207]
    v_exp_f32 v102, v102
    v_exp_f32 v103, v103
    v_cvt_pk_bf16_f32 v190, v100, v101
    v_cvt_pk_bf16_f32 v191, v102, v103
    v_mfma_f32_32x32x16_bf16 v[88:103], a[120:123], a[176:179], v[120:135]
    buffer_load_dwordx4 a[96:99], v18, s[32:35], s64 offen offset:0
    v_exp_f32 v104, v104
    v_exp_f32 v105, v105
    v_exp_f32 v106, v106
    v_exp_f32 v107, v107
    v_mfma_f32_32x32x16_bf16 v[88:103], a[124:127], a[180:183], v[88:103]
    buffer_load_dwordx4 a[100:103], v18, s[32:35], s64 offen offset:1024
    v_cvt_pk_bf16_f32 v192, v104, v105
    v_exp_f32 v108, v108
    v_exp_f32 v109, v109
    v_cvt_pk_bf16_f32 v193, v106, v107
    v_mfma_f32_32x32x16_bf16 v[152:167], a[112:115], v[184:187], v[152:167]
    buffer_load_dwordx4 a[104:107], v18, s[32:35], s64 offen offset:2048
    v_exp_f32 v110, v110
    v_exp_f32 v111, v111
    v_cvt_pk_bf16_f32 v194, v108, v109
    v_exp_f32 v112, v112
    v_mfma_f32_16x16x32_bf16 v[200:203], v[208:211], v[184:187], v[200:203]
    buffer_load_dwordx4 a[108:111], v18, s[32:35], s64 offen offset:3072
    v_exp_f32 v113, v113
    v_cvt_pk_bf16_f32 v195, v110, v111
    v_exp_f32 v114, v114
    v_exp_f32 v115, v115
    v_mfma_f32_32x32x16_bf16 v[152:167], a[116:119], v[188:191], v[152:167]
    s_add_u32 s64, s64, 4096
    s_and_b32 s64, s64, 0x3ffff
    v_cvt_pk_bf16_f32 v196, v112, v113
    v_exp_f32 v116, v116
    v_exp_f32 v117, v117
    v_cvt_pk_bf16_f32 v197, v114, v115
    v_mfma_f32_16x16x32_bf16 v[200:203], v[208:211], v[188:191], v[200:203]
    v_exp_f32 v118, v118
    v_exp_f32 v119, v119
    v_cvt_pk_bf16_f32 v198, v116, v117
    v_cvt_pk_bf16_f32 v199, v118, v119
    v_mfma_f32_32x32x16_bf16 v[104:119], a[120:123], a[184:187], v[136:151]
    s_add_u32 m0, s55, 16384
    s_nop 0
    buffer_load_dwordx4 v6, s[32:35], s53 offen offset:0 sc1 lds
    v_exp_f32 v88, v88
    v_exp_f32 v89, v89
    v_exp_f32 v90, v90
    v_exp_f32 v91, v91
    v_mfma_f32_32x32x16_bf16 v[104:119], a[124:127], a[188:191], v[104:119]
    buffer_load_dwordx4 v6, s[32:35], s53 offen offset:1024 sc1 lds
    v_cvt_pk_bf16_f32 v184, v88, v89
    v_exp_f32 v92, v92
    v_exp_f32 v93, v93
    v_cvt_pk_bf16_f32 v185, v90, v91
    v_mfma_f32_32x32x16_bf16 v[168:183], a[112:115], v[192:195], v[168:183]
    v_exp_f32 v94, v94
    v_exp_f32 v95, v95
    v_cvt_pk_bf16_f32 v186, v92, v93
    v_exp_f32 v96, v96
    v_mfma_f32_16x16x32_bf16 v[204:207], v[208:211], v[192:195], v[204:207]
    v_exp_f32 v97, v97
    v_cvt_pk_bf16_f32 v187, v94, v95
    v_exp_f32 v98, v98
    v_exp_f32 v99, v99
    v_mfma_f32_32x32x16_bf16 v[168:183], a[116:119], v[196:199], v[168:183]
    v_cvt_pk_bf16_f32 v188, v96, v97
    v_exp_f32 v100, v100
    v_exp_f32 v101, v101
    v_cvt_pk_bf16_f32 v189, v98, v99
    v_mfma_f32_16x16x32_bf16 v[204:207], v[208:211], v[196:199], v[204:207]
    v_exp_f32 v102, v102
    v_exp_f32 v103, v103
    v_cvt_pk_bf16_f32 v190, v100, v101
    v_cvt_pk_bf16_f32 v191, v102, v103
    v_mfma_f32_32x32x16_bf16 v[88:103], a[136:139], a[176:179], v[120:135]
    buffer_load_dwordx4 a[112:115], v18, s[32:35], s64 offen offset:0
    v_exp_f32 v104, v104
    v_exp_f32 v105, v105
    v_exp_f32 v106, v106
    v_exp_f32 v107, v107
    v_mfma_f32_32x32x16_bf16 v[88:103], a[140:143], a[180:183], v[88:103]
    buffer_load_dwordx4 a[116:119], v18, s[32:35], s64 offen offset:1024
    v_cvt_pk_bf16_f32 v192, v104, v105
    v_exp_f32 v108, v108
    v_exp_f32 v109, v109
    v_cvt_pk_bf16_f32 v193, v106, v107
    v_mfma_f32_32x32x16_bf16 v[152:167], a[128:131], v[184:187], v[152:167]
    buffer_load_dwordx4 a[120:123], v18, s[32:35], s64 offen offset:2048
    v_exp_f32 v110, v110
    v_exp_f32 v111, v111
    v_cvt_pk_bf16_f32 v194, v108, v109
    v_exp_f32 v112, v112
    v_mfma_f32_16x16x32_bf16 v[200:203], v[208:211], v[184:187], v[200:203]
    buffer_load_dwordx4 a[124:127], v18, s[32:35], s64 offen offset:3072
    v_exp_f32 v113, v113
    v_cvt_pk_bf16_f32 v195, v110, v111
    v_exp_f32 v114, v114
    v_exp_f32 v115, v115
    v_mfma_f32_32x32x16_bf16 v[152:167], a[132:135], v[188:191], v[152:167]
    s_add_u32 s64, s64, 4096
    s_and_b32 s64, s64, 0x3ffff
    v_cvt_pk_bf16_f32 v196, v112, v113
    v_exp_f32 v116, v116
    v_exp_f32 v117, v117
    v_cvt_pk_bf16_f32 v197, v114, v115
    v_mfma_f32_16x16x32_bf16 v[200:203], v[208:211], v[188:191], v[200:203]
    v_exp_f32 v118, v118
    v_exp_f32 v119, v119
    v_cvt_pk_bf16_f32 v198, v116, v117
    v_cvt_pk_bf16_f32 v199, v118, v119
    v_mfma_f32_32x32x16_bf16 v[104:119], a[136:139], a[184:187], v[136:151]
    buffer_load_dwordx4 v6, s[32:35], s53 offen offset:2048 sc1 lds
    v_exp_f32 v88, v88
    v_exp_f32 v89, v89
    v_exp_f32 v90, v90
    v_exp_f32 v91, v91
    v_mfma_f32_32x32x16_bf16 v[104:119], a[140:143], a[188:191], v[104:119]
    s_mov_b32 exec_hi, 0
    buffer_load_dwordx4 v6, s[32:35], s53 offen offset:3072 sc1 lds
    s_mov_b32 exec_hi, -1
    s_add_u32 s53, s53, 14336
    v_cvt_pk_bf16_f32 v184, v88, v89
    v_exp_f32 v92, v92
    v_exp_f32 v93, v93
    v_cvt_pk_bf16_f32 v185, v90, v91
    v_mfma_f32_32x32x16_bf16 v[168:183], a[128:131], v[192:195], v[168:183]
    v_exp_f32 v94, v94
    v_exp_f32 v95, v95
    v_cvt_pk_bf16_f32 v186, v92, v93
    v_exp_f32 v96, v96
    v_mfma_f32_16x16x32_bf16 v[204:207], v[208:211], v[192:195], v[204:207]
    v_exp_f32 v97, v97
    v_cvt_pk_bf16_f32 v187, v94, v95
    v_exp_f32 v98, v98
    v_exp_f32 v99, v99
    v_mfma_f32_32x32x16_bf16 v[168:183], a[132:135], v[196:199], v[168:183]
    v_cvt_pk_bf16_f32 v188, v96, v97
    v_exp_f32 v100, v100
    v_exp_f32 v101, v101
    v_cvt_pk_bf16_f32 v189, v98, v99
    v_mfma_f32_16x16x32_bf16 v[204:207], v[208:211], v[196:199], v[204:207]
    v_exp_f32 v102, v102
    v_exp_f32 v103, v103
    v_cvt_pk_bf16_f32 v190, v100, v101
    v_cvt_pk_bf16_f32 v191, v102, v103
    v_mfma_f32_32x32x16_bf16 v[88:103], a[152:155], a[176:179], v[120:135]
    buffer_load_dwordx4 a[128:131], v18, s[32:35], s64 offen offset:0
    v_exp_f32 v104, v104
    v_exp_f32 v105, v105
    v_exp_f32 v106, v106
    v_exp_f32 v107, v107
    v_mfma_f32_32x32x16_bf16 v[88:103], a[156:159], a[180:183], v[88:103]
    buffer_load_dwordx4 a[132:135], v18, s[32:35], s64 offen offset:1024
    v_cvt_pk_bf16_f32 v192, v104, v105
    v_exp_f32 v108, v108
    v_exp_f32 v109, v109
    v_cvt_pk_bf16_f32 v193, v106, v107
    v_mfma_f32_32x32x16_bf16 v[152:167], a[144:147], v[184:187], v[152:167]
    buffer_load_dwordx4 a[136:139], v18, s[32:35], s64 offen offset:2048
    v_exp_f32 v110, v110
    v_exp_f32 v111, v111
    v_cvt_pk_bf16_f32 v194, v108, v109
    v_exp_f32 v112, v112
    v_mfma_f32_16x16x32_bf16 v[200:203], v[208:211], v[184:187], v[200:203]
    buffer_load_dwordx4 a[140:143], v18, s[32:35], s64 offen offset:3072
    v_exp_f32 v113, v113
    v_cvt_pk_bf16_f32 v195, v110, v111
    v_exp_f32 v114, v114
    v_exp_f32 v115, v115
    v_mfma_f32_32x32x16_bf16 v[152:167], a[148:151], v[188:191], v[152:167]
    s_add_u32 s64, s64, 4096
    s_and_b32 s64, s64, 0x3ffff
    v_cvt_pk_bf16_f32 v196, v112, v113
    v_exp_f32 v116, v116
    v_exp_f32 v117, v117
    v_cvt_pk_bf16_f32 v197, v114, v115
    v_mfma_f32_16x16x32_bf16 v[200:203], v[208:211], v[188:191], v[200:203]
    v_exp_f32 v118, v118
    v_exp_f32 v119, v119
    v_cvt_pk_bf16_f32 v198, v116, v117
    v_cvt_pk_bf16_f32 v199, v118, v119
    v_mfma_f32_32x32x16_bf16 v[104:119], a[152:155], a[184:187], v[136:151]
    s_add_u32 m0, s55, 47104
    s_nop 0
    buffer_load_dwordx4 v6, s[32:35], s53 offen offset:0 sc1 lds
    v_exp_f32 v88, v88
    v_exp_f32 v89, v89
    v_exp_f32 v90, v90
    v_exp_f32 v91, v91
    v_mfma_f32_32x32x16_bf16 v[104:119], a[156:159], a[188:191], v[104:119]
    buffer_load_dwordx4 v6, s[32:35], s53 offen offset:1024 sc1 lds
    v_cvt_pk_bf16_f32 v184, v88, v89
    v_exp_f32 v92, v92
    v_exp_f32 v93, v93
    v_cvt_pk_bf16_f32 v185, v90, v91
    v_mfma_f32_32x32x16_bf16 v[168:183], a[144:147], v[192:195], v[168:183]
    v_exp_f32 v94, v94
    v_exp_f32 v95, v95
    v_cvt_pk_bf16_f32 v186, v92, v93
    v_exp_f32 v96, v96
    v_mfma_f32_16x16x32_bf16 v[204:207], v[208:211], v[192:195], v[204:207]
    v_exp_f32 v97, v97
    v_cvt_pk_bf16_f32 v187, v94, v95
    v_exp_f32 v98, v98
    v_exp_f32 v99, v99
    v_mfma_f32_32x32x16_bf16 v[168:183], a[148:151], v[196:199], v[168:183]
    v_cvt_pk_bf16_f32 v188, v96, v97
    v_exp_f32 v100, v100
    v_exp_f32 v101, v101
    v_cvt_pk_bf16_f32 v189, v98, v99
    v_mfma_f32_16x16x32_bf16 v[204:207], v[208:211], v[196:199], v[204:207]
    v_exp_f32 v102, v102
    v_exp_f32 v103, v103
    v_cvt_pk_bf16_f32 v190, v100, v101
    v_cvt_pk_bf16_f32 v191, v102, v103
    v_mfma_f32_32x32x16_bf16 v[88:103], a[168:171], a[176:179], v[120:135]
    buffer_load_dwordx4 a[144:147], v18, s[32:35], s64 offen offset:0
    v_exp_f32 v104, v104
    v_exp_f32 v105, v105
    v_exp_f32 v106, v106
    v_exp_f32 v107, v107
    v_mfma_f32_32x32x16_bf16 v[88:103], a[172:175], a[180:183], v[88:103]
    buffer_load_dwordx4 a[148:151], v18, s[32:35], s64 offen offset:1024
    v_cvt_pk_bf16_f32 v192, v104, v105
    v_exp_f32 v108, v108
    v_exp_f32 v109, v109
    v_cvt_pk_bf16_f32 v193, v106, v107
    v_mfma_f32_32x32x16_bf16 v[152:167], a[160:163], v[184:187], v[152:167]
    buffer_load_dwordx4 a[152:155], v18, s[32:35], s64 offen offset:2048
    v_exp_f32 v110, v110
    v_exp_f32 v111, v111
    v_cvt_pk_bf16_f32 v194, v108, v109
    v_exp_f32 v112, v112
    v_mfma_f32_16x16x32_bf16 v[200:203], v[208:211], v[184:187], v[200:203]
    buffer_load_dwordx4 a[156:159], v18, s[32:35], s64 offen offset:3072
    v_exp_f32 v113, v113
    v_cvt_pk_bf16_f32 v195, v110, v111
    v_exp_f32 v114, v114
    v_exp_f32 v115, v115
    v_mfma_f32_32x32x16_bf16 v[152:167], a[164:167], v[188:191], v[152:167]
    s_add_u32 s64, s64, 4096
    s_and_b32 s64, s64, 0x3ffff
    v_cvt_pk_bf16_f32 v196, v112, v113
    v_exp_f32 v116, v116
    v_exp_f32 v117, v117
    v_cvt_pk_bf16_f32 v197, v114, v115
    v_mfma_f32_16x16x32_bf16 v[200:203], v[208:211], v[188:191], v[200:203]
    v_exp_f32 v118, v118
    v_exp_f32 v119, v119
    v_cvt_pk_bf16_f32 v198, v116, v117
    v_cvt_pk_bf16_f32 v199, v118, v119
    v_mfma_f32_32x32x16_bf16 v[104:119], a[168:171], a[184:187], v[136:151]
    buffer_load_dwordx4 v6, s[32:35], s53 offen offset:2048 sc1 lds
    v_exp_f32 v88, v88
    v_exp_f32 v89, v89
    v_exp_f32 v90, v90
    v_exp_f32 v91, v91
    v_mfma_f32_32x32x16_bf16 v[104:119], a[172:175], a[188:191], v[104:119]
    s_mov_b32 exec_hi, 0
    buffer_load_dwordx4 v6, s[32:35], s53 offen offset:3072 sc1 lds
    s_mov_b32 exec_hi, -1
    s_add_u32 s53, s53, 14336
    v_cvt_pk_bf16_f32 v184, v88, v89
    v_exp_f32 v92, v92
    v_exp_f32 v93, v93
    v_cvt_pk_bf16_f32 v185, v90, v91
    v_mfma_f32_32x32x16_bf16 v[168:183], a[160:163], v[192:195], v[168:183]
    v_exp_f32 v94, v94
    v_exp_f32 v95, v95
    v_cvt_pk_bf16_f32 v186, v92, v93
    v_exp_f32 v96, v96
    v_mfma_f32_16x16x32_bf16 v[204:207], v[208:211], v[192:195], v[204:207]
    v_exp_f32 v97, v97
    v_cvt_pk_bf16_f32 v187, v94, v95
    v_exp_f32 v98, v98
    v_exp_f32 v99, v99
    v_mfma_f32_32x32x16_bf16 v[168:183], a[164:167], v[196:199], v[168:183]
    v_cvt_pk_bf16_f32 v188, v96, v97
    v_exp_f32 v100, v100
    v_exp_f32 v101, v101
    v_cvt_pk_bf16_f32 v189, v98, v99
    v_mfma_f32_16x16x32_bf16 v[204:207], v[208:211], v[196:199], v[204:207]
    v_exp_f32 v102, v102
    v_exp_f32 v103, v103
    v_cvt_pk_bf16_f32 v190, v100, v101
    v_cvt_pk_bf16_f32 v191, v102, v103
    s_waitcnt vmcnt(36)
    v_mfma_f32_32x32x16_bf16 v[88:103], a[8:11], a[176:179], v[120:135]
    buffer_load_dwordx4 a[160:163], v18, s[32:35], s64 offen offset:0
    v_exp_f32 v104, v104
    v_exp_f32 v105, v105
    v_exp_f32 v106, v106
    v_exp_f32 v107, v107
    v_mfma_f32_32x32x16_bf16 v[88:103], a[12:15], a[180:183], v[88:103]
    buffer_load_dwordx4 a[164:167], v18, s[32:35], s64 offen offset:1024
    v_cvt_pk_bf16_f32 v192, v104, v105
    v_exp_f32 v108, v108
    v_exp_f32 v109, v109
    v_cvt_pk_bf16_f32 v193, v106, v107
    v_mfma_f32_32x32x16_bf16 v[152:167], a[0:3], v[184:187], v[152:167]
    s_add_u32 s64, s64, 4096
    s_and_b32 s64, s64, 0x3ffff
    v_exp_f32 v110, v110
    v_exp_f32 v111, v111
    v_cvt_pk_bf16_f32 v194, v108, v109
    v_exp_f32 v112, v112
    v_mfma_f32_16x16x32_bf16 v[200:203], v[208:211], v[184:187], v[200:203]
    v_exp_f32 v113, v113
    v_cvt_pk_bf16_f32 v195, v110, v111
    v_exp_f32 v114, v114
    v_exp_f32 v115, v115
    v_mfma_f32_32x32x16_bf16 v[152:167], a[4:7], v[188:191], v[152:167]
    v_cvt_pk_bf16_f32 v196, v112, v113
    v_exp_f32 v116, v116
    v_exp_f32 v117, v117
    v_cvt_pk_bf16_f32 v197, v114, v115
    v_mfma_f32_16x16x32_bf16 v[200:203], v[208:211], v[188:191], v[200:203]
    v_exp_f32 v118, v118
    v_exp_f32 v119, v119
    v_cvt_pk_bf16_f32 v198, v116, v117
    v_cvt_pk_bf16_f32 v199, v118, v119
    v_mfma_f32_32x32x16_bf16 v[104:119], a[8:11], a[184:187], v[136:151]
    s_add_u32 m0, s55, 77824
    s_nop 0
    buffer_load_dwordx4 v6, s[32:35], s53 offen offset:0 sc1 lds
    v_exp_f32 v88, v88
    v_exp_f32 v89, v89
    v_exp_f32 v90, v90
    v_exp_f32 v91, v91
    v_mfma_f32_32x32x16_bf16 v[104:119], a[12:15], a[188:191], v[104:119]
    buffer_load_dwordx4 v6, s[32:35], s53 offen offset:1024 sc1 lds
    v_cvt_pk_bf16_f32 v184, v88, v89
    v_exp_f32 v92, v92
    v_exp_f32 v93, v93
    v_cvt_pk_bf16_f32 v185, v90, v91
    v_mfma_f32_32x32x16_bf16 v[168:183], a[0:3], v[192:195], v[168:183]
    v_exp_f32 v94, v94
    v_exp_f32 v95, v95
    v_cvt_pk_bf16_f32 v186, v92, v93
    v_exp_f32 v96, v96
    v_mfma_f32_16x16x32_bf16 v[204:207], v[208:211], v[192:195], v[204:207]
    v_exp_f32 v97, v97
    v_cvt_pk_bf16_f32 v187, v94, v95
    v_exp_f32 v98, v98
    v_exp_f32 v99, v99
    v_mfma_f32_32x32x16_bf16 v[168:183], a[4:7], v[196:199], v[168:183]
    v_cvt_pk_bf16_f32 v188, v96, v97
    v_exp_f32 v100, v100
    v_exp_f32 v101, v101
    v_cvt_pk_bf16_f32 v189, v98, v99
    v_mfma_f32_16x16x32_bf16 v[204:207], v[208:211], v[196:199], v[204:207]
    v_exp_f32 v102, v102
    v_exp_f32 v103, v103
    v_cvt_pk_bf16_f32 v190, v100, v101
    v_cvt_pk_bf16_f32 v191, v102, v103
    s_waitcnt vmcnt(36)
    v_mfma_f32_32x32x16_bf16 v[88:103], a[24:27], a[176:179], v[120:135]
    v_exp_f32 v104, v104
    v_exp_f32 v105, v105
    v_exp_f32 v106, v106
    v_exp_f32 v107, v107
    v_mfma_f32_32x32x16_bf16 v[88:103], a[28:31], a[180:183], v[88:103]
    v_cvt_pk_bf16_f32 v192, v104, v105
    v_exp_f32 v108, v108
    v_exp_f32 v109, v109
    v_cvt_pk_bf16_f32 v193, v106, v107
    v_mfma_f32_32x32x16_bf16 v[152:167], a[16:19], v[184:187], v[152:167]
    v_exp_f32 v110, v110
    v_exp_f32 v111, v111
    v_cvt_pk_bf16_f32 v194, v108, v109
    v_exp_f32 v112, v112
    v_mfma_f32_16x16x32_bf16 v[200:203], v[208:211], v[184:187], v[200:203]
    v_exp_f32 v113, v113
    v_cvt_pk_bf16_f32 v195, v110, v111
    v_exp_f32 v114, v114
    v_exp_f32 v115, v115
    v_mfma_f32_32x32x16_bf16 v[152:167], a[20:23], v[188:191], v[152:167]
    v_cvt_pk_bf16_f32 v196, v112, v113
    v_exp_f32 v116, v116
    v_exp_f32 v117, v117
    v_cvt_pk_bf16_f32 v197, v114, v115
    v_mfma_f32_16x16x32_bf16 v[200:203], v[208:211], v[188:191], v[200:203]
    v_exp_f32 v118, v118
    v_exp_f32 v119, v119
    v_cvt_pk_bf16_f32 v198, v116, v117
    v_cvt_pk_bf16_f32 v199, v118, v119
    v_mfma_f32_32x32x16_bf16 v[104:119], a[24:27], a[184:187], v[136:151]
    buffer_load_dwordx4 v6, s[32:35], s53 offen offset:2048 sc1 lds
    v_exp_f32 v88, v88
    v_exp_f32 v89, v89
    v_exp_f32 v90, v90
    v_exp_f32 v91, v91
    v_mfma_f32_32x32x16_bf16 v[104:119], a[28:31], a[188:191], v[104:119]
    s_mov_b32 exec_hi, 0
    buffer_load_dwordx4 v6, s[32:35], s53 offen offset:3072 sc1 lds
    s_mov_b32 exec_hi, -1
    s_add_u32 s53, s53, 14336
    v_cvt_pk_bf16_f32 v184, v88, v89
    v_exp_f32 v92, v92
    v_exp_f32 v93, v93
    v_cvt_pk_bf16_f32 v185, v90, v91
    v_mfma_f32_32x32x16_bf16 v[168:183], a[16:19], v[192:195], v[168:183]
    v_exp_f32 v94, v94
    v_exp_f32 v95, v95
    v_cvt_pk_bf16_f32 v186, v92, v93
    v_exp_f32 v96, v96
    v_mfma_f32_16x16x32_bf16 v[204:207], v[208:211], v[192:195], v[204:207]
    v_exp_f32 v97, v97
    v_cvt_pk_bf16_f32 v187, v94, v95
    v_exp_f32 v98, v98
    v_exp_f32 v99, v99
    v_mfma_f32_32x32x16_bf16 v[168:183], a[20:23], v[196:199], v[168:183]
    v_cvt_pk_bf16_f32 v188, v96, v97
    v_exp_f32 v100, v100
    v_exp_f32 v101, v101
    v_cvt_pk_bf16_f32 v189, v98, v99
    v_mfma_f32_16x16x32_bf16 v[204:207], v[208:211], v[196:199], v[204:207]
    v_exp_f32 v102, v102
    v_exp_f32 v103, v103
    v_cvt_pk_bf16_f32 v190, v100, v101
    v_cvt_pk_bf16_f32 v191, v102, v103
    s_waitcnt vmcnt(34)
    v_mfma_f32_32x32x16_bf16 v[88:103], a[40:43], a[176:179], v[120:135]
    v_exp_f32 v104, v104
    v_exp_f32 v105, v105
    v_exp_f32 v106, v106
    v_exp_f32 v107, v107
    v_mfma_f32_32x32x16_bf16 v[88:103], a[44:47], a[180:183], v[88:103]
    v_cvt_pk_bf16_f32 v192, v104, v105
    v_exp_f32 v108, v108
    v_exp_f32 v109, v109
    v_cvt_pk_bf16_f32 v193, v106, v107
    v_mfma_f32_32x32x16_bf16 v[152:167], a[32:35], v[184:187], v[152:167]
    v_exp_f32 v110, v110
    v_exp_f32 v111, v111
    v_cvt_pk_bf16_f32 v194, v108, v109
    v_exp_f32 v112, v112
    v_mfma_f32_16x16x32_bf16 v[200:203], v[208:211], v[184:187], v[200:203]
    v_exp_f32 v113, v113
    v_cvt_pk_bf16_f32 v195, v110, v111
    v_exp_f32 v114, v114
    v_exp_f32 v115, v115
    v_mfma_f32_32x32x16_bf16 v[152:167], a[36:39], v[188:191], v[152:167]
    v_cvt_pk_bf16_f32 v196, v112, v113
    v_exp_f32 v116, v116
    v_exp_f32 v117, v117
    v_cvt_pk_bf16_f32 v197, v114, v115
    v_mfma_f32_16x16x32_bf16 v[200:203], v[208:211], v[188:191], v[200:203]
    v_exp_f32 v118, v118
    v_exp_f32 v119, v119
    v_cvt_pk_bf16_f32 v198, v116, v117
    v_cvt_pk_bf16_f32 v199, v118, v119
    v_mfma_f32_32x32x16_bf16 v[104:119], a[40:43], a[184:187], v[136:151]
    s_add_u32 m0, s55, 108544
    s_nop 0
    buffer_load_dwordx4 v6, s[32:35], s53 offen offset:0 sc1 lds
    v_exp_f32 v88, v88
    v_exp_f32 v89, v89
    v_exp_f32 v90, v90
    v_exp_f32 v91, v91
    v_mfma_f32_32x32x16_bf16 v[104:119], a[44:47], a[188:191], v[104:119]
    buffer_load_dwordx4 v6, s[32:35], s53 offen offset:1024 sc1 lds
    v_cvt_pk_bf16_f32 v184, v88, v89
    v_exp_f32 v92, v92
    v_exp_f32 v93, v93
    v_cvt_pk_bf16_f32 v185, v90, v91
    v_mfma_f32_32x32x16_bf16 v[168:183], a[32:35], v[192:195], v[168:183]
    v_exp_f32 v94, v94
    v_exp_f32 v95, v95
    v_cvt_pk_bf16_f32 v186, v92, v93
    v_exp_f32 v96, v96
    v_mfma_f32_16x16x32_bf16 v[204:207], v[208:211], v[192:195], v[204:207]
    v_exp_f32 v97, v97
    v_cvt_pk_bf16_f32 v187, v94, v95
    v_exp_f32 v98, v98
    v_exp_f32 v99, v99
    v_mfma_f32_32x32x16_bf16 v[168:183], a[36:39], v[196:199], v[168:183]
    v_cvt_pk_bf16_f32 v188, v96, v97
    v_exp_f32 v100, v100
    v_exp_f32 v101, v101
    v_cvt_pk_bf16_f32 v189, v98, v99
    v_mfma_f32_16x16x32_bf16 v[204:207], v[208:211], v[196:199], v[204:207]
    v_exp_f32 v102, v102
    v_exp_f32 v103, v103
    v_cvt_pk_bf16_f32 v190, v100, v101
    v_cvt_pk_bf16_f32 v191, v102, v103
    s_waitcnt vmcnt(28)
    v_mfma_f32_32x32x16_bf16 v[88:103], a[104:107], a[176:179], v[120:135]
    v_exp_f32 v104, v104
    v_exp_f32 v105, v105
    v_exp_f32 v106, v106
    v_exp_f32 v107, v107
    v_mfma_f32_32x32x16_bf16 v[88:103], a[108:111], a[180:183], v[88:103]
    v_cvt_pk_bf16_f32 v192, v104, v105
    v_exp_f32 v108, v108
    v_exp_f32 v109, v109
    v_cvt_pk_bf16_f32 v193, v106, v107
    v_mfma_f32_32x32x16_bf16 v[152:167], a[96:99], v[184:187], v[152:167]
    v_exp_f32 v110, v110
    v_exp_f32 v111, v111
    v_cvt_pk_bf16_f32 v194, v108, v109
    v_exp_f32 v112, v112
    v_mfma_f32_16x16x32_bf16 v[200:203], v[208:211], v[184:187], v[200:203]
    v_exp_f32 v113, v113
    v_cvt_pk_bf16_f32 v195, v110, v111
    v_exp_f32 v114, v114
    v_exp_f32 v115, v115
    v_mfma_f32_32x32x16_bf16 v[152:167], a[100:103], v[188:191], v[152:167]
    v_cvt_pk_bf16_f32 v196, v112, v113
    v_exp_f32 v116, v116
    v_exp_f32 v117, v117
    v_cvt_pk_bf16_f32 v197, v114, v115
    v_mfma_f32_16x16x32_bf16 v[200:203], v[208:211], v[188:191], v[200:203]
    v_exp_f32 v118, v118
    v_exp_f32 v119, v119
    v_cvt_pk_bf16_f32 v198, v116, v117
    v_cvt_pk_bf16_f32 v199, v118, v119
    v_mfma_f32_32x32x16_bf16 v[104:119], a[104:107], a[184:187], v[136:151]
    buffer_load_dwordx4 v6, s[32:35], s53 offen offset:2048 sc1 lds
    v_exp_f32 v88, v88
    v_exp_f32 v89, v89
    v_exp_f32 v90, v90
    v_exp_f32 v91, v91
    v_mfma_f32_32x32x16_bf16 v[104:119], a[108:111], a[188:191], v[104:119]
    s_mov_b32 exec_hi, 0
    buffer_load_dwordx4 v6, s[32:35], s53 offen offset:3072 sc1 lds
    s_mov_b32 exec_hi, -1
    s_add_u32 s53, s53, 14336
    v_cvt_pk_bf16_f32 v184, v88, v89
    v_exp_f32 v92, v92
    v_exp_f32 v93, v93
    v_cvt_pk_bf16_f32 v185, v90, v91
    v_mfma_f32_32x32x16_bf16 v[168:183], a[96:99], v[192:195], v[168:183]
    v_exp_f32 v94, v94
    v_exp_f32 v95, v95
    v_cvt_pk_bf16_f32 v186, v92, v93
    v_exp_f32 v96, v96
    v_mfma_f32_16x16x32_bf16 v[204:207], v[208:211], v[192:195], v[204:207]
    v_exp_f32 v97, v97
    v_cvt_pk_bf16_f32 v187, v94, v95
    v_exp_f32 v98, v98
    v_exp_f32 v99, v99
    v_mfma_f32_32x32x16_bf16 v[168:183], a[100:103], v[196:199], v[168:183]
    v_cvt_pk_bf16_f32 v188, v96, v97
    v_exp_f32 v100, v100
    v_exp_f32 v101, v101
    v_cvt_pk_bf16_f32 v189, v98, v99
    v_mfma_f32_16x16x32_bf16 v[204:207], v[208:211], v[196:199], v[204:207]
    v_exp_f32 v102, v102
    v_exp_f32 v103, v103
    v_cvt_pk_bf16_f32 v190, v100, v101
    v_cvt_pk_bf16_f32 v191, v102, v103
    s_waitcnt vmcnt(24)
    v_mfma_f32_32x32x16_bf16 v[88:103], a[120:123], a[176:179], v[120:135]
    v_exp_f32 v104, v104
    v_exp_f32 v105, v105
    v_exp_f32 v106, v106
    v_exp_f32 v107, v107
    v_mfma_f32_32x32x16_bf16 v[88:103], a[124:127], a[180:183], v[88:103]
    v_cvt_pk_bf16_f32 v192, v104, v105
    v_exp_f32 v108, v108
    v_exp_f32 v109, v109
    v_cvt_pk_bf16_f32 v193, v106, v107
    v_mfma_f32_32x32x16_bf16 v[152:167], a[112:115], v[184:187], v[152:167]
    v_exp_f32 v110, v110
    v_exp_f32 v111, v111
    v_cvt_pk_bf16_f32 v194, v108, v109
    v_exp_f32 v112, v112
    v_mfma_f32_16x16x32_bf16 v[200:203], v[208:211], v[184:187], v[200:203]
    v_exp_f32 v113, v113
    v_cvt_pk_bf16_f32 v195, v110, v111
    v_exp_f32 v114, v114
    v_exp_f32 v115, v115
    v_mfma_f32_32x32x16_bf16 v[152:167], a[116:119], v[188:191], v[152:167]
    v_cvt_pk_bf16_f32 v196, v112, v113
    v_exp_f32 v116, v116
    v_exp_f32 v117, v117
    v_cvt_pk_bf16_f32 v197, v114, v115
    v_mfma_f32_16x16x32_bf16 v[200:203], v[208:211], v[188:191], v[200:203]
    v_exp_f32 v118, v118
    v_exp_f32 v119, v119
    v_cvt_pk_bf16_f32 v198, v116, v117
    v_cvt_pk_bf16_f32 v199, v118, v119
    v_mfma_f32_32x32x16_bf16 v[104:119], a[120:123], a[184:187], v[136:151]
    s_add_u32 m0, s55, 139264
    s_nop 0
    buffer_load_dwordx4 v6, s[32:35], s53 offen offset:0 sc1 lds
    v_exp_f32 v88, v88
    v_exp_f32 v89, v89
    v_exp_f32 v90, v90
    v_exp_f32 v91, v91
    v_mfma_f32_32x32x16_bf16 v[104:119], a[124:127], a[188:191], v[104:119]
    buffer_load_dwordx4 v6, s[32:35], s53 offen offset:1024 sc1 lds
    v_cvt_pk_bf16_f32 v184, v88, v89
    v_exp_f32 v92, v92
    v_exp_f32 v93, v93
    v_cvt_pk_bf16_f32 v185, v90, v91
    v_mfma_f32_32x32x16_bf16 v[168:183], a[112:115], v[192:195], v[168:183]
    v_exp_f32 v94, v94
    v_exp_f32 v95, v95
    v_cvt_pk_bf16_f32 v186, v92, v93
    v_exp_f32 v96, v96
    v_mfma_f32_16x16x32_bf16 v[204:207], v[208:211], v[192:195], v[204:207]
    v_exp_f32 v97, v97
    v_cvt_pk_bf16_f32 v187, v94, v95
    v_exp_f32 v98, v98
    v_exp_f32 v99, v99
    v_mfma_f32_32x32x16_bf16 v[168:183], a[116:119], v[196:199], v[168:183]
    v_cvt_pk_bf16_f32 v188, v96, v97
    v_exp_f32 v100, v100
    v_exp_f32 v101, v101
    v_cvt_pk_bf16_f32 v189, v98, v99
    v_mfma_f32_16x16x32_bf16 v[204:207], v[208:211], v[196:199], v[204:207]
    v_exp_f32 v102, v102
    v_exp_f32 v103, v103
    v_cvt_pk_bf16_f32 v190, v100, v101
    v_cvt_pk_bf16_f32 v191, v102, v103
    s_waitcnt vmcnt(20)
    v_mfma_f32_32x32x16_bf16 v[88:103], a[136:139], a[176:179], v[120:135]
    v_exp_f32 v104, v104
    v_exp_f32 v105, v105
    v_exp_f32 v106, v106
    v_exp_f32 v107, v107
    v_mfma_f32_32x32x16_bf16 v[88:103], a[140:143], a[180:183], v[88:103]
    v_cvt_pk_bf16_f32 v192, v104, v105
    v_exp_f32 v108, v108
    v_exp_f32 v109, v109
    v_cvt_pk_bf16_f32 v193, v106, v107
    v_mfma_f32_32x32x16_bf16 v[152:167], a[128:131], v[184:187], v[152:167]
    v_exp_f32 v110, v110
    v_exp_f32 v111, v111
    v_cvt_pk_bf16_f32 v194, v108, v109
    v_exp_f32 v112, v112
    v_mfma_f32_16x16x32_bf16 v[200:203], v[208:211], v[184:187], v[200:203]
    v_exp_f32 v113, v113
    v_cvt_pk_bf16_f32 v195, v110, v111
    v_exp_f32 v114, v114
    v_exp_f32 v115, v115
    v_mfma_f32_32x32x16_bf16 v[152:167], a[132:135], v[188:191], v[152:167]
    v_cvt_pk_bf16_f32 v196, v112, v113
    v_exp_f32 v116, v116
    v_exp_f32 v117, v117
    v_cvt_pk_bf16_f32 v197, v114, v115
    v_mfma_f32_16x16x32_bf16 v[200:203], v[208:211], v[188:191], v[200:203]
    v_exp_f32 v118, v118
    v_exp_f32 v119, v119
    v_cvt_pk_bf16_f32 v198, v116, v117
    v_cvt_pk_bf16_f32 v199, v118, v119
    v_mfma_f32_32x32x16_bf16 v[104:119], a[136:139], a[184:187], v[136:151]
    buffer_load_dwordx4 v6, s[32:35], s53 offen offset:2048 sc1 lds
    v_exp_f32 v88, v88
    v_exp_f32 v89, v89
    v_exp_f32 v90, v90
    v_exp_f32 v91, v91
    v_mfma_f32_32x32x16_bf16 v[104:119], a[140:143], a[188:191], v[104:119]
    s_mov_b32 exec_hi, 0
    buffer_load_dwordx4 v6, s[32:35], s53 offen offset:3072 sc1 lds
    s_mov_b32 exec_hi, -1
    s_add_u32 s53, s53, 14336
    v_cvt_pk_bf16_f32 v184, v88, v89
    v_exp_f32 v92, v92
    v_exp_f32 v93, v93
    v_cvt_pk_bf16_f32 v185, v90, v91
    v_mfma_f32_32x32x16_bf16 v[168:183], a[128:131], v[192:195], v[168:183]
    v_exp_f32 v94, v94
    v_exp_f32 v95, v95
    v_cvt_pk_bf16_f32 v186, v92, v93
    v_exp_f32 v96, v96
    v_mfma_f32_16x16x32_bf16 v[204:207], v[208:211], v[192:195], v[204:207]
    v_exp_f32 v97, v97
    v_cvt_pk_bf16_f32 v187, v94, v95
    v_exp_f32 v98, v98
    v_exp_f32 v99, v99
    v_mfma_f32_32x32x16_bf16 v[168:183], a[132:135], v[196:199], v[168:183]
    v_cvt_pk_bf16_f32 v188, v96, v97
    v_exp_f32 v100, v100
    v_exp_f32 v101, v101
    v_cvt_pk_bf16_f32 v189, v98, v99
    v_mfma_f32_16x16x32_bf16 v[204:207], v[208:211], v[196:199], v[204:207]
    v_exp_f32 v102, v102
    v_exp_f32 v103, v103
    v_cvt_pk_bf16_f32 v190, v100, v101
    v_cvt_pk_bf16_f32 v191, v102, v103
    s_waitcnt vmcnt(16)
    v_mfma_f32_32x32x16_bf16 v[88:103], a[152:155], a[176:179], v[120:135]
    v_exp_f32 v104, v104
    v_exp_f32 v105, v105
    v_exp_f32 v106, v106
    v_exp_f32 v107, v107
    v_mfma_f32_32x32x16_bf16 v[88:103], a[156:159], a[180:183], v[88:103]
    v_cvt_pk_bf16_f32 v192, v104, v105
    v_exp_f32 v108, v108
    v_exp_f32 v109, v109
    v_cvt_pk_bf16_f32 v193, v106, v107
    v_mfma_f32_32x32x16_bf16 v[152:167], a[144:147], v[184:187], v[152:167]
    v_exp_f32 v110, v110
    v_exp_f32 v111, v111
    v_cvt_pk_bf16_f32 v194, v108, v109
    v_exp_f32 v112, v112
    v_mfma_f32_16x16x32_bf16 v[200:203], v[208:211], v[184:187], v[200:203]
    v_exp_f32 v113, v113
    v_cvt_pk_bf16_f32 v195, v110, v111
    v_exp_f32 v114, v114
    v_exp_f32 v115, v115
    v_mfma_f32_32x32x16_bf16 v[152:167], a[148:151], v[188:191], v[152:167]
    v_cvt_pk_bf16_f32 v196, v112, v113
    v_exp_f32 v116, v116
    v_exp_f32 v117, v117
    v_cvt_pk_bf16_f32 v197, v114, v115
    v_mfma_f32_16x16x32_bf16 v[200:203], v[208:211], v[188:191], v[200:203]
    v_exp_f32 v118, v118
    v_exp_f32 v119, v119
    v_cvt_pk_bf16_f32 v198, v116, v117
    v_cvt_pk_bf16_f32 v199, v118, v119
    v_mfma_f32_32x32x16_bf16 v[104:119], a[152:155], a[184:187], v[136:151]
    v_exp_f32 v88, v88
    v_exp_f32 v89, v89
    v_exp_f32 v90, v90
    v_exp_f32 v91, v91
    v_mfma_f32_32x32x16_bf16 v[104:119], a[156:159], a[188:191], v[104:119]
    v_cvt_pk_bf16_f32 v184, v88, v89
    v_exp_f32 v92, v92
    v_exp_f32 v93, v93
    v_cvt_pk_bf16_f32 v185, v90, v91
    v_mfma_f32_32x32x16_bf16 v[168:183], a[144:147], v[192:195], v[168:183]
    v_exp_f32 v94, v94
    v_exp_f32 v95, v95
    v_cvt_pk_bf16_f32 v186, v92, v93
    v_exp_f32 v96, v96
    v_mfma_f32_16x16x32_bf16 v[204:207], v[208:211], v[192:195], v[204:207]
    v_exp_f32 v97, v97
    v_cvt_pk_bf16_f32 v187, v94, v95
    v_exp_f32 v98, v98
    v_exp_f32 v99, v99
    v_mfma_f32_32x32x16_bf16 v[168:183], a[148:151], v[196:199], v[168:183]
    v_cvt_pk_bf16_f32 v188, v96, v97
    v_exp_f32 v100, v100
    v_exp_f32 v101, v101
    v_cvt_pk_bf16_f32 v189, v98, v99
    v_mfma_f32_16x16x32_bf16 v[204:207], v[208:211], v[196:199], v[204:207]
    v_exp_f32 v102, v102
    v_exp_f32 v103, v103
    v_cvt_pk_bf16_f32 v190, v100, v101
    v_cvt_pk_bf16_f32 v191, v102, v103
    s_waitcnt vmcnt(12)
    v_mfma_f32_32x32x16_bf16 v[152:167], a[160:163], v[184:187], v[152:167]
    v_exp_f32 v104, v104
    v_exp_f32 v105, v105
    v_exp_f32 v106, v106
    v_exp_f32 v107, v107
    v_cvt_pk_bf16_f32 v192, v104, v105
    v_exp_f32 v108, v108
    v_mfma_f32_16x16x32_bf16 v[200:203], v[208:211], v[184:187], v[200:203]
    v_exp_f32 v109, v109
    v_cvt_pk_bf16_f32 v193, v106, v107
    v_exp_f32 v110, v110
    v_exp_f32 v111, v111
    v_cvt_pk_bf16_f32 v194, v108, v109
    v_exp_f32 v112, v112
    v_mfma_f32_32x32x16_bf16 v[152:167], a[164:167], v[188:191], v[152:167]
    v_exp_f32 v113, v113
    v_cvt_pk_bf16_f32 v195, v110, v111
    v_exp_f32 v114, v114
    v_exp_f32 v115, v115
    v_cvt_pk_bf16_f32 v196, v112, v113
    v_exp_f32 v116, v116
    v_mfma_f32_16x16x32_bf16 v[200:203], v[208:211], v[188:191], v[200:203]
    v_exp_f32 v117, v117
    v_cvt_pk_bf16_f32 v197, v114, v115
    v_exp_f32 v118, v118
    v_exp_f32 v119, v119
    v_cvt_pk_bf16_f32 v198, v116, v117
    v_cvt_pk_bf16_f32 v199, v118, v119
    v_mfma_f32_32x32x16_bf16 v[168:183], a[160:163], v[192:195], v[168:183]
    v_mfma_f32_16x16x32_bf16 v[204:207], v[208:211], v[192:195], v[204:207]
    v_mfma_f32_32x32x16_bf16 v[168:183], a[164:167], v[196:199], v[168:183]
    v_mfma_f32_16x16x32_bf16 v[204:207], v[208:211], v[196:199], v[204:207]
    s_mul_i32 s56, s6, 720896
    s_lshr_b32 s57, s65, 5
    s_add_u32 s56, s56, s57
    s_lshl_b32 s57, s4, 12
    s_add_u32 s56, s56, s57
    s_add_u32 s56, s56, 25165824
    v_bfe_u32 v216, v1, 4, 1
    v_lshlrev_b32 v216, 10, v216
    v_lshrrev_b32 v217, 5, v1
    v_lshl_or_b32 v216, v217, 8, v216
    v_and_b32 v217, 15, v1
    v_lshl_or_b32 v216, v217, 4, v216
    v_max_f32 v212, v200, v204
    v_mul_f32 v214, 0, v200
    v_mul_f32 v215, 0, v204
    v_pk_fma_f32 v[214:215], v[152:153], 0, v[214:215]
    v_pk_fma_f32 v[214:215], v[154:155], 0, v[214:215]
    v_pk_fma_f32 v[214:215], v[156:157], 0, v[214:215]
    v_pk_fma_f32 v[214:215], v[158:159], 0, v[214:215]
    v_pk_fma_f32 v[214:215], v[160:161], 0, v[214:215]
    v_pk_fma_f32 v[214:215], v[162:163], 0, v[214:215]
    v_pk_fma_f32 v[214:215], v[164:165], 0, v[214:215]
    v_pk_fma_f32 v[214:215], v[166:167], 0, v[214:215]
    v_pk_fma_f32 v[214:215], v[168:169], 0, v[214:215]
    v_pk_fma_f32 v[214:215], v[170:171], 0, v[214:215]
    v_pk_fma_f32 v[214:215], v[172:173], 0, v[214:215]
    v_pk_fma_f32 v[214:215], v[174:175], 0, v[214:215]
    v_pk_fma_f32 v[214:215], v[176:177], 0, v[214:215]
    v_pk_fma_f32 v[214:215], v[178:179], 0, v[214:215]
    v_pk_fma_f32 v[214:215], v[180:181], 0, v[214:215]
    v_pk_fma_f32 v[214:215], v[182:183], 0, v[214:215]
    v_add_f32 v212, v212, v214
    v_add_f32 v212, v212, v215
    v_cmp_nge_f32 vcc, 1317011456, v212
    s_nop 4
    s_cbranch_vccz ATT_OK_10
    s_waitcnt vmcnt(0)
    v_mov_b32 v220, 4284592614
    v_mov_b32 v221, 4284592614
    v_mov_b32 v152, 0
    v_mov_b32 v153, 0
    v_mov_b32 v154, 0
    v_mov_b32 v155, 0
    v_mov_b32 v156, 0
    v_mov_b32 v157, 0
    v_mov_b32 v158, 0
    v_mov_b32 v159, 0
    v_mov_b32 v160, 0
    v_mov_b32 v161, 0
    v_mov_b32 v162, 0
    v_mov_b32 v163, 0
    v_mov_b32 v164, 0
    v_mov_b32 v165, 0
    v_mov_b32 v166, 0
    v_mov_b32 v167, 0
    v_mov_b32 v168, 0
    v_mov_b32 v169, 0
    v_mov_b32 v170, 0
    v_mov_b32 v171, 0
    v_mov_b32 v172, 0
    v_mov_b32 v173, 0
    v_mov_b32 v174, 0
    v_mov_b32 v175, 0
    v_mov_b32 v176, 0
    v_mov_b32 v177, 0
    v_mov_b32 v178, 0
    v_mov_b32 v179, 0
    v_mov_b32 v180, 0
    v_mov_b32 v181, 0
    v_mov_b32 v182, 0
    v_mov_b32 v183, 0
    v_mov_b32 v200, 0
    v_mov_b32 v201, 0
    v_mov_b32 v202, 0
    v_mov_b32 v203, 0
    v_mov_b32 v204, 0
    v_mov_b32 v205, 0
    v_mov_b32 v206, 0
    v_mov_b32 v207, 0
    s_add_u32 s58, s65, 258048
    s_mov_b32 s64, s65
    s_mov_b32 s59, 64
    s_nop 15
    s_nop 3
ATT_FB_11:
    buffer_load_dwordx4 a[0:3], v20, s[32:35], s58 offen offset:2048 sc1
    buffer_load_dwordx4 a[8:11], v20, s[32:35], s64 offen offset:0 sc1
    buffer_load_dwordx4 a[4:7], v20, s[32:35], s58 offen offset:3072 sc1
    buffer_load_dwordx4 a[12:15], v20, s[32:35], s64 offen offset:1024 sc1
    s_mov_b32 s58, s64
    s_add_u32 s64, s64, 4096
    s_waitcnt vmcnt(0)
    v_mfma_f32_32x32x16_bf16 v[88:103], a[0:3], a[176:179], 0
    v_mfma_f32_32x32x16_bf16 v[88:103], a[4:7], a[180:183], v[88:103]
    s_nop 11
    v_max3_f32 v212, v88, v89, v90
    v_max3_f32 v212, v91, v92, v212
    v_max3_f32 v212, v93, v94, v212
    v_max3_f32 v212, v95, v96, v212
    v_max3_f32 v212, v97, v98, v212
    v_max3_f32 v212, v99, v100, v212
    v_max3_f32 v212, v101, v102, v212
    v_max_f32 v212, v103, v212
    v_mov_b32 v213, v212
    s_nop 1
    v_permlane32_swap_b32 v212, v213
    v_max_f32 v212, v212, v213
    v_max_f32 v212, v212, v220
    v_sub_f32 v213, v220, v212
    v_exp_f32 v213, v213
    v_mov_b32 v220, v212
    v_mul_f32 v152, v213, v152
    v_mul_f32 v153, v213, v153
    v_mul_f32 v154, v213, v154
    v_mul_f32 v155, v213, v155
    v_mul_f32 v156, v213, v156
    v_mul_f32 v157, v213, v157
    v_mul_f32 v158, v213, v158
    v_mul_f32 v159, v213, v159
    v_mul_f32 v160, v213, v160
    v_mul_f32 v161, v213, v161
    v_mul_f32 v162, v213, v162
    v_mul_f32 v163, v213, v163
    v_mul_f32 v164, v213, v164
    v_mul_f32 v165, v213, v165
    v_mul_f32 v166, v213, v166
    v_mul_f32 v167, v213, v167
    v_mul_f32 v200, v213, v200
    v_sub_f32 v88, v88, v220
    v_sub_f32 v89, v89, v220
    v_sub_f32 v90, v90, v220
    v_sub_f32 v91, v91, v220
    v_sub_f32 v92, v92, v220
    v_sub_f32 v93, v93, v220
    v_sub_f32 v94, v94, v220
    v_sub_f32 v95, v95, v220
    v_sub_f32 v96, v96, v220
    v_sub_f32 v97, v97, v220
    v_sub_f32 v98, v98, v220
    v_sub_f32 v99, v99, v220
    v_sub_f32 v100, v100, v220
    v_sub_f32 v101, v101, v220
    v_sub_f32 v102, v102, v220
    v_sub_f32 v103, v103, v220
    v_exp_f32 v88, v88
    v_exp_f32 v89, v89
    v_exp_f32 v90, v90
    v_exp_f32 v91, v91
    v_exp_f32 v92, v92
    v_exp_f32 v93, v93
    v_exp_f32 v94, v94
    v_exp_f32 v95, v95
    v_exp_f32 v96, v96
    v_exp_f32 v97, v97
    v_exp_f32 v98, v98
    v_exp_f32 v99, v99
    v_exp_f32 v100, v100
    v_exp_f32 v101, v101
    v_exp_f32 v102, v102
    v_exp_f32 v103, v103
    v_cvt_pk_bf16_f32 v184, v88, v89
    v_cvt_pk_bf16_f32 v185, v90, v91
    v_cvt_pk_bf16_f32 v186, v92, v93
    v_cvt_pk_bf16_f32 v187, v94, v95
    v_cvt_pk_bf16_f32 v188, v96, v97
    v_cvt_pk_bf16_f32 v189, v98, v99
    v_cvt_pk_bf16_f32 v190, v100, v101
    v_cvt_pk_bf16_f32 v191, v102, v103
    v_mfma_f32_32x32x16_bf16 v[152:167], a[8:11], v[184:187], v[152:167]
    v_mfma_f32_16x16x32_bf16 v[200:203], v[208:211], v[184:187], v[200:203]
    v_mfma_f32_32x32x16_bf16 v[152:167], a[12:15], v[188:191], v[152:167]
    v_mfma_f32_16x16x32_bf16 v[200:203], v[208:211], v[188:191], v[200:203]
    v_mfma_f32_32x32x16_bf16 v[104:119], a[0:3], a[184:187], 0
    v_mfma_f32_32x32x16_bf16 v[104:119], a[4:7], a[188:191], v[104:119]
    s_nop 11
    v_max3_f32 v212, v104, v105, v106
    v_max3_f32 v212, v107, v108, v212
    v_max3_f32 v212, v109, v110, v212
    v_max3_f32 v212, v111, v112, v212
    v_max3_f32 v212, v113, v114, v212
    v_max3_f32 v212, v115, v116, v212
    v_max3_f32 v212, v117, v118, v212
    v_max_f32 v212, v119, v212
    v_mov_b32 v213, v212
    s_nop 1
    v_permlane32_swap_b32 v212, v213
    v_max_f32 v212, v212, v213
    v_max_f32 v212, v212, v221
    v_sub_f32 v213, v221, v212
    v_exp_f32 v213, v213
    v_mov_b32 v221, v212
    v_mul_f32 v168, v213, v168
    v_mul_f32 v169, v213, v169
    v_mul_f32 v170, v213, v170
    v_mul_f32 v171, v213, v171
    v_mul_f32 v172, v213, v172
    v_mul_f32 v173, v213, v173
    v_mul_f32 v174, v213, v174
    v_mul_f32 v175, v213, v175
    v_mul_f32 v176, v213, v176
    v_mul_f32 v177, v213, v177
    v_mul_f32 v178, v213, v178
    v_mul_f32 v179, v213, v179
    v_mul_f32 v180, v213, v180
    v_mul_f32 v181, v213, v181
    v_mul_f32 v182, v213, v182
    v_mul_f32 v183, v213, v183
    v_mul_f32 v204, v213, v204
    v_sub_f32 v104, v104, v221
    v_sub_f32 v105, v105, v221
    v_sub_f32 v106, v106, v221
    v_sub_f32 v107, v107, v221
    v_sub_f32 v108, v108, v221
    v_sub_f32 v109, v109, v221
    v_sub_f32 v110, v110, v221
    v_sub_f32 v111, v111, v221
    v_sub_f32 v112, v112, v221
    v_sub_f32 v113, v113, v221
    v_sub_f32 v114, v114, v221
    v_sub_f32 v115, v115, v221
    v_sub_f32 v116, v116, v221
    v_sub_f32 v117, v117, v221
    v_sub_f32 v118, v118, v221
    v_sub_f32 v119, v119, v221
    v_exp_f32 v104, v104
    v_exp_f32 v105, v105
    v_exp_f32 v106, v106
    v_exp_f32 v107, v107
    v_exp_f32 v108, v108
    v_exp_f32 v109, v109
    v_exp_f32 v110, v110
    v_exp_f32 v111, v111
    v_exp_f32 v112, v112
    v_exp_f32 v113, v113
    v_exp_f32 v114, v114
    v_exp_f32 v115, v115
    v_exp_f32 v116, v116
    v_exp_f32 v117, v117
    v_exp_f32 v118, v118
    v_exp_f32 v119, v119
    v_cvt_pk_bf16_f32 v192, v104, v105
    v_cvt_pk_bf16_f32 v193, v106, v107
    v_cvt_pk_bf16_f32 v194, v108, v109
    v_cvt_pk_bf16_f32 v195, v110, v111
    v_cvt_pk_bf16_f32 v196, v112, v113
    v_cvt_pk_bf16_f32 v197, v114, v115
    v_cvt_pk_bf16_f32 v198, v116, v117
    v_cvt_pk_bf16_f32 v199, v118, v119
    v_mfma_f32_32x32x16_bf16 v[168:183], a[8:11], v[192:195], v[168:183]
    v_mfma_f32_16x16x32_bf16 v[204:207], v[208:211], v[192:195], v[204:207]
    v_mfma_f32_32x32x16_bf16 v[168:183], a[12:15], v[196:199], v[168:183]
    v_mfma_f32_16x16x32_bf16 v[204:207], v[208:211], v[196:199], v[204:207]
    s_nop 15
    s_nop 3
    s_sub_u32 s59, s59, 1
    s_cmp_lg_u32 s59, 0
    s_cbranch_scc1 ATT_FB_11
    s_nop 15
    s_nop 3
ATT_OK_10:
    v_rcp_f32 v212, v200
    v_rcp_f32 v214, v204
    v_pk_mul_f32 v[152:153], v[152:153], v[212:213] op_sel_hi:[1,0]
    v_pk_mul_f32 v[154:155], v[154:155], v[212:213] op_sel_hi:[1,0]
    v_pk_mul_f32 v[156:157], v[156:157], v[212:213] op_sel_hi:[1,0]
    v_pk_mul_f32 v[158:159], v[158:159], v[212:213] op_sel_hi:[1,0]
    v_pk_mul_f32 v[160:161], v[160:161], v[212:213] op_sel_hi:[1,0]
    v_pk_mul_f32 v[162:163], v[162:163], v[212:213] op_sel_hi:[1,0]
    v_pk_mul_f32 v[164:165], v[164:165], v[212:213] op_sel_hi:[1,0]
    v_pk_mul_f32 v[166:167], v[166:167], v[212:213] op_sel_hi:[1,0]
    v_cvt_pk_bf16_f32 v184, v152, v153
    v_cvt_pk_bf16_f32 v185, v154, v155
    v_cvt_pk_bf16_f32 v186, v156, v157
    v_cvt_pk_bf16_f32 v187, v158, v159
    v_cvt_pk_bf16_f32 v188, v160, v161
    v_cvt_pk_bf16_f32 v189, v162, v163
    v_cvt_pk_bf16_f32 v190, v164, v165
    v_cvt_pk_bf16_f32 v191, v166, v167
    v_permlane32_swap_b32 v184, v186
    v_permlane32_swap_b32 v185, v187
    v_permlane32_swap_b32 v188, v190
    v_permlane32_swap_b32 v189, v191
    buffer_store_dwordx4 v[184:187], v216, s[32:35], s56 offen offset:0 sc1
    buffer_store_dwordx4 v[188:191], v216, s[32:35], s56 offen offset:512 sc1
    v_pk_mul_f32 v[168:169], v[168:169], v[214:215] op_sel_hi:[1,0]
    v_pk_mul_f32 v[170:171], v[170:171], v[214:215] op_sel_hi:[1,0]
    v_pk_mul_f32 v[172:173], v[172:173], v[214:215] op_sel_hi:[1,0]
    v_pk_mul_f32 v[174:175], v[174:175], v[214:215] op_sel_hi:[1,0]
    v_pk_mul_f32 v[176:177], v[176:177], v[214:215] op_sel_hi:[1,0]
    v_pk_mul_f32 v[178:179], v[178:179], v[214:215] op_sel_hi:[1,0]
    v_pk_mul_f32 v[180:181], v[180:181], v[214:215] op_sel_hi:[1,0]
    v_pk_mul_f32 v[182:183], v[182:183], v[214:215] op_sel_hi:[1,0]
    v_cvt_pk_bf16_f32 v192, v168, v169
    v_cvt_pk_bf16_f32 v193, v170, v171
    v_cvt_pk_bf16_f32 v194, v172, v173
    v_cvt_pk_bf16_f32 v195, v174, v175
    v_cvt_pk_bf16_f32 v196, v176, v177
    v_cvt_pk_bf16_f32 v197, v178, v179
    v_cvt_pk_bf16_f32 v198, v180, v181
    v_cvt_pk_bf16_f32 v199, v182, v183
    v_permlane32_swap_b32 v192, v194
    v_permlane32_swap_b32 v193, v195
    v_permlane32_swap_b32 v196, v198
    v_permlane32_swap_b32 v197, v199
    buffer_store_dwordx4 v[192:195], v216, s[32:35], s56 offen offset:2048 sc1
    buffer_store_dwordx4 v[196:199], v216, s[32:35], s56 offen offset:2560 sc1
    v_accvgpr_read_b32 v13, a196
    s_lshl_b32 s56, s5, 12
    v_add_u32 v200, s56, v13
    v_subrev_u32 v206, s56, v13
    v_add_u32 v206, 4096, v206
    v_xor_b32 v203, 64, v200
    v_add_u32 v201, 0x10000, v200
    v_add_u32 v202, 0x20000, v200
    v_add_u32 v204, 0x10000, v203
    v_add_u32 v205, 0x20000, v203
    v_xor_b32 v209, 64, v206
    v_add_u32 v207, 0x10000, v206
    v_add_u32 v208, 0x20000, v206
    v_add_u32 v210, 0x10000, v209
    v_add_u32 v211, 0x20000, v209
    s_lshl_b32 s56, s5, 12
    v_lshlrev_b32 v22, 3, v1
    v_add_u32 v19, s56, v22
    v_add_u32 v22, 3072, v22
    v_add_u32 v20, 0x10000, v19
    v_add_u32 v21, 0x20000, v19
    v_add_u32 v23, 0x10000, v22
    v_add_u32 v24, 0x20000, v22
    s_barrier
    ds_read_b64_tr_b16 a[16:17], v19 offset:16384
    ds_read_b64_tr_b16 a[18:19], v19 offset:16896
    ds_read_b128 a[0:3], v200 offset:0
    ds_read_b128 a[4:7], v200 offset:2048
    ds_read_b128 a[8:11], v206 offset:0
    ds_read_b128 a[12:15], v206 offset:2048
    ds_read_b64_tr_b16 a[20:21], v19 offset:17408
    ds_read_b64_tr_b16 a[22:23], v19 offset:17920
    ds_read_b64_tr_b16 a[24:25], v19 offset:18432
    ds_read_b64_tr_b16 a[26:27], v19 offset:18944
    ds_read_b64_tr_b16 a[28:29], v22 offset:16384
    ds_read_b64_tr_b16 a[30:31], v22 offset:16896
    s_waitcnt lgkmcnt(0)
    v_mfma_f32_16x16x32_bf16 v[88:91], a[16:19], a[0:3], 0
    ds_read_b64_tr_b16 a[64:65], v19 offset:23552
    v_mfma_f32_16x16x32_bf16 v[92:95], a[16:19], a[4:7], 0
    ds_read_b64_tr_b16 a[66:67], v19 offset:24064
    v_mfma_f32_16x16x32_bf16 v[96:99], a[16:19], a[8:11], 0
    ds_read_b128 a[48:51], v203 offset:0
    v_mfma_f32_16x16x32_bf16 v[100:103], a[16:19], a[12:15], 0
    ds_read_b128 a[52:55], v203 offset:2048
    v_mfma_f32_16x16x32_bf16 v[104:107], a[20:23], a[0:3], 0
    ds_read_b128 a[56:59], v209 offset:0
    v_mfma_f32_16x16x32_bf16 v[108:111], a[20:23], a[4:7], 0
    ds_read_b128 a[60:63], v209 offset:2048
    v_mfma_f32_16x16x32_bf16 v[112:115], a[20:23], a[8:11], 0
    ds_read_b64_tr_b16 a[68:69], v19 offset:24576
    v_mfma_f32_16x16x32_bf16 v[116:119], a[20:23], a[12:15], 0
    ds_read_b64_tr_b16 a[70:71], v19 offset:25088
    v_mfma_f32_16x16x32_bf16 v[120:123], a[24:27], a[0:3], 0
    ds_read_b64_tr_b16 a[72:73], v19 offset:25600
    v_mfma_f32_16x16x32_bf16 v[124:127], a[24:27], a[4:7], 0
    ds_read_b64_tr_b16 a[74:75], v19 offset:26112
    v_mfma_f32_16x16x32_bf16 v[128:131], a[24:27], a[8:11], 0
    ds_read_b64_tr_b16 a[76:77], v22 offset:23552
    v_mfma_f32_16x16x32_bf16 v[132:135], a[24:27], a[12:15], 0
    ds_read_b64_tr_b16 a[78:79], v22 offset:24064
    v_mfma_f32_16x16x32_bf16 v[136:139], a[28:31], a[0:3], 0
    v_mfma_f32_16x16x32_bf16 v[140:143], a[28:31], a[4:7], 0
    s_waitcnt lgkmcnt(0)
    s_barrier
    v_mfma_f32_16x16x32_bf16 v[88:91], a[64:67], a[48:51], v[88:91]
    ds_read_b64_tr_b16 a[16:17], v19 offset:47104
    s_add_u32 m0, s54, 0
    v_mfma_f32_16x16x32_bf16 v[92:95], a[64:67], a[52:55], v[92:95]
    ds_read_b64_tr_b16 a[18:19], v19 offset:47616
    buffer_load_dwordx4 v2, s[20:23], s52 offen offset:0 lds
    v_mfma_f32_16x16x32_bf16 v[96:99], a[64:67], a[56:59], v[96:99]
    ds_read_b128 a[0:3], v200 offset:30720
    v_mfma_f32_16x16x32_bf16 v[100:103], a[64:67], a[60:63], v[100:103]
    ds_read_b128 a[4:7], v200 offset:32768
    v_mfma_f32_16x16x32_bf16 v[104:107], a[68:71], a[48:51], v[104:107]
    ds_read_b128 a[8:11], v206 offset:30720
    v_mfma_f32_16x16x32_bf16 v[108:111], a[68:71], a[52:55], v[108:111]
    ds_read_b128 a[12:15], v206 offset:32768
    buffer_load_dwordx4 v3, s[20:23], s52 offen offset:1024 lds
    v_mfma_f32_16x16x32_bf16 v[112:115], a[68:71], a[56:59], v[112:115]
    ds_read_b64_tr_b16 a[20:21], v19 offset:48128
    v_mfma_f32_16x16x32_bf16 v[116:119], a[68:71], a[60:63], v[116:119]
    ds_read_b64_tr_b16 a[22:23], v19 offset:48640
    v_mfma_f32_16x16x32_bf16 v[120:123], a[72:75], a[48:51], v[120:123]
    ds_read_b64_tr_b16 a[24:25], v19 offset:49152
    buffer_load_dwordx4 v4, s[20:23], s52 offen offset:2048 lds
    v_mfma_f32_16x16x32_bf16 v[124:127], a[72:75], a[52:55], v[124:127]
    ds_read_b64_tr_b16 a[26:27], v19 offset:49664
    v_mfma_f32_16x16x32_bf16 v[128:131], a[72:75], a[56:59], v[128:131]
    ds_read_b64_tr_b16 a[28:29], v22 offset:47104
    v_mfma_f32_16x16x32_bf16 v[132:135], a[72:75], a[60:63], v[132:135]
    ds_read_b64_tr_b16 a[30:31], v22 offset:47616
    v_mfma_f32_16x16x32_bf16 v[136:139], a[76:79], a[48:51], v[136:139]
    buffer_load_dwordx4 v5, s[20:23], s52 offen offset:3072 lds
    s_add_u32 s52, s52, 128
    v_mfma_f32_16x16x32_bf16 v[140:143], a[76:79], a[52:55], v[140:143]
    s_waitcnt lgkmcnt(0)
    v_mfma_f32_16x16x32_bf16 v[88:91], a[16:19], a[0:3], v[88:91]
    ds_read_b64_tr_b16 a[64:65], v19 offset:54272
    s_add_u32 m0, s55, 16384
    v_mfma_f32_16x16x32_bf16 v[92:95], a[16:19], a[4:7], v[92:95]
    ds_read_b64_tr_b16 a[66:67], v19 offset:54784
    buffer_load_dwordx4 v6, s[32:35], s53 offen offset:0 sc1 lds
    v_mfma_f32_16x16x32_bf16 v[96:99], a[16:19], a[8:11], v[96:99]
    ds_read_b128 a[48:51], v203 offset:30720
    v_mfma_f32_16x16x32_bf16 v[100:103], a[16:19], a[12:15], v[100:103]
    ds_read_b128 a[52:55], v203 offset:32768
    v_mfma_f32_16x16x32_bf16 v[104:107], a[20:23], a[0:3], v[104:107]
    ds_read_b128 a[56:59], v209 offset:30720
    v_mfma_f32_16x16x32_bf16 v[108:111], a[20:23], a[4:7], v[108:111]
    ds_read_b128 a[60:63], v209 offset:32768
    buffer_load_dwordx4 v6, s[32:35], s53 offen offset:1024 sc1 lds
    v_mfma_f32_16x16x32_bf16 v[112:115], a[20:23], a[8:11], v[112:115]
    ds_read_b64_tr_b16 a[68:69], v19 offset:55296
    v_mfma_f32_16x16x32_bf16 v[116:119], a[20:23], a[12:15], v[116:119]
    ds_read_b64_tr_b16 a[70:71], v19 offset:55808
    v_mfma_f32_16x16x32_bf16 v[120:123], a[24:27], a[0:3], v[120:123]
    ds_read_b64_tr_b16 a[72:73], v19 offset:56320
    buffer_load_dwordx4 v6, s[32:35], s53 offen offset:2048 sc1 lds
    v_mfma_f32_16x16x32_bf16 v[124:127], a[24:27], a[4:7], v[124:127]
    ds_read_b64_tr_b16 a[74:75], v19 offset:56832
    v_mfma_f32_16x16x32_bf16 v[128:131], a[24:27], a[8:11], v[128:131]
    ds_read_b64_tr_b16 a[76:77], v22 offset:54272
    v_mfma_f32_16x16x32_bf16 v[132:135], a[24:27], a[12:15], v[132:135]
    ds_read_b64_tr_b16 a[78:79], v22 offset:54784
    v_mfma_f32_16x16x32_bf16 v[136:139], a[28:31], a[0:3], v[136:139]
    s_mov_b32 exec_hi, 0
    buffer_load_dwordx4 v6, s[32:35], s53 offen offset:3072 sc1 lds
    s_mov_b32 exec_hi, -1
    s_add_u32 s53, s53, 14336
    v_mfma_f32_16x16x32_bf16 v[140:143], a[28:31], a[4:7], v[140:143]
    s_waitcnt vmcnt(20) lgkmcnt(0)
    s_barrier
    v_mfma_f32_16x16x32_bf16 v[88:91], a[64:67], a[48:51], v[88:91]
    ds_read_b64_tr_b16 a[16:17], v20 offset:12288
    s_add_u32 m0, s54, 30720
    v_mfma_f32_16x16x32_bf16 v[92:95], a[64:67], a[52:55], v[92:95]
    ds_read_b64_tr_b16 a[18:19], v20 offset:12800
    buffer_load_dwordx4 v2, s[20:23], s52 offen offset:0 lds
    v_mfma_f32_16x16x32_bf16 v[96:99], a[64:67], a[56:59], v[96:99]
    ds_read_b128 a[0:3], v200 offset:61440
    v_mfma_f32_16x16x32_bf16 v[100:103], a[64:67], a[60:63], v[100:103]
    ds_read_b128 a[4:7], v200 offset:63488
    v_mfma_f32_16x16x32_bf16 v[104:107], a[68:71], a[48:51], v[104:107]
    ds_read_b128 a[8:11], v206 offset:61440
    v_mfma_f32_16x16x32_bf16 v[108:111], a[68:71], a[52:55], v[108:111]
    ds_read_b128 a[12:15], v206 offset:63488
    buffer_load_dwordx4 v3, s[20:23], s52 offen offset:1024 lds
    v_mfma_f32_16x16x32_bf16 v[112:115], a[68:71], a[56:59], v[112:115]
    ds_read_b64_tr_b16 a[20:21], v20 offset:13312
    v_mfma_f32_16x16x32_bf16 v[116:119], a[68:71], a[60:63], v[116:119]
    ds_read_b64_tr_b16 a[22:23], v20 offset:13824
    v_mfma_f32_16x16x32_bf16 v[120:123], a[72:75], a[48:51], v[120:123]
    ds_read_b64_tr_b16 a[24:25], v20 offset:14336
    buffer_load_dwordx4 v4, s[20:23], s52 offen offset:2048 lds
    v_mfma_f32_16x16x32_bf16 v[124:127], a[72:75], a[52:55], v[124:127]
    ds_read_b64_tr_b16 a[26:27], v20 offset:14848
    v_mfma_f32_16x16x32_bf16 v[128:131], a[72:75], a[56:59], v[128:131]
    ds_read_b64_tr_b16 a[28:29], v23 offset:12288
    v_mfma_f32_16x16x32_bf16 v[132:135], a[72:75], a[60:63], v[132:135]
    ds_read_b64_tr_b16 a[30:31], v23 offset:12800
    v_mfma_f32_16x16x32_bf16 v[136:139], a[76:79], a[48:51], v[136:139]
    buffer_load_dwordx4 v5, s[20:23], s52 offen offset:3072 lds
    s_add_u32 s52, s52, 128
    v_mfma_f32_16x16x32_bf16 v[140:143], a[76:79], a[52:55], v[140:143]
    s_waitcnt lgkmcnt(0)
    v_mfma_f32_16x16x32_bf16 v[88:91], a[16:19], a[0:3], v[88:91]
    ds_read_b64_tr_b16 a[64:65], v20 offset:19456
    s_add_u32 m0, s55, 47104
    v_mfma_f32_16x16x32_bf16 v[92:95], a[16:19], a[4:7], v[92:95]
    ds_read_b64_tr_b16 a[66:67], v20 offset:19968
    buffer_load_dwordx4 v6, s[32:35], s53 offen offset:0 sc1 lds
    v_mfma_f32_16x16x32_bf16 v[96:99], a[16:19], a[8:11], v[96:99]
    ds_read_b128 a[48:51], v203 offset:61440
    v_mfma_f32_16x16x32_bf16 v[100:103], a[16:19], a[12:15], v[100:103]
    ds_read_b128 a[52:55], v203 offset:63488
    v_mfma_f32_16x16x32_bf16 v[104:107], a[20:23], a[0:3], v[104:107]
    ds_read_b128 a[56:59], v209 offset:61440
    v_mfma_f32_16x16x32_bf16 v[108:111], a[20:23], a[4:7], v[108:111]
    ds_read_b128 a[60:63], v209 offset:63488
    buffer_load_dwordx4 v6, s[32:35], s53 offen offset:1024 sc1 lds
    v_mfma_f32_16x16x32_bf16 v[112:115], a[20:23], a[8:11], v[112:115]
    ds_read_b64_tr_b16 a[68:69], v20 offset:20480
    v_mfma_f32_16x16x32_bf16 v[116:119], a[20:23], a[12:15], v[116:119]
    ds_read_b64_tr_b16 a[70:71], v20 offset:20992
    v_mfma_f32_16x16x32_bf16 v[120:123], a[24:27], a[0:3], v[120:123]
    ds_read_b64_tr_b16 a[72:73], v20 offset:21504
    buffer_load_dwordx4 v6, s[32:35], s53 offen offset:2048 sc1 lds
    v_mfma_f32_16x16x32_bf16 v[124:127], a[24:27], a[4:7], v[124:127]
    ds_read_b64_tr_b16 a[74:75], v20 offset:22016
    v_mfma_f32_16x16x32_bf16 v[128:131], a[24:27], a[8:11], v[128:131]
    ds_read_b64_tr_b16 a[76:77], v23 offset:19456
    v_mfma_f32_16x16x32_bf16 v[132:135], a[24:27], a[12:15], v[132:135]
    ds_read_b64_tr_b16 a[78:79], v23 offset:19968
    v_mfma_f32_16x16x32_bf16 v[136:139], a[28:31], a[0:3], v[136:139]
    s_mov_b32 exec_hi, 0
    buffer_load_dwordx4 v6, s[32:35], s53 offen offset:3072 sc1 lds
    s_mov_b32 exec_hi, -1
    s_add_u32 s53, s53, 14336
    v_mfma_f32_16x16x32_bf16 v[140:143], a[28:31], a[4:7], v[140:143]
    s_waitcnt vmcnt(24) lgkmcnt(0)
    s_barrier
    v_mfma_f32_16x16x32_bf16 v[88:91], a[64:67], a[48:51], v[88:91]
    ds_read_b64_tr_b16 a[16:17], v20 offset:43008
    s_add_u32 m0, s54, 61440
    v_mfma_f32_16x16x32_bf16 v[92:95], a[64:67], a[52:55], v[92:95]
    ds_read_b64_tr_b16 a[18:19], v20 offset:43520
    buffer_load_dwordx4 v2, s[20:23], s52 offen offset:0 lds
    v_mfma_f32_16x16x32_bf16 v[96:99], a[64:67], a[56:59], v[96:99]
    ds_read_b128 a[0:3], v201 offset:26624
    v_mfma_f32_16x16x32_bf16 v[100:103], a[64:67], a[60:63], v[100:103]
    ds_read_b128 a[4:7], v201 offset:28672
    v_mfma_f32_16x16x32_bf16 v[104:107], a[68:71], a[48:51], v[104:107]
    ds_read_b128 a[8:11], v207 offset:26624
    v_mfma_f32_16x16x32_bf16 v[108:111], a[68:71], a[52:55], v[108:111]
    ds_read_b128 a[12:15], v207 offset:28672
    buffer_load_dwordx4 v3, s[20:23], s52 offen offset:1024 lds
    v_mfma_f32_16x16x32_bf16 v[112:115], a[68:71], a[56:59], v[112:115]
    ds_read_b64_tr_b16 a[20:21], v20 offset:44032
    v_mfma_f32_16x16x32_bf16 v[116:119], a[68:71], a[60:63], v[116:119]
    ds_read_b64_tr_b16 a[22:23], v20 offset:44544
    v_mfma_f32_16x16x32_bf16 v[120:123], a[72:75], a[48:51], v[120:123]
    ds_read_b64_tr_b16 a[24:25], v20 offset:45056
    buffer_load_dwordx4 v4, s[20:23], s52 offen offset:2048 lds
    v_mfma_f32_16x16x32_bf16 v[124:127], a[72:75], a[52:55], v[124:127]
    ds_read_b64_tr_b16 a[26:27], v20 offset:45568
    v_mfma_f32_16x16x32_bf16 v[128:131], a[72:75], a[56:59], v[128:131]
    ds_read_b64_tr_b16 a[28:29], v23 offset:43008
    v_mfma_f32_16x16x32_bf16 v[132:135], a[72:75], a[60:63], v[132:135]
    ds_read_b64_tr_b16 a[30:31], v23 offset:43520
    v_mfma_f32_16x16x32_bf16 v[136:139], a[76:79], a[48:51], v[136:139]
    buffer_load_dwordx4 v5, s[20:23], s52 offen offset:3072 lds
    s_add_u32 s52, s52, 128
    v_mfma_f32_16x16x32_bf16 v[140:143], a[76:79], a[52:55], v[140:143]
    s_waitcnt lgkmcnt(0)
    v_mfma_f32_16x16x32_bf16 v[88:91], a[16:19], a[0:3], v[88:91]
    ds_read_b64_tr_b16 a[64:65], v20 offset:50176
    s_add_u32 m0, s55, 77824
    v_mfma_f32_16x16x32_bf16 v[92:95], a[16:19], a[4:7], v[92:95]
    ds_read_b64_tr_b16 a[66:67], v20 offset:50688
    buffer_load_dwordx4 v6, s[32:35], s53 offen offset:0 sc1 lds
    v_mfma_f32_16x16x32_bf16 v[96:99], a[16:19], a[8:11], v[96:99]
    ds_read_b128 a[48:51], v204 offset:26624
    v_mfma_f32_16x16x32_bf16 v[100:103], a[16:19], a[12:15], v[100:103]
    ds_read_b128 a[52:55], v204 offset:28672
    v_mfma_f32_16x16x32_bf16 v[104:107], a[20:23], a[0:3], v[104:107]
    ds_read_b128 a[56:59], v210 offset:26624
    v_mfma_f32_16x16x32_bf16 v[108:111], a[20:23], a[4:7], v[108:111]
    ds_read_b128 a[60:63], v210 offset:28672
    buffer_load_dwordx4 v6, s[32:35], s53 offen offset:1024 sc1 lds
    v_mfma_f32_16x16x32_bf16 v[112:115], a[20:23], a[8:11], v[112:115]
    ds_read_b64_tr_b16 a[68:69], v20 offset:51200
    v_mfma_f32_16x16x32_bf16 v[116:119], a[20:23], a[12:15], v[116:119]
    ds_read_b64_tr_b16 a[70:71], v20 offset:51712
    v_mfma_f32_16x16x32_bf16 v[120:123], a[24:27], a[0:3], v[120:123]
    ds_read_b64_tr_b16 a[72:73], v20 offset:52224
    buffer_load_dwordx4 v6, s[32:35], s53 offen offset:2048 sc1 lds
    v_mfma_f32_16x16x32_bf16 v[124:127], a[24:27], a[4:7], v[124:127]
    ds_read_b64_tr_b16 a[74:75], v20 offset:52736
    v_mfma_f32_16x16x32_bf16 v[128:131], a[24:27], a[8:11], v[128:131]
    ds_read_b64_tr_b16 a[76:77], v23 offset:50176
    v_mfma_f32_16x16x32_bf16 v[132:135], a[24:27], a[12:15], v[132:135]
    ds_read_b64_tr_b16 a[78:79], v23 offset:50688
    v_mfma_f32_16x16x32_bf16 v[136:139], a[28:31], a[0:3], v[136:139]
    s_mov_b32 exec_hi, 0
    buffer_load_dwordx4 v6, s[32:35], s53 offen offset:3072 sc1 lds
    s_mov_b32 exec_hi, -1
    s_add_u32 s53, s53, 14336
    v_mfma_f32_16x16x32_bf16 v[140:143], a[28:31], a[4:7], v[140:143]
    s_waitcnt vmcnt(24) lgkmcnt(0)
    s_barrier
    s_cmp_lg_u32 s3, 1
    s_cbranch_scc1 PUB_12
    s_add_u32 s99, s94, 4
    v_mov_b32 v0, s99
    s_mov_b64 exec, 1
    buffer_store_dword v0, v255, s[32:35], s92 offen sc1
    s_mov_b64 exec, -1
PUB_12:
    v_mfma_f32_16x16x32_bf16 v[88:91], a[64:67], a[48:51], v[88:91]
    ds_read_b64_tr_b16 a[16:17], v21 offset:8192
    s_add_u32 m0, s54, 92160
    v_mfma_f32_16x16x32_bf16 v[92:95], a[64:67], a[52:55], v[92:95]
    ds_read_b64_tr_b16 a[18:19], v21 offset:8704
    buffer_load_dwordx4 v2, s[20:23], s52 offen offset:0 lds
    v_mfma_f32_16x16x32_bf16 v[96:99], a[64:67], a[56:59], v[96:99]
    ds_read_b128 a[0:3], v201 offset:57344
    v_mfma_f32_16x16x32_bf16 v[100:103], a[64:67], a[60:63], v[100:103]
    ds_read_b128 a[4:7], v201 offset:59392
    v_mfma_f32_16x16x32_bf16 v[104:107], a[68:71], a[48:51], v[104:107]
    ds_read_b128 a[8:11], v207 offset:57344
    v_mfma_f32_16x16x32_bf16 v[108:111], a[68:71], a[52:55], v[108:111]
    ds_read_b128 a[12:15], v207 offset:59392
    buffer_load_dwordx4 v3, s[20:23], s52 offen offset:1024 lds
    v_mfma_f32_16x16x32_bf16 v[112:115], a[68:71], a[56:59], v[112:115]
    ds_read_b64_tr_b16 a[20:21], v21 offset:9216
    v_mfma_f32_16x16x32_bf16 v[116:119], a[68:71], a[60:63], v[116:119]
    ds_read_b64_tr_b16 a[22:23], v21 offset:9728
    v_mfma_f32_16x16x32_bf16 v[120:123], a[72:75], a[48:51], v[120:123]
    ds_read_b64_tr_b16 a[24:25], v21 offset:10240
    buffer_load_dwordx4 v4, s[20:23], s52 offen offset:2048 lds
    v_mfma_f32_16x16x32_bf16 v[124:127], a[72:75], a[52:55], v[124:127]
    ds_read_b64_tr_b16 a[26:27], v21 offset:10752
    v_mfma_f32_16x16x32_bf16 v[128:131], a[72:75], a[56:59], v[128:131]
    ds_read_b64_tr_b16 a[28:29], v24 offset:8192
    v_mfma_f32_16x16x32_bf16 v[132:135], a[72:75], a[60:63], v[132:135]
    ds_read_b64_tr_b16 a[30:31], v24 offset:8704
    v_mfma_f32_16x16x32_bf16 v[136:139], a[76:79], a[48:51], v[136:139]
    buffer_load_dwordx4 v5, s[20:23], s52 offen offset:3072 lds
    s_add_u32 s52, s52, 128
    v_mfma_f32_16x16x32_bf16 v[140:143], a[76:79], a[52:55], v[140:143]
    s_waitcnt lgkmcnt(0)
    s_mov_b32 s98, 4
.p2align 3
LOOP_p3_1:
    v_mfma_f32_16x16x32_bf16 v[88:91], a[16:19], a[0:3], v[88:91]
    ds_read_b64_tr_b16 a[64:65], v21 offset:15360
    s_add_u32 m0, s55, 108544
    v_mfma_f32_16x16x32_bf16 v[92:95], a[16:19], a[4:7], v[92:95]
    ds_read_b64_tr_b16 a[66:67], v21 offset:15872
    buffer_load_dwordx4 v6, s[32:35], s53 offen offset:0 sc1 lds
    v_mfma_f32_16x16x32_bf16 v[96:99], a[16:19], a[8:11], v[96:99]
    ds_read_b128 a[48:51], v204 offset:57344
    v_mfma_f32_16x16x32_bf16 v[100:103], a[16:19], a[12:15], v[100:103]
    ds_read_b128 a[52:55], v204 offset:59392
    v_mfma_f32_16x16x32_bf16 v[104:107], a[20:23], a[0:3], v[104:107]
    ds_read_b128 a[56:59], v210 offset:57344
    v_mfma_f32_16x16x32_bf16 v[108:111], a[20:23], a[4:7], v[108:111]
    ds_read_b128 a[60:63], v210 offset:59392
    buffer_load_dwordx4 v6, s[32:35], s53 offen offset:1024 sc1 lds
    v_mfma_f32_16x16x32_bf16 v[112:115], a[20:23], a[8:11], v[112:115]
    ds_read_b64_tr_b16 a[68:69], v21 offset:16384
    v_mfma_f32_16x16x32_bf16 v[116:119], a[20:23], a[12:15], v[116:119]
    ds_read_b64_tr_b16 a[70:71], v21 offset:16896
    v_mfma_f32_16x16x32_bf16 v[120:123], a[24:27], a[0:3], v[120:123]
    ds_read_b64_tr_b16 a[72:73], v21 offset:17408
    buffer_load_dwordx4 v6, s[32:35], s53 offen offset:2048 sc1 lds
    v_mfma_f32_16x16x32_bf16 v[124:127], a[24:27], a[4:7], v[124:127]
    ds_read_b64_tr_b16 a[74:75], v21 offset:17920
    v_mfma_f32_16x16x32_bf16 v[128:131], a[24:27], a[8:11], v[128:131]
    ds_read_b64_tr_b16 a[76:77], v24 offset:15360
    v_mfma_f32_16x16x32_bf16 v[132:135], a[24:27], a[12:15], v[132:135]
    ds_read_b64_tr_b16 a[78:79], v24 offset:15872
    v_mfma_f32_16x16x32_bf16 v[136:139], a[28:31], a[0:3], v[136:139]
    s_mov_b32 exec_hi, 0
    buffer_load_dwordx4 v6, s[32:35], s53 offen offset:3072 sc1 lds
    s_mov_b32 exec_hi, -1
    s_add_u32 s53, s53, 14336
    v_mfma_f32_16x16x32_bf16 v[140:143], a[28:31], a[4:7], v[140:143]
    s_waitcnt vmcnt(24) lgkmcnt(0)
    s_barrier
    v_mfma_f32_16x16x32_bf16 v[88:91], a[64:67], a[48:51], v[88:91]
    ds_read_b64_tr_b16 a[16:17], v19 offset:16384
    s_add_u32 m0, s54, 122880
    v_mfma_f32_16x16x32_bf16 v[92:95], a[64:67], a[52:55], v[92:95]
    ds_read_b64_tr_b16 a[18:19], v19 offset:16896
    buffer_load_dwordx4 v2, s[20:23], s52 offen offset:0 lds
    v_mfma_f32_16x16x32_bf16 v[96:99], a[64:67], a[56:59], v[96:99]
    ds_read_b128 a[0:3], v200 offset:0
    v_mfma_f32_16x16x32_bf16 v[100:103], a[64:67], a[60:63], v[100:103]
    ds_read_b128 a[4:7], v200 offset:2048
    v_mfma_f32_16x16x32_bf16 v[104:107], a[68:71], a[48:51], v[104:107]
    ds_read_b128 a[8:11], v206 offset:0
    v_mfma_f32_16x16x32_bf16 v[108:111], a[68:71], a[52:55], v[108:111]
    ds_read_b128 a[12:15], v206 offset:2048
    buffer_load_dwordx4 v3, s[20:23], s52 offen offset:1024 lds
    v_mfma_f32_16x16x32_bf16 v[112:115], a[68:71], a[56:59], v[112:115]
    ds_read_b64_tr_b16 a[20:21], v19 offset:17408
    v_mfma_f32_16x16x32_bf16 v[116:119], a[68:71], a[60:63], v[116:119]
    ds_read_b64_tr_b16 a[22:23], v19 offset:17920
    v_mfma_f32_16x16x32_bf16 v[120:123], a[72:75], a[48:51], v[120:123]
    ds_read_b64_tr_b16 a[24:25], v19 offset:18432
    buffer_load_dwordx4 v4, s[20:23], s52 offen offset:2048 lds
    v_mfma_f32_16x16x32_bf16 v[124:127], a[72:75], a[52:55], v[124:127]
    ds_read_b64_tr_b16 a[26:27], v19 offset:18944
    v_mfma_f32_16x16x32_bf16 v[128:131], a[72:75], a[56:59], v[128:131]
    ds_read_b64_tr_b16 a[28:29], v22 offset:16384
    v_mfma_f32_16x16x32_bf16 v[132:135], a[72:75], a[60:63], v[132:135]
    ds_read_b64_tr_b16 a[30:31], v22 offset:16896
    v_mfma_f32_16x16x32_bf16 v[136:139], a[76:79], a[48:51], v[136:139]
    buffer_load_dwordx4 v5, s[20:23], s52 offen offset:3072 lds
    s_add_u32 s52, s52, 128
    v_mfma_f32_16x16x32_bf16 v[140:143], a[76:79], a[52:55], v[140:143]
    s_waitcnt lgkmcnt(0)
    v_mfma_f32_16x16x32_bf16 v[88:91], a[16:19], a[0:3], v[88:91]
    ds_read_b64_tr_b16 a[64:65], v19 offset:23552
    s_add_u32 m0, s55, 139264
    v_mfma_f32_16x16x32_bf16 v[92:95], a[16:19], a[4:7], v[92:95]
    ds_read_b64_tr_b16 a[66:67], v19 offset:24064
    buffer_load_dwordx4 v6, s[32:35], s53 offen offset:0 sc1 lds
    v_mfma_f32_16x16x32_bf16 v[96:99], a[16:19], a[8:11], v[96:99]
    ds_read_b128 a[48:51], v203 offset:0
    v_mfma_f32_16x16x32_bf16 v[100:103], a[16:19], a[12:15], v[100:103]
    ds_read_b128 a[52:55], v203 offset:2048
    v_mfma_f32_16x16x32_bf16 v[104:107], a[20:23], a[0:3], v[104:107]
    ds_read_b128 a[56:59], v209 offset:0
    v_mfma_f32_16x16x32_bf16 v[108:111], a[20:23], a[4:7], v[108:111]
    ds_read_b128 a[60:63], v209 offset:2048
    buffer_load_dwordx4 v6, s[32:35], s53 offen offset:1024 sc1 lds
    v_mfma_f32_16x16x32_bf16 v[112:115], a[20:23], a[8:11], v[112:115]
    ds_read_b64_tr_b16 a[68:69], v19 offset:24576
    v_mfma_f32_16x16x32_bf16 v[116:119], a[20:23], a[12:15], v[116:119]
    ds_read_b64_tr_b16 a[70:71], v19 offset:25088
    v_mfma_f32_16x16x32_bf16 v[120:123], a[24:27], a[0:3], v[120:123]
    ds_read_b64_tr_b16 a[72:73], v19 offset:25600
    buffer_load_dwordx4 v6, s[32:35], s53 offen offset:2048 sc1 lds
    v_mfma_f32_16x16x32_bf16 v[124:127], a[24:27], a[4:7], v[124:127]
    ds_read_b64_tr_b16 a[74:75], v19 offset:26112
    v_mfma_f32_16x16x32_bf16 v[128:131], a[24:27], a[8:11], v[128:131]
    ds_read_b64_tr_b16 a[76:77], v22 offset:23552
    v_mfma_f32_16x16x32_bf16 v[132:135], a[24:27], a[12:15], v[132:135]
    ds_read_b64_tr_b16 a[78:79], v22 offset:24064
    v_mfma_f32_16x16x32_bf16 v[136:139], a[28:31], a[0:3], v[136:139]
    s_mov_b32 exec_hi, 0
    buffer_load_dwordx4 v6, s[32:35], s53 offen offset:3072 sc1 lds
    s_mov_b32 exec_hi, -1
    s_add_u32 s53, s53, 14336
    v_mfma_f32_16x16x32_bf16 v[140:143], a[28:31], a[4:7], v[140:143]
    s_waitcnt vmcnt(24) lgkmcnt(0)
    s_barrier
    v_mfma_f32_16x16x32_bf16 v[88:91], a[64:67], a[48:51], v[88:91]
    ds_read_b64_tr_b16 a[16:17], v19 offset:47104
    s_add_u32 m0, s54, 0
    v_mfma_f32_16x16x32_bf16 v[92:95], a[64:67], a[52:55], v[92:95]
    ds_read_b64_tr_b16 a[18:19], v19 offset:47616
    buffer_load_dwordx4 v2, s[20:23], s52 offen offset:0 lds
    v_mfma_f32_16x16x32_bf16 v[96:99], a[64:67], a[56:59], v[96:99]
    ds_read_b128 a[0:3], v200 offset:30720
    v_mfma_f32_16x16x32_bf16 v[100:103], a[64:67], a[60:63], v[100:103]
    ds_read_b128 a[4:7], v200 offset:32768
    v_mfma_f32_16x16x32_bf16 v[104:107], a[68:71], a[48:51], v[104:107]
    ds_read_b128 a[8:11], v206 offset:30720
    v_mfma_f32_16x16x32_bf16 v[108:111], a[68:71], a[52:55], v[108:111]
    ds_read_b128 a[12:15], v206 offset:32768
    buffer_load_dwordx4 v3, s[20:23], s52 offen offset:1024 lds
    v_mfma_f32_16x16x32_bf16 v[112:115], a[68:71], a[56:59], v[112:115]
    ds_read_b64_tr_b16 a[20:21], v19 offset:48128
    v_mfma_f32_16x16x32_bf16 v[116:119], a[68:71], a[60:63], v[116:119]
    ds_read_b64_tr_b16 a[22:23], v19 offset:48640
    v_mfma_f32_16x16x32_bf16 v[120:123], a[72:75], a[48:51], v[120:123]
    ds_read_b64_tr_b16 a[24:25], v19 offset:49152
    buffer_load_dwordx4 v4, s[20:23], s52 offen offset:2048 lds
    v_mfma_f32_16x16x32_bf16 v[124:127], a[72:75], a[52:55], v[124:127]
    ds_read_b64_tr_b16 a[26:27], v19 offset:49664
    v_mfma_f32_16x16x32_bf16 v[128:131], a[72:75], a[56:59], v[128:131]
    ds_read_b64_tr_b16 a[28:29], v22 offset:47104
    v_mfma_f32_16x16x32_bf16 v[132:135], a[72:75], a[60:63], v[132:135]
    ds_read_b64_tr_b16 a[30:31], v22 offset:47616
    v_mfma_f32_16x16x32_bf16 v[136:139], a[76:79], a[48:51], v[136:139]
    buffer_load_dwordx4 v5, s[20:23], s52 offen offset:3072 lds
    s_add_u32 s52, s52, 128
    v_mfma_f32_16x16x32_bf16 v[140:143], a[76:79], a[52:55], v[140:143]
    s_waitcnt lgkmcnt(0)
    v_mfma_f32_16x16x32_bf16 v[88:91], a[16:19], a[0:3], v[88:91]
    ds_read_b64_tr_b16 a[64:65], v19 offset:54272
    s_add_u32 m0, s55, 16384
    v_mfma_f32_16x16x32_bf16 v[92:95], a[16:19], a[4:7], v[92:95]
    ds_read_b64_tr_b16 a[66:67], v19 offset:54784
    buffer_load_dwordx4 v6, s[32:35], s53 offen offset:0 sc1 lds
    v_mfma_f32_16x16x32_bf16 v[96:99], a[16:19], a[8:11], v[96:99]
    ds_read_b128 a[48:51], v203 offset:30720
    v_mfma_f32_16x16x32_bf16 v[100:103], a[16:19], a[12:15], v[100:103]
    ds_read_b128 a[52:55], v203 offset:32768
    v_mfma_f32_16x16x32_bf16 v[104:107], a[20:23], a[0:3], v[104:107]
    ds_read_b128 a[56:59], v209 offset:30720
    v_mfma_f32_16x16x32_bf16 v[108:111], a[20:23], a[4:7], v[108:111]
    ds_read_b128 a[60:63], v209 offset:32768
    buffer_load_dwordx4 v6, s[32:35], s53 offen offset:1024 sc1 lds
    v_mfma_f32_16x16x32_bf16 v[112:115], a[20:23], a[8:11], v[112:115]
    ds_read_b64_tr_b16 a[68:69], v19 offset:55296
    v_mfma_f32_16x16x32_bf16 v[116:119], a[20:23], a[12:15], v[116:119]
    ds_read_b64_tr_b16 a[70:71], v19 offset:55808
    v_mfma_f32_16x16x32_bf16 v[120:123], a[24:27], a[0:3], v[120:123]
    ds_read_b64_tr_b16 a[72:73], v19 offset:56320
    buffer_load_dwordx4 v6, s[32:35], s53 offen offset:2048 sc1 lds
    v_mfma_f32_16x16x32_bf16 v[124:127], a[24:27], a[4:7], v[124:127]
    ds_read_b64_tr_b16 a[74:75], v19 offset:56832
    v_mfma_f32_16x16x32_bf16 v[128:131], a[24:27], a[8:11], v[128:131]
    ds_read_b64_tr_b16 a[76:77], v22 offset:54272
    v_mfma_f32_16x16x32_bf16 v[132:135], a[24:27], a[12:15], v[132:135]
    ds_read_b64_tr_b16 a[78:79], v22 offset:54784
    v_mfma_f32_16x16x32_bf16 v[136:139], a[28:31], a[0:3], v[136:139]
    s_mov_b32 exec_hi, 0
    buffer_load_dwordx4 v6, s[32:35], s53 offen offset:3072 sc1 lds
    s_mov_b32 exec_hi, -1
    s_add_u32 s53, s53, 14336
    v_mfma_f32_16x16x32_bf16 v[140:143], a[28:31], a[4:7], v[140:143]
    s_waitcnt vmcnt(24) lgkmcnt(0)
    s_barrier
    v_mfma_f32_16x16x32_bf16 v[88:91], a[64:67], a[48:51], v[88:91]
    ds_read_b64_tr_b16 a[16:17], v20 offset:12288
    s_add_u32 m0, s54, 30720
    v_mfma_f32_16x16x32_bf16 v[92:95], a[64:67], a[52:55], v[92:95]
    ds_read_b64_tr_b16 a[18:19], v20 offset:12800
    buffer_load_dwordx4 v2, s[20:23], s52 offen offset:0 lds
    v_mfma_f32_16x16x32_bf16 v[96:99], a[64:67], a[56:59], v[96:99]
    ds_read_b128 a[0:3], v200 offset:61440
    v_mfma_f32_16x16x32_bf16 v[100:103], a[64:67], a[60:63], v[100:103]
    ds_read_b128 a[4:7], v200 offset:63488
    v_mfma_f32_16x16x32_bf16 v[104:107], a[68:71], a[48:51], v[104:107]
    ds_read_b128 a[8:11], v206 offset:61440
    v_mfma_f32_16x16x32_bf16 v[108:111], a[68:71], a[52:55], v[108:111]
    ds_read_b128 a[12:15], v206 offset:63488
    buffer_load_dwordx4 v3, s[20:23], s52 offen offset:1024 lds
    v_mfma_f32_16x16x32_bf16 v[112:115], a[68:71], a[56:59], v[112:115]
    ds_read_b64_tr_b16 a[20:21], v20 offset:13312
    v_mfma_f32_16x16x32_bf16 v[116:119], a[68:71], a[60:63], v[116:119]
    ds_read_b64_tr_b16 a[22:23], v20 offset:13824
    v_mfma_f32_16x16x32_bf16 v[120:123], a[72:75], a[48:51], v[120:123]
    ds_read_b64_tr_b16 a[24:25], v20 offset:14336
    buffer_load_dwordx4 v4, s[20:23], s52 offen offset:2048 lds
    v_mfma_f32_16x16x32_bf16 v[124:127], a[72:75], a[52:55], v[124:127]
    ds_read_b64_tr_b16 a[26:27], v20 offset:14848
    v_mfma_f32_16x16x32_bf16 v[128:131], a[72:75], a[56:59], v[128:131]
    ds_read_b64_tr_b16 a[28:29], v23 offset:12288
    v_mfma_f32_16x16x32_bf16 v[132:135], a[72:75], a[60:63], v[132:135]
    ds_read_b64_tr_b16 a[30:31], v23 offset:12800
    v_mfma_f32_16x16x32_bf16 v[136:139], a[76:79], a[48:51], v[136:139]
    buffer_load_dwordx4 v5, s[20:23], s52 offen offset:3072 lds
    s_add_u32 s52, s52, 128
    v_mfma_f32_16x16x32_bf16 v[140:143], a[76:79], a[52:55], v[140:143]
    s_waitcnt lgkmcnt(0)
    v_mfma_f32_16x16x32_bf16 v[88:91], a[16:19], a[0:3], v[88:91]
    ds_read_b64_tr_b16 a[64:65], v20 offset:19456
    s_add_u32 m0, s55, 47104
    v_mfma_f32_16x16x32_bf16 v[92:95], a[16:19], a[4:7], v[92:95]
    ds_read_b64_tr_b16 a[66:67], v20 offset:19968
    buffer_load_dwordx4 v6, s[32:35], s53 offen offset:0 sc1 lds
    v_mfma_f32_16x16x32_bf16 v[96:99], a[16:19], a[8:11], v[96:99]
    ds_read_b128 a[48:51], v203 offset:61440
    v_mfma_f32_16x16x32_bf16 v[100:103], a[16:19], a[12:15], v[100:103]
    ds_read_b128 a[52:55], v203 offset:63488
    v_mfma_f32_16x16x32_bf16 v[104:107], a[20:23], a[0:3], v[104:107]
    ds_read_b128 a[56:59], v209 offset:61440
    v_mfma_f32_16x16x32_bf16 v[108:111], a[20:23], a[4:7], v[108:111]
    ds_read_b128 a[60:63], v209 offset:63488
    buffer_load_dwordx4 v6, s[32:35], s53 offen offset:1024 sc1 lds
    v_mfma_f32_16x16x32_bf16 v[112:115], a[20:23], a[8:11], v[112:115]
    ds_read_b64_tr_b16 a[68:69], v20 offset:20480
    v_mfma_f32_16x16x32_bf16 v[116:119], a[20:23], a[12:15], v[116:119]
    ds_read_b64_tr_b16 a[70:71], v20 offset:20992
    v_mfma_f32_16x16x32_bf16 v[120:123], a[24:27], a[0:3], v[120:123]
    ds_read_b64_tr_b16 a[72:73], v20 offset:21504
    buffer_load_dwordx4 v6, s[32:35], s53 offen offset:2048 sc1 lds
    v_mfma_f32_16x16x32_bf16 v[124:127], a[24:27], a[4:7], v[124:127]
    ds_read_b64_tr_b16 a[74:75], v20 offset:22016
    v_mfma_f32_16x16x32_bf16 v[128:131], a[24:27], a[8:11], v[128:131]
    ds_read_b64_tr_b16 a[76:77], v23 offset:19456
    v_mfma_f32_16x16x32_bf16 v[132:135], a[24:27], a[12:15], v[132:135]
    ds_read_b64_tr_b16 a[78:79], v23 offset:19968
    v_mfma_f32_16x16x32_bf16 v[136:139], a[28:31], a[0:3], v[136:139]
    s_mov_b32 exec_hi, 0
    buffer_load_dwordx4 v6, s[32:35], s53 offen offset:3072 sc1 lds
    s_mov_b32 exec_hi, -1
    s_add_u32 s53, s53, 14336
    v_mfma_f32_16x16x32_bf16 v[140:143], a[28:31], a[4:7], v[140:143]
    s_waitcnt vmcnt(24) lgkmcnt(0)
    s_barrier
    v_mfma_f32_16x16x32_bf16 v[88:91], a[64:67], a[48:51], v[88:91]
    ds_read_b64_tr_b16 a[16:17], v20 offset:43008
    s_add_u32 m0, s54, 61440
    v_mfma_f32_16x16x32_bf16 v[92:95], a[64:67], a[52:55], v[92:95]
    ds_read_b64_tr_b16 a[18:19], v20 offset:43520
    buffer_load_dwordx4 v2, s[20:23], s52 offen offset:0 lds
    v_mfma_f32_16x16x32_bf16 v[96:99], a[64:67], a[56:59], v[96:99]
    ds_read_b128 a[0:3], v201 offset:26624
    v_mfma_f32_16x16x32_bf16 v[100:103], a[64:67], a[60:63], v[100:103]
    ds_read_b128 a[4:7], v201 offset:28672
    v_mfma_f32_16x16x32_bf16 v[104:107], a[68:71], a[48:51], v[104:107]
    ds_read_b128 a[8:11], v207 offset:26624
    v_mfma_f32_16x16x32_bf16 v[108:111], a[68:71], a[52:55], v[108:111]
    ds_read_b128 a[12:15], v207 offset:28672
    buffer_load_dwordx4 v3, s[20:23], s52 offen offset:1024 lds
    v_mfma_f32_16x16x32_bf16 v[112:115], a[68:71], a[56:59], v[112:115]
    ds_read_b64_tr_b16 a[20:21], v20 offset:44032
    v_mfma_f32_16x16x32_bf16 v[116:119], a[68:71], a[60:63], v[116:119]
    ds_read_b64_tr_b16 a[22:23], v20 offset:44544
    v_mfma_f32_16x16x32_bf16 v[120:123], a[72:75], a[48:51], v[120:123]
    ds_read_b64_tr_b16 a[24:25], v20 offset:45056
    buffer_load_dwordx4 v4, s[20:23], s52 offen offset:2048 lds
    v_mfma_f32_16x16x32_bf16 v[124:127], a[72:75], a[52:55], v[124:127]
    ds_read_b64_tr_b16 a[26:27], v20 offset:45568
    v_mfma_f32_16x16x32_bf16 v[128:131], a[72:75], a[56:59], v[128:131]
    ds_read_b64_tr_b16 a[28:29], v23 offset:43008
    v_mfma_f32_16x16x32_bf16 v[132:135], a[72:75], a[60:63], v[132:135]
    ds_read_b64_tr_b16 a[30:31], v23 offset:43520
    v_mfma_f32_16x16x32_bf16 v[136:139], a[76:79], a[48:51], v[136:139]
    buffer_load_dwordx4 v5, s[20:23], s52 offen offset:3072 lds
    s_add_u32 s52, s52, 128
    v_mfma_f32_16x16x32_bf16 v[140:143], a[76:79], a[52:55], v[140:143]
    s_waitcnt lgkmcnt(0)
    v_mfma_f32_16x16x32_bf16 v[88:91], a[16:19], a[0:3], v[88:91]
    ds_read_b64_tr_b16 a[64:65], v20 offset:50176
    s_add_u32 m0, s55, 77824
    v_mfma_f32_16x16x32_bf16 v[92:95], a[16:19], a[4:7], v[92:95]
    ds_read_b64_tr_b16 a[66:67], v20 offset:50688
    buffer_load_dwordx4 v6, s[32:35], s53 offen offset:0 sc1 lds
    v_mfma_f32_16x16x32_bf16 v[96:99], a[16:19], a[8:11], v[96:99]
    ds_read_b128 a[48:51], v204 offset:26624
    v_mfma_f32_16x16x32_bf16 v[100:103], a[16:19], a[12:15], v[100:103]
    ds_read_b128 a[52:55], v204 offset:28672
    v_mfma_f32_16x16x32_bf16 v[104:107], a[20:23], a[0:3], v[104:107]
    ds_read_b128 a[56:59], v210 offset:26624
    v_mfma_f32_16x16x32_bf16 v[108:111], a[20:23], a[4:7], v[108:111]
    ds_read_b128 a[60:63], v210 offset:28672
    buffer_load_dwordx4 v6, s[32:35], s53 offen offset:1024 sc1 lds
    v_mfma_f32_16x16x32_bf16 v[112:115], a[20:23], a[8:11], v[112:115]
    ds_read_b64_tr_b16 a[68:69], v20 offset:51200
    v_mfma_f32_16x16x32_bf16 v[116:119], a[20:23], a[12:15], v[116:119]
    ds_read_b64_tr_b16 a[70:71], v20 offset:51712
    v_mfma_f32_16x16x32_bf16 v[120:123], a[24:27], a[0:3], v[120:123]
    ds_read_b64_tr_b16 a[72:73], v20 offset:52224
    buffer_load_dwordx4 v6, s[32:35], s53 offen offset:2048 sc1 lds
    v_mfma_f32_16x16x32_bf16 v[124:127], a[24:27], a[4:7], v[124:127]
    ds_read_b64_tr_b16 a[74:75], v20 offset:52736
    v_mfma_f32_16x16x32_bf16 v[128:131], a[24:27], a[8:11], v[128:131]
    ds_read_b64_tr_b16 a[76:77], v23 offset:50176
    v_mfma_f32_16x16x32_bf16 v[132:135], a[24:27], a[12:15], v[132:135]
    ds_read_b64_tr_b16 a[78:79], v23 offset:50688
    v_mfma_f32_16x16x32_bf16 v[136:139], a[28:31], a[0:3], v[136:139]
    s_mov_b32 exec_hi, 0
    buffer_load_dwordx4 v6, s[32:35], s53 offen offset:3072 sc1 lds
    s_mov_b32 exec_hi, -1
    s_add_u32 s53, s53, 14336
    v_mfma_f32_16x16x32_bf16 v[140:143], a[28:31], a[4:7], v[140:143]
    s_waitcnt vmcnt(24) lgkmcnt(0)
    s_barrier
    v_mfma_f32_16x16x32_bf16 v[88:91], a[64:67], a[48:51], v[88:91]
    ds_read_b64_tr_b16 a[16:17], v21 offset:8192
    s_add_u32 m0, s54, 92160
    v_mfma_f32_16x16x32_bf16 v[92:95], a[64:67], a[52:55], v[92:95]
    ds_read_b64_tr_b16 a[18:19], v21 offset:8704
    buffer_load_dwordx4 v2, s[20:23], s52 offen offset:0 lds
    v_mfma_f32_16x16x32_bf16 v[96:99], a[64:67], a[56:59], v[96:99]
    ds_read_b128 a[0:3], v201 offset:57344
    v_mfma_f32_16x16x32_bf16 v[100:103], a[64:67], a[60:63], v[100:103]
    ds_read_b128 a[4:7], v201 offset:59392
    v_mfma_f32_16x16x32_bf16 v[104:107], a[68:71], a[48:51], v[104:107]
    ds_read_b128 a[8:11], v207 offset:57344
    v_mfma_f32_16x16x32_bf16 v[108:111], a[68:71], a[52:55], v[108:111]
    ds_read_b128 a[12:15], v207 offset:59392
    buffer_load_dwordx4 v3, s[20:23], s52 offen offset:1024 lds
    v_mfma_f32_16x16x32_bf16 v[112:115], a[68:71], a[56:59], v[112:115]
    ds_read_b64_tr_b16 a[20:21], v21 offset:9216
    v_mfma_f32_16x16x32_bf16 v[116:119], a[68:71], a[60:63], v[116:119]
    ds_read_b64_tr_b16 a[22:23], v21 offset:9728
    v_mfma_f32_16x16x32_bf16 v[120:123], a[72:75], a[48:51], v[120:123]
    ds_read_b64_tr_b16 a[24:25], v21 offset:10240
    buffer_load_dwordx4 v4, s[20:23], s52 offen offset:2048 lds
    v_mfma_f32_16x16x32_bf16 v[124:127], a[72:75], a[52:55], v[124:127]
    ds_read_b64_tr_b16 a[26:27], v21 offset:10752
    v_mfma_f32_16x16x32_bf16 v[128:131], a[72:75], a[56:59], v[128:131]
    ds_read_b64_tr_b16 a[28:29], v24 offset:8192
    v_mfma_f32_16x16x32_bf16 v[132:135], a[72:75], a[60:63], v[132:135]
    ds_read_b64_tr_b16 a[30:31], v24 offset:8704
    v_mfma_f32_16x16x32_bf16 v[136:139], a[76:79], a[48:51], v[136:139]
    buffer_load_dwordx4 v5, s[20:23], s52 offen offset:3072 lds
    s_add_u32 s52, s52, 128
    v_mfma_f32_16x16x32_bf16 v[140:143], a[76:79], a[52:55], v[140:143]
    s_waitcnt lgkmcnt(0)
    s_sub_u32 s98, s98, 1
    s_cmp_lg_u32 s98, 0
    s_cbranch_scc1 LOOP_p3_1
    v_mfma_f32_16x16x32_bf16 v[88:91], a[16:19], a[0:3], v[88:91]
    ds_read_b64_tr_b16 a[64:65], v21 offset:15360
    s_add_u32 m0, s55, 108544
    v_mfma_f32_16x16x32_bf16 v[92:95], a[16:19], a[4:7], v[92:95]
    ds_read_b64_tr_b16 a[66:67], v21 offset:15872
    buffer_load_dwordx4 v6, s[32:35], s53 offen offset:0 sc1 lds
    v_mfma_f32_16x16x32_bf16 v[96:99], a[16:19], a[8:11], v[96:99]
    ds_read_b128 a[48:51], v204 offset:57344
    v_mfma_f32_16x16x32_bf16 v[100:103], a[16:19], a[12:15], v[100:103]
    ds_read_b128 a[52:55], v204 offset:59392
    v_mfma_f32_16x16x32_bf16 v[104:107], a[20:23], a[0:3], v[104:107]
    ds_read_b128 a[56:59], v210 offset:57344
    v_mfma_f32_16x16x32_bf16 v[108:111], a[20:23], a[4:7], v[108:111]
    ds_read_b128 a[60:63], v210 offset:59392
    buffer_load_dwordx4 v6, s[32:35], s53 offen offset:1024 sc1 lds
    v_mfma_f32_16x16x32_bf16 v[112:115], a[20:23], a[8:11], v[112:115]
    ds_read_b64_tr_b16 a[68:69], v21 offset:16384
    v_mfma_f32_16x16x32_bf16 v[116:119], a[20:23], a[12:15], v[116:119]
    ds_read_b64_tr_b16 a[70:71], v21 offset:16896
    v_mfma_f32_16x16x32_bf16 v[120:123], a[24:27], a[0:3], v[120:123]
    ds_read_b64_tr_b16 a[72:73], v21 offset:17408
    buffer_load_dwordx4 v6, s[32:35], s53 offen offset:2048 sc1 lds
    v_mfma_f32_16x16x32_bf16 v[124:127], a[24:27], a[4:7], v[124:127]
    ds_read_b64_tr_b16 a[74:75], v21 offset:17920
    v_mfma_f32_16x16x32_bf16 v[128:131], a[24:27], a[8:11], v[128:131]
    ds_read_b64_tr_b16 a[76:77], v24 offset:15360
    v_mfma_f32_16x16x32_bf16 v[132:135], a[24:27], a[12:15], v[132:135]
    ds_read_b64_tr_b16 a[78:79], v24 offset:15872
    v_mfma_f32_16x16x32_bf16 v[136:139], a[28:31], a[0:3], v[136:139]
    s_mov_b32 exec_hi, 0
    buffer_load_dwordx4 v6, s[32:35], s53 offen offset:3072 sc1 lds
    s_mov_b32 exec_hi, -1
    s_add_u32 s53, s53, 14336
    v_mfma_f32_16x16x32_bf16 v[140:143], a[28:31], a[4:7], v[140:143]
    s_waitcnt vmcnt(24) lgkmcnt(0)
    s_barrier
    v_mfma_f32_16x16x32_bf16 v[88:91], a[64:67], a[48:51], v[88:91]
    ds_read_b64_tr_b16 a[16:17], v19 offset:16384
    s_add_u32 m0, s54, 122880
    v_mfma_f32_16x16x32_bf16 v[92:95], a[64:67], a[52:55], v[92:95]
    ds_read_b64_tr_b16 a[18:19], v19 offset:16896
    buffer_load_dwordx4 v2, s[20:23], s52 offen offset:0 lds
    v_mfma_f32_16x16x32_bf16 v[96:99], a[64:67], a[56:59], v[96:99]
    ds_read_b128 a[0:3], v200 offset:0
    v_mfma_f32_16x16x32_bf16 v[100:103], a[64:67], a[60:63], v[100:103]
    ds_read_b128 a[4:7], v200 offset:2048
    v_mfma_f32_16x16x32_bf16 v[104:107], a[68:71], a[48:51], v[104:107]
    ds_read_b128 a[8:11], v206 offset:0
    v_mfma_f32_16x16x32_bf16 v[108:111], a[68:71], a[52:55], v[108:111]
    ds_read_b128 a[12:15], v206 offset:2048
    buffer_load_dwordx4 v3, s[20:23], s52 offen offset:1024 lds
    v_mfma_f32_16x16x32_bf16 v[112:115], a[68:71], a[56:59], v[112:115]
    ds_read_b64_tr_b16 a[20:21], v19 offset:17408
    v_mfma_f32_16x16x32_bf16 v[116:119], a[68:71], a[60:63], v[116:119]
    ds_read_b64_tr_b16 a[22:23], v19 offset:17920
    v_mfma_f32_16x16x32_bf16 v[120:123], a[72:75], a[48:51], v[120:123]
    ds_read_b64_tr_b16 a[24:25], v19 offset:18432
    buffer_load_dwordx4 v4, s[20:23], s52 offen offset:2048 lds
    v_mfma_f32_16x16x32_bf16 v[124:127], a[72:75], a[52:55], v[124:127]
    ds_read_b64_tr_b16 a[26:27], v19 offset:18944
    v_mfma_f32_16x16x32_bf16 v[128:131], a[72:75], a[56:59], v[128:131]
    ds_read_b64_tr_b16 a[28:29], v22 offset:16384
    v_mfma_f32_16x16x32_bf16 v[132:135], a[72:75], a[60:63], v[132:135]
    ds_read_b64_tr_b16 a[30:31], v22 offset:16896
    v_mfma_f32_16x16x32_bf16 v[136:139], a[76:79], a[48:51], v[136:139]
    buffer_load_dwordx4 v5, s[20:23], s52 offen offset:3072 lds
    s_add_u32 s52, s52, 128
    v_mfma_f32_16x16x32_bf16 v[140:143], a[76:79], a[52:55], v[140:143]
    s_waitcnt lgkmcnt(0)
    v_mfma_f32_16x16x32_bf16 v[88:91], a[16:19], a[0:3], v[88:91]
    ds_read_b64_tr_b16 a[64:65], v19 offset:23552
    s_add_u32 m0, s55, 139264
    v_mfma_f32_16x16x32_bf16 v[92:95], a[16:19], a[4:7], v[92:95]
    ds_read_b64_tr_b16 a[66:67], v19 offset:24064
    buffer_load_dwordx4 v6, s[32:35], s53 offen offset:0 sc1 lds
    v_mfma_f32_16x16x32_bf16 v[96:99], a[16:19], a[8:11], v[96:99]
    ds_read_b128 a[48:51], v203 offset:0
    v_mfma_f32_16x16x32_bf16 v[100:103], a[16:19], a[12:15], v[100:103]
    ds_read_b128 a[52:55], v203 offset:2048
    v_mfma_f32_16x16x32_bf16 v[104:107], a[20:23], a[0:3], v[104:107]
    ds_read_b128 a[56:59], v209 offset:0
    v_mfma_f32_16x16x32_bf16 v[108:111], a[20:23], a[4:7], v[108:111]
    ds_read_b128 a[60:63], v209 offset:2048
    buffer_load_dwordx4 v6, s[32:35], s53 offen offset:1024 sc1 lds
    v_mfma_f32_16x16x32_bf16 v[112:115], a[20:23], a[8:11], v[112:115]
    ds_read_b64_tr_b16 a[68:69], v19 offset:24576
    v_mfma_f32_16x16x32_bf16 v[116:119], a[20:23], a[12:15], v[116:119]
    ds_read_b64_tr_b16 a[70:71], v19 offset:25088
    v_mfma_f32_16x16x32_bf16 v[120:123], a[24:27], a[0:3], v[120:123]
    ds_read_b64_tr_b16 a[72:73], v19 offset:25600
    buffer_load_dwordx4 v6, s[32:35], s53 offen offset:2048 sc1 lds
    v_mfma_f32_16x16x32_bf16 v[124:127], a[24:27], a[4:7], v[124:127]
    ds_read_b64_tr_b16 a[74:75], v19 offset:26112
    v_mfma_f32_16x16x32_bf16 v[128:131], a[24:27], a[8:11], v[128:131]
    ds_read_b64_tr_b16 a[76:77], v22 offset:23552
    v_mfma_f32_16x16x32_bf16 v[132:135], a[24:27], a[12:15], v[132:135]
    ds_read_b64_tr_b16 a[78:79], v22 offset:24064
    v_mfma_f32_16x16x32_bf16 v[136:139], a[28:31], a[0:3], v[136:139]
    s_mov_b32 exec_hi, 0
    buffer_load_dwordx4 v6, s[32:35], s53 offen offset:3072 sc1 lds
    s_mov_b32 exec_hi, -1
    s_add_u32 s53, s53, 14336
    v_mfma_f32_16x16x32_bf16 v[140:143], a[28:31], a[4:7], v[140:143]
    s_waitcnt vmcnt(24) lgkmcnt(0)
    s_barrier
    v_mfma_f32_16x16x32_bf16 v[88:91], a[64:67], a[48:51], v[88:91]
    ds_read_b64_tr_b16 a[16:17], v19 offset:47104
    s_add_u32 m0, s54, 0
    v_mfma_f32_16x16x32_bf16 v[92:95], a[64:67], a[52:55], v[92:95]
    ds_read_b64_tr_b16 a[18:19], v19 offset:47616
    buffer_load_dwordx4 v2, s[20:23], s52 offen offset:0 lds
    v_mfma_f32_16x16x32_bf16 v[96:99], a[64:67], a[56:59], v[96:99]
    ds_read_b128 a[0:3], v200 offset:30720
    v_mfma_f32_16x16x32_bf16 v[100:103], a[64:67], a[60:63], v[100:103]
    ds_read_b128 a[4:7], v200 offset:32768
    v_mfma_f32_16x16x32_bf16 v[104:107], a[68:71], a[48:51], v[104:107]
    ds_read_b128 a[8:11], v206 offset:30720
    v_mfma_f32_16x16x32_bf16 v[108:111], a[68:71], a[52:55], v[108:111]
    ds_read_b128 a[12:15], v206 offset:32768
    buffer_load_dwordx4 v3, s[20:23], s52 offen offset:1024 lds
    v_mfma_f32_16x16x32_bf16 v[112:115], a[68:71], a[56:59], v[112:115]
    ds_read_b64_tr_b16 a[20:21], v19 offset:48128
    v_mfma_f32_16x16x32_bf16 v[116:119], a[68:71], a[60:63], v[116:119]
    ds_read_b64_tr_b16 a[22:23], v19 offset:48640
    v_mfma_f32_16x16x32_bf16 v[120:123], a[72:75], a[48:51], v[120:123]
    ds_read_b64_tr_b16 a[24:25], v19 offset:49152
    buffer_load_dwordx4 v4, s[20:23], s52 offen offset:2048 lds
    v_mfma_f32_16x16x32_bf16 v[124:127], a[72:75], a[52:55], v[124:127]
    ds_read_b64_tr_b16 a[26:27], v19 offset:49664
    v_mfma_f32_16x16x32_bf16 v[128:131], a[72:75], a[56:59], v[128:131]
    ds_read_b64_tr_b16 a[28:29], v22 offset:47104
    v_mfma_f32_16x16x32_bf16 v[132:135], a[72:75], a[60:63], v[132:135]
    ds_read_b64_tr_b16 a[30:31], v22 offset:47616
    v_mfma_f32_16x16x32_bf16 v[136:139], a[76:79], a[48:51], v[136:139]
    buffer_load_dwordx4 v5, s[20:23], s52 offen offset:3072 lds
    s_add_u32 s52, s52, 128
    v_mfma_f32_16x16x32_bf16 v[140:143], a[76:79], a[52:55], v[140:143]
    s_waitcnt lgkmcnt(0)
    v_mfma_f32_16x16x32_bf16 v[88:91], a[16:19], a[0:3], v[88:91]
    ds_read_b64_tr_b16 a[64:65], v19 offset:54272
    s_add_u32 m0, s55, 16384
    v_mfma_f32_16x16x32_bf16 v[92:95], a[16:19], a[4:7], v[92:95]
    ds_read_b64_tr_b16 a[66:67], v19 offset:54784
    buffer_load_dwordx4 v6, s[32:35], s53 offen offset:0 sc1 lds
    v_mfma_f32_16x16x32_bf16 v[96:99], a[16:19], a[8:11], v[96:99]
    ds_read_b128 a[48:51], v203 offset:30720
    v_mfma_f32_16x16x32_bf16 v[100:103], a[16:19], a[12:15], v[100:103]
    ds_read_b128 a[52:55], v203 offset:32768
    v_mfma_f32_16x16x32_bf16 v[104:107], a[20:23], a[0:3], v[104:107]
    ds_read_b128 a[56:59], v209 offset:30720
    v_mfma_f32_16x16x32_bf16 v[108:111], a[20:23], a[4:7], v[108:111]
    ds_read_b128 a[60:63], v209 offset:32768
    buffer_load_dwordx4 v6, s[32:35], s53 offen offset:1024 sc1 lds
    v_mfma_f32_16x16x32_bf16 v[112:115], a[20:23], a[8:11], v[112:115]
    ds_read_b64_tr_b16 a[68:69], v19 offset:55296
    v_mfma_f32_16x16x32_bf16 v[116:119], a[20:23], a[12:15], v[116:119]
    ds_read_b64_tr_b16 a[70:71], v19 offset:55808
    v_mfma_f32_16x16x32_bf16 v[120:123], a[24:27], a[0:3], v[120:123]
    ds_read_b64_tr_b16 a[72:73], v19 offset:56320
    buffer_load_dwordx4 v6, s[32:35], s53 offen offset:2048 sc1 lds
    v_mfma_f32_16x16x32_bf16 v[124:127], a[24:27], a[4:7], v[124:127]
    ds_read_b64_tr_b16 a[74:75], v19 offset:56832
    v_mfma_f32_16x16x32_bf16 v[128:131], a[24:27], a[8:11], v[128:131]
    ds_read_b64_tr_b16 a[76:77], v22 offset:54272
    v_mfma_f32_16x16x32_bf16 v[132:135], a[24:27], a[12:15], v[132:135]
    ds_read_b64_tr_b16 a[78:79], v22 offset:54784
    v_mfma_f32_16x16x32_bf16 v[136:139], a[28:31], a[0:3], v[136:139]
    s_mov_b32 exec_hi, 0
    buffer_load_dwordx4 v6, s[32:35], s53 offen offset:3072 sc1 lds
    s_mov_b32 exec_hi, -1
    s_add_u32 s53, s53, 14336
    v_mfma_f32_16x16x32_bf16 v[140:143], a[28:31], a[4:7], v[140:143]
    s_waitcnt vmcnt(24) lgkmcnt(0)
    s_barrier
    buffer_load_dword v252, v253, s[32:35], 0 offen sc1
    v_mfma_f32_16x16x32_bf16 v[88:91], a[64:67], a[48:51], v[88:91]
    ds_read_b64_tr_b16 a[16:17], v20 offset:12288
    s_add_u32 m0, s54, 30720
    v_mfma_f32_16x16x32_bf16 v[92:95], a[64:67], a[52:55], v[92:95]
    ds_read_b64_tr_b16 a[18:19], v20 offset:12800
    buffer_load_dwordx4 v2, s[20:23], s52 offen offset:0 lds
    v_mfma_f32_16x16x32_bf16 v[96:99], a[64:67], a[56:59], v[96:99]
    ds_read_b128 a[0:3], v200 offset:61440
    v_mfma_f32_16x16x32_bf16 v[100:103], a[64:67], a[60:63], v[100:103]
    ds_read_b128 a[4:7], v200 offset:63488
    v_mfma_f32_16x16x32_bf16 v[104:107], a[68:71], a[48:51], v[104:107]
    ds_read_b128 a[8:11], v206 offset:61440
    v_mfma_f32_16x16x32_bf16 v[108:111], a[68:71], a[52:55], v[108:111]
    ds_read_b128 a[12:15], v206 offset:63488
    buffer_load_dwordx4 v3, s[20:23], s52 offen offset:1024 lds
    v_mfma_f32_16x16x32_bf16 v[112:115], a[68:71], a[56:59], v[112:115]
    ds_read_b64_tr_b16 a[20:21], v20 offset:13312
    v_mfma_f32_16x16x32_bf16 v[116:119], a[68:71], a[60:63], v[116:119]
    ds_read_b64_tr_b16 a[22:23], v20 offset:13824
    v_mfma_f32_16x16x32_bf16 v[120:123], a[72:75], a[48:51], v[120:123]
    ds_read_b64_tr_b16 a[24:25], v20 offset:14336
    buffer_load_dwordx4 v4, s[20:23], s52 offen offset:2048 lds
    v_mfma_f32_16x16x32_bf16 v[124:127], a[72:75], a[52:55], v[124:127]
    ds_read_b64_tr_b16 a[26:27], v20 offset:14848
    v_mfma_f32_16x16x32_bf16 v[128:131], a[72:75], a[56:59], v[128:131]
    ds_read_b64_tr_b16 a[28:29], v23 offset:12288
    v_mfma_f32_16x16x32_bf16 v[132:135], a[72:75], a[60:63], v[132:135]
    ds_read_b64_tr_b16 a[30:31], v23 offset:12800
    v_mfma_f32_16x16x32_bf16 v[136:139], a[76:79], a[48:51], v[136:139]
    buffer_load_dwordx4 v5, s[20:23], s52 offen offset:3072 lds
    s_add_u32 s52, s52, 128
    v_mfma_f32_16x16x32_bf16 v[140:143], a[76:79], a[52:55], v[140:143]
    s_waitcnt lgkmcnt(0)
    v_mfma_f32_16x16x32_bf16 v[88:91], a[16:19], a[0:3], v[88:91]
    ds_read_b64_tr_b16 a[64:65], v20 offset:19456
    s_add_u32 m0, s55, 47104
    v_mfma_f32_16x16x32_bf16 v[92:95], a[16:19], a[4:7], v[92:95]
    ds_read_b64_tr_b16 a[66:67], v20 offset:19968
    buffer_load_dwordx4 v6, s[32:35], s53 offen offset:0 sc1 lds
    v_mfma_f32_16x16x32_bf16 v[96:99], a[16:19], a[8:11], v[96:99]
    ds_read_b128 a[48:51], v203 offset:61440
    v_mfma_f32_16x16x32_bf16 v[100:103], a[16:19], a[12:15], v[100:103]
    ds_read_b128 a[52:55], v203 offset:63488
    v_mfma_f32_16x16x32_bf16 v[104:107], a[20:23], a[0:3], v[104:107]
    ds_read_b128 a[56:59], v209 offset:61440
    v_mfma_f32_16x16x32_bf16 v[108:111], a[20:23], a[4:7], v[108:111]
    ds_read_b128 a[60:63], v209 offset:63488
    buffer_load_dwordx4 v6, s[32:35], s53 offen offset:1024 sc1 lds
    v_mfma_f32_16x16x32_bf16 v[112:115], a[20:23], a[8:11], v[112:115]
    ds_read_b64_tr_b16 a[68:69], v20 offset:20480
    v_mfma_f32_16x16x32_bf16 v[116:119], a[20:23], a[12:15], v[116:119]
    ds_read_b64_tr_b16 a[70:71], v20 offset:20992
    v_mfma_f32_16x16x32_bf16 v[120:123], a[24:27], a[0:3], v[120:123]
    ds_read_b64_tr_b16 a[72:73], v20 offset:21504
    buffer_load_dwordx4 v6, s[32:35], s53 offen offset:2048 sc1 lds
    v_mfma_f32_16x16x32_bf16 v[124:127], a[24:27], a[4:7], v[124:127]
    ds_read_b64_tr_b16 a[74:75], v20 offset:22016
    v_mfma_f32_16x16x32_bf16 v[128:131], a[24:27], a[8:11], v[128:131]
    ds_read_b64_tr_b16 a[76:77], v23 offset:19456
    v_mfma_f32_16x16x32_bf16 v[132:135], a[24:27], a[12:15], v[132:135]
    ds_read_b64_tr_b16 a[78:79], v23 offset:19968
    v_mfma_f32_16x16x32_bf16 v[136:139], a[28:31], a[0:3], v[136:139]
    s_mov_b32 exec_hi, 0
    buffer_load_dwordx4 v6, s[32:35], s53 offen offset:3072 sc1 lds
    s_mov_b32 exec_hi, -1
    s_add_u32 s53, s53, 14336
    v_mfma_f32_16x16x32_bf16 v[140:143], a[28:31], a[4:7], v[140:143]
    s_waitcnt vmcnt(25) lgkmcnt(0)
    s_barrier
    v_mfma_f32_16x16x32_bf16 v[88:91], a[64:67], a[48:51], v[88:91]
    ds_read_b64_tr_b16 a[16:17], v20 offset:43008
    v_mfma_f32_16x16x32_bf16 v[92:95], a[64:67], a[52:55], v[92:95]
    ds_read_b64_tr_b16 a[18:19], v20 offset:43520
    v_mfma_f32_16x16x32_bf16 v[96:99], a[64:67], a[56:59], v[96:99]
    ds_read_b128 a[0:3], v201 offset:26624
    v_mfma_f32_16x16x32_bf16 v[100:103], a[64:67], a[60:63], v[100:103]
    ds_read_b128 a[4:7], v201 offset:28672
    v_mfma_f32_16x16x32_bf16 v[104:107], a[68:71], a[48:51], v[104:107]
    ds_read_b128 a[8:11], v207 offset:26624
    v_mfma_f32_16x16x32_bf16 v[108:111], a[68:71], a[52:55], v[108:111]
    ds_read_b128 a[12:15], v207 offset:28672
    v_mfma_f32_16x16x32_bf16 v[112:115], a[68:71], a[56:59], v[112:115]
    ds_read_b64_tr_b16 a[20:21], v20 offset:44032
    v_mfma_f32_16x16x32_bf16 v[116:119], a[68:71], a[60:63], v[116:119]
    ds_read_b64_tr_b16 a[22:23], v20 offset:44544
    v_mfma_f32_16x16x32_bf16 v[120:123], a[72:75], a[48:51], v[120:123]
    ds_read_b64_tr_b16 a[24:25], v20 offset:45056
    v_mfma_f32_16x16x32_bf16 v[124:127], a[72:75], a[52:55], v[124:127]
    ds_read_b64_tr_b16 a[26:27], v20 offset:45568
    v_mfma_f32_16x16x32_bf16 v[128:131], a[72:75], a[56:59], v[128:131]
    ds_read_b64_tr_b16 a[28:29], v23 offset:43008
    v_mfma_f32_16x16x32_bf16 v[132:135], a[72:75], a[60:63], v[132:135]
    ds_read_b64_tr_b16 a[30:31], v23 offset:43520
    v_mfma_f32_16x16x32_bf16 v[136:139], a[76:79], a[48:51], v[136:139]
    v_mfma_f32_16x16x32_bf16 v[140:143], a[76:79], a[52:55], v[140:143]
    s_waitcnt lgkmcnt(0)
    s_waitcnt vmcnt(8)
    s_add_u32 s91, s94, 4
    v_subrev_u32 v252, s91, v252
    v_cmp_lt_u32 vcc, 3, v252
    s_nop 4
    s_cbranch_vccz POK_13
    s_mov_b32 s99, 0x8000
PSPIN_14:
    s_sleep 2
    buffer_load_dword v252, v253, s[32:35], 0 offen sc1
    s_sub_u32 s99, s99, 1
    s_cbranch_scc1 POK_13
    s_waitcnt vmcnt(0)
    v_subrev_u32 v252, s91, v252
    v_cmp_lt_u32 vcc, 3, v252
    s_nop 4
    s_cbranch_vccnz PSPIN_14
POK_13:
    v_mfma_f32_16x16x32_bf16 v[88:91], a[16:19], a[0:3], v[88:91]
    ds_read_b64_tr_b16 a[64:65], v20 offset:50176
    v_mfma_f32_16x16x32_bf16 v[92:95], a[16:19], a[4:7], v[92:95]
    ds_read_b64_tr_b16 a[66:67], v20 offset:50688
    v_mfma_f32_16x16x32_bf16 v[96:99], a[16:19], a[8:11], v[96:99]
    ds_read_b128 a[48:51], v204 offset:26624
    v_mfma_f32_16x16x32_bf16 v[100:103], a[16:19], a[12:15], v[100:103]
    ds_read_b128 a[52:55], v204 offset:28672
    v_mfma_f32_16x16x32_bf16 v[104:107], a[20:23], a[0:3], v[104:107]
    ds_read_b128 a[56:59], v210 offset:26624
    v_mfma_f32_16x16x32_bf16 v[108:111], a[20:23], a[4:7], v[108:111]
    ds_read_b128 a[60:63], v210 offset:28672
    v_mfma_f32_16x16x32_bf16 v[112:115], a[20:23], a[8:11], v[112:115]
    ds_read_b64_tr_b16 a[68:69], v20 offset:51200
    v_mfma_f32_16x16x32_bf16 v[116:119], a[20:23], a[12:15], v[116:119]
    ds_read_b64_tr_b16 a[70:71], v20 offset:51712
    v_mfma_f32_16x16x32_bf16 v[120:123], a[24:27], a[0:3], v[120:123]
    ds_read_b64_tr_b16 a[72:73], v20 offset:52224
    v_mfma_f32_16x16x32_bf16 v[124:127], a[24:27], a[4:7], v[124:127]
    ds_read_b64_tr_b16 a[74:75], v20 offset:52736
    v_mfma_f32_16x16x32_bf16 v[128:131], a[24:27], a[8:11], v[128:131]
    ds_read_b64_tr_b16 a[76:77], v23 offset:50176
    v_mfma_f32_16x16x32_bf16 v[132:135], a[24:27], a[12:15], v[132:135]
    ds_read_b64_tr_b16 a[78:79], v23 offset:50688
    v_mfma_f32_16x16x32_bf16 v[136:139], a[28:31], a[0:3], v[136:139]
    v_mfma_f32_16x16x32_bf16 v[140:143], a[28:31], a[4:7], v[140:143]
    s_waitcnt lgkmcnt(0)
    s_barrier
    v_accvgpr_read_b32 v6, a197
    v_accvgpr_read_b32 v7, a198
    v_lshlrev_b32 v2, 4, v1
    s_mul_i32 s75, s6, 720896
    s_add_u32 s75, s75, s54
    s_add_u32 s75, s75, 25165824
    s_lshl_b32 s52, s101, 14
    s_add_u32 s52, s52, s75
    s_lshl_b32 s53, s101, 17
    s_lshl_b32 s55, s3, 11
    s_mov_b32 s88, 0
    v_mfma_f32_16x16x32_bf16 v[88:91], a[64:67], a[48:51], v[88:91]
    ds_read_b64_tr_b16 a[16:17], v21 offset:8192
    s_add_u32 m0, s54, 73728
    v_mfma_f32_16x16x32_bf16 v[92:95], a[64:67], a[52:55], v[92:95]
    ds_read_b64_tr_b16 a[18:19], v21 offset:8704
    buffer_load_dwordx4 v2, s[32:35], s52 offen offset:0 sc1 lds
    s_add_u32 s88, s88, 1
    v_mfma_f32_16x16x32_bf16 v[96:99], a[64:67], a[56:59], v[96:99]
    ds_read_b128 a[0:3], v201 offset:57344
    s_add_u32 s89, s88, s101
    v_mfma_f32_16x16x32_bf16 v[100:103], a[64:67], a[60:63], v[100:103]
    ds_read_b128 a[4:7], v201 offset:59392
    v_mfma_f32_16x16x32_bf16 v[104:107], a[68:71], a[48:51], v[104:107]
    ds_read_b128 a[8:11], v207 offset:57344
    v_mfma_f32_16x16x32_bf16 v[108:111], a[68:71], a[52:55], v[108:111]
    ds_read_b128 a[12:15], v207 offset:59392
    buffer_load_dwordx4 v2, s[32:35], s52 offen offset:1024 sc1 lds
    s_and_b32 s89, s89, 3
    v_mfma_f32_16x16x32_bf16 v[112:115], a[68:71], a[56:59], v[112:115]
    ds_read_b64_tr_b16 a[20:21], v21 offset:9216
    s_andn2_b32 s90, s88, 3
    v_mfma_f32_16x16x32_bf16 v[116:119], a[68:71], a[60:63], v[116:119]
    ds_read_b64_tr_b16 a[22:23], v21 offset:9728
    v_mfma_f32_16x16x32_bf16 v[120:123], a[72:75], a[48:51], v[120:123]
    ds_read_b64_tr_b16 a[24:25], v21 offset:10240
    buffer_load_dwordx4 v2, s[32:35], s52 offen offset:2048 sc1 lds
    s_or_b32 s89, s89, s90
    v_mfma_f32_16x16x32_bf16 v[124:127], a[72:75], a[52:55], v[124:127]
    ds_read_b64_tr_b16 a[26:27], v21 offset:10752
    s_lshl_b32 s76, s89, 14
    v_mfma_f32_16x16x32_bf16 v[128:131], a[72:75], a[56:59], v[128:131]
    ds_read_b64_tr_b16 a[28:29], v24 offset:8192
    v_mfma_f32_16x16x32_bf16 v[132:135], a[72:75], a[60:63], v[132:135]
    ds_read_b64_tr_b16 a[30:31], v24 offset:8704
    v_mfma_f32_16x16x32_bf16 v[136:139], a[76:79], a[48:51], v[136:139]
    buffer_load_dwordx4 v2, s[32:35], s52 offen offset:3072 sc1 lds
    s_add_u32 s52, s76, s75
    v_mfma_f32_16x16x32_bf16 v[140:143], a[76:79], a[52:55], v[140:143]
    s_waitcnt lgkmcnt(0)
    v_mfma_f32_16x16x32_bf16 v[88:91], a[16:19], a[0:3], v[88:91]
    ds_read_b64_tr_b16 a[64:65], v21 offset:15360
    s_add_u32 m0, s55, 90112
    v_mfma_f32_16x16x32_bf16 v[92:95], a[16:19], a[4:7], v[92:95]
    ds_read_b64_tr_b16 a[66:67], v21 offset:15872
    buffer_load_dwordx4 v6, s[24:27], s53 offen offset:0 lds
    v_mfma_f32_16x16x32_bf16 v[96:99], a[16:19], a[8:11], v[96:99]
    ds_read_b128 a[48:51], v204 offset:57344
    v_mfma_f32_16x16x32_bf16 v[100:103], a[16:19], a[12:15], v[100:103]
    ds_read_b128 a[52:55], v204 offset:59392
    v_mfma_f32_16x16x32_bf16 v[104:107], a[20:23], a[0:3], v[104:107]
    ds_read_b128 a[56:59], v210 offset:57344
    v_mfma_f32_16x16x32_bf16 v[108:111], a[20:23], a[4:7], v[108:111]
    ds_read_b128 a[60:63], v210 offset:59392
    buffer_load_dwordx4 v7, s[24:27], s53 offen offset:1024 lds
    s_mul_i32 s53, s89, 131072
    v_mfma_f32_16x16x32_bf16 v[112:115], a[20:23], a[8:11], v[112:115]
    ds_read_b64_tr_b16 a[68:69], v21 offset:16384
    v_mfma_f32_16x16x32_bf16 v[116:119], a[20:23], a[12:15], v[116:119]
    ds_read_b64_tr_b16 a[70:71], v21 offset:16896
    s_add_u32 m0, s54, 98304
    v_mfma_f32_16x16x32_bf16 v[120:123], a[24:27], a[0:3], v[120:123]
    ds_read_b64_tr_b16 a[72:73], v21 offset:17408
    buffer_load_dwordx4 v2, s[32:35], s52 offen offset:0 sc1 lds
    s_add_u32 s88, s88, 1
    v_mfma_f32_16x16x32_bf16 v[124:127], a[24:27], a[4:7], v[124:127]
    ds_read_b64_tr_b16 a[74:75], v21 offset:17920
    s_add_u32 s89, s88, s101
    v_mfma_f32_16x16x32_bf16 v[128:131], a[24:27], a[8:11], v[128:131]
    ds_read_b64_tr_b16 a[76:77], v24 offset:15360
    v_mfma_f32_16x16x32_bf16 v[132:135], a[24:27], a[12:15], v[132:135]
    ds_read_b64_tr_b16 a[78:79], v24 offset:15872
    v_mfma_f32_16x16x32_bf16 v[136:139], a[28:31], a[0:3], v[136:139]
    buffer_load_dwordx4 v2, s[32:35], s52 offen offset:1024 sc1 lds
    s_and_b32 s89, s89, 3
    v_mfma_f32_16x16x32_bf16 v[140:143], a[28:31], a[4:7], v[140:143]
    s_andn2_b32 s90, s88, 3
    s_waitcnt lgkmcnt(0)
    s_barrier
    v_mfma_f32_16x16x32_bf16 v[88:91], a[64:67], a[48:51], v[88:91]
    ds_read_b64_tr_b16 a[16:17], v19 offset:16384
    v_mfma_f32_16x16x32_bf16 v[92:95], a[64:67], a[52:55], v[92:95]
    ds_read_b64_tr_b16 a[18:19], v19 offset:16896
    buffer_load_dwordx4 v2, s[32:35], s52 offen offset:2048 sc1 lds
    s_or_b32 s89, s89, s90
    v_mfma_f32_16x16x32_bf16 v[96:99], a[64:67], a[56:59], v[96:99]
    ds_read_b128 a[0:3], v200 offset:0
    s_lshl_b32 s76, s89, 14
    v_mfma_f32_16x16x32_bf16 v[100:103], a[64:67], a[60:63], v[100:103]
    ds_read_b128 a[4:7], v200 offset:2048
    v_mfma_f32_16x16x32_bf16 v[104:107], a[68:71], a[48:51], v[104:107]
    ds_read_b128 a[8:11], v206 offset:0
    v_mfma_f32_16x16x32_bf16 v[108:111], a[68:71], a[52:55], v[108:111]
    ds_read_b128 a[12:15], v206 offset:2048
    buffer_load_dwordx4 v2, s[32:35], s52 offen offset:3072 sc1 lds
    s_add_u32 s52, s76, s75
    v_mfma_f32_16x16x32_bf16 v[112:115], a[68:71], a[56:59], v[112:115]
    ds_read_b64_tr_b16 a[20:21], v19 offset:17408
    v_mfma_f32_16x16x32_bf16 v[116:119], a[68:71], a[60:63], v[116:119]
    ds_read_b64_tr_b16 a[22:23], v19 offset:17920
    s_add_u32 m0, s55, 114688
    v_mfma_f32_16x16x32_bf16 v[120:123], a[72:75], a[48:51], v[120:123]
    ds_read_b64_tr_b16 a[24:25], v19 offset:18432
    buffer_load_dwordx4 v6, s[24:27], s53 offen offset:0 lds
    v_mfma_f32_16x16x32_bf16 v[124:127], a[72:75], a[52:55], v[124:127]
    ds_read_b64_tr_b16 a[26:27], v19 offset:18944
    v_mfma_f32_16x16x32_bf16 v[128:131], a[72:75], a[56:59], v[128:131]
    ds_read_b64_tr_b16 a[28:29], v22 offset:16384
    v_mfma_f32_16x16x32_bf16 v[132:135], a[72:75], a[60:63], v[132:135]
    ds_read_b64_tr_b16 a[30:31], v22 offset:16896
    v_mfma_f32_16x16x32_bf16 v[136:139], a[76:79], a[48:51], v[136:139]
    buffer_load_dwordx4 v7, s[24:27], s53 offen offset:1024 lds
    s_mul_i32 s53, s89, 131072
    v_mfma_f32_16x16x32_bf16 v[140:143], a[76:79], a[52:55], v[140:143]
    s_waitcnt lgkmcnt(0)
    v_mfma_f32_16x16x32_bf16 v[88:91], a[16:19], a[0:3], v[88:91]
    ds_read_b64_tr_b16 a[64:65], v19 offset:23552
    s_add_u32 m0, s54, 122880
    v_mfma_f32_16x16x32_bf16 v[92:95], a[16:19], a[4:7], v[92:95]
    ds_read_b64_tr_b16 a[66:67], v19 offset:24064
    buffer_load_dwordx4 v2, s[32:35], s52 offen offset:0 sc1 lds
    s_add_u32 s88, s88, 1
    v_mfma_f32_16x16x32_bf16 v[96:99], a[16:19], a[8:11], v[96:99]
    ds_read_b128 a[48:51], v203 offset:0
    s_add_u32 s89, s88, s101
    v_mfma_f32_16x16x32_bf16 v[100:103], a[16:19], a[12:15], v[100:103]
    ds_read_b128 a[52:55], v203 offset:2048
    v_mfma_f32_16x16x32_bf16 v[104:107], a[20:23], a[0:3], v[104:107]
    ds_read_b128 a[56:59], v209 offset:0
    v_mfma_f32_16x16x32_bf16 v[108:111], a[20:23], a[4:7], v[108:111]
    ds_read_b128 a[60:63], v209 offset:2048
    buffer_load_dwordx4 v2, s[32:35], s52 offen offset:1024 sc1 lds
    s_and_b32 s89, s89, 3
    v_mfma_f32_16x16x32_bf16 v[112:115], a[20:23], a[8:11], v[112:115]
    ds_read_b64_tr_b16 a[68:69], v19 offset:24576
    s_andn2_b32 s90, s88, 3
    v_mfma_f32_16x16x32_bf16 v[116:119], a[20:23], a[12:15], v[116:119]
    ds_read_b64_tr_b16 a[70:71], v19 offset:25088
    v_mfma_f32_16x16x32_bf16 v[120:123], a[24:27], a[0:3], v[120:123]
    ds_read_b64_tr_b16 a[72:73], v19 offset:25600
    buffer_load_dwordx4 v2, s[32:35], s52 offen offset:2048 sc1 lds
    s_or_b32 s89, s89, s90
    v_mfma_f32_16x16x32_bf16 v[124:127], a[24:27], a[4:7], v[124:127]
    ds_read_b64_tr_b16 a[74:75], v19 offset:26112
    s_lshl_b32 s76, s89, 14
    v_mfma_f32_16x16x32_bf16 v[128:131], a[24:27], a[8:11], v[128:131]
    ds_read_b64_tr_b16 a[76:77], v22 offset:23552
    v_mfma_f32_16x16x32_bf16 v[132:135], a[24:27], a[12:15], v[132:135]
    ds_read_b64_tr_b16 a[78:79], v22 offset:24064
    v_mfma_f32_16x16x32_bf16 v[136:139], a[28:31], a[0:3], v[136:139]
    buffer_load_dwordx4 v2, s[32:35], s52 offen offset:3072 sc1 lds
    s_add_u32 s52, s76, s75
    v_mfma_f32_16x16x32_bf16 v[140:143], a[28:31], a[4:7], v[140:143]
    s_waitcnt vmcnt(16) lgkmcnt(0)
    s_barrier
    v_mfma_f32_16x16x32_bf16 v[88:91], a[64:67], a[48:51], v[88:91]
    ds_read_b64_tr_b16 a[16:17], v19 offset:47104
    s_add_u32 m0, s55, 139264
    v_mfma_f32_16x16x32_bf16 v[92:95], a[64:67], a[52:55], v[92:95]
    ds_read_b64_tr_b16 a[18:19], v19 offset:47616
    buffer_load_dwordx4 v6, s[24:27], s53 offen offset:0 lds
    v_mfma_f32_16x16x32_bf16 v[96:99], a[64:67], a[56:59], v[96:99]
    ds_read_b128 a[0:3], v200 offset:30720
    v_mfma_f32_16x16x32_bf16 v[100:103], a[64:67], a[60:63], v[100:103]
    ds_read_b128 a[4:7], v200 offset:32768
    v_mfma_f32_16x16x32_bf16 v[104:107], a[68:71], a[48:51], v[104:107]
    ds_read_b128 a[8:11], v206 offset:30720
    v_mfma_f32_16x16x32_bf16 v[108:111], a[68:71], a[52:55], v[108:111]
    ds_read_b128 a[12:15], v206 offset:32768
    buffer_load_dwordx4 v7, s[24:27], s53 offen offset:1024 lds
    s_mul_i32 s53, s89, 131072
    v_mfma_f32_16x16x32_bf16 v[112:115], a[68:71], a[56:59], v[112:115]
    ds_read_b64_tr_b16 a[20:21], v19 offset:48128
    v_mfma_f32_16x16x32_bf16 v[116:119], a[68:71], a[60:63], v[116:119]
    ds_read_b64_tr_b16 a[22:23], v19 offset:48640
    s_add_u32 m0, s54, 0
    v_mfma_f32_16x16x32_bf16 v[120:123], a[72:75], a[48:51], v[120:123]
    ds_read_b64_tr_b16 a[24:25], v19 offset:49152
    buffer_load_dwordx4 v2, s[32:35], s52 offen offset:0 sc1 lds
    s_add_u32 s88, s88, 1
    v_mfma_f32_16x16x32_bf16 v[124:127], a[72:75], a[52:55], v[124:127]
    ds_read_b64_tr_b16 a[26:27], v19 offset:49664
    s_add_u32 s89, s88, s101
    v_mfma_f32_16x16x32_bf16 v[128:131], a[72:75], a[56:59], v[128:131]
    ds_read_b64_tr_b16 a[28:29], v22 offset:47104
    v_mfma_f32_16x16x32_bf16 v[132:135], a[72:75], a[60:63], v[132:135]
    ds_read_b64_tr_b16 a[30:31], v22 offset:47616
    v_mfma_f32_16x16x32_bf16 v[136:139], a[76:79], a[48:51], v[136:139]
    buffer_load_dwordx4 v2, s[32:35], s52 offen offset:1024 sc1 lds
    s_and_b32 s89, s89, 3
    v_mfma_f32_16x16x32_bf16 v[140:143], a[76:79], a[52:55], v[140:143]
    s_andn2_b32 s90, s88, 3
    s_waitcnt lgkmcnt(0)
    v_mfma_f32_16x16x32_bf16 v[88:91], a[16:19], a[0:3], v[88:91]
    ds_read_b64_tr_b16 a[64:65], v19 offset:54272
    v_mfma_f32_16x16x32_bf16 v[92:95], a[16:19], a[4:7], v[92:95]
    ds_read_b64_tr_b16 a[66:67], v19 offset:54784
    buffer_load_dwordx4 v2, s[32:35], s52 offen offset:2048 sc1 lds
    s_or_b32 s89, s89, s90
    v_mfma_f32_16x16x32_bf16 v[96:99], a[16:19], a[8:11], v[96:99]
    ds_read_b128 a[48:51], v203 offset:30720
    s_lshl_b32 s76, s89, 14
    v_mfma_f32_16x16x32_bf16 v[100:103], a[16:19], a[12:15], v[100:103]
    ds_read_b128 a[52:55], v203 offset:32768
    v_mfma_f32_16x16x32_bf16 v[104:107], a[20:23], a[0:3], v[104:107]
    ds_read_b128 a[56:59], v209 offset:30720
    v_mfma_f32_16x16x32_bf16 v[108:111], a[20:23], a[4:7], v[108:111]
    ds_read_b128 a[60:63], v209 offset:32768
    buffer_load_dwordx4 v2, s[32:35], s52 offen offset:3072 sc1 lds
    s_add_u32 s52, s76, s75
    v_mfma_f32_16x16x32_bf16 v[112:115], a[20:23], a[8:11], v[112:115]
    ds_read_b64_tr_b16 a[68:69], v19 offset:55296
    v_mfma_f32_16x16x32_bf16 v[116:119], a[20:23], a[12:15], v[116:119]
    ds_read_b64_tr_b16 a[70:71], v19 offset:55808
    s_add_u32 m0, s55, 16384
    v_mfma_f32_16x16x32_bf16 v[120:123], a[24:27], a[0:3], v[120:123]
    ds_read_b64_tr_b16 a[72:73], v19 offset:56320
    buffer_load_dwordx4 v6, s[24:27], s53 offen offset:0 lds
    v_mfma_f32_16x16x32_bf16 v[124:127], a[24:27], a[4:7], v[124:127]
    ds_read_b64_tr_b16 a[74:75], v19 offset:56832
    v_mfma_f32_16x16x32_bf16 v[128:131], a[24:27], a[8:11], v[128:131]
    ds_read_b64_tr_b16 a[76:77], v22 offset:54272
    v_mfma_f32_16x16x32_bf16 v[132:135], a[24:27], a[12:15], v[132:135]
    ds_read_b64_tr_b16 a[78:79], v22 offset:54784
    v_mfma_f32_16x16x32_bf16 v[136:139], a[28:31], a[0:3], v[136:139]
    buffer_load_dwordx4 v7, s[24:27], s53 offen offset:1024 lds
    s_mul_i32 s53, s89, 131072
    v_mfma_f32_16x16x32_bf16 v[140:143], a[28:31], a[4:7], v[140:143]
    s_waitcnt lgkmcnt(0)
    s_barrier
    v_mfma_f32_16x16x32_bf16 v[88:91], a[64:67], a[48:51], v[88:91]
    s_add_u32 m0, s54, 24576
    v_mfma_f32_16x16x32_bf16 v[92:95], a[64:67], a[52:55], v[92:95]
    buffer_load_dwordx4 v2, s[32:35], s52 offen offset:0 sc1 lds
    s_add_u32 s88, s88, 1
    v_mfma_f32_16x16x32_bf16 v[96:99], a[64:67], a[56:59], v[96:99]
    s_add_u32 s89, s88, s101
    v_mfma_f32_16x16x32_bf16 v[100:103], a[64:67], a[60:63], v[100:103]
    v_mfma_f32_16x16x32_bf16 v[104:107], a[68:71], a[48:51], v[104:107]
    v_mfma_f32_16x16x32_bf16 v[108:111], a[68:71], a[52:55], v[108:111]
    buffer_load_dwordx4 v2, s[32:35], s52 offen offset:1024 sc1 lds
    s_and_b32 s89, s89, 3
    v_mfma_f32_16x16x32_bf16 v[112:115], a[68:71], a[56:59], v[112:115]
    s_andn2_b32 s90, s88, 3
    v_mfma_f32_16x16x32_bf16 v[116:119], a[68:71], a[60:63], v[116:119]
    v_mfma_f32_16x16x32_bf16 v[120:123], a[72:75], a[48:51], v[120:123]
    buffer_load_dwordx4 v2, s[32:35], s52 offen offset:2048 sc1 lds
    s_or_b32 s89, s89, s90
    v_mfma_f32_16x16x32_bf16 v[124:127], a[72:75], a[52:55], v[124:127]
    s_lshl_b32 s76, s89, 14
    v_mfma_f32_16x16x32_bf16 v[128:131], a[72:75], a[56:59], v[128:131]
    v_mfma_f32_16x16x32_bf16 v[132:135], a[72:75], a[60:63], v[132:135]
    v_mfma_f32_16x16x32_bf16 v[136:139], a[76:79], a[48:51], v[136:139]
    buffer_load_dwordx4 v2, s[32:35], s52 offen offset:3072 sc1 lds
    s_add_u32 s52, s76, s75
    v_mfma_f32_16x16x32_bf16 v[140:143], a[76:79], a[52:55], v[140:143]
    v_lshlrev_b32 v248, 16, v248
    v_lshlrev_b32 v249, 16, v249
    v_lshlrev_b32 v250, 16, v250
    v_lshlrev_b32 v251, 16, v251
    v_bfe_u32 v25, v1, 4, 1
    v_lshlrev_b32 v25, 10, v25
    v_lshrrev_b32 v26, 5, v1
    v_lshl_or_b32 v25, v26, 8, v25
    v_and_b32 v26, 15, v1
    v_lshl_or_b32 v25, v26, 4, v25
    s_add_u32 m0, s55, 40960
    s_nop 0
    buffer_load_dwordx4 v6, s[24:27], s53 offen offset:0 lds
    s_lshl_b32 s57, s5, 11
    v_or_b32 v25, s57, v25
    v_xor_b32 v26, 2048, v25
    s_mul_i32 s61, s6, 720896
    s_lshl_b32 s57, s4, 12
    s_add_u32 s61, s61, s57
    s_add_u32 s61, s61, 25427968
    s_mul_i32 s60, s7, 7
    s_lshl_b32 s63, s5, 2
    s_add_u32 s63, s63, s60
    buffer_load_dwordx4 v7, s[24:27], s53 offen offset:1024 lds
    s_add_u32 s56, s63, 0
    s_lshr_b32 s62, s56, 1
    s_lshl_b32 s62, s62, 13
    s_and_b32 s56, s56, 1
    s_lshl_b32 s56, s56, 9
    s_add_u32 s56, s56, s62
    s_add_u32 s56, s56, s61
    s_add_u32 s57, s63, 1
    s_lshr_b32 s62, s57, 1
    s_lshl_b32 s62, s62, 13
    s_mul_i32 s53, s89, 131072
    s_add_u32 m0, s54, 49152
    s_nop 0
    buffer_load_dwordx4 v2, s[32:35], s52 offen offset:0 sc1 lds
    s_and_b32 s57, s57, 1
    s_lshl_b32 s57, s57, 9
    s_add_u32 s57, s57, s62
    s_add_u32 s57, s57, s61
    s_add_u32 s58, s63, 2
    s_lshr_b32 s62, s58, 1
    s_lshl_b32 s62, s62, 13
    s_and_b32 s58, s58, 1
    s_lshl_b32 s58, s58, 9
    s_add_u32 s58, s58, s62
    s_add_u32 s88, s88, 1
    s_add_u32 s89, s88, s101
    buffer_load_dwordx4 v2, s[32:35], s52 offen offset:1024 sc1 lds
    s_add_u32 s58, s58, s61
    s_add_u32 s59, s60, 3
    s_lshr_b32 s62, s59, 1
    s_lshl_b32 s62, s62, 13
    s_and_b32 s59, s59, 1
    s_lshl_b32 s59, s59, 9
    s_add_u32 s59, s59, s62
    s_add_u32 s59, s59, s61
    s_mov_b32 s60, 0xffff0000
    v_lshlrev_b32 v212, 16, v32
    s_and_b32 s89, s89, 3
    s_andn2_b32 s90, s88, 3
    buffer_load_dwordx4 v2, s[32:35], s52 offen offset:2048 sc1 lds
    v_and_b32 v213, s60, v32
    v_lshlrev_b32 v214, 16, v33
    v_and_b32 v215, s60, v33
    v_pk_add_f32 v[88:89], v[88:89], v[248:249] op_sel_hi:[1,0]
    v_pk_add_f32 v[90:91], v[90:91], v[248:249] op_sel_hi:[1,0]
    v_pk_mul_f32 v[88:89], v[88:89], v[212:213]
    v_pk_mul_f32 v[90:91], v[90:91], v[214:215]
    v_cvt_pk_bf16_f32 v152, v88, v89
    v_cvt_pk_bf16_f32 v153, v90, v91
    v_lshlrev_b32 v216, 16, v34
    s_or_b32 s89, s89, s90
    s_lshl_b32 s76, s89, 14
    buffer_load_dwordx4 v2, s[32:35], s52 offen offset:3072 sc1 lds
    v_and_b32 v217, s60, v34
    v_lshlrev_b32 v218, 16, v35
    v_and_b32 v219, s60, v35
    v_pk_add_f32 v[92:93], v[92:93], v[248:249] op_sel:[0,1] op_sel_hi:[1,1]
    v_pk_add_f32 v[94:95], v[94:95], v[248:249] op_sel:[0,1] op_sel_hi:[1,1]
    v_pk_mul_f32 v[92:93], v[92:93], v[216:217]
    v_pk_mul_f32 v[94:95], v[94:95], v[218:219]
    v_cvt_pk_bf16_f32 v154, v92, v93
    v_cvt_pk_bf16_f32 v155, v94, v95
    s_nop 0
    v_permlane16_swap_b32 v152, v154
    s_add_u32 s52, s76, s75
    s_add_u32 m0, s55, 65536
    s_nop 0
    buffer_load_dwordx4 v6, s[24:27], s53 offen offset:0 lds
    v_permlane16_swap_b32 v153, v155
    buffer_store_dwordx4 v[152:155], v25, s[32:35], s56 offen sc1
    v_lshlrev_b32 v220, 16, v36
    v_and_b32 v221, s60, v36
    v_lshlrev_b32 v222, 16, v37
    v_and_b32 v223, s60, v37
    v_pk_add_f32 v[96:97], v[96:97], v[250:251] op_sel_hi:[1,0]
    v_pk_add_f32 v[98:99], v[98:99], v[250:251] op_sel_hi:[1,0]
    v_pk_mul_f32 v[96:97], v[96:97], v[220:221]
    v_pk_mul_f32 v[98:99], v[98:99], v[222:223]
    buffer_load_dwordx4 v7, s[24:27], s53 offen offset:1024 lds
    v_cvt_pk_bf16_f32 v156, v96, v97
    v_cvt_pk_bf16_f32 v157, v98, v99
    v_lshlrev_b32 v224, 16, v38
    v_and_b32 v225, s60, v38
    v_lshlrev_b32 v226, 16, v39
    v_and_b32 v227, s60, v39
    v_pk_add_f32 v[100:101], v[100:101], v[250:251] op_sel:[0,1] op_sel_hi:[1,1]
    v_pk_add_f32 v[102:103], v[102:103], v[250:251] op_sel:[0,1] op_sel_hi:[1,1]
    v_pk_mul_f32 v[100:101], v[100:101], v[224:225]
    v_pk_mul_f32 v[102:103], v[102:103], v[226:227]
    s_mul_i32 s53, s89, 131072
    v_cvt_pk_bf16_f32 v158, v100, v101
    v_cvt_pk_bf16_f32 v159, v102, v103
    s_nop 0
    v_permlane16_swap_b32 v156, v158
    v_permlane16_swap_b32 v157, v159
    buffer_store_dwordx4 v[156:159], v26, s[32:35], s56 offen sc1
    v_lshlrev_b32 v212, 16, v40
    v_and_b32 v213, s60, v40
    v_lshlrev_b32 v214, 16, v41
    v_and_b32 v215, s60, v41
    v_pk_add_f32 v[104:105], v[104:105], v[248:249] op_sel_hi:[1,0]
    v_pk_add_f32 v[106:107], v[106:107], v[248:249] op_sel_hi:[1,0]
    v_pk_mul_f32 v[104:105], v[104:105], v[212:213]
    v_pk_mul_f32 v[106:107], v[106:107], v[214:215]
    v_cvt_pk_bf16_f32 v160, v104, v105
    v_cvt_pk_bf16_f32 v161, v106, v107
    v_lshlrev_b32 v216, 16, v42
    v_and_b32 v217, s60, v42
    v_lshlrev_b32 v218, 16, v43
    v_and_b32 v219, s60, v43
    v_pk_add_f32 v[108:109], v[108:109], v[248:249] op_sel:[0,1] op_sel_hi:[1,1]
    v_pk_add_f32 v[110:111], v[110:111], v[248:249] op_sel:[0,1] op_sel_hi:[1,1]
    v_pk_mul_f32 v[108:109], v[108:109], v[216:217]
    v_pk_mul_f32 v[110:111], v[110:111], v[218:219]
    v_cvt_pk_bf16_f32 v162, v108, v109
    v_cvt_pk_bf16_f32 v163, v110, v111
    s_nop 0
    v_permlane16_swap_b32 v160, v162
    v_permlane16_swap_b32 v161, v163
    buffer_store_dwordx4 v[160:163], v25, s[32:35], s57 offen sc1
    v_lshlrev_b32 v220, 16, v44
    v_and_b32 v221, s60, v44
    v_lshlrev_b32 v222, 16, v45
    v_and_b32 v223, s60, v45
    v_pk_add_f32 v[112:113], v[112:113], v[250:251] op_sel_hi:[1,0]
    v_pk_add_f32 v[114:115], v[114:115], v[250:251] op_sel_hi:[1,0]
    v_pk_mul_f32 v[112:113], v[112:113], v[220:221]
    v_pk_mul_f32 v[114:115], v[114:115], v[222:223]
    v_cvt_pk_bf16_f32 v164, v112, v113
    v_cvt_pk_bf16_f32 v165, v114, v115
    v_lshlrev_b32 v224, 16, v46
    v_and_b32 v225, s60, v46
    v_lshlrev_b32 v226, 16, v47
    v_and_b32 v227, s60, v47
    v_pk_add_f32 v[116:117], v[116:117], v[250:251] op_sel:[0,1] op_sel_hi:[1,1]
    v_pk_add_f32 v[118:119], v[118:119], v[250:251] op_sel:[0,1] op_sel_hi:[1,1]
    v_pk_mul_f32 v[116:117], v[116:117], v[224:225]
    v_pk_mul_f32 v[118:119], v[118:119], v[226:227]
    v_cvt_pk_bf16_f32 v166, v116, v117
    v_cvt_pk_bf16_f32 v167, v118, v119
    s_nop 0
    v_permlane16_swap_b32 v164, v166
    v_permlane16_swap_b32 v165, v167
    buffer_store_dwordx4 v[164:167], v26, s[32:35], s57 offen sc1
    v_lshlrev_b32 v212, 16, v48
    v_and_b32 v213, s60, v48
    v_lshlrev_b32 v214, 16, v49
    v_and_b32 v215, s60, v49
    v_pk_add_f32 v[120:121], v[120:121], v[248:249] op_sel_hi:[1,0]
    v_pk_add_f32 v[122:123], v[122:123], v[248:249] op_sel_hi:[1,0]
    v_pk_mul_f32 v[120:121], v[120:121], v[212:213]
    v_pk_mul_f32 v[122:123], v[122:123], v[214:215]
    v_cvt_pk_bf16_f32 v168, v120, v121
    v_cvt_pk_bf16_f32 v169, v122, v123
    v_lshlrev_b32 v216, 16, v50
    v_and_b32 v217, s60, v50
    v_lshlrev_b32 v218, 16, v51
    v_and_b32 v219, s60, v51
    v_pk_add_f32 v[124:125], v[124:125], v[248:249] op_sel:[0,1] op_sel_hi:[1,1]
    v_pk_add_f32 v[126:127], v[126:127], v[248:249] op_sel:[0,1] op_sel_hi:[1,1]
    v_pk_mul_f32 v[124:125], v[124:125], v[216:217]
    v_pk_mul_f32 v[126:127], v[126:127], v[218:219]
    v_cvt_pk_bf16_f32 v170, v124, v125
    v_cvt_pk_bf16_f32 v171, v126, v127
    s_nop 0
    v_permlane16_swap_b32 v168, v170
    v_permlane16_swap_b32 v169, v171
    buffer_store_dwordx4 v[168:171], v25, s[32:35], s58 offen sc1
    v_lshlrev_b32 v220, 16, v52
    v_and_b32 v221, s60, v52
    v_lshlrev_b32 v222, 16, v53
    v_and_b32 v223, s60, v53
    v_pk_add_f32 v[128:129], v[128:129], v[250:251] op_sel_hi:[1,0]
    v_pk_add_f32 v[130:131], v[130:131], v[250:251] op_sel_hi:[1,0]
    v_pk_mul_f32 v[128:129], v[128:129], v[220:221]
    v_pk_mul_f32 v[130:131], v[130:131], v[222:223]
    v_cvt_pk_bf16_f32 v172, v128, v129
    v_cvt_pk_bf16_f32 v173, v130, v131
    v_lshlrev_b32 v224, 16, v54
    v_and_b32 v225, s60, v54
    v_lshlrev_b32 v226, 16, v55
    v_and_b32 v227, s60, v55
    v_pk_add_f32 v[132:133], v[132:133], v[250:251] op_sel:[0,1] op_sel_hi:[1,1]
    v_pk_add_f32 v[134:135], v[134:135], v[250:251] op_sel:[0,1] op_sel_hi:[1,1]
    v_pk_mul_f32 v[132:133], v[132:133], v[224:225]
    v_pk_mul_f32 v[134:135], v[134:135], v[226:227]
    v_cvt_pk_bf16_f32 v174, v132, v133
    v_cvt_pk_bf16_f32 v175, v134, v135
    s_nop 0
    v_permlane16_swap_b32 v172, v174
    v_permlane16_swap_b32 v173, v175
    buffer_store_dwordx4 v[172:175], v26, s[32:35], s58 offen sc1
    v_lshlrev_b32 v212, 16, v80
    v_and_b32 v213, s60, v80
    v_lshlrev_b32 v214, 16, v81
    v_and_b32 v215, s60, v81
    v_pk_add_f32 v[136:137], v[136:137], v[248:249] op_sel_hi:[1,0]
    v_pk_add_f32 v[138:139], v[138:139], v[248:249] op_sel_hi:[1,0]
    v_pk_mul_f32 v[136:137], v[136:137], v[212:213]
    v_pk_mul_f32 v[138:139], v[138:139], v[214:215]
    v_cvt_pk_bf16_f32 v176, v136, v137
    v_cvt_pk_bf16_f32 v177, v138, v139
    v_lshlrev_b32 v216, 16, v82
    v_and_b32 v217, s60, v82
    v_lshlrev_b32 v218, 16, v83
    v_and_b32 v219, s60, v83
    v_pk_add_f32 v[140:141], v[140:141], v[248:249] op_sel:[0,1] op_sel_hi:[1,1]
    v_pk_add_f32 v[142:143], v[142:143], v[248:249] op_sel:[0,1] op_sel_hi:[1,1]
    v_pk_mul_f32 v[140:141], v[140:141], v[216:217]
    v_pk_mul_f32 v[142:143], v[142:143], v[218:219]
    v_cvt_pk_bf16_f32 v178, v140, v141
    v_cvt_pk_bf16_f32 v179, v142, v143
    s_nop 0
    v_permlane16_swap_b32 v176, v178
    v_permlane16_swap_b32 v177, v179
    buffer_store_dwordx4 v[176:179], v25, s[32:35], s59 offen sc1
    v_accvgpr_read_b32 v19, a199
    v_xor_b32 v22, 32, v19
    v_add_u32 v20, 0x10000, v19
    v_add_u32 v21, 0x20000, v19
    v_add_u32 v23, 0x10000, v22
    v_add_u32 v24, 0x20000, v22
    s_lshl_b32 s60, s4, 12
    v_add_u32 v13, s60, v2
    v_add_u32 v14, 0x10000, v13
    v_add_u32 v15, 0x20000, v13
    s_waitcnt vmcnt(31)
    s_barrier
    ds_read_b64_tr_b16 a[16:17], v20 offset:24576
    ds_read_b64_tr_b16 a[18:19], v20 offset:25088
    ds_read_b128 a[0:3], v14 offset:8192
    ds_read_b128 a[4:7], v14 offset:9216
    ds_read_b128 a[8:11], v14 offset:10240
    ds_read_b128 a[12:15], v14 offset:11264
    ds_read_b64_tr_b16 a[20:21], v23 offset:24576
    ds_read_b64_tr_b16 a[22:23], v23 offset:25088
    ds_read_b64_tr_b16 a[48:49], v20 offset:28672
    ds_read_b64_tr_b16 a[50:51], v20 offset:29184
    ds_read_b128 a[32:35], v14 offset:16384
    ds_read_b128 a[36:39], v14 offset:17408
    ds_read_b128 a[40:43], v14 offset:18432
    ds_read_b128 a[44:47], v14 offset:19456
    ds_read_b64_tr_b16 a[52:53], v23 offset:28672
    ds_read_b64_tr_b16 a[54:55], v23 offset:29184
    s_waitcnt lgkmcnt(8)
    v_mfma_f32_16x16x32_bf16 v[88:91], a[16:19], a[0:3], 0
    ds_read_b64_tr_b16 a[80:81], v20 offset:49152
    v_mfma_f32_16x16x32_bf16 v[92:95], a[16:19], a[4:7], 0
    ds_read_b64_tr_b16 a[82:83], v20 offset:49664
    v_mfma_f32_16x16x32_bf16 v[96:99], a[16:19], a[8:11], 0
    ds_read_b128 a[64:67], v14 offset:32768
    v_mfma_f32_16x16x32_bf16 v[100:103], a[16:19], a[12:15], 0
    ds_read_b128 a[68:71], v14 offset:33792
    v_mfma_f32_16x16x32_bf16 v[104:107], a[20:23], a[0:3], 0
    ds_read_b128 a[72:75], v14 offset:34816
    v_mfma_f32_16x16x32_bf16 v[108:111], a[20:23], a[4:7], 0
    ds_read_b128 a[76:79], v14 offset:35840
    v_mfma_f32_16x16x32_bf16 v[112:115], a[20:23], a[8:11], 0
    ds_read_b64_tr_b16 a[84:85], v23 offset:49152
    v_mfma_f32_16x16x32_bf16 v[116:119], a[20:23], a[12:15], 0
    ds_read_b64_tr_b16 a[86:87], v23 offset:49664
    s_waitcnt vmcnt(25) lgkmcnt(8)
    s_barrier
    v_mfma_f32_16x16x32_bf16 v[88:91], a[48:51], a[32:35], v[88:91]
    ds_read_b64_tr_b16 a[16:17], v20 offset:53248
    s_add_u32 m0, s54, 73728
    v_mfma_f32_16x16x32_bf16 v[92:95], a[48:51], a[36:39], v[92:95]
    ds_read_b64_tr_b16 a[18:19], v20 offset:53760
    buffer_load_dwordx4 v2, s[32:35], s52 offen offset:0 sc1 lds
    s_add_u32 s88, s88, 1
    v_mfma_f32_16x16x32_bf16 v[96:99], a[48:51], a[40:43], v[96:99]
    ds_read_b128 a[0:3], v14 offset:40960
    s_add_u32 s89, s88, s101
    v_mfma_f32_16x16x32_bf16 v[100:103], a[48:51], a[44:47], v[100:103]
    ds_read_b128 a[4:7], v14 offset:41984
    v_mfma_f32_16x16x32_bf16 v[104:107], a[52:55], a[32:35], v[104:107]
    ds_read_b128 a[8:11], v14 offset:43008
    buffer_load_dwordx4 v2, s[32:35], s52 offen offset:1024 sc1 lds
    s_and_b32 s89, s89, 3
    v_mfma_f32_16x16x32_bf16 v[108:111], a[52:55], a[36:39], v[108:111]
    ds_read_b128 a[12:15], v14 offset:44032
    s_andn2_b32 s90, s88, 3
    v_mfma_f32_16x16x32_bf16 v[112:115], a[52:55], a[40:43], v[112:115]
    ds_read_b64_tr_b16 a[20:21], v23 offset:53248
    buffer_load_dwordx4 v2, s[32:35], s52 offen offset:2048 sc1 lds
    s_or_b32 s89, s89, s90
    v_mfma_f32_16x16x32_bf16 v[116:119], a[52:55], a[44:47], v[116:119]
    ds_read_b64_tr_b16 a[22:23], v23 offset:53760
    s_lshl_b32 s76, s89, 14
    s_waitcnt lgkmcnt(8)
    v_mfma_f32_16x16x32_bf16 v[88:91], a[80:83], a[64:67], v[88:91]
    ds_read_b64_tr_b16 a[48:49], v21 offset:8192
    v_mfma_f32_16x16x32_bf16 v[92:95], a[80:83], a[68:71], v[92:95]
    ds_read_b64_tr_b16 a[50:51], v21 offset:8704
    buffer_load_dwordx4 v2, s[32:35], s52 offen offset:3072 sc1 lds
    s_add_u32 s52, s76, s75
    v_mfma_f32_16x16x32_bf16 v[96:99], a[80:83], a[72:75], v[96:99]
    ds_read_b128 a[32:35], v14 offset:57344
    v_mfma_f32_16x16x32_bf16 v[100:103], a[80:83], a[76:79], v[100:103]
    ds_read_b128 a[36:39], v14 offset:58368
    s_add_u32 m0, s55, 90112
    v_mfma_f32_16x16x32_bf16 v[104:107], a[84:87], a[64:67], v[104:107]
    ds_read_b128 a[40:43], v14 offset:59392
    buffer_load_dwordx4 v6, s[24:27], s53 offen offset:0 lds
    v_mfma_f32_16x16x32_bf16 v[108:111], a[84:87], a[68:71], v[108:111]
    ds_read_b128 a[44:47], v14 offset:60416
    v_mfma_f32_16x16x32_bf16 v[112:115], a[84:87], a[72:75], v[112:115]
    ds_read_b64_tr_b16 a[52:53], v24 offset:8192
    buffer_load_dwordx4 v7, s[24:27], s53 offen offset:1024 lds
    s_mul_i32 s53, s89, 131072
    v_mfma_f32_16x16x32_bf16 v[116:119], a[84:87], a[76:79], v[116:119]
    ds_read_b64_tr_b16 a[54:55], v24 offset:8704
    s_waitcnt vmcnt(25) lgkmcnt(8)
    s_barrier
    v_mfma_f32_16x16x32_bf16 v[88:91], a[16:19], a[0:3], v[88:91]
    ds_read_b64_tr_b16 a[80:81], v21 offset:12288
    s_add_u32 m0, s54, 98304
    v_mfma_f32_16x16x32_bf16 v[92:95], a[16:19], a[4:7], v[92:95]
    ds_read_b64_tr_b16 a[82:83], v21 offset:12800
    buffer_load_dwordx4 v2, s[32:35], s52 offen offset:0 sc1 lds
    s_add_u32 s88, s88, 1
    v_mfma_f32_16x16x32_bf16 v[96:99], a[16:19], a[8:11], v[96:99]
    ds_read_b128 a[64:67], v15 offset:0
    s_add_u32 s89, s88, s101
    v_mfma_f32_16x16x32_bf16 v[100:103], a[16:19], a[12:15], v[100:103]
    ds_read_b128 a[68:71], v15 offset:1024
    v_mfma_f32_16x16x32_bf16 v[104:107], a[20:23], a[0:3], v[104:107]
    ds_read_b128 a[72:75], v15 offset:2048
    buffer_load_dwordx4 v2, s[32:35], s52 offen offset:1024 sc1 lds
    s_and_b32 s89, s89, 3
    v_mfma_f32_16x16x32_bf16 v[108:111], a[20:23], a[4:7], v[108:111]
    ds_read_b128 a[76:79], v15 offset:3072
    s_andn2_b32 s90, s88, 3
    v_mfma_f32_16x16x32_bf16 v[112:115], a[20:23], a[8:11], v[112:115]
    ds_read_b64_tr_b16 a[84:85], v24 offset:12288
    buffer_load_dwordx4 v2, s[32:35], s52 offen offset:2048 sc1 lds
    s_or_b32 s89, s89, s90
    v_mfma_f32_16x16x32_bf16 v[116:119], a[20:23], a[12:15], v[116:119]
    ds_read_b64_tr_b16 a[86:87], v24 offset:12800
    s_lshl_b32 s76, s89, 14
    s_waitcnt lgkmcnt(8)
    v_mfma_f32_16x16x32_bf16 v[88:91], a[48:51], a[32:35], v[88:91]
    ds_read_b64_tr_b16 a[16:17], v19 offset:16384
    v_mfma_f32_16x16x32_bf16 v[92:95], a[48:51], a[36:39], v[92:95]
    ds_read_b64_tr_b16 a[18:19], v19 offset:16896
    buffer_load_dwordx4 v2, s[32:35], s52 offen offset:3072 sc1 lds
    s_add_u32 s52, s76, s75
    v_mfma_f32_16x16x32_bf16 v[96:99], a[48:51], a[40:43], v[96:99]
    ds_read_b128 a[0:3], v13 offset:0
    v_mfma_f32_16x16x32_bf16 v[100:103], a[48:51], a[44:47], v[100:103]
    ds_read_b128 a[4:7], v13 offset:1024
    s_add_u32 m0, s55, 114688
    v_mfma_f32_16x16x32_bf16 v[104:107], a[52:55], a[32:35], v[104:107]
    ds_read_b128 a[8:11], v13 offset:2048
    buffer_load_dwordx4 v6, s[24:27], s53 offen offset:0 lds
    v_mfma_f32_16x16x32_bf16 v[108:111], a[52:55], a[36:39], v[108:111]
    ds_read_b128 a[12:15], v13 offset:3072
    v_mfma_f32_16x16x32_bf16 v[112:115], a[52:55], a[40:43], v[112:115]
    ds_read_b64_tr_b16 a[20:21], v22 offset:16384
    buffer_load_dwordx4 v7, s[24:27], s53 offen offset:1024 lds
    s_mul_i32 s53, s89, 131072
    v_mfma_f32_16x16x32_bf16 v[116:119], a[52:55], a[44:47], v[116:119]
    ds_read_b64_tr_b16 a[22:23], v22 offset:16896
    s_waitcnt vmcnt(25) lgkmcnt(8)
    s_barrier
    v_mfma_f32_16x16x32_bf16 v[88:91], a[80:83], a[64:67], v[88:91]
    ds_read_b64_tr_b16 a[48:49], v19 offset:20480
    s_add_u32 m0, s54, 122880
    v_mfma_f32_16x16x32_bf16 v[92:95], a[80:83], a[68:71], v[92:95]
    ds_read_b64_tr_b16 a[50:51], v19 offset:20992
    buffer_load_dwordx4 v2, s[32:35], s52 offen offset:0 sc1 lds
    s_add_u32 s88, s88, 1
    v_mfma_f32_16x16x32_bf16 v[96:99], a[80:83], a[72:75], v[96:99]
    ds_read_b128 a[32:35], v13 offset:8192
    s_add_u32 s89, s88, s101
    v_mfma_f32_16x16x32_bf16 v[100:103], a[80:83], a[76:79], v[100:103]
    ds_read_b128 a[36:39], v13 offset:9216
    v_mfma_f32_16x16x32_bf16 v[104:107], a[84:87], a[64:67], v[104:107]
    ds_read_b128 a[40:43], v13 offset:10240
    buffer_load_dwordx4 v2, s[32:35], s52 offen offset:1024 sc1 lds
    s_and_b32 s89, s89, 3
    v_mfma_f32_16x16x32_bf16 v[108:111], a[84:87], a[68:71], v[108:111]
    ds_read_b128 a[44:47], v13 offset:11264
    s_andn2_b32 s90, s88, 3
    v_mfma_f32_16x16x32_bf16 v[112:115], a[84:87], a[72:75], v[112:115]
    ds_read_b64_tr_b16 a[52:53], v22 offset:20480
    buffer_load_dwordx4 v2, s[32:35], s52 offen offset:2048 sc1 lds
    s_or_b32 s89, s89, s90
    v_mfma_f32_16x16x32_bf16 v[116:119], a[84:87], a[76:79], v[116:119]
    ds_read_b64_tr_b16 a[54:55], v22 offset:20992
    s_lshl_b32 s76, s89, 14
    s_waitcnt lgkmcnt(8)
    v_mfma_f32_16x16x32_bf16 v[88:91], a[16:19], a[0:3], v[88:91]
    ds_read_b64_tr_b16 a[80:81], v19 offset:40960
    v_mfma_f32_16x16x32_bf16 v[92:95], a[16:19], a[4:7], v[92:95]
    ds_read_b64_tr_b16 a[82:83], v19 offset:41472
    buffer_load_dwordx4 v2, s[32:35], s52 offen offset:3072 sc1 lds
    s_add_u32 s52, s76, s75
    v_mfma_f32_16x16x32_bf16 v[96:99], a[16:19], a[8:11], v[96:99]
    ds_read_b128 a[64:67], v13 offset:24576
    v_mfma_f32_16x16x32_bf16 v[100:103], a[16:19], a[12:15], v[100:103]
    ds_read_b128 a[68:71], v13 offset:25600
    s_add_u32 m0, s55, 139264
    v_mfma_f32_16x16x32_bf16 v[104:107], a[20:23], a[0:3], v[104:107]
    ds_read_b128 a[72:75], v13 offset:26624
    buffer_load_dwordx4 v6, s[24:27], s53 offen offset:0 lds
    v_mfma_f32_16x16x32_bf16 v[108:111], a[20:23], a[4:7], v[108:111]
    ds_read_b128 a[76:79], v13 offset:27648
    v_mfma_f32_16x16x32_bf16 v[112:115], a[20:23], a[8:11], v[112:115]
    ds_read_b64_tr_b16 a[84:85], v22 offset:40960
    buffer_load_dwordx4 v7, s[24:27], s53 offen offset:1024 lds
    s_mul_i32 s53, s89, 131072
    v_mfma_f32_16x16x32_bf16 v[116:119], a[20:23], a[12:15], v[116:119]
    ds_read_b64_tr_b16 a[86:87], v22 offset:41472
    s_waitcnt vmcnt(18) lgkmcnt(8)
    s_barrier
    s_cmp_lg_u32 s3, 1
    s_cbranch_scc1 PUB_15
    s_add_u32 s99, s94, 5
    v_mov_b32 v0, s99
    s_mov_b64 exec, 1
    buffer_store_dword v0, v255, s[32:35], s92 offen sc1
    s_mov_b64 exec, -1
PUB_15:
    v_mfma_f32_16x16x32_bf16 v[88:91], a[48:51], a[32:35], v[88:91]
    ds_read_b64_tr_b16 a[16:17], v19 offset:45056
    s_add_u32 m0, s54, 0
    v_mfma_f32_16x16x32_bf16 v[92:95], a[48:51], a[36:39], v[92:95]
    ds_read_b64_tr_b16 a[18:19], v19 offset:45568
    buffer_load_dwordx4 v2, s[32:35], s52 offen offset:0 sc1 lds
    s_add_u32 s88, s88, 1
    v_mfma_f32_16x16x32_bf16 v[96:99], a[48:51], a[40:43], v[96:99]
    ds_read_b128 a[0:3], v13 offset:32768
    s_add_u32 s89, s88, s101
    v_mfma_f32_16x16x32_bf16 v[100:103], a[48:51], a[44:47], v[100:103]
    ds_read_b128 a[4:7], v13 offset:33792
    v_mfma_f32_16x16x32_bf16 v[104:107], a[52:55], a[32:35], v[104:107]
    ds_read_b128 a[8:11], v13 offset:34816
    buffer_load_dwordx4 v2, s[32:35], s52 offen offset:1024 sc1 lds
    s_and_b32 s89, s89, 3
    v_mfma_f32_16x16x32_bf16 v[108:111], a[52:55], a[36:39], v[108:111]
    ds_read_b128 a[12:15], v13 offset:35840
    s_andn2_b32 s90, s88, 3
    v_mfma_f32_16x16x32_bf16 v[112:115], a[52:55], a[40:43], v[112:115]
    ds_read_b64_tr_b16 a[20:21], v22 offset:45056
    buffer_load_dwordx4 v2, s[32:35], s52 offen offset:2048 sc1 lds
    s_or_b32 s89, s89, s90
    v_mfma_f32_16x16x32_bf16 v[116:119], a[52:55], a[44:47], v[116:119]
    ds_read_b64_tr_b16 a[22:23], v22 offset:45568
    s_lshl_b32 s76, s89, 14
    s_waitcnt lgkmcnt(8)
    v_mfma_f32_16x16x32_bf16 v[88:91], a[80:83], a[64:67], v[88:91]
    ds_read_b64_tr_b16 a[48:49], v20 offset:0
    v_mfma_f32_16x16x32_bf16 v[92:95], a[80:83], a[68:71], v[92:95]
    ds_read_b64_tr_b16 a[50:51], v20 offset:512
    buffer_load_dwordx4 v2, s[32:35], s52 offen offset:3072 sc1 lds
    s_add_u32 s52, s76, s75
    v_mfma_f32_16x16x32_bf16 v[96:99], a[80:83], a[72:75], v[96:99]
    ds_read_b128 a[32:35], v13 offset:49152
    v_mfma_f32_16x16x32_bf16 v[100:103], a[80:83], a[76:79], v[100:103]
    ds_read_b128 a[36:39], v13 offset:50176
    s_add_u32 m0, s55, 16384
    v_mfma_f32_16x16x32_bf16 v[104:107], a[84:87], a[64:67], v[104:107]
    ds_read_b128 a[40:43], v13 offset:51200
    buffer_load_dwordx4 v6, s[24:27], s53 offen offset:0 lds
    v_mfma_f32_16x16x32_bf16 v[108:111], a[84:87], a[68:71], v[108:111]
    ds_read_b128 a[44:47], v13 offset:52224
    v_mfma_f32_16x16x32_bf16 v[112:115], a[84:87], a[72:75], v[112:115]
    ds_read_b64_tr_b16 a[52:53], v23 offset:0
    buffer_load_dwordx4 v7, s[24:27], s53 offen offset:1024 lds
    s_mul_i32 s53, s89, 131072
    v_mfma_f32_16x16x32_bf16 v[116:119], a[84:87], a[76:79], v[116:119]
    ds_read_b64_tr_b16 a[54:55], v23 offset:512
    s_waitcnt vmcnt(18) lgkmcnt(8)
    s_barrier
    v_mfma_f32_16x16x32_bf16 v[88:91], a[16:19], a[0:3], v[88:91]
    ds_read_b64_tr_b16 a[80:81], v20 offset:4096
    s_add_u32 m0, s54, 24576
    v_mfma_f32_16x16x32_bf16 v[92:95], a[16:19], a[4:7], v[92:95]
    ds_read_b64_tr_b16 a[82:83], v20 offset:4608
    buffer_load_dwordx4 v2, s[32:35], s52 offen offset:0 sc1 lds
    s_add_u32 s88, s88, 1
    v_mfma_f32_16x16x32_bf16 v[96:99], a[16:19], a[8:11], v[96:99]
    ds_read_b128 a[64:67], v13 offset:57344
    s_add_u32 s89, s88, s101
    v_mfma_f32_16x16x32_bf16 v[100:103], a[16:19], a[12:15], v[100:103]
    ds_read_b128 a[68:71], v13 offset:58368
    v_mfma_f32_16x16x32_bf16 v[104:107], a[20:23], a[0:3], v[104:107]
    ds_read_b128 a[72:75], v13 offset:59392
    buffer_load_dwordx4 v2, s[32:35], s52 offen offset:1024 sc1 lds
    s_and_b32 s89, s89, 3
    v_mfma_f32_16x16x32_bf16 v[108:111], a[20:23], a[4:7], v[108:111]
    ds_read_b128 a[76:79], v13 offset:60416
    s_andn2_b32 s90, s88, 3
    v_mfma_f32_16x16x32_bf16 v[112:115], a[20:23], a[8:11], v[112:115]
    ds_read_b64_tr_b16 a[84:85], v23 offset:4096
    buffer_load_dwordx4 v2, s[32:35], s52 offen offset:2048 sc1 lds
    s_or_b32 s89, s89, s90
    v_mfma_f32_16x16x32_bf16 v[116:119], a[20:23], a[12:15], v[116:119]
    ds_read_b64_tr_b16 a[86:87], v23 offset:4608
    s_lshl_b32 s76, s89, 14
    s_waitcnt lgkmcnt(8)
    v_mfma_f32_16x16x32_bf16 v[88:91], a[48:51], a[32:35], v[88:91]
    ds_read_b64_tr_b16 a[16:17], v20 offset:24576
    v_mfma_f32_16x16x32_bf16 v[92:95], a[48:51], a[36:39], v[92:95]
    ds_read_b64_tr_b16 a[18:19], v20 offset:25088
    buffer_load_dwordx4 v2, s[32:35], s52 offen offset:3072 sc1 lds
    s_add_u32 s52, s76, s75
    v_mfma_f32_16x16x32_bf16 v[96:99], a[48:51], a[40:43], v[96:99]
    ds_read_b128 a[0:3], v14 offset:8192
    v_mfma_f32_16x16x32_bf16 v[100:103], a[48:51], a[44:47], v[100:103]
    ds_read_b128 a[4:7], v14 offset:9216
    s_add_u32 m0, s55, 40960
    v_mfma_f32_16x16x32_bf16 v[104:107], a[52:55], a[32:35], v[104:107]
    ds_read_b128 a[8:11], v14 offset:10240
    buffer_load_dwordx4 v6, s[24:27], s53 offen offset:0 lds
    v_mfma_f32_16x16x32_bf16 v[108:111], a[52:55], a[36:39], v[108:111]
    ds_read_b128 a[12:15], v14 offset:11264
    v_mfma_f32_16x16x32_bf16 v[112:115], a[52:55], a[40:43], v[112:115]
    ds_read_b64_tr_b16 a[20:21], v23 offset:24576
    buffer_load_dwordx4 v7, s[24:27], s53 offen offset:1024 lds
    s_mul_i32 s53, s89, 131072
    v_mfma_f32_16x16x32_bf16 v[116:119], a[52:55], a[44:47], v[116:119]
    ds_read_b64_tr_b16 a[22:23], v23 offset:25088
    s_waitcnt vmcnt(18) lgkmcnt(8)
    s_barrier
    v_mfma_f32_16x16x32_bf16 v[88:91], a[80:83], a[64:67], v[88:91]
    ds_read_b64_tr_b16 a[48:49], v20 offset:28672
    s_add_u32 m0, s54, 49152
    v_mfma_f32_16x16x32_bf16 v[92:95], a[80:83], a[68:71], v[92:95]
    ds_read_b64_tr_b16 a[50:51], v20 offset:29184
    buffer_load_dwordx4 v2, s[32:35], s52 offen offset:0 sc1 lds
    s_add_u32 s88, s88, 1
    v_mfma_f32_16x16x32_bf16 v[96:99], a[80:83], a[72:75], v[96:99]
    ds_read_b128 a[32:35], v14 offset:16384
    s_add_u32 s89, s88, s101
    v_mfma_f32_16x16x32_bf16 v[100:103], a[80:83], a[76:79], v[100:103]
    ds_read_b128 a[36:39], v14 offset:17408
    v_mfma_f32_16x16x32_bf16 v[104:107], a[84:87], a[64:67], v[104:107]
    ds_read_b128 a[40:43], v14 offset:18432
    buffer_load_dwordx4 v2, s[32:35], s52 offen offset:1024 sc1 lds
    s_and_b32 s89, s89, 3
    v_mfma_f32_16x16x32_bf16 v[108:111], a[84:87], a[68:71], v[108:111]
    ds_read_b128 a[44:47], v14 offset:19456
    s_andn2_b32 s90, s88, 3
    v_mfma_f32_16x16x32_bf16 v[112:115], a[84:87], a[72:75], v[112:115]
    ds_read_b64_tr_b16 a[52:53], v23 offset:28672
    buffer_load_dwordx4 v2, s[32:35], s52 offen offset:2048 sc1 lds
    s_or_b32 s89, s89, s90
    v_mfma_f32_16x16x32_bf16 v[116:119], a[84:87], a[76:79], v[116:119]
    ds_read_b64_tr_b16 a[54:55], v23 offset:29184
    s_lshl_b32 s76, s89, 14
    s_waitcnt lgkmcnt(8)
    v_mfma_f32_16x16x32_bf16 v[88:91], a[16:19], a[0:3], v[88:91]
    ds_read_b64_tr_b16 a[80:81], v20 offset:49152
    v_mfma_f32_16x16x32_bf16 v[92:95], a[16:19], a[4:7], v[92:95]
    ds_read_b64_tr_b16 a[82:83], v20 offset:49664
    buffer_load_dwordx4 v2, s[32:35], s52 offen offset:3072 sc1 lds
    s_add_u32 s52, s76, s75
    v_mfma_f32_16x16x32_bf16 v[96:99], a[16:19], a[8:11], v[96:99]
    ds_read_b128 a[64:67], v14 offset:32768
    v_mfma_f32_16x16x32_bf16 v[100:103], a[16:19], a[12:15], v[100:103]
    ds_read_b128 a[68:71], v14 offset:33792
    s_add_u32 m0, s55, 65536
    v_mfma_f32_16x16x32_bf16 v[104:107], a[20:23], a[0:3], v[104:107]
    ds_read_b128 a[72:75], v14 offset:34816
    buffer_load_dwordx4 v6, s[24:27], s53 offen offset:0 lds
    v_mfma_f32_16x16x32_bf16 v[108:111], a[20:23], a[4:7], v[108:111]
    ds_read_b128 a[76:79], v14 offset:35840
    v_mfma_f32_16x16x32_bf16 v[112:115], a[20:23], a[8:11], v[112:115]
    ds_read_b64_tr_b16 a[84:85], v23 offset:49152
    buffer_load_dwordx4 v7, s[24:27], s53 offen offset:1024 lds
    s_mul_i32 s53, s89, 131072
    v_mfma_f32_16x16x32_bf16 v[116:119], a[20:23], a[12:15], v[116:119]
    ds_read_b64_tr_b16 a[86:87], v23 offset:49664
    s_waitcnt vmcnt(18) lgkmcnt(8)
    s_barrier
    v_mfma_f32_16x16x32_bf16 v[88:91], a[48:51], a[32:35], v[88:91]
    ds_read_b64_tr_b16 a[16:17], v20 offset:53248
    s_add_u32 m0, s54, 73728
    v_mfma_f32_16x16x32_bf16 v[92:95], a[48:51], a[36:39], v[92:95]
    ds_read_b64_tr_b16 a[18:19], v20 offset:53760
    buffer_load_dwordx4 v2, s[32:35], s52 offen offset:0 sc1 lds
    s_add_u32 s88, s88, 1
    v_mfma_f32_16x16x32_bf16 v[96:99], a[48:51], a[40:43], v[96:99]
    ds_read_b128 a[0:3], v14 offset:40960
    s_add_u32 s89, s88, s101
    v_mfma_f32_16x16x32_bf16 v[100:103], a[48:51], a[44:47], v[100:103]
    ds_read_b128 a[4:7], v14 offset:41984
    v_mfma_f32_16x16x32_bf16 v[104:107], a[52:55], a[32:35], v[104:107]
    ds_read_b128 a[8:11], v14 offset:43008
    buffer_load_dwordx4 v2, s[32:35], s52 offen offset:1024 sc1 lds
    s_and_b32 s89, s89, 3
    v_mfma_f32_16x16x32_bf16 v[108:111], a[52:55], a[36:39], v[108:111]
    ds_read_b128 a[12:15], v14 offset:44032
    s_andn2_b32 s90, s88, 3
    v_mfma_f32_16x16x32_bf16 v[112:115], a[52:55], a[40:43], v[112:115]
    ds_read_b64_tr_b16 a[20:21], v23 offset:53248
    buffer_load_dwordx4 v2, s[32:35], s52 offen offset:2048 sc1 lds
    s_or_b32 s89, s89, s90
    v_mfma_f32_16x16x32_bf16 v[116:119], a[52:55], a[44:47], v[116:119]
    ds_read_b64_tr_b16 a[22:23], v23 offset:53760
    s_lshl_b32 s76, s89, 14
    s_waitcnt lgkmcnt(8)
    v_mfma_f32_16x16x32_bf16 v[88:91], a[80:83], a[64:67], v[88:91]
    ds_read_b64_tr_b16 a[48:49], v21 offset:8192
    v_mfma_f32_16x16x32_bf16 v[92:95], a[80:83], a[68:71], v[92:95]
    ds_read_b64_tr_b16 a[50:51], v21 offset:8704
    buffer_load_dwordx4 v2, s[32:35], s52 offen offset:3072 sc1 lds
    s_add_u32 s52, s76, s75
    v_mfma_f32_16x16x32_bf16 v[96:99], a[80:83], a[72:75], v[96:99]
    ds_read_b128 a[32:35], v14 offset:57344
    v_mfma_f32_16x16x32_bf16 v[100:103], a[80:83], a[76:79], v[100:103]
    ds_read_b128 a[36:39], v14 offset:58368
    s_add_u32 m0, s55, 90112
    v_mfma_f32_16x16x32_bf16 v[104:107], a[84:87], a[64:67], v[104:107]
    ds_read_b128 a[40:43], v14 offset:59392
    buffer_load_dwordx4 v6, s[24:27], s53 offen offset:0 lds
    v_mfma_f32_16x16x32_bf16 v[108:111], a[84:87], a[68:71], v[108:111]
    ds_read_b128 a[44:47], v14 offset:60416
    v_mfma_f32_16x16x32_bf16 v[112:115], a[84:87], a[72:75], v[112:115]
    ds_read_b64_tr_b16 a[52:53], v24 offset:8192
    buffer_load_dwordx4 v7, s[24:27], s53 offen offset:1024 lds
    s_mul_i32 s53, s89, 131072
    v_mfma_f32_16x16x32_bf16 v[116:119], a[84:87], a[76:79], v[116:119]
    ds_read_b64_tr_b16 a[54:55], v24 offset:8704
    s_waitcnt vmcnt(18) lgkmcnt(8)
    s_barrier
    v_mfma_f32_16x16x32_bf16 v[88:91], a[16:19], a[0:3], v[88:91]
    ds_read_b64_tr_b16 a[80:81], v21 offset:12288
    s_add_u32 m0, s54, 98304
    v_mfma_f32_16x16x32_bf16 v[92:95], a[16:19], a[4:7], v[92:95]
    ds_read_b64_tr_b16 a[82:83], v21 offset:12800
    buffer_load_dwordx4 v2, s[32:35], s52 offen offset:0 sc1 lds
    s_add_u32 s88, s88, 1
    v_mfma_f32_16x16x32_bf16 v[96:99], a[16:19], a[8:11], v[96:99]
    ds_read_b128 a[64:67], v15 offset:0
    s_add_u32 s89, s88, s101
    v_mfma_f32_16x16x32_bf16 v[100:103], a[16:19], a[12:15], v[100:103]
    ds_read_b128 a[68:71], v15 offset:1024
    v_mfma_f32_16x16x32_bf16 v[104:107], a[20:23], a[0:3], v[104:107]
    ds_read_b128 a[72:75], v15 offset:2048
    buffer_load_dwordx4 v2, s[32:35], s52 offen offset:1024 sc1 lds
    s_and_b32 s89, s89, 3
    v_mfma_f32_16x16x32_bf16 v[108:111], a[20:23], a[4:7], v[108:111]
    ds_read_b128 a[76:79], v15 offset:3072
    s_andn2_b32 s90, s88, 3
    v_mfma_f32_16x16x32_bf16 v[112:115], a[20:23], a[8:11], v[112:115]
    ds_read_b64_tr_b16 a[84:85], v24 offset:12288
    buffer_load_dwordx4 v2, s[32:35], s52 offen offset:2048 sc1 lds
    s_or_b32 s89, s89, s90
    v_mfma_f32_16x16x32_bf16 v[116:119], a[20:23], a[12:15], v[116:119]
    ds_read_b64_tr_b16 a[86:87], v24 offset:12800
    s_lshl_b32 s76, s89, 14
    s_waitcnt lgkmcnt(8)
    v_mfma_f32_16x16x32_bf16 v[88:91], a[48:51], a[32:35], v[88:91]
    ds_read_b64_tr_b16 a[16:17], v19 offset:16384
    v_mfma_f32_16x16x32_bf16 v[92:95], a[48:51], a[36:39], v[92:95]
    ds_read_b64_tr_b16 a[18:19], v19 offset:16896
    buffer_load_dwordx4 v2, s[32:35], s52 offen offset:3072 sc1 lds
    s_add_u32 s52, s76, s75
    v_mfma_f32_16x16x32_bf16 v[96:99], a[48:51], a[40:43], v[96:99]
    ds_read_b128 a[0:3], v13 offset:0
    v_mfma_f32_16x16x32_bf16 v[100:103], a[48:51], a[44:47], v[100:103]
    ds_read_b128 a[4:7], v13 offset:1024
    s_add_u32 m0, s55, 114688
    v_mfma_f32_16x16x32_bf16 v[104:107], a[52:55], a[32:35], v[104:107]
    ds_read_b128 a[8:11], v13 offset:2048
    buffer_load_dwordx4 v6, s[24:27], s53 offen offset:0 lds
    v_mfma_f32_16x16x32_bf16 v[108:111], a[52:55], a[36:39], v[108:111]
    ds_read_b128 a[12:15], v13 offset:3072
    v_mfma_f32_16x16x32_bf16 v[112:115], a[52:55], a[40:43], v[112:115]
    ds_read_b64_tr_b16 a[20:21], v22 offset:16384
    buffer_load_dwordx4 v7, s[24:27], s53 offen offset:1024 lds
    s_mul_i32 s53, s89, 131072
    v_mfma_f32_16x16x32_bf16 v[116:119], a[52:55], a[44:47], v[116:119]
    ds_read_b64_tr_b16 a[22:23], v22 offset:16896
    s_waitcnt vmcnt(18) lgkmcnt(8)
    s_barrier
    v_mfma_f32_16x16x32_bf16 v[88:91], a[80:83], a[64:67], v[88:91]
    ds_read_b64_tr_b16 a[48:49], v19 offset:20480
    s_add_u32 m0, s54, 122880
    v_mfma_f32_16x16x32_bf16 v[92:95], a[80:83], a[68:71], v[92:95]
    ds_read_b64_tr_b16 a[50:51], v19 offset:20992
    buffer_load_dwordx4 v2, s[32:35], s52 offen offset:0 sc1 lds
    s_add_u32 s88, s88, 1
    v_mfma_f32_16x16x32_bf16 v[96:99], a[80:83], a[72:75], v[96:99]
    ds_read_b128 a[32:35], v13 offset:8192
    s_add_u32 s89, s88, s101
    v_mfma_f32_16x16x32_bf16 v[100:103], a[80:83], a[76:79], v[100:103]
    ds_read_b128 a[36:39], v13 offset:9216
    v_mfma_f32_16x16x32_bf16 v[104:107], a[84:87], a[64:67], v[104:107]
    ds_read_b128 a[40:43], v13 offset:10240
    buffer_load_dwordx4 v2, s[32:35], s52 offen offset:1024 sc1 lds
    s_and_b32 s89, s89, 3
    v_mfma_f32_16x16x32_bf16 v[108:111], a[84:87], a[68:71], v[108:111]
    ds_read_b128 a[44:47], v13 offset:11264
    s_andn2_b32 s90, s88, 3
    v_mfma_f32_16x16x32_bf16 v[112:115], a[84:87], a[72:75], v[112:115]
    ds_read_b64_tr_b16 a[52:53], v22 offset:20480
    buffer_load_dwordx4 v2, s[32:35], s52 offen offset:2048 sc1 lds
    s_or_b32 s89, s89, s90
    v_mfma_f32_16x16x32_bf16 v[116:119], a[84:87], a[76:79], v[116:119]
    ds_read_b64_tr_b16 a[54:55], v22 offset:20992
    s_lshl_b32 s76, s89, 14
    s_waitcnt lgkmcnt(8)
    v_mfma_f32_16x16x32_bf16 v[88:91], a[16:19], a[0:3], v[88:91]
    ds_read_b64_tr_b16 a[80:81], v19 offset:40960
    v_mfma_f32_16x16x32_bf16 v[92:95], a[16:19], a[4:7], v[92:95]
    ds_read_b64_tr_b16 a[82:83], v19 offset:41472
    buffer_load_dwordx4 v2, s[32:35], s52 offen offset:3072 sc1 lds
    s_add_u32 s52, s76, s75
    v_mfma_f32_16x16x32_bf16 v[96:99], a[16:19], a[8:11], v[96:99]
    ds_read_b128 a[64:67], v13 offset:24576
    v_mfma_f32_16x16x32_bf16 v[100:103], a[16:19], a[12:15], v[100:103]
    ds_read_b128 a[68:71], v13 offset:25600
    s_add_u32 m0, s55, 139264
    v_mfma_f32_16x16x32_bf16 v[104:107], a[20:23], a[0:3], v[104:107]
    ds_read_b128 a[72:75], v13 offset:26624
    buffer_load_dwordx4 v6, s[24:27], s53 offen offset:0 lds
    v_mfma_f32_16x16x32_bf16 v[108:111], a[20:23], a[4:7], v[108:111]
    ds_read_b128 a[76:79], v13 offset:27648
    v_mfma_f32_16x16x32_bf16 v[112:115], a[20:23], a[8:11], v[112:115]
    ds_read_b64_tr_b16 a[84:85], v22 offset:40960
    buffer_load_dwordx4 v7, s[24:27], s53 offen offset:1024 lds
    s_mul_i32 s53, s89, 131072
    v_mfma_f32_16x16x32_bf16 v[116:119], a[20:23], a[12:15], v[116:119]
    ds_read_b64_tr_b16 a[86:87], v22 offset:41472
    s_waitcnt vmcnt(18) lgkmcnt(8)
    s_barrier
    buffer_load_dword v252, v253, s[32:35], 0 offen sc1
    v_mfma_f32_16x16x32_bf16 v[88:91], a[48:51], a[32:35], v[88:91]
    ds_read_b64_tr_b16 a[16:17], v19 offset:45056
    s_add_u32 m0, s54, 0
    v_mfma_f32_16x16x32_bf16 v[92:95], a[48:51], a[36:39], v[92:95]
    ds_read_b64_tr_b16 a[18:19], v19 offset:45568
    buffer_load_dwordx4 v2, s[32:35], s52 offen offset:0 sc1 lds
    s_add_u32 s88, s88, 1
    v_mfma_f32_16x16x32_bf16 v[96:99], a[48:51], a[40:43], v[96:99]
    ds_read_b128 a[0:3], v13 offset:32768
    s_add_u32 s89, s88, s101
    v_mfma_f32_16x16x32_bf16 v[100:103], a[48:51], a[44:47], v[100:103]
    ds_read_b128 a[4:7], v13 offset:33792
    v_mfma_f32_16x16x32_bf16 v[104:107], a[52:55], a[32:35], v[104:107]
    ds_read_b128 a[8:11], v13 offset:34816
    buffer_load_dwordx4 v2, s[32:35], s52 offen offset:1024 sc1 lds
    s_and_b32 s89, s89, 3
    v_mfma_f32_16x16x32_bf16 v[108:111], a[52:55], a[36:39], v[108:111]
    ds_read_b128 a[12:15], v13 offset:35840
    s_andn2_b32 s90, s88, 3
    v_mfma_f32_16x16x32_bf16 v[112:115], a[52:55], a[40:43], v[112:115]
    ds_read_b64_tr_b16 a[20:21], v22 offset:45056
    buffer_load_dwordx4 v2, s[32:35], s52 offen offset:2048 sc1 lds
    s_or_b32 s89, s89, s90
    v_mfma_f32_16x16x32_bf16 v[116:119], a[52:55], a[44:47], v[116:119]
    ds_read_b64_tr_b16 a[22:23], v22 offset:45568
    s_lshl_b32 s76, s89, 14
    s_waitcnt lgkmcnt(8)
    v_mfma_f32_16x16x32_bf16 v[88:91], a[80:83], a[64:67], v[88:91]
    ds_read_b64_tr_b16 a[48:49], v20 offset:0
    v_mfma_f32_16x16x32_bf16 v[92:95], a[80:83], a[68:71], v[92:95]
    ds_read_b64_tr_b16 a[50:51], v20 offset:512
    buffer_load_dwordx4 v2, s[32:35], s52 offen offset:3072 sc1 lds
    s_mul_i32 s77, s89, 131072
    v_mfma_f32_16x16x32_bf16 v[96:99], a[80:83], a[72:75], v[96:99]
    ds_read_b128 a[32:35], v13 offset:49152
    s_add_u32 s52, s76, s75
    v_mfma_f32_16x16x32_bf16 v[100:103], a[80:83], a[76:79], v[100:103]
    ds_read_b128 a[36:39], v13 offset:50176
    s_add_u32 m0, s55, 16384
    v_mfma_f32_16x16x32_bf16 v[104:107], a[84:87], a[64:67], v[104:107]
    ds_read_b128 a[40:43], v13 offset:51200
    buffer_load_dwordx4 v6, s[24:27], s53 offen offset:0 lds
    v_mfma_f32_16x16x32_bf16 v[108:111], a[84:87], a[68:71], v[108:111]
    ds_read_b128 a[44:47], v13 offset:52224
    v_mfma_f32_16x16x32_bf16 v[112:115], a[84:87], a[72:75], v[112:115]
    ds_read_b64_tr_b16 a[52:53], v23 offset:0
    buffer_load_dwordx4 v7, s[24:27], s53 offen offset:1024 lds
    s_sub_u32 s53, s77, 2097152
    v_mfma_f32_16x16x32_bf16 v[116:119], a[84:87], a[76:79], v[116:119]
    ds_read_b64_tr_b16 a[54:55], v23 offset:512
    s_waitcnt vmcnt(19) lgkmcnt(8)
    s_barrier
    v_mfma_f32_16x16x32_bf16 v[88:91], a[16:19], a[0:3], v[88:91]
    ds_read_b64_tr_b16 a[80:81], v20 offset:4096
    v_mfma_f32_16x16x32_bf16 v[92:95], a[16:19], a[4:7], v[92:95]
    ds_read_b64_tr_b16 a[82:83], v20 offset:4608
    v_mfma_f32_16x16x32_bf16 v[96:99], a[16:19], a[8:11], v[96:99]
    ds_read_b128 a[64:67], v13 offset:57344
    v_mfma_f32_16x16x32_bf16 v[100:103], a[16:19], a[12:15], v[100:103]
    ds_read_b128 a[68:71], v13 offset:58368
    v_mfma_f32_16x16x32_bf16 v[104:107], a[20:23], a[0:3], v[104:107]
    ds_read_b128 a[72:75], v13 offset:59392
    v_mfma_f32_16x16x32_bf16 v[108:111], a[20:23], a[4:7], v[108:111]
    ds_read_b128 a[76:79], v13 offset:60416
    v_mfma_f32_16x16x32_bf16 v[112:115], a[20:23], a[8:11], v[112:115]
    ds_read_b64_tr_b16 a[84:85], v23 offset:4096
    v_mfma_f32_16x16x32_bf16 v[116:119], a[20:23], a[12:15], v[116:119]
    ds_read_b64_tr_b16 a[86:87], v23 offset:4608
    s_waitcnt lgkmcnt(8)
    v_mfma_f32_16x16x32_bf16 v[88:91], a[48:51], a[32:35], v[88:91]
    ds_read_b64_tr_b16 a[16:17], v20 offset:24576
    v_mfma_f32_16x16x32_bf16 v[92:95], a[48:51], a[36:39], v[92:95]
    ds_read_b64_tr_b16 a[18:19], v20 offset:25088
    v_mfma_f32_16x16x32_bf16 v[96:99], a[48:51], a[40:43], v[96:99]
    ds_read_b128 a[0:3], v14 offset:8192
    v_mfma_f32_16x16x32_bf16 v[100:103], a[48:51], a[44:47], v[100:103]
    ds_read_b128 a[4:7], v14 offset:9216
    v_mfma_f32_16x16x32_bf16 v[104:107], a[52:55], a[32:35], v[104:107]
    ds_read_b128 a[8:11], v14 offset:10240
    v_mfma_f32_16x16x32_bf16 v[108:111], a[52:55], a[36:39], v[108:111]
    ds_read_b128 a[12:15], v14 offset:11264
    v_mfma_f32_16x16x32_bf16 v[112:115], a[52:55], a[40:43], v[112:115]
    ds_read_b64_tr_b16 a[20:21], v23 offset:24576
    v_mfma_f32_16x16x32_bf16 v[116:119], a[52:55], a[44:47], v[116:119]
    ds_read_b64_tr_b16 a[22:23], v23 offset:25088
    s_waitcnt vmcnt(13) lgkmcnt(8)
    s_barrier
    s_waitcnt vmcnt(6)
    s_add_u32 s91, s94, 5
    v_subrev_u32 v252, s91, v252
    v_cmp_lt_u32 vcc, 2, v252
    s_nop 4
    s_cbranch_vccz POK_16
    s_mov_b32 s99, 0x8000
PSPIN_17:
    s_sleep 2
    buffer_load_dword v252, v253, s[32:35], 0 offen sc1
    s_sub_u32 s99, s99, 1
    s_cbranch_scc1 POK_16
    s_waitcnt vmcnt(0)
    v_subrev_u32 v252, s91, v252
    v_cmp_lt_u32 vcc, 2, v252
    s_nop 4
    s_cbranch_vccnz PSPIN_17
POK_16:
    v_mfma_f32_16x16x32_bf16 v[88:91], a[80:83], a[64:67], v[88:91]
    ds_read_b64_tr_b16 a[48:49], v20 offset:28672
    s_add_u32 m0, s54, 24576
    v_mfma_f32_16x16x32_bf16 v[92:95], a[80:83], a[68:71], v[92:95]
    ds_read_b64_tr_b16 a[50:51], v20 offset:29184
    buffer_load_dwordx4 v2, s[32:35], s52 offen offset:0 sc1 lds
    s_add_u32 s88, s88, 1
    v_mfma_f32_16x16x32_bf16 v[96:99], a[80:83], a[72:75], v[96:99]
    ds_read_b128 a[32:35], v14 offset:16384
    s_add_u32 s89, s88, s101
    v_mfma_f32_16x16x32_bf16 v[100:103], a[80:83], a[76:79], v[100:103]
    ds_read_b128 a[36:39], v14 offset:17408
    v_mfma_f32_16x16x32_bf16 v[104:107], a[84:87], a[64:67], v[104:107]
    ds_read_b128 a[40:43], v14 offset:18432
    buffer_load_dwordx4 v2, s[32:35], s52 offen offset:1024 sc1 lds
    s_and_b32 s89, s89, 3
    v_mfma_f32_16x16x32_bf16 v[108:111], a[84:87], a[68:71], v[108:111]
    ds_read_b128 a[44:47], v14 offset:19456
    s_andn2_b32 s90, s88, 3
    v_mfma_f32_16x16x32_bf16 v[112:115], a[84:87], a[72:75], v[112:115]
    ds_read_b64_tr_b16 a[52:53], v23 offset:28672
    buffer_load_dwordx4 v2, s[32:35], s52 offen offset:2048 sc1 lds
    s_or_b32 s89, s89, s90
    v_mfma_f32_16x16x32_bf16 v[116:119], a[84:87], a[76:79], v[116:119]
    ds_read_b64_tr_b16 a[54:55], v23 offset:29184
    s_lshl_b32 s76, s89, 14
    s_waitcnt lgkmcnt(8)
    v_mfma_f32_16x16x32_bf16 v[88:91], a[16:19], a[0:3], v[88:91]
    ds_read_b64_tr_b16 a[80:81], v20 offset:49152
    buffer_load_dwordx4 v2, s[32:35], s52 offen offset:3072 sc1 lds
    s_mul_i32 s77, s89, 131072
    v_mfma_f32_16x16x32_bf16 v[92:95], a[16:19], a[4:7], v[92:95]
    ds_read_b64_tr_b16 a[82:83], v20 offset:49664
    s_add_u32 s52, s76, s75
    s_add_u32 m0, s55, 40960
    v_mfma_f32_16x16x32_bf16 v[96:99], a[16:19], a[8:11], v[96:99]
    ds_read_b128 a[64:67], v14 offset:32768
    buffer_load_dwordx4 v6, s[28:31], s53 offen offset:0 lds
    v_mfma_f32_16x16x32_bf16 v[100:103], a[16:19], a[12:15], v[100:103]
    ds_read_b128 a[68:71], v14 offset:33792
    v_mfma_f32_16x16x32_bf16 v[104:107], a[20:23], a[0:3], v[104:107]
    ds_read_b128 a[72:75], v14 offset:34816
    buffer_load_dwordx4 v7, s[28:31], s53 offen offset:1024 lds
    s_sub_u32 s53, s77, 2097152
    s_add_u32 m0, s54, 49152
    v_mfma_f32_16x16x32_bf16 v[108:111], a[20:23], a[4:7], v[108:111]
    ds_read_b128 a[76:79], v14 offset:35840
    buffer_load_dwordx4 v2, s[32:35], s52 offen offset:0 sc1 lds
    s_add_u32 s88, s88, 1
    v_mfma_f32_16x16x32_bf16 v[112:115], a[20:23], a[8:11], v[112:115]
    ds_read_b64_tr_b16 a[84:85], v23 offset:49152
    s_add_u32 s89, s88, s101
    v_mfma_f32_16x16x32_bf16 v[116:119], a[20:23], a[12:15], v[116:119]
    ds_read_b64_tr_b16 a[86:87], v23 offset:49664
    buffer_load_dwordx4 v2, s[32:35], s52 offen offset:1024 sc1 lds
    s_and_b32 s89, s89, 3
    s_andn2_b32 s90, s88, 3
    s_waitcnt lgkmcnt(8)
    s_barrier
    v_mfma_f32_16x16x32_bf16 v[88:91], a[48:51], a[32:35], v[88:91]
    ds_read_b64_tr_b16 a[16:17], v20 offset:53248
    buffer_load_dwordx4 v2, s[32:35], s52 offen offset:2048 sc1 lds
    s_or_b32 s89, s89, s90
    v_mfma_f32_16x16x32_bf16 v[92:95], a[48:51], a[36:39], v[92:95]
    ds_read_b64_tr_b16 a[18:19], v20 offset:53760
    s_lshl_b32 s76, s89, 14
    v_mfma_f32_16x16x32_bf16 v[96:99], a[48:51], a[40:43], v[96:99]
    ds_read_b128 a[0:3], v14 offset:40960
    buffer_load_dwordx4 v2, s[32:35], s52 offen offset:3072 sc1 lds
    s_mul_i32 s77, s89, 131072
    v_mfma_f32_16x16x32_bf16 v[100:103], a[48:51], a[44:47], v[100:103]
    ds_read_b128 a[4:7], v14 offset:41984
    s_add_u32 s52, s76, s75
    s_add_u32 m0, s55, 65536
    v_mfma_f32_16x16x32_bf16 v[104:107], a[52:55], a[32:35], v[104:107]
    ds_read_b128 a[8:11], v14 offset:43008
    buffer_load_dwordx4 v6, s[28:31], s53 offen offset:0 lds
    v_mfma_f32_16x16x32_bf16 v[108:111], a[52:55], a[36:39], v[108:111]
    ds_read_b128 a[12:15], v14 offset:44032
    buffer_load_dwordx4 v7, s[28:31], s53 offen offset:1024 lds
    s_sub_u32 s53, s77, 2097152
    v_mfma_f32_16x16x32_bf16 v[112:115], a[52:55], a[40:43], v[112:115]
    ds_read_b64_tr_b16 a[20:21], v23 offset:53248
    s_add_u32 m0, s54, 73728
    v_mfma_f32_16x16x32_bf16 v[116:119], a[52:55], a[44:47], v[116:119]
    ds_read_b64_tr_b16 a[22:23], v23 offset:53760
    buffer_load_dwordx4 v2, s[32:35], s52 offen offset:0 sc1 lds
    s_add_u32 s88, s88, 1
    s_add_u32 s89, s88, s101
    s_waitcnt lgkmcnt(8)
    v_mfma_f32_16x16x32_bf16 v[88:91], a[80:83], a[64:67], v[88:91]
    ds_read_b64_tr_b16 a[48:49], v21 offset:8192
    buffer_load_dwordx4 v2, s[32:35], s52 offen offset:1024 sc1 lds
    s_and_b32 s89, s89, 3
    v_mfma_f32_16x16x32_bf16 v[92:95], a[80:83], a[68:71], v[92:95]
    ds_read_b64_tr_b16 a[50:51], v21 offset:8704
    s_andn2_b32 s90, s88, 3
    v_mfma_f32_16x16x32_bf16 v[96:99], a[80:83], a[72:75], v[96:99]
    ds_read_b128 a[32:35], v14 offset:57344
    buffer_load_dwordx4 v2, s[32:35], s52 offen offset:2048 sc1 lds
    s_or_b32 s89, s89, s90
    v_mfma_f32_16x16x32_bf16 v[100:103], a[80:83], a[76:79], v[100:103]
    ds_read_b128 a[36:39], v14 offset:58368
    s_lshl_b32 s76, s89, 14
    v_mfma_f32_16x16x32_bf16 v[104:107], a[84:87], a[64:67], v[104:107]
    ds_read_b128 a[40:43], v14 offset:59392
    buffer_load_dwordx4 v2, s[32:35], s52 offen offset:3072 sc1 lds
    s_mul_i32 s77, s89, 131072
    s_add_u32 s52, s76, s75
    s_add_u32 m0, s55, 90112
    v_mfma_f32_16x16x32_bf16 v[108:111], a[84:87], a[68:71], v[108:111]
    ds_read_b128 a[44:47], v14 offset:60416
    buffer_load_dwordx4 v6, s[28:31], s53 offen offset:0 lds
    v_mfma_f32_16x16x32_bf16 v[112:115], a[84:87], a[72:75], v[112:115]
    ds_read_b64_tr_b16 a[52:53], v24 offset:8192
    v_mfma_f32_16x16x32_bf16 v[116:119], a[84:87], a[76:79], v[116:119]
    ds_read_b64_tr_b16 a[54:55], v24 offset:8704
    buffer_load_dwordx4 v7, s[28:31], s53 offen offset:1024 lds
    s_sub_u32 s53, s77, 2097152
    s_waitcnt vmcnt(18) lgkmcnt(8)
    s_barrier
    v_mfma_f32_16x16x32_bf16 v[88:91], a[16:19], a[0:3], v[88:91]
    ds_read_b64_tr_b16 a[80:81], v21 offset:12288
    s_add_u32 m0, s54, 98304
    v_mfma_f32_16x16x32_bf16 v[92:95], a[16:19], a[4:7], v[92:95]
    ds_read_b64_tr_b16 a[82:83], v21 offset:12800
    buffer_load_dwordx4 v2, s[32:35], s52 offen offset:0 sc1 lds
    s_add_u32 s88, s88, 1
    v_mfma_f32_16x16x32_bf16 v[96:99], a[16:19], a[8:11], v[96:99]
    ds_read_b128 a[64:67], v15 offset:0
    s_add_u32 s89, s88, s101
    v_mfma_f32_16x16x32_bf16 v[100:103], a[16:19], a[12:15], v[100:103]
    ds_read_b128 a[68:71], v15 offset:1024
    v_mfma_f32_16x16x32_bf16 v[104:107], a[20:23], a[0:3], v[104:107]
    ds_read_b128 a[72:75], v15 offset:2048
    buffer_load_dwordx4 v2, s[32:35], s52 offen offset:1024 sc1 lds
    s_and_b32 s89, s89, 3
    v_mfma_f32_16x16x32_bf16 v[108:111], a[20:23], a[4:7], v[108:111]
    ds_read_b128 a[76:79], v15 offset:3072
    s_andn2_b32 s90, s88, 3
    v_mfma_f32_16x16x32_bf16 v[112:115], a[20:23], a[8:11], v[112:115]
    ds_read_b64_tr_b16 a[84:85], v24 offset:12288
    buffer_load_dwordx4 v2, s[32:35], s52 offen offset:2048 sc1 lds
    s_or_b32 s89, s89, s90
    v_mfma_f32_16x16x32_bf16 v[116:119], a[20:23], a[12:15], v[116:119]
    ds_read_b64_tr_b16 a[86:87], v24 offset:12800
    s_lshl_b32 s76, s89, 14
    s_waitcnt lgkmcnt(8)
    v_mfma_f32_16x16x32_bf16 v[88:91], a[48:51], a[32:35], v[88:91]
    ds_read_b64_tr_b16 a[16:17], v19 offset:16384
    v_mfma_f32_16x16x32_bf16 v[92:95], a[48:51], a[36:39], v[92:95]
    ds_read_b64_tr_b16 a[18:19], v19 offset:16896
    buffer_load_dwordx4 v2, s[32:35], s52 offen offset:3072 sc1 lds
    s_mul_i32 s77, s89, 131072
    v_mfma_f32_16x16x32_bf16 v[96:99], a[48:51], a[40:43], v[96:99]
    ds_read_b128 a[0:3], v13 offset:0
    s_add_u32 s52, s76, s75
    v_mfma_f32_16x16x32_bf16 v[100:103], a[48:51], a[44:47], v[100:103]
    ds_read_b128 a[4:7], v13 offset:1024
    s_add_u32 m0, s55, 114688
    v_mfma_f32_16x16x32_bf16 v[104:107], a[52:55], a[32:35], v[104:107]
    ds_read_b128 a[8:11], v13 offset:2048
    buffer_load_dwordx4 v6, s[28:31], s53 offen offset:0 lds
    v_mfma_f32_16x16x32_bf16 v[108:111], a[52:55], a[36:39], v[108:111]
    ds_read_b128 a[12:15], v13 offset:3072
    v_mfma_f32_16x16x32_bf16 v[112:115], a[52:55], a[40:43], v[112:115]
    ds_read_b64_tr_b16 a[20:21], v22 offset:16384
    buffer_load_dwordx4 v7, s[28:31], s53 offen offset:1024 lds
    s_sub_u32 s53, s77, 2097152
    v_mfma_f32_16x16x32_bf16 v[116:119], a[52:55], a[44:47], v[116:119]
    ds_read_b64_tr_b16 a[22:23], v22 offset:16896
    s_waitcnt vmcnt(18) lgkmcnt(8)
    s_barrier
    v_mfma_f32_16x16x32_bf16 v[88:91], a[80:83], a[64:67], v[88:91]
    ds_read_b64_tr_b16 a[48:49], v19 offset:20480
    s_add_u32 m0, s54, 122880
    v_mfma_f32_16x16x32_bf16 v[92:95], a[80:83], a[68:71], v[92:95]
    ds_read_b64_tr_b16 a[50:51], v19 offset:20992
    buffer_load_dwordx4 v2, s[32:35], s52 offen offset:0 sc1 lds
    s_add_u32 s88, s88, 1
    v_mfma_f32_16x16x32_bf16 v[96:99], a[80:83], a[72:75], v[96:99]
    ds_read_b128 a[32:35], v13 offset:8192
    s_add_u32 s89, s88, s101
    v_mfma_f32_16x16x32_bf16 v[100:103], a[80:83], a[76:79], v[100:103]
    ds_read_b128 a[36:39], v13 offset:9216
    v_mfma_f32_16x16x32_bf16 v[104:107], a[84:87], a[64:67], v[104:107]
    ds_read_b128 a[40:43], v13 offset:10240
    buffer_load_dwordx4 v2, s[32:35], s52 offen offset:1024 sc1 lds
    s_and_b32 s89, s89, 3
    v_mfma_f32_16x16x32_bf16 v[108:111], a[84:87], a[68:71], v[108:111]
    ds_read_b128 a[44:47], v13 offset:11264
    s_andn2_b32 s90, s88, 3
    v_mfma_f32_16x16x32_bf16 v[112:115], a[84:87], a[72:75], v[112:115]
    ds_read_b64_tr_b16 a[52:53], v22 offset:20480
    buffer_load_dwordx4 v2, s[32:35], s52 offen offset:2048 sc1 lds
    s_or_b32 s89, s89, s90
    v_mfma_f32_16x16x32_bf16 v[116:119], a[84:87], a[76:79], v[116:119]
    ds_read_b64_tr_b16 a[54:55], v22 offset:20992
    s_lshl_b32 s76, s89, 14
    s_waitcnt lgkmcnt(8)
    v_mfma_f32_16x16x32_bf16 v[88:91], a[16:19], a[0:3], v[88:91]
    ds_read_b64_tr_b16 a[80:81], v19 offset:40960
    v_mfma_f32_16x16x32_bf16 v[92:95], a[16:19], a[4:7], v[92:95]
    ds_read_b64_tr_b16 a[82:83], v19 offset:41472
    buffer_load_dwordx4 v2, s[32:35], s52 offen offset:3072 sc1 lds
    s_mul_i32 s77, s89, 131072
    v_mfma_f32_16x16x32_bf16 v[96:99], a[16:19], a[8:11], v[96:99]
    ds_read_b128 a[64:67], v13 offset:24576
    s_add_u32 s52, s76, s75
    v_mfma_f32_16x16x32_bf16 v[100:103], a[16:19], a[12:15], v[100:103]
    ds_read_b128 a[68:71], v13 offset:25600
    s_add_u32 m0, s55, 139264
    v_mfma_f32_16x16x32_bf16 v[104:107], a[20:23], a[0:3], v[104:107]
    ds_read_b128 a[72:75], v13 offset:26624
    buffer_load_dwordx4 v6, s[28:31], s53 offen offset:0 lds
    v_mfma_f32_16x16x32_bf16 v[108:111], a[20:23], a[4:7], v[108:111]
    ds_read_b128 a[76:79], v13 offset:27648
    v_mfma_f32_16x16x32_bf16 v[112:115], a[20:23], a[8:11], v[112:115]
    ds_read_b64_tr_b16 a[84:85], v22 offset:40960
    buffer_load_dwordx4 v7, s[28:31], s53 offen offset:1024 lds
    s_sub_u32 s53, s77, 2097152
    v_mfma_f32_16x16x32_bf16 v[116:119], a[20:23], a[12:15], v[116:119]
    ds_read_b64_tr_b16 a[86:87], v22 offset:41472
    s_waitcnt vmcnt(18) lgkmcnt(8)
    s_barrier
    v_mfma_f32_16x16x32_bf16 v[88:91], a[48:51], a[32:35], v[88:91]
    ds_read_b64_tr_b16 a[16:17], v19 offset:45056
    s_add_u32 m0, s54, 0
    v_mfma_f32_16x16x32_bf16 v[92:95], a[48:51], a[36:39], v[92:95]
    ds_read_b64_tr_b16 a[18:19], v19 offset:45568
    buffer_load_dwordx4 v2, s[32:35], s52 offen offset:0 sc1 lds
    s_add_u32 s88, s88, 1
    v_mfma_f32_16x16x32_bf16 v[96:99], a[48:51], a[40:43], v[96:99]
    ds_read_b128 a[0:3], v13 offset:32768
    s_add_u32 s89, s88, s101
    v_mfma_f32_16x16x32_bf16 v[100:103], a[48:51], a[44:47], v[100:103]
    ds_read_b128 a[4:7], v13 offset:33792
    v_mfma_f32_16x16x32_bf16 v[104:107], a[52:55], a[32:35], v[104:107]
    ds_read_b128 a[8:11], v13 offset:34816
    buffer_load_dwordx4 v2, s[32:35], s52 offen offset:1024 sc1 lds
    s_and_b32 s89, s89, 3
    v_mfma_f32_16x16x32_bf16 v[108:111], a[52:55], a[36:39], v[108:111]
    ds_read_b128 a[12:15], v13 offset:35840
    s_andn2_b32 s90, s88, 3
    v_mfma_f32_16x16x32_bf16 v[112:115], a[52:55], a[40:43], v[112:115]
    ds_read_b64_tr_b16 a[20:21], v22 offset:45056
    buffer_load_dwordx4 v2, s[32:35], s52 offen offset:2048 sc1 lds
    s_or_b32 s89, s89, s90
    v_mfma_f32_16x16x32_bf16 v[116:119], a[52:55], a[44:47], v[116:119]
    ds_read_b64_tr_b16 a[22:23], v22 offset:45568
    s_lshl_b32 s76, s89, 14
    s_waitcnt lgkmcnt(8)
    v_mfma_f32_16x16x32_bf16 v[120:123], a[80:83], a[64:67], 0
    ds_read_b64_tr_b16 a[48:49], v20 offset:0
    v_mfma_f32_16x16x32_bf16 v[124:127], a[80:83], a[68:71], 0
    ds_read_b64_tr_b16 a[50:51], v20 offset:512
    buffer_load_dwordx4 v2, s[32:35], s52 offen offset:3072 sc1 lds
    s_mul_i32 s77, s89, 131072
    v_mfma_f32_16x16x32_bf16 v[128:131], a[80:83], a[72:75], 0
    ds_read_b128 a[32:35], v13 offset:49152
    s_add_u32 s52, s76, s75
    v_mfma_f32_16x16x32_bf16 v[132:135], a[80:83], a[76:79], 0
    ds_read_b128 a[36:39], v13 offset:50176
    s_add_u32 m0, s55, 16384
    v_mfma_f32_16x16x32_bf16 v[136:139], a[84:87], a[64:67], 0
    ds_read_b128 a[40:43], v13 offset:51200
    buffer_load_dwordx4 v6, s[28:31], s53 offen offset:0 lds
    v_mfma_f32_16x16x32_bf16 v[140:143], a[84:87], a[68:71], 0
    ds_read_b128 a[44:47], v13 offset:52224
    v_mfma_f32_16x16x32_bf16 v[144:147], a[84:87], a[72:75], 0
    ds_read_b64_tr_b16 a[52:53], v23 offset:0
    buffer_load_dwordx4 v7, s[28:31], s53 offen offset:1024 lds
    s_sub_u32 s53, s77, 2097152
    v_mfma_f32_16x16x32_bf16 v[148:151], a[84:87], a[76:79], 0
    ds_read_b64_tr_b16 a[54:55], v23 offset:512
    s_waitcnt vmcnt(18) lgkmcnt(8)
    s_barrier
    v_mfma_f32_16x16x32_bf16 v[120:123], a[16:19], a[0:3], v[120:123]
    ds_read_b64_tr_b16 a[80:81], v20 offset:4096
    s_add_u32 m0, s54, 24576
    v_mfma_f32_16x16x32_bf16 v[124:127], a[16:19], a[4:7], v[124:127]
    ds_read_b64_tr_b16 a[82:83], v20 offset:4608
    buffer_load_dwordx4 v2, s[32:35], s52 offen offset:0 sc1 lds
    s_add_u32 s88, s88, 1
    v_mfma_f32_16x16x32_bf16 v[128:131], a[16:19], a[8:11], v[128:131]
    ds_read_b128 a[64:67], v13 offset:57344
    s_add_u32 s89, s88, s101
    v_mfma_f32_16x16x32_bf16 v[132:135], a[16:19], a[12:15], v[132:135]
    ds_read_b128 a[68:71], v13 offset:58368
    v_mfma_f32_16x16x32_bf16 v[136:139], a[20:23], a[0:3], v[136:139]
    ds_read_b128 a[72:75], v13 offset:59392
    buffer_load_dwordx4 v2, s[32:35], s52 offen offset:1024 sc1 lds
    s_and_b32 s89, s89, 3
    v_mfma_f32_16x16x32_bf16 v[140:143], a[20:23], a[4:7], v[140:143]
    ds_read_b128 a[76:79], v13 offset:60416
    s_andn2_b32 s90, s88, 3
    v_mfma_f32_16x16x32_bf16 v[144:147], a[20:23], a[8:11], v[144:147]
    ds_read_b64_tr_b16 a[84:85], v23 offset:4096
    buffer_load_dwordx4 v2, s[32:35], s52 offen offset:2048 sc1 lds
    s_or_b32 s89, s89, s90
    v_mfma_f32_16x16x32_bf16 v[148:151], a[20:23], a[12:15], v[148:151]
    ds_read_b64_tr_b16 a[86:87], v23 offset:4608
    s_lshl_b32 s76, s89, 14
    s_waitcnt lgkmcnt(8)
    s_mov_b32 s98, 3
.p2align 3
LOOP_p4_1:
    v_mfma_f32_16x16x32_bf16 v[120:123], a[48:51], a[32:35], v[120:123]
    ds_read_b64_tr_b16 a[16:17], v20 offset:24576
    v_mfma_f32_16x16x32_bf16 v[124:127], a[48:51], a[36:39], v[124:127]
    ds_read_b64_tr_b16 a[18:19], v20 offset:25088
    buffer_load_dwordx4 v2, s[32:35], s52 offen offset:3072 sc1 lds
    s_mul_i32 s77, s89, 131072
    v_mfma_f32_16x16x32_bf16 v[128:131], a[48:51], a[40:43], v[128:131]
    ds_read_b128 a[0:3], v14 offset:8192
    s_add_u32 s52, s76, s75
    v_mfma_f32_16x16x32_bf16 v[132:135], a[48:51], a[44:47], v[132:135]
    ds_read_b128 a[4:7], v14 offset:9216
    s_add_u32 m0, s55, 40960
    v_mfma_f32_16x16x32_bf16 v[136:139], a[52:55], a[32:35], v[136:139]
    ds_read_b128 a[8:11], v14 offset:10240
    buffer_load_dwordx4 v6, s[28:31], s53 offen offset:0 lds
    v_mfma_f32_16x16x32_bf16 v[140:143], a[52:55], a[36:39], v[140:143]
    ds_read_b128 a[12:15], v14 offset:11264
    v_mfma_f32_16x16x32_bf16 v[144:147], a[52:55], a[40:43], v[144:147]
    ds_read_b64_tr_b16 a[20:21], v23 offset:24576
    buffer_load_dwordx4 v7, s[28:31], s53 offen offset:1024 lds
    s_sub_u32 s53, s77, 2097152
    v_mfma_f32_16x16x32_bf16 v[148:151], a[52:55], a[44:47], v[148:151]
    ds_read_b64_tr_b16 a[22:23], v23 offset:25088
    s_waitcnt vmcnt(18) lgkmcnt(8)
    s_barrier
    v_mfma_f32_16x16x32_bf16 v[120:123], a[80:83], a[64:67], v[120:123]
    ds_read_b64_tr_b16 a[48:49], v20 offset:28672
    s_add_u32 m0, s54, 49152
    v_mfma_f32_16x16x32_bf16 v[124:127], a[80:83], a[68:71], v[124:127]
    ds_read_b64_tr_b16 a[50:51], v20 offset:29184
    buffer_load_dwordx4 v2, s[32:35], s52 offen offset:0 sc1 lds
    s_add_u32 s88, s88, 1
    v_mfma_f32_16x16x32_bf16 v[128:131], a[80:83], a[72:75], v[128:131]
    ds_read_b128 a[32:35], v14 offset:16384
    s_add_u32 s89, s88, s101
    v_mfma_f32_16x16x32_bf16 v[132:135], a[80:83], a[76:79], v[132:135]
    ds_read_b128 a[36:39], v14 offset:17408
    v_mfma_f32_16x16x32_bf16 v[136:139], a[84:87], a[64:67], v[136:139]
    ds_read_b128 a[40:43], v14 offset:18432
    buffer_load_dwordx4 v2, s[32:35], s52 offen offset:1024 sc1 lds
    s_and_b32 s89, s89, 3
    v_mfma_f32_16x16x32_bf16 v[140:143], a[84:87], a[68:71], v[140:143]
    ds_read_b128 a[44:47], v14 offset:19456
    s_andn2_b32 s90, s88, 3
    v_mfma_f32_16x16x32_bf16 v[144:147], a[84:87], a[72:75], v[144:147]
    ds_read_b64_tr_b16 a[52:53], v23 offset:28672
    buffer_load_dwordx4 v2, s[32:35], s52 offen offset:2048 sc1 lds
    s_or_b32 s89, s89, s90
    v_mfma_f32_16x16x32_bf16 v[148:151], a[84:87], a[76:79], v[148:151]
    ds_read_b64_tr_b16 a[54:55], v23 offset:29184
    s_lshl_b32 s76, s89, 14
    s_waitcnt lgkmcnt(8)
    v_mfma_f32_16x16x32_bf16 v[120:123], a[16:19], a[0:3], v[120:123]
    ds_read_b64_tr_b16 a[80:81], v20 offset:49152
    v_mfma_f32_16x16x32_bf16 v[124:127], a[16:19], a[4:7], v[124:127]
    ds_read_b64_tr_b16 a[82:83], v20 offset:49664
    buffer_load_dwordx4 v2, s[32:35], s52 offen offset:3072 sc1 lds
    s_mul_i32 s77, s89, 131072
    v_mfma_f32_16x16x32_bf16 v[128:131], a[16:19], a[8:11], v[128:131]
    ds_read_b128 a[64:67], v14 offset:32768
    s_add_u32 s52, s76, s75
    v_mfma_f32_16x16x32_bf16 v[132:135], a[16:19], a[12:15], v[132:135]
    ds_read_b128 a[68:71], v14 offset:33792
    s_add_u32 m0, s55, 65536
    v_mfma_f32_16x16x32_bf16 v[136:139], a[20:23], a[0:3], v[136:139]
    ds_read_b128 a[72:75], v14 offset:34816
    buffer_load_dwordx4 v6, s[28:31], s53 offen offset:0 lds
    v_mfma_f32_16x16x32_bf16 v[140:143], a[20:23], a[4:7], v[140:143]
    ds_read_b128 a[76:79], v14 offset:35840
    v_mfma_f32_16x16x32_bf16 v[144:147], a[20:23], a[8:11], v[144:147]
    ds_read_b64_tr_b16 a[84:85], v23 offset:49152
    buffer_load_dwordx4 v7, s[28:31], s53 offen offset:1024 lds
    s_sub_u32 s53, s77, 2097152
    v_mfma_f32_16x16x32_bf16 v[148:151], a[20:23], a[12:15], v[148:151]
    ds_read_b64_tr_b16 a[86:87], v23 offset:49664
    s_waitcnt vmcnt(18) lgkmcnt(8)
    s_barrier
    v_mfma_f32_16x16x32_bf16 v[120:123], a[48:51], a[32:35], v[120:123]
    ds_read_b64_tr_b16 a[16:17], v20 offset:53248
    s_add_u32 m0, s54, 73728
    v_mfma_f32_16x16x32_bf16 v[124:127], a[48:51], a[36:39], v[124:127]
    ds_read_b64_tr_b16 a[18:19], v20 offset:53760
    buffer_load_dwordx4 v2, s[32:35], s52 offen offset:0 sc1 lds
    s_add_u32 s88, s88, 1
    v_mfma_f32_16x16x32_bf16 v[128:131], a[48:51], a[40:43], v[128:131]
    ds_read_b128 a[0:3], v14 offset:40960
    s_add_u32 s89, s88, s101
    v_mfma_f32_16x16x32_bf16 v[132:135], a[48:51], a[44:47], v[132:135]
    ds_read_b128 a[4:7], v14 offset:41984
    v_mfma_f32_16x16x32_bf16 v[136:139], a[52:55], a[32:35], v[136:139]
    ds_read_b128 a[8:11], v14 offset:43008
    buffer_load_dwordx4 v2, s[32:35], s52 offen offset:1024 sc1 lds
    s_and_b32 s89, s89, 3
    v_mfma_f32_16x16x32_bf16 v[140:143], a[52:55], a[36:39], v[140:143]
    ds_read_b128 a[12:15], v14 offset:44032
    s_andn2_b32 s90, s88, 3
    v_mfma_f32_16x16x32_bf16 v[144:147], a[52:55], a[40:43], v[144:147]
    ds_read_b64_tr_b16 a[20:21], v23 offset:53248
    buffer_load_dwordx4 v2, s[32:35], s52 offen offset:2048 sc1 lds
    s_or_b32 s89, s89, s90
    v_mfma_f32_16x16x32_bf16 v[148:151], a[52:55], a[44:47], v[148:151]
    ds_read_b64_tr_b16 a[22:23], v23 offset:53760
    s_lshl_b32 s76, s89, 14
    s_waitcnt lgkmcnt(8)
    v_mfma_f32_16x16x32_bf16 v[120:123], a[80:83], a[64:67], v[120:123]
    ds_read_b64_tr_b16 a[48:49], v21 offset:8192
    v_mfma_f32_16x16x32_bf16 v[124:127], a[80:83], a[68:71], v[124:127]
    ds_read_b64_tr_b16 a[50:51], v21 offset:8704
    buffer_load_dwordx4 v2, s[32:35], s52 offen offset:3072 sc1 lds
    s_mul_i32 s77, s89, 131072
    v_mfma_f32_16x16x32_bf16 v[128:131], a[80:83], a[72:75], v[128:131]
    ds_read_b128 a[32:35], v14 offset:57344
    s_add_u32 s52, s76, s75
    v_mfma_f32_16x16x32_bf16 v[132:135], a[80:83], a[76:79], v[132:135]
    ds_read_b128 a[36:39], v14 offset:58368
    s_add_u32 m0, s55, 90112
    v_mfma_f32_16x16x32_bf16 v[136:139], a[84:87], a[64:67], v[136:139]
    ds_read_b128 a[40:43], v14 offset:59392
    buffer_load_dwordx4 v6, s[28:31], s53 offen offset:0 lds
    v_mfma_f32_16x16x32_bf16 v[140:143], a[84:87], a[68:71], v[140:143]
    ds_read_b128 a[44:47], v14 offset:60416
    v_mfma_f32_16x16x32_bf16 v[144:147], a[84:87], a[72:75], v[144:147]
    ds_read_b64_tr_b16 a[52:53], v24 offset:8192
    buffer_load_dwordx4 v7, s[28:31], s53 offen offset:1024 lds
    s_sub_u32 s53, s77, 2097152
    v_mfma_f32_16x16x32_bf16 v[148:151], a[84:87], a[76:79], v[148:151]
    ds_read_b64_tr_b16 a[54:55], v24 offset:8704
    s_waitcnt vmcnt(18) lgkmcnt(8)
    s_barrier
    v_mfma_f32_16x16x32_bf16 v[120:123], a[16:19], a[0:3], v[120:123]
    ds_read_b64_tr_b16 a[80:81], v21 offset:12288
    s_add_u32 m0, s54, 98304
    v_mfma_f32_16x16x32_bf16 v[124:127], a[16:19], a[4:7], v[124:127]
    ds_read_b64_tr_b16 a[82:83], v21 offset:12800
    buffer_load_dwordx4 v2, s[32:35], s52 offen offset:0 sc1 lds
    s_add_u32 s88, s88, 1
    v_mfma_f32_16x16x32_bf16 v[128:131], a[16:19], a[8:11], v[128:131]
    ds_read_b128 a[64:67], v15 offset:0
    s_add_u32 s89, s88, s101
    v_mfma_f32_16x16x32_bf16 v[132:135], a[16:19], a[12:15], v[132:135]
    ds_read_b128 a[68:71], v15 offset:1024
    v_mfma_f32_16x16x32_bf16 v[136:139], a[20:23], a[0:3], v[136:139]
    ds_read_b128 a[72:75], v15 offset:2048
    buffer_load_dwordx4 v2, s[32:35], s52 offen offset:1024 sc1 lds
    s_and_b32 s89, s89, 3
    v_mfma_f32_16x16x32_bf16 v[140:143], a[20:23], a[4:7], v[140:143]
    ds_read_b128 a[76:79], v15 offset:3072
    s_andn2_b32 s90, s88, 3
    v_mfma_f32_16x16x32_bf16 v[144:147], a[20:23], a[8:11], v[144:147]
    ds_read_b64_tr_b16 a[84:85], v24 offset:12288
    buffer_load_dwordx4 v2, s[32:35], s52 offen offset:2048 sc1 lds
    s_or_b32 s89, s89, s90
    v_mfma_f32_16x16x32_bf16 v[148:151], a[20:23], a[12:15], v[148:151]
    ds_read_b64_tr_b16 a[86:87], v24 offset:12800
    s_lshl_b32 s76, s89, 14
    s_waitcnt lgkmcnt(8)
    v_mfma_f32_16x16x32_bf16 v[120:123], a[48:51], a[32:35], v[120:123]
    ds_read_b64_tr_b16 a[16:17], v19 offset:16384
    v_mfma_f32_16x16x32_bf16 v[124:127], a[48:51], a[36:39], v[124:127]
    ds_read_b64_tr_b16 a[18:19], v19 offset:16896
    buffer_load_dwordx4 v2, s[32:35], s52 offen offset:3072 sc1 lds
    s_mul_i32 s77, s89, 131072
    v_mfma_f32_16x16x32_bf16 v[128:131], a[48:51], a[40:43], v[128:131]
    ds_read_b128 a[0:3], v13 offset:0
    s_add_u32 s52, s76, s75
    v_mfma_f32_16x16x32_bf16 v[132:135], a[48:51], a[44:47], v[132:135]
    ds_read_b128 a[4:7], v13 offset:1024
    s_add_u32 m0, s55, 114688
    v_mfma_f32_16x16x32_bf16 v[136:139], a[52:55], a[32:35], v[136:139]
    ds_read_b128 a[8:11], v13 offset:2048
    buffer_load_dwordx4 v6, s[28:31], s53 offen offset:0 lds
    v_mfma_f32_16x16x32_bf16 v[140:143], a[52:55], a[36:39], v[140:143]
    ds_read_b128 a[12:15], v13 offset:3072
    v_mfma_f32_16x16x32_bf16 v[144:147], a[52:55], a[40:43], v[144:147]
    ds_read_b64_tr_b16 a[20:21], v22 offset:16384
    buffer_load_dwordx4 v7, s[28:31], s53 offen offset:1024 lds
    s_sub_u32 s53, s77, 2097152
    v_mfma_f32_16x16x32_bf16 v[148:151], a[52:55], a[44:47], v[148:151]
    ds_read_b64_tr_b16 a[22:23], v22 offset:16896
    s_waitcnt vmcnt(18) lgkmcnt(8)
    s_barrier
    v_mfma_f32_16x16x32_bf16 v[120:123], a[80:83], a[64:67], v[120:123]
    ds_read_b64_tr_b16 a[48:49], v19 offset:20480
    s_add_u32 m0, s54, 122880
    v_mfma_f32_16x16x32_bf16 v[124:127], a[80:83], a[68:71], v[124:127]
    ds_read_b64_tr_b16 a[50:51], v19 offset:20992
    buffer_load_dwordx4 v2, s[32:35], s52 offen offset:0 sc1 lds
    s_add_u32 s88, s88, 1
    v_mfma_f32_16x16x32_bf16 v[128:131], a[80:83], a[72:75], v[128:131]
    ds_read_b128 a[32:35], v13 offset:8192
    s_add_u32 s89, s88, s101
    v_mfma_f32_16x16x32_bf16 v[132:135], a[80:83], a[76:79], v[132:135]
    ds_read_b128 a[36:39], v13 offset:9216
    v_mfma_f32_16x16x32_bf16 v[136:139], a[84:87], a[64:67], v[136:139]
    ds_read_b128 a[40:43], v13 offset:10240
    buffer_load_dwordx4 v2, s[32:35], s52 offen offset:1024 sc1 lds
    s_and_b32 s89, s89, 3
    v_mfma_f32_16x16x32_bf16 v[140:143], a[84:87], a[68:71], v[140:143]
    ds_read_b128 a[44:47], v13 offset:11264
    s_andn2_b32 s90, s88, 3
    v_mfma_f32_16x16x32_bf16 v[144:147], a[84:87], a[72:75], v[144:147]
    ds_read_b64_tr_b16 a[52:53], v22 offset:20480
    buffer_load_dwordx4 v2, s[32:35], s52 offen offset:2048 sc1 lds
    s_or_b32 s89, s89, s90
    v_mfma_f32_16x16x32_bf16 v[148:151], a[84:87], a[76:79], v[148:151]
    ds_read_b64_tr_b16 a[54:55], v22 offset:20992
    s_lshl_b32 s76, s89, 14
    s_waitcnt lgkmcnt(8)
    v_mfma_f32_16x16x32_bf16 v[120:123], a[16:19], a[0:3], v[120:123]
    ds_read_b64_tr_b16 a[80:81], v19 offset:40960
    v_mfma_f32_16x16x32_bf16 v[124:127], a[16:19], a[4:7], v[124:127]
    ds_read_b64_tr_b16 a[82:83], v19 offset:41472
    buffer_load_dwordx4 v2, s[32:35], s52 offen offset:3072 sc1 lds
    s_mul_i32 s77, s89, 131072
    v_mfma_f32_16x16x32_bf16 v[128:131], a[16:19], a[8:11], v[128:131]
    ds_read_b128 a[64:67], v13 offset:24576
    s_add_u32 s52, s76, s75
    v_mfma_f32_16x16x32_bf16 v[132:135], a[16:19], a[12:15], v[132:135]
    ds_read_b128 a[68:71], v13 offset:25600
    s_add_u32 m0, s55, 139264
    v_mfma_f32_16x16x32_bf16 v[136:139], a[20:23], a[0:3], v[136:139]
    ds_read_b128 a[72:75], v13 offset:26624
    buffer_load_dwordx4 v6, s[28:31], s53 offen offset:0 lds
    v_mfma_f32_16x16x32_bf16 v[140:143], a[20:23], a[4:7], v[140:143]
    ds_read_b128 a[76:79], v13 offset:27648
    v_mfma_f32_16x16x32_bf16 v[144:147], a[20:23], a[8:11], v[144:147]
    ds_read_b64_tr_b16 a[84:85], v22 offset:40960
    buffer_load_dwordx4 v7, s[28:31], s53 offen offset:1024 lds
    s_sub_u32 s53, s77, 2097152
    v_mfma_f32_16x16x32_bf16 v[148:151], a[20:23], a[12:15], v[148:151]
    ds_read_b64_tr_b16 a[86:87], v22 offset:41472
    s_waitcnt vmcnt(18) lgkmcnt(8)
    s_barrier
    v_mfma_f32_16x16x32_bf16 v[120:123], a[48:51], a[32:35], v[120:123]
    ds_read_b64_tr_b16 a[16:17], v19 offset:45056
    s_add_u32 m0, s54, 0
    v_mfma_f32_16x16x32_bf16 v[124:127], a[48:51], a[36:39], v[124:127]
    ds_read_b64_tr_b16 a[18:19], v19 offset:45568
    buffer_load_dwordx4 v2, s[32:35], s52 offen offset:0 sc1 lds
    s_add_u32 s88, s88, 1
    v_mfma_f32_16x16x32_bf16 v[128:131], a[48:51], a[40:43], v[128:131]
    ds_read_b128 a[0:3], v13 offset:32768
    s_add_u32 s89, s88, s101
    v_mfma_f32_16x16x32_bf16 v[132:135], a[48:51], a[44:47], v[132:135]
    ds_read_b128 a[4:7], v13 offset:33792
    v_mfma_f32_16x16x32_bf16 v[136:139], a[52:55], a[32:35], v[136:139]
    ds_read_b128 a[8:11], v13 offset:34816
    buffer_load_dwordx4 v2, s[32:35], s52 offen offset:1024 sc1 lds
    s_and_b32 s89, s89, 3
    v_mfma_f32_16x16x32_bf16 v[140:143], a[52:55], a[36:39], v[140:143]
    ds_read_b128 a[12:15], v13 offset:35840
    s_andn2_b32 s90, s88, 3
    v_mfma_f32_16x16x32_bf16 v[144:147], a[52:55], a[40:43], v[144:147]
    ds_read_b64_tr_b16 a[20:21], v22 offset:45056
    buffer_load_dwordx4 v2, s[32:35], s52 offen offset:2048 sc1 lds
    s_or_b32 s89, s89, s90
    v_mfma_f32_16x16x32_bf16 v[148:151], a[52:55], a[44:47], v[148:151]
    ds_read_b64_tr_b16 a[22:23], v22 offset:45568
    s_lshl_b32 s76, s89, 14
    s_waitcnt lgkmcnt(8)
    v_mfma_f32_16x16x32_bf16 v[120:123], a[80:83], a[64:67], v[120:123]
    ds_read_b64_tr_b16 a[48:49], v20 offset:0
    v_mfma_f32_16x16x32_bf16 v[124:127], a[80:83], a[68:71], v[124:127]
    ds_read_b64_tr_b16 a[50:51], v20 offset:512
    buffer_load_dwordx4 v2, s[32:35], s52 offen offset:3072 sc1 lds
    s_mul_i32 s77, s89, 131072
    v_mfma_f32_16x16x32_bf16 v[128:131], a[80:83], a[72:75], v[128:131]
    ds_read_b128 a[32:35], v13 offset:49152
    s_add_u32 s52, s76, s75
    v_mfma_f32_16x16x32_bf16 v[132:135], a[80:83], a[76:79], v[132:135]
    ds_read_b128 a[36:39], v13 offset:50176
    s_add_u32 m0, s55, 16384
    v_mfma_f32_16x16x32_bf16 v[136:139], a[84:87], a[64:67], v[136:139]
    ds_read_b128 a[40:43], v13 offset:51200
    buffer_load_dwordx4 v6, s[28:31], s53 offen offset:0 lds
    v_mfma_f32_16x16x32_bf16 v[140:143], a[84:87], a[68:71], v[140:143]
    ds_read_b128 a[44:47], v13 offset:52224
    v_mfma_f32_16x16x32_bf16 v[144:147], a[84:87], a[72:75], v[144:147]
    ds_read_b64_tr_b16 a[52:53], v23 offset:0
    buffer_load_dwordx4 v7, s[28:31], s53 offen offset:1024 lds
    s_sub_u32 s53, s77, 2097152
    v_mfma_f32_16x16x32_bf16 v[148:151], a[84:87], a[76:79], v[148:151]
    ds_read_b64_tr_b16 a[54:55], v23 offset:512
    s_waitcnt vmcnt(18) lgkmcnt(8)
    s_barrier
    v_mfma_f32_16x16x32_bf16 v[120:123], a[16:19], a[0:3], v[120:123]
    ds_read_b64_tr_b16 a[80:81], v20 offset:4096
    s_add_u32 m0, s54, 24576
    v_mfma_f32_16x16x32_bf16 v[124:127], a[16:19], a[4:7], v[124:127]
    ds_read_b64_tr_b16 a[82:83], v20 offset:4608
    buffer_load_dwordx4 v2, s[32:35], s52 offen offset:0 sc1 lds
    s_add_u32 s88, s88, 1
    v_mfma_f32_16x16x32_bf16 v[128:131], a[16:19], a[8:11], v[128:131]
    ds_read_b128 a[64:67], v13 offset:57344
    s_add_u32 s89, s88, s101
    v_mfma_f32_16x16x32_bf16 v[132:135], a[16:19], a[12:15], v[132:135]
    ds_read_b128 a[68:71], v13 offset:58368
    v_mfma_f32_16x16x32_bf16 v[136:139], a[20:23], a[0:3], v[136:139]
    ds_read_b128 a[72:75], v13 offset:59392
    buffer_load_dwordx4 v2, s[32:35], s52 offen offset:1024 sc1 lds
    s_and_b32 s89, s89, 3
    v_mfma_f32_16x16x32_bf16 v[140:143], a[20:23], a[4:7], v[140:143]
    ds_read_b128 a[76:79], v13 offset:60416
    s_andn2_b32 s90, s88, 3
    v_mfma_f32_16x16x32_bf16 v[144:147], a[20:23], a[8:11], v[144:147]
    ds_read_b64_tr_b16 a[84:85], v23 offset:4096
    buffer_load_dwordx4 v2, s[32:35], s52 offen offset:2048 sc1 lds
    s_or_b32 s89, s89, s90
    v_mfma_f32_16x16x32_bf16 v[148:151], a[20:23], a[12:15], v[148:151]
    ds_read_b64_tr_b16 a[86:87], v23 offset:4608
    s_lshl_b32 s76, s89, 14
    s_waitcnt lgkmcnt(8)
    s_sub_u32 s98, s98, 1
    s_cmp_lg_u32 s98, 0
    s_cbranch_scc1 LOOP_p4_1
    v_mfma_f32_16x16x32_bf16 v[120:123], a[48:51], a[32:35], v[120:123]
    ds_read_b64_tr_b16 a[16:17], v20 offset:24576
    v_mfma_f32_16x16x32_bf16 v[124:127], a[48:51], a[36:39], v[124:127]
    ds_read_b64_tr_b16 a[18:19], v20 offset:25088
    buffer_load_dwordx4 v2, s[32:35], s52 offen offset:3072 sc1 lds
    s_mul_i32 s77, s89, 131072
    v_mfma_f32_16x16x32_bf16 v[128:131], a[48:51], a[40:43], v[128:131]
    ds_read_b128 a[0:3], v14 offset:8192
    s_add_u32 s52, s76, s75
    v_mfma_f32_16x16x32_bf16 v[132:135], a[48:51], a[44:47], v[132:135]
    ds_read_b128 a[4:7], v14 offset:9216
    s_add_u32 m0, s55, 40960
    v_mfma_f32_16x16x32_bf16 v[136:139], a[52:55], a[32:35], v[136:139]
    ds_read_b128 a[8:11], v14 offset:10240
    buffer_load_dwordx4 v6, s[28:31], s53 offen offset:0 lds
    v_mfma_f32_16x16x32_bf16 v[140:143], a[52:55], a[36:39], v[140:143]
    ds_read_b128 a[12:15], v14 offset:11264
    v_mfma_f32_16x16x32_bf16 v[144:147], a[52:55], a[40:43], v[144:147]
    ds_read_b64_tr_b16 a[20:21], v23 offset:24576
    buffer_load_dwordx4 v7, s[28:31], s53 offen offset:1024 lds
    s_sub_u32 s53, s77, 2097152
    v_mfma_f32_16x16x32_bf16 v[148:151], a[52:55], a[44:47], v[148:151]
    ds_read_b64_tr_b16 a[22:23], v23 offset:25088
    s_waitcnt vmcnt(18) lgkmcnt(8)
    s_barrier
    v_mfma_f32_16x16x32_bf16 v[120:123], a[80:83], a[64:67], v[120:123]
    ds_read_b64_tr_b16 a[48:49], v20 offset:28672
    s_add_u32 m0, s54, 49152
    v_mfma_f32_16x16x32_bf16 v[124:127], a[80:83], a[68:71], v[124:127]
    ds_read_b64_tr_b16 a[50:51], v20 offset:29184
    buffer_load_dwordx4 v2, s[32:35], s52 offen offset:0 sc1 lds
    s_add_u32 s88, s88, 1
    v_mfma_f32_16x16x32_bf16 v[128:131], a[80:83], a[72:75], v[128:131]
    ds_read_b128 a[32:35], v14 offset:16384
    s_add_u32 s89, s88, s101
    v_mfma_f32_16x16x32_bf16 v[132:135], a[80:83], a[76:79], v[132:135]
    ds_read_b128 a[36:39], v14 offset:17408
    v_mfma_f32_16x16x32_bf16 v[136:139], a[84:87], a[64:67], v[136:139]
    ds_read_b128 a[40:43], v14 offset:18432
    buffer_load_dwordx4 v2, s[32:35], s52 offen offset:1024 sc1 lds
    s_and_b32 s89, s89, 3
    v_mfma_f32_16x16x32_bf16 v[140:143], a[84:87], a[68:71], v[140:143]
    ds_read_b128 a[44:47], v14 offset:19456
    s_andn2_b32 s90, s88, 3
    v_mfma_f32_16x16x32_bf16 v[144:147], a[84:87], a[72:75], v[144:147]
    ds_read_b64_tr_b16 a[52:53], v23 offset:28672
    buffer_load_dwordx4 v2, s[32:35], s52 offen offset:2048 sc1 lds
    s_or_b32 s89, s89, s90
    v_mfma_f32_16x16x32_bf16 v[148:151], a[84:87], a[76:79], v[148:151]
    ds_read_b64_tr_b16 a[54:55], v23 offset:29184
    s_lshl_b32 s76, s89, 14
    s_waitcnt lgkmcnt(8)
    s_lshl_b32 s56, s6, 9
    s_lshl_b32 s57, s4, 8
    s_add_u32 s56, s56, s57
    s_add_u32 s56, s56, 38797312
    v_and_b32 v31, 15, v1
    v_lshlrev_b32 v31, 2, v31
    buffer_load_dword v8, v31, s[32:35], s56 offen offset:0 sc1
    buffer_load_dword v9, v31, s[32:35], s56 offen offset:64 sc1
    buffer_load_dword v10, v31, s[32:35], s56 offen offset:128 sc1
    buffer_load_dword v11, v31, s[32:35], s56 offen offset:192 sc1
    v_and_b32 v25, 15, v1
    v_lshlrev_b32 v25, 11, v25
    v_bfe_u32 v26, v1, 4, 1
    v_lshl_or_b32 v25, v26, 5, v25
    v_lshrrev_b32 v26, 5, v1
    v_lshl_or_b32 v25, v26, 4, v25
    s_lshl_b32 s56, s6, 18
    s_lshl_b32 s57, s4, 17
    s_add_u32 s56, s56, s57
    s_lshl_b32 s57, s7, 7
    s_add_u32 s56, s56, s57
    s_lshl_b32 s57, s5, 6
    s_add_u32 s56, s56, s57
    v_mfma_f32_16x16x32_bf16 v[120:123], a[16:19], a[0:3], v[120:123]
    ds_read_b64_tr_b16 a[80:81], v20 offset:49152
    v_mfma_f32_16x16x32_bf16 v[124:127], a[16:19], a[4:7], v[124:127]
    ds_read_b64_tr_b16 a[82:83], v20 offset:49664
    buffer_load_dwordx4 v2, s[32:35], s52 offen offset:3072 sc1 lds
    s_mul_i32 s77, s89, 131072
    v_mfma_f32_16x16x32_bf16 v[128:131], a[16:19], a[8:11], v[128:131]
    ds_read_b128 a[64:67], v14 offset:32768
    s_add_u32 s52, s76, s75
    v_mfma_f32_16x16x32_bf16 v[132:135], a[16:19], a[12:15], v[132:135]
    ds_read_b128 a[68:71], v14 offset:33792
    s_add_u32 m0, s55, 65536
    v_mfma_f32_16x16x32_bf16 v[136:139], a[20:23], a[0:3], v[136:139]
    ds_read_b128 a[72:75], v14 offset:34816
    buffer_load_dwordx4 v6, s[28:31], s53 offen offset:0 lds
    v_mfma_f32_16x16x32_bf16 v[140:143], a[20:23], a[4:7], v[140:143]
    ds_read_b128 a[76:79], v14 offset:35840
    v_mfma_f32_16x16x32_bf16 v[144:147], a[20:23], a[8:11], v[144:147]
    ds_read_b64_tr_b16 a[84:85], v23 offset:49152
    buffer_load_dwordx4 v7, s[28:31], s53 offen offset:1024 lds
    s_sub_u32 s53, s77, 2097152
    v_mfma_f32_16x16x32_bf16 v[148:151], a[20:23], a[12:15], v[148:151]
    ds_read_b64_tr_b16 a[86:87], v23 offset:49664
    s_waitcnt vmcnt(22) lgkmcnt(8)
    s_barrier
    v_mfma_f32_16x16x32_bf16 v[120:123], a[48:51], a[32:35], v[120:123]
    ds_read_b64_tr_b16 a[16:17], v20 offset:53248
    s_add_u32 m0, s54, 73728
    v_mfma_f32_16x16x32_bf16 v[124:127], a[48:51], a[36:39], v[124:127]
    ds_read_b64_tr_b16 a[18:19], v20 offset:53760
    buffer_load_dwordx4 v2, s[32:35], s52 offen offset:0 sc1 lds
    s_add_u32 s88, s88, 1
    v_mfma_f32_16x16x32_bf16 v[128:131], a[48:51], a[40:43], v[128:131]
    ds_read_b128 a[0:3], v14 offset:40960
    s_add_u32 s89, s88, s101
    v_mfma_f32_16x16x32_bf16 v[132:135], a[48:51], a[44:47], v[132:135]
    ds_read_b128 a[4:7], v14 offset:41984
    v_mfma_f32_16x16x32_bf16 v[136:139], a[52:55], a[32:35], v[136:139]
    ds_read_b128 a[8:11], v14 offset:43008
    buffer_load_dwordx4 v2, s[32:35], s52 offen offset:1024 sc1 lds
    s_and_b32 s89, s89, 3
    v_mfma_f32_16x16x32_bf16 v[140:143], a[52:55], a[36:39], v[140:143]
    ds_read_b128 a[12:15], v14 offset:44032
    s_andn2_b32 s90, s88, 3
    v_mfma_f32_16x16x32_bf16 v[144:147], a[52:55], a[40:43], v[144:147]
    ds_read_b64_tr_b16 a[20:21], v23 offset:53248
    buffer_load_dwordx4 v2, s[32:35], s52 offen offset:2048 sc1 lds
    s_or_b32 s89, s89, s90
    v_mfma_f32_16x16x32_bf16 v[148:151], a[52:55], a[44:47], v[148:151]
    ds_read_b64_tr_b16 a[22:23], v23 offset:53760
    s_lshl_b32 s76, s89, 14
    s_waitcnt lgkmcnt(8)
    v_mfma_f32_16x16x32_bf16 v[120:123], a[80:83], a[64:67], v[120:123]
    ds_read_b64_tr_b16 a[48:49], v21 offset:8192
    v_mfma_f32_16x16x32_bf16 v[124:127], a[80:83], a[68:71], v[124:127]
    ds_read_b64_tr_b16 a[50:51], v21 offset:8704
    buffer_load_dwordx4 v2, s[32:35], s52 offen offset:3072 sc1 lds
    s_mul_i32 s77, s89, 131072
    v_mfma_f32_16x16x32_bf16 v[128:131], a[80:83], a[72:75], v[128:131]
    ds_read_b128 a[32:35], v14 offset:57344
    s_add_u32 s52, s76, s75
    v_mfma_f32_16x16x32_bf16 v[132:135], a[80:83], a[76:79], v[132:135]
    ds_read_b128 a[36:39], v14 offset:58368
    s_add_u32 m0, s55, 90112
    v_mfma_f32_16x16x32_bf16 v[136:139], a[84:87], a[64:67], v[136:139]
    ds_read_b128 a[40:43], v14 offset:59392
    buffer_load_dwordx4 v6, s[28:31], s53 offen offset:0 lds
    v_mfma_f32_16x16x32_bf16 v[140:143], a[84:87], a[68:71], v[140:143]
    ds_read_b128 a[44:47], v14 offset:60416
    v_mfma_f32_16x16x32_bf16 v[144:147], a[84:87], a[72:75], v[144:147]
    ds_read_b64_tr_b16 a[52:53], v24 offset:8192
    buffer_load_dwordx4 v7, s[28:31], s53 offen offset:1024 lds
    s_sub_u32 s53, s77, 2097152
    v_mfma_f32_16x16x32_bf16 v[148:151], a[84:87], a[76:79], v[148:151]
    ds_read_b64_tr_b16 a[54:55], v24 offset:8704
    s_waitcnt vmcnt(22) lgkmcnt(8)
    s_barrier
    v_mfma_f32_16x16x32_bf16 v[120:123], a[16:19], a[0:3], v[120:123]
    ds_read_b64_tr_b16 a[80:81], v21 offset:12288
    s_add_u32 m0, s54, 98304
    v_mfma_f32_16x16x32_bf16 v[124:127], a[16:19], a[4:7], v[124:127]
    ds_read_b64_tr_b16 a[82:83], v21 offset:12800
    buffer_load_dwordx4 v2, s[32:35], s52 offen offset:0 sc1 lds
    s_add_u32 s88, s88, 1
    v_mfma_f32_16x16x32_bf16 v[128:131], a[16:19], a[8:11], v[128:131]
    ds_read_b128 a[64:67], v15 offset:0
    s_add_u32 s89, s88, s101
    v_mfma_f32_16x16x32_bf16 v[132:135], a[16:19], a[12:15], v[132:135]
    ds_read_b128 a[68:71], v15 offset:1024
    v_mfma_f32_16x16x32_bf16 v[136:139], a[20:23], a[0:3], v[136:139]
    ds_read_b128 a[72:75], v15 offset:2048
    buffer_load_dwordx4 v2, s[32:35], s52 offen offset:1024 sc1 lds
    s_and_b32 s89, s89, 3
    v_mfma_f32_16x16x32_bf16 v[140:143], a[20:23], a[4:7], v[140:143]
    ds_read_b128 a[76:79], v15 offset:3072
    s_andn2_b32 s90, s88, 3
    v_mfma_f32_16x16x32_bf16 v[144:147], a[20:23], a[8:11], v[144:147]
    ds_read_b64_tr_b16 a[84:85], v24 offset:12288
    buffer_load_dwordx4 v2, s[32:35], s52 offen offset:2048 sc1 lds
    s_or_b32 s89, s89, s90
    v_mfma_f32_16x16x32_bf16 v[148:151], a[20:23], a[12:15], v[148:151]
    ds_read_b64_tr_b16 a[86:87], v24 offset:12800
    s_lshl_b32 s76, s89, 14
    s_waitcnt lgkmcnt(8)
    v_mfma_f32_16x16x32_bf16 v[120:123], a[48:51], a[32:35], v[120:123]
    ds_read_b64_tr_b16 a[16:17], v19 offset:16384
    v_mfma_f32_16x16x32_bf16 v[124:127], a[48:51], a[36:39], v[124:127]
    ds_read_b64_tr_b16 a[18:19], v19 offset:16896
    buffer_load_dwordx4 v2, s[32:35], s52 offen offset:3072 sc1 lds
    s_mul_i32 s77, s89, 131072
    v_mfma_f32_16x16x32_bf16 v[128:131], a[48:51], a[40:43], v[128:131]
    ds_read_b128 a[0:3], v13 offset:0
    s_add_u32 s52, s76, s75
    v_mfma_f32_16x16x32_bf16 v[132:135], a[48:51], a[44:47], v[132:135]
    ds_read_b128 a[4:7], v13 offset:1024
    s_add_u32 m0, s55, 114688
    v_mfma_f32_16x16x32_bf16 v[136:139], a[52:55], a[32:35], v[136:139]
    ds_read_b128 a[8:11], v13 offset:2048
    buffer_load_dwordx4 v6, s[28:31], s53 offen offset:0 lds
    v_mfma_f32_16x16x32_bf16 v[140:143], a[52:55], a[36:39], v[140:143]
    ds_read_b128 a[12:15], v13 offset:3072
    v_mfma_f32_16x16x32_bf16 v[144:147], a[52:55], a[40:43], v[144:147]
    ds_read_b64_tr_b16 a[20:21], v22 offset:16384
    buffer_load_dwordx4 v7, s[28:31], s53 offen offset:1024 lds
    s_sub_u32 s53, s77, 2097152
    v_mfma_f32_16x16x32_bf16 v[148:151], a[52:55], a[44:47], v[148:151]
    ds_read_b64_tr_b16 a[22:23], v22 offset:16896
    s_waitcnt vmcnt(22) lgkmcnt(8)
    s_barrier
    v_mfma_f32_16x16x32_bf16 v[120:123], a[80:83], a[64:67], v[120:123]
    ds_read_b64_tr_b16 a[48:49], v19 offset:20480
    v_mfma_f32_16x16x32_bf16 v[124:127], a[80:83], a[68:71], v[124:127]
    ds_read_b64_tr_b16 a[50:51], v19 offset:20992
    v_mfma_f32_16x16x32_bf16 v[128:131], a[80:83], a[72:75], v[128:131]
    ds_read_b128 a[32:35], v13 offset:8192
    v_mfma_f32_16x16x32_bf16 v[132:135], a[80:83], a[76:79], v[132:135]
    ds_read_b128 a[36:39], v13 offset:9216
    v_mfma_f32_16x16x32_bf16 v[136:139], a[84:87], a[64:67], v[136:139]
    ds_read_b128 a[40:43], v13 offset:10240
    v_mfma_f32_16x16x32_bf16 v[140:143], a[84:87], a[68:71], v[140:143]
    ds_read_b128 a[44:47], v13 offset:11264
    v_mfma_f32_16x16x32_bf16 v[144:147], a[84:87], a[72:75], v[144:147]
    ds_read_b64_tr_b16 a[52:53], v22 offset:20480
    v_mfma_f32_16x16x32_bf16 v[148:151], a[84:87], a[76:79], v[148:151]
    ds_read_b64_tr_b16 a[54:55], v22 offset:20992
    s_waitcnt lgkmcnt(8)
    v_mfma_f32_16x16x32_bf16 v[120:123], a[16:19], a[0:3], v[120:123]
    ds_read_b64_tr_b16 a[80:81], v19 offset:40960
    v_mfma_f32_16x16x32_bf16 v[124:127], a[16:19], a[4:7], v[124:127]
    ds_read_b64_tr_b16 a[82:83], v19 offset:41472
    v_mfma_f32_16x16x32_bf16 v[128:131], a[16:19], a[8:11], v[128:131]
    ds_read_b128 a[64:67], v13 offset:24576
    v_mfma_f32_16x16x32_bf16 v[132:135], a[16:19], a[12:15], v[132:135]
    ds_read_b128 a[68:71], v13 offset:25600
    v_mfma_f32_16x16x32_bf16 v[136:139], a[20:23], a[0:3], v[136:139]
    ds_read_b128 a[72:75], v13 offset:26624
    v_mfma_f32_16x16x32_bf16 v[140:143], a[20:23], a[4:7], v[140:143]
    ds_read_b128 a[76:79], v13 offset:27648
    v_mfma_f32_16x16x32_bf16 v[144:147], a[20:23], a[8:11], v[144:147]
    ds_read_b64_tr_b16 a[84:85], v22 offset:40960
    v_mfma_f32_16x16x32_bf16 v[148:151], a[20:23], a[12:15], v[148:151]
    ds_read_b64_tr_b16 a[86:87], v22 offset:41472
    s_waitcnt vmcnt(12) lgkmcnt(8)
    s_barrier
    v_mfma_f32_16x16x32_bf16 v[120:123], a[48:51], a[32:35], v[120:123]
    ds_read_b64_tr_b16 a[16:17], v19 offset:45056
    v_mfma_f32_16x16x32_bf16 v[124:127], a[48:51], a[36:39], v[124:127]
    ds_read_b64_tr_b16 a[18:19], v19 offset:45568
    v_mfma_f32_16x16x32_bf16 v[128:131], a[48:51], a[40:43], v[128:131]
    ds_read_b128 a[0:3], v13 offset:32768
    v_mfma_f32_16x16x32_bf16 v[132:135], a[48:51], a[44:47], v[132:135]
    ds_read_b128 a[4:7], v13 offset:33792
    v_mfma_f32_16x16x32_bf16 v[136:139], a[52:55], a[32:35], v[136:139]
    ds_read_b128 a[8:11], v13 offset:34816
    v_mfma_f32_16x16x32_bf16 v[140:143], a[52:55], a[36:39], v[140:143]
    ds_read_b128 a[12:15], v13 offset:35840
    v_mfma_f32_16x16x32_bf16 v[144:147], a[52:55], a[40:43], v[144:147]
    ds_read_b64_tr_b16 a[20:21], v22 offset:45056
    v_mfma_f32_16x16x32_bf16 v[148:151], a[52:55], a[44:47], v[148:151]
    ds_read_b64_tr_b16 a[22:23], v22 offset:45568
    s_waitcnt lgkmcnt(8)
    v_mfma_f32_16x16x32_bf16 v[120:123], a[80:83], a[64:67], v[120:123]
    ds_read_b64_tr_b16 a[48:49], v20 offset:0
    v_mfma_f32_16x16x32_bf16 v[124:127], a[80:83], a[68:71], v[124:127]
    ds_read_b64_tr_b16 a[50:51], v20 offset:512
    v_mfma_f32_16x16x32_bf16 v[128:131], a[80:83], a[72:75], v[128:131]
    ds_read_b128 a[32:35], v13 offset:49152
    v_mfma_f32_16x16x32_bf16 v[132:135], a[80:83], a[76:79], v[132:135]
    ds_read_b128 a[36:39], v13 offset:50176
    v_mfma_f32_16x16x32_bf16 v[136:139], a[84:87], a[64:67], v[136:139]
    ds_read_b128 a[40:43], v13 offset:51200
    v_mfma_f32_16x16x32_bf16 v[140:143], a[84:87], a[68:71], v[140:143]
    ds_read_b128 a[44:47], v13 offset:52224
    v_mfma_f32_16x16x32_bf16 v[144:147], a[84:87], a[72:75], v[144:147]
    ds_read_b64_tr_b16 a[52:53], v23 offset:0
    v_mfma_f32_16x16x32_bf16 v[148:151], a[84:87], a[76:79], v[148:151]
    ds_read_b64_tr_b16 a[54:55], v23 offset:512
    s_waitcnt vmcnt(6) lgkmcnt(8)
    s_barrier
    v_mfma_f32_16x16x32_bf16 v[120:123], a[16:19], a[0:3], v[120:123]
    ds_read_b64_tr_b16 a[80:81], v20 offset:4096
    v_mfma_f32_16x16x32_bf16 v[124:127], a[16:19], a[4:7], v[124:127]
    ds_read_b64_tr_b16 a[82:83], v20 offset:4608
    v_mfma_f32_16x16x32_bf16 v[128:131], a[16:19], a[8:11], v[128:131]
    ds_read_b128 a[64:67], v13 offset:57344
    v_mfma_f32_16x16x32_bf16 v[132:135], a[16:19], a[12:15], v[132:135]
    ds_read_b128 a[68:71], v13 offset:58368
    v_mfma_f32_16x16x32_bf16 v[136:139], a[20:23], a[0:3], v[136:139]
    ds_read_b128 a[72:75], v13 offset:59392
    v_mfma_f32_16x16x32_bf16 v[140:143], a[20:23], a[4:7], v[140:143]
    ds_read_b128 a[76:79], v13 offset:60416
    v_mfma_f32_16x16x32_bf16 v[144:147], a[20:23], a[8:11], v[144:147]
    ds_read_b64_tr_b16 a[84:85], v23 offset:4096
    v_mfma_f32_16x16x32_bf16 v[148:151], a[20:23], a[12:15], v[148:151]
    ds_read_b64_tr_b16 a[86:87], v23 offset:4608
    s_waitcnt lgkmcnt(8)
    v_mfma_f32_16x16x32_bf16 v[120:123], a[48:51], a[32:35], v[120:123]
    ds_read_b64_tr_b16 a[16:17], v20 offset:24576
    v_mfma_f32_16x16x32_bf16 v[124:127], a[48:51], a[36:39], v[124:127]
    ds_read_b64_tr_b16 a[18:19], v20 offset:25088
    v_mfma_f32_16x16x32_bf16 v[128:131], a[48:51], a[40:43], v[128:131]
    ds_read_b128 a[0:3], v14 offset:8192
    v_mfma_f32_16x16x32_bf16 v[132:135], a[48:51], a[44:47], v[132:135]
    ds_read_b128 a[4:7], v14 offset:9216
    v_mfma_f32_16x16x32_bf16 v[136:139], a[52:55], a[32:35], v[136:139]
    ds_read_b128 a[8:11], v14 offset:10240
    v_mfma_f32_16x16x32_bf16 v[140:143], a[52:55], a[36:39], v[140:143]
    ds_read_b128 a[12:15], v14 offset:11264
    v_mfma_f32_16x16x32_bf16 v[144:147], a[52:55], a[40:43], v[144:147]
    ds_read_b64_tr_b16 a[20:21], v23 offset:24576
    v_mfma_f32_16x16x32_bf16 v[148:151], a[52:55], a[44:47], v[148:151]
    ds_read_b64_tr_b16 a[22:23], v23 offset:25088
    s_waitcnt vmcnt(0) lgkmcnt(8)
    s_barrier
    v_mfma_f32_16x16x32_bf16 v[120:123], a[80:83], a[64:67], v[120:123]
    ds_read_b64_tr_b16 a[48:49], v20 offset:28672
    v_mfma_f32_16x16x32_bf16 v[124:127], a[80:83], a[68:71], v[124:127]
    ds_read_b64_tr_b16 a[50:51], v20 offset:29184
    v_mfma_f32_16x16x32_bf16 v[128:131], a[80:83], a[72:75], v[128:131]
    ds_read_b128 a[32:35], v14 offset:16384
    v_mfma_f32_16x16x32_bf16 v[132:135], a[80:83], a[76:79], v[132:135]
    ds_read_b128 a[36:39], v14 offset:17408
    v_mfma_f32_16x16x32_bf16 v[136:139], a[84:87], a[64:67], v[136:139]
    ds_read_b128 a[40:43], v14 offset:18432
    v_mfma_f32_16x16x32_bf16 v[140:143], a[84:87], a[68:71], v[140:143]
    ds_read_b128 a[44:47], v14 offset:19456
    v_mfma_f32_16x16x32_bf16 v[144:147], a[84:87], a[72:75], v[144:147]
    ds_read_b64_tr_b16 a[52:53], v23 offset:28672
    v_mfma_f32_16x16x32_bf16 v[148:151], a[84:87], a[76:79], v[148:151]
    ds_read_b64_tr_b16 a[54:55], v23 offset:29184
    s_waitcnt lgkmcnt(8)
    v_mfma_f32_16x16x32_bf16 v[120:123], a[16:19], a[0:3], v[120:123]
    ds_read_b64_tr_b16 a[80:81], v20 offset:49152
    v_mfma_f32_16x16x32_bf16 v[124:127], a[16:19], a[4:7], v[124:127]
    ds_read_b64_tr_b16 a[82:83], v20 offset:49664
    v_mfma_f32_16x16x32_bf16 v[128:131], a[16:19], a[8:11], v[128:131]
    ds_read_b128 a[64:67], v14 offset:32768
    v_mfma_f32_16x16x32_bf16 v[132:135], a[16:19], a[12:15], v[132:135]
    ds_read_b128 a[68:71], v14 offset:33792
    v_mfma_f32_16x16x32_bf16 v[136:139], a[20:23], a[0:3], v[136:139]
    ds_read_b128 a[72:75], v14 offset:34816
    v_mfma_f32_16x16x32_bf16 v[140:143], a[20:23], a[4:7], v[140:143]
    ds_read_b128 a[76:79], v14 offset:35840
    v_mfma_f32_16x16x32_bf16 v[144:147], a[20:23], a[8:11], v[144:147]
    ds_read_b64_tr_b16 a[84:85], v23 offset:49152
    v_mfma_f32_16x16x32_bf16 v[148:151], a[20:23], a[12:15], v[148:151]
    ds_read_b64_tr_b16 a[86:87], v23 offset:49664
    s_waitcnt lgkmcnt(8)
    s_barrier
    v_mfma_f32_16x16x32_bf16 v[120:123], a[48:51], a[32:35], v[120:123]
    ds_read_b64_tr_b16 a[16:17], v20 offset:53248
    v_mfma_f32_16x16x32_bf16 v[124:127], a[48:51], a[36:39], v[124:127]
    ds_read_b64_tr_b16 a[18:19], v20 offset:53760
    v_mfma_f32_16x16x32_bf16 v[128:131], a[48:51], a[40:43], v[128:131]
    ds_read_b128 a[0:3], v14 offset:40960
    v_mfma_f32_16x16x32_bf16 v[132:135], a[48:51], a[44:47], v[132:135]
    ds_read_b128 a[4:7], v14 offset:41984
    v_mfma_f32_16x16x32_bf16 v[136:139], a[52:55], a[32:35], v[136:139]
    ds_read_b128 a[8:11], v14 offset:43008
    v_mfma_f32_16x16x32_bf16 v[140:143], a[52:55], a[36:39], v[140:143]
    ds_read_b128 a[12:15], v14 offset:44032
    v_mfma_f32_16x16x32_bf16 v[144:147], a[52:55], a[40:43], v[144:147]
    ds_read_b64_tr_b16 a[20:21], v23 offset:53248
    v_mfma_f32_16x16x32_bf16 v[148:151], a[52:55], a[44:47], v[148:151]
    ds_read_b64_tr_b16 a[22:23], v23 offset:53760
    s_waitcnt lgkmcnt(8)
    v_mfma_f32_16x16x32_bf16 v[120:123], a[80:83], a[64:67], v[120:123]
    v_mfma_f32_16x16x32_bf16 v[124:127], a[80:83], a[68:71], v[124:127]
    v_mfma_f32_16x16x32_bf16 v[128:131], a[80:83], a[72:75], v[128:131]
    v_mfma_f32_16x16x32_bf16 v[132:135], a[80:83], a[76:79], v[132:135]
    v_mfma_f32_16x16x32_bf16 v[136:139], a[84:87], a[64:67], v[136:139]
    v_mfma_f32_16x16x32_bf16 v[140:143], a[84:87], a[68:71], v[140:143]
    v_mfma_f32_16x16x32_bf16 v[144:147], a[84:87], a[72:75], v[144:147]
    v_mfma_f32_16x16x32_bf16 v[148:151], a[84:87], a[76:79], v[148:151]
    s_waitcnt lgkmcnt(0)
    s_barrier
    v_mfma_f32_16x16x32_bf16 v[120:123], a[16:19], a[0:3], v[120:123]
    v_mfma_f32_16x16x32_bf16 v[124:127], a[16:19], a[4:7], v[124:127]
    v_mfma_f32_16x16x32_bf16 v[128:131], a[16:19], a[8:11], v[128:131]
    v_mfma_f32_16x16x32_bf16 v[132:135], a[16:19], a[12:15], v[132:135]
    v_mfma_f32_16x16x32_bf16 v[136:139], a[20:23], a[0:3], v[136:139]
    v_mfma_f32_16x16x32_bf16 v[140:143], a[20:23], a[4:7], v[140:143]
    v_mfma_f32_16x16x32_bf16 v[144:147], a[20:23], a[8:11], v[144:147]
    v_mfma_f32_16x16x32_bf16 v[148:151], a[20:23], a[12:15], v[148:151]
    s_nop 0
    v_pk_add_f32 v[88:89], v[88:89], v[120:121] neg_lo:[0,1] neg_hi:[0,1]
    v_pk_add_f32 v[90:91], v[90:91], v[122:123] neg_lo:[0,1] neg_hi:[0,1]
    v_pk_fma_f32 v[88:89], v[88:89], v[8:9], v[120:121] op_sel_hi:[1,0,1]
    v_pk_fma_f32 v[90:91], v[90:91], v[8:9], v[122:123] op_sel_hi:[1,0,1]
    v_cvt_pk_bf16_f32 v184, v88, v89
    v_cvt_pk_bf16_f32 v185, v90, v91
    v_pk_add_f32 v[104:105], v[104:105], v[136:137] neg_lo:[0,1] neg_hi:[0,1]
    v_pk_add_f32 v[106:107], v[106:107], v[138:139] neg_lo:[0,1] neg_hi:[0,1]
    v_pk_fma_f32 v[104:105], v[104:105], v[8:9], v[136:137] op_sel_hi:[1,0,1]
    v_pk_fma_f32 v[106:107], v[106:107], v[8:9], v[138:139] op_sel_hi:[1,0,1]
    v_cvt_pk_bf16_f32 v186, v104, v105
    v_cvt_pk_bf16_f32 v187, v106, v107
    s_nop 0
    v_permlane16_swap_b32 v184, v186
    v_permlane16_swap_b32 v185, v187
    buffer_store_dwordx4 v[184:187], v25, s[36:39], s56 offen sc1
    s_add_u32 s56, s56, 32768
    v_pk_add_f32 v[92:93], v[92:93], v[124:125] neg_lo:[0,1] neg_hi:[0,1]
    v_pk_add_f32 v[94:95], v[94:95], v[126:127] neg_lo:[0,1] neg_hi:[0,1]
    v_pk_fma_f32 v[92:93], v[92:93], v[8:9], v[124:125] op_sel:[0,1,0] op_sel_hi:[1,1,1]
    v_pk_fma_f32 v[94:95], v[94:95], v[8:9], v[126:127] op_sel:[0,1,0] op_sel_hi:[1,1,1]
    v_cvt_pk_bf16_f32 v188, v92, v93
    v_cvt_pk_bf16_f32 v189, v94, v95
    v_pk_add_f32 v[108:109], v[108:109], v[140:141] neg_lo:[0,1] neg_hi:[0,1]
    v_pk_add_f32 v[110:111], v[110:111], v[142:143] neg_lo:[0,1] neg_hi:[0,1]
    v_pk_fma_f32 v[108:109], v[108:109], v[8:9], v[140:141] op_sel:[0,1,0] op_sel_hi:[1,1,1]
    v_pk_fma_f32 v[110:111], v[110:111], v[8:9], v[142:143] op_sel:[0,1,0] op_sel_hi:[1,1,1]
    v_cvt_pk_bf16_f32 v190, v108, v109
    v_cvt_pk_bf16_f32 v191, v110, v111
    s_nop 0
    v_permlane16_swap_b32 v188, v190
    v_permlane16_swap_b32 v189, v191
    buffer_store_dwordx4 v[188:191], v25, s[36:39], s56 offen sc1
    s_add_u32 s56, s56, 32768
    v_pk_add_f32 v[96:97], v[96:97], v[128:129] neg_lo:[0,1] neg_hi:[0,1]
    v_pk_add_f32 v[98:99], v[98:99], v[130:131] neg_lo:[0,1] neg_hi:[0,1]
    v_pk_fma_f32 v[96:97], v[96:97], v[10:11], v[128:129] op_sel_hi:[1,0,1]
    v_pk_fma_f32 v[98:99], v[98:99], v[10:11], v[130:131] op_sel_hi:[1,0,1]
    v_cvt_pk_bf16_f32 v192, v96, v97
    v_cvt_pk_bf16_f32 v193, v98, v99
    v_pk_add_f32 v[112:113], v[112:113], v[144:145] neg_lo:[0,1] neg_hi:[0,1]
    v_pk_add_f32 v[114:115], v[114:115], v[146:147] neg_lo:[0,1] neg_hi:[0,1]
    v_pk_fma_f32 v[112:113], v[112:113], v[10:11], v[144:145] op_sel_hi:[1,0,1]
    v_pk_fma_f32 v[114:115], v[114:115], v[10:11], v[146:147] op_sel_hi:[1,0,1]
    v_cvt_pk_bf16_f32 v194, v112, v113
    v_cvt_pk_bf16_f32 v195, v114, v115
    s_nop 0
    v_permlane16_swap_b32 v192, v194
    v_permlane16_swap_b32 v193, v195
    buffer_store_dwordx4 v[192:195], v25, s[36:39], s56 offen sc1
    s_add_u32 s56, s56, 32768
    v_pk_add_f32 v[100:101], v[100:101], v[132:133] neg_lo:[0,1] neg_hi:[0,1]
    v_pk_add_f32 v[102:103], v[102:103], v[134:135] neg_lo:[0,1] neg_hi:[0,1]
    v_pk_fma_f32 v[100:101], v[100:101], v[10:11], v[132:133] op_sel:[0,1,0] op_sel_hi:[1,1,1]
    v_pk_fma_f32 v[102:103], v[102:103], v[10:11], v[134:135] op_sel:[0,1,0] op_sel_hi:[1,1,1]
    v_cvt_pk_bf16_f32 v196, v100, v101
    v_cvt_pk_bf16_f32 v197, v102, v103
    v_pk_add_f32 v[116:117], v[116:117], v[148:149] neg_lo:[0,1] neg_hi:[0,1]
    v_pk_add_f32 v[118:119], v[118:119], v[150:151] neg_lo:[0,1] neg_hi:[0,1]
    v_pk_fma_f32 v[116:117], v[116:117], v[10:11], v[148:149] op_sel:[0,1,0] op_sel_hi:[1,1,1]
    v_pk_fma_f32 v[118:119], v[118:119], v[10:11], v[150:151] op_sel:[0,1,0] op_sel_hi:[1,1,1]
    v_cvt_pk_bf16_f32 v198, v116, v117
    v_cvt_pk_bf16_f32 v199, v118, v119
    s_nop 0
    v_permlane16_swap_b32 v196, v198
    v_permlane16_swap_b32 v197, v199
    buffer_store_dwordx4 v[196:199], v25, s[36:39], s56 offen sc1
    s_cmp_lg_u32 s100, 0
    s_cbranch_scc1 GEN_18
    s_add_u32 s99, s95, 1
    v_mov_b32 v0, s99
    s_mov_b32 s99, 38871040
    s_mov_b64 exec, 1
    buffer_store_dword v0, v255, s[32:35], s99 offen sc1
    s_mov_b64 exec, -1
GEN_18:
KERNEL_END:
    s_endpgm
.set CODE_BYTES, (KERNEL_END - gated_mix__mha_block__mixer_gmlp__prompt_kernel - 512) & 0xffffff00
.section .rodata,"a"
.p2align 6
.amdhsa_kernel gated_mix__mha_block__mixer_gmlp__prompt_kernel
  .amdhsa_next_free_vgpr 512
  .amdhsa_next_free_sgpr 102
  .amdhsa_accum_offset 256
  .amdhsa_group_segment_fixed_size 0
  .amdhsa_kernarg_size 96
  .amdhsa_user_sgpr_count 2
  .amdhsa_user_sgpr_kernarg_segment_ptr 1
  .amdhsa_system_sgpr_workgroup_id_x 1
  .amdhsa_float_denorm_mode_32 3
.end_amdhsa_kernel
```
